```python
import torch

def _softmax(x, axis=-1):
    return torch.softmax(x, dim=axis)

def _gelu(x):
    return torch.nn.functional.gelu(x, approximate='tanh')

def _silu(x):
    return torch.nn.functional.silu(x)

def _sigmoid(x):
    return torch.sigmoid(x)

def _layernorm(x, axis=-1, eps=1e-05):
    m = x.mean(dim=axis, keepdim=True)
    v = x.var(dim=axis, keepdim=True, unbiased=False)
    return (x - m) / torch.sqrt(v + eps)

def _scatter_add(tgt, idx, src, axis=0):
    return tgt.clone().index_add_(axis, idx, src)

def _segment_sum(src, seg, n):
    out = torch.zeros((n,) + src.shape[1:], dtype=src.dtype)
    return out.index_add_(0, seg, src)

def _pad(x, pw):
    flat = tuple((v for pair in reversed(pw) for v in pair))
    return torch.nn.functional.pad(x, flat)
kernel_name = 'adaLN_cond__gqa_block_cached__mixer_gmlp__prompt'

def setup_inputs():

    _w = lambda a: (lambda t: t.to(torch.bfloat16) if t.is_floating_point() else t)(torch.as_tensor(a))

    def _A_setup():
        B, Sq, D = (1, 2048, 448)
        Hq, Hkv, Sk, Dh = (16, 8, 2048, 256)
        assert Hq % Hkv == 0, (Hq, Hkv)
        return {'x': _w((lambda *s: torch.randn(*s, dtype=torch.bfloat16) * 0.05)(B, Sq, D)), 'k_cache': _w((lambda *s: torch.randn(*s, dtype=torch.bfloat16) * 3.2)(B, Hkv, Sk, Dh)), 'v_cache': _w((lambda *s: torch.randn(*s, dtype=torch.bfloat16) * 0.4)(B, Hkv, Sk, Dh)), 'wq': _w((lambda *s: torch.randn(*s, dtype=torch.bfloat16) * 3.2)(D, Hq * Dh) * D ** (-0.5)), 'wo': _w((lambda *s: torch.randn(*s, dtype=torch.bfloat16) * 0.4)(Hq * Dh, D) * (Hq * Dh) ** (-0.5))}
    _A_in = _A_setup()

    def _B_setup():
        B, S, D, F = (1, 2048, 448, 1792)
        Fh = F // 2
        return {'x': _w((lambda *s: torch.randn(*s, dtype=torch.bfloat16) * 0.05)(B, S, D)), 'w_in': _w((lambda *s: torch.randn(*s, dtype=torch.bfloat16) * 0.8)(D, 2 * Fh)), 'w_sp': _w(0.01 * (lambda *s: torch.randn(*s, dtype=torch.bfloat16) * 0.8)(S, S)), 'b_sp': _w(1.0 + 0.01 * (lambda *s: torch.randn(*s, dtype=torch.bfloat16) * 0.05)(S)), 'w_out': _w((lambda *s: torch.randn(*s, dtype=torch.bfloat16) * 0.05)(Fh, D))}
    _B_in = _B_setup()
    return {'A_x': _A_in['x'], 'A_k_cache': _A_in['k_cache'], 'A_v_cache': _A_in['v_cache'], 'A_wq': _A_in['wq'], 'A_wo': _A_in['wo'], 'B_x': _B_in['x'], 'B_w_in': _B_in['w_in'], 'B_w_sp': _B_in['w_sp'], 'B_b_sp': _B_in['b_sp'], 'B_w_out': _B_in['w_out'], 'c': _w((lambda *s: torch.randn(*s, dtype=torch.bfloat16) * 0.1)(1, 448) * 8.0), 'w_mod': _w((lambda *s: torch.randn(*s, dtype=torch.bfloat16) * 0.1)(448, 6 * 448) * 448 ** (-0.5) * 8.0)}

def reference(A_x, A_k_cache, A_v_cache, A_wq, A_wo, B_x, B_w_in, B_w_sp, B_b_sp, B_w_out, c, w_mod):

    def _A_ref(x, k_cache, v_cache, wq, wo):
        B, Sq, D = x.shape
        Hq, Dh = (16, 256)
        Hkv = k_cache.shape[1]
        rep = Hq // Hkv
        q = (lambda x, *d: x.permute(*d))((x @ wq).reshape(B, Sq, Hq, Dh), 0, 2, 1, 3)
        k = (lambda x, n, axis: torch.repeat_interleave(x, n, dim=axis))(k_cache, rep, axis=1)
        v = (lambda x, n, axis: torch.repeat_interleave(x, n, dim=axis))(v_cache, rep, axis=1)
        scores = torch.einsum('bhqd,bhkd->bhqk', q, k) * Dh ** (-0.5)
        p = _softmax(scores, axis=-1)
        o = torch.einsum('bhqk,bhkd->bhqd', p, v)
        return (lambda x, *d: x.permute(*d))(o, 0, 2, 1, 3).reshape(B, Sq, Hq * Dh) @ wo

    def _B_ref(x, w_in, w_sp, b_sp, w_out):
        B, S, D = x.shape
        F = w_in.shape[-1]
        Fh = F // 2
        z = _gelu(torch.einsum('bsd,df->bsf', x, w_in))
        z1 = z[..., :Fh].clone()
        z2 = _layernorm(z[..., Fh:], axis=-1)
        g = torch.einsum('ts,bsf->btf', w_sp, z2) + b_sp[None, :, None]
        return torch.einsum('bsf,fd->bsd', z1 * g, w_out)
    x = A_x
    mod = (_silu(c) @ w_mod).reshape(c.shape[0], 6, 1, -1)
    sa, ca, ga, sb, cb, gb = (mod[:, 0].clone(), mod[:, 1].clone(), mod[:, 2].clone(), mod[:, 3].clone(), mod[:, 4].clone(), mod[:, 5].clone())
    h = _layernorm(x, axis=-1) * (1 + ca) + sa
    x = x + ga * _A_ref(h, A_k_cache, A_v_cache, A_wq, A_wo)
    h = _layernorm(x, axis=-1) * (1 + cb) + sb
    x = x + gb * _B_ref(h, B_w_in, B_w_sp, B_b_sp, B_w_out)
    return x
```

```asm
; @launch kernel=att_kernel grid=(256,1,1) block=(256,1,1) lds=163840
; @launch kernel=cd_kernel grid=(256,1,1) block=(448,1,1) lds=32768
; @launch kernel=ef_kernel grid=(224,1,1) block=(256,1,1) lds=163840
.amdgcn_target "amdgcn-amd-amdhsa--gfx950"
.text
.globl att_kernel
.p2align 8
.type att_kernel,@function
att_kernel:
    s_cmp_ge_u32 s2, 256
    s_cbranch_scc1 Latt_done
    s_mov_b32 s100, 0
Latt_top:
    s_load_dwordx4 s[4:7], s[0:1], 8
    s_load_dwordx4 s[32:35], s[0:1], 24
    s_load_dwordx4 s[56:59], s[0:1], 104
    s_load_dwordx2 s[46:47], s[0:1], 0
    s_load_dwordx4 s[40:43], s[0:1], 80
    s_load_dwordx4 s[60:63], s[0:1], 48
    v_lshrrev_b32 v1, 6, v0
    v_and_b32 v2, 63, v0
    v_readfirstlane_b32 s3, v1
    v_lshlrev_b32 v247, 4, v2
    v_and_b32 v4, 15, v2
    v_lshrrev_b32 v3, 4, v2
    v_bfe_u32 v5, v2, 2, 2
    v_and_b32 v6, 3, v2
    s_and_b32 s52, s2, 7
    s_lshr_b32 s51, s2, 3
    s_add_u32 s50, s51, s52
    s_and_b32 s50, s50, 7
    s_mul_i32 s101, s51, 7
    s_add_u32 s101, s101, s50
    s_cmp_eq_u32 s50, 7
    s_cselect_b32 s101, 255, s101
    s_lshl_b32 s50, s52, 20
    s_movk_i32 s53, 896
    v_mul_lo_u32 v7, v4, s53
    v_lshl_add_u32 v7, v3, 4, v7
    s_lshl_b32 s48, s51, 2
    s_add_u32 s48, s48, s3
    s_getpc_b64 s[28:29]
Latt_pc:
    s_sub_u32 s28, s28, Latt_pc - att_kernel
    s_subb_u32 s29, s29, 0
    s_lshl_b32 s53, s48, 10
    v_add_u32 v8, s53, v247
    v_min_u32 v8, Ltext_end - att_kernel - 16, v8
    v_and_b32 v8, -16, v8
    v_mov_b32 v9, s29
    v_add_co_u32 v254, vcc, s28, v8
    s_mov_b32 m0, 162816
    s_nop 0
    v_addc_co_u32 v255, vcc, 0, v9, vcc
    global_load_lds_dwordx4 v[254:255], off
    s_mul_i32 s48, s48, 14336
    s_waitcnt lgkmcnt(0)
    s_mov_b32 s36, s58
    s_mov_b32 s37, s59
    s_cmp_ge_u32 s101, 84
    s_cbranch_scc1 Latt_wload
    s_mov_b32 s8, s40
    s_mov_b32 s9, s41
    s_mov_b32 s10, 896
    s_mov_b32 s11, 0x20000
    s_mov_b32 s12, s42
    s_mov_b32 s13, s43
    s_mov_b32 s14, 2408448
    s_mov_b32 s15, 0x20000
    v_lshrrev_b32 v8, 2, v0
    s_movk_i32 s53, 5376
    v_mul_lo_u32 v9, v8, s53
    v_lshl_add_u32 v9, v6, 4, v9
    v_lshlrev_b32 v8, 1, v8
    buffer_load_ushort v64, v8, s[8:11], 0 offen offset:0
    buffer_load_ushort v65, v8, s[8:11], 0 offen offset:128
    buffer_load_ushort v66, v8, s[8:11], 0 offen offset:256
    buffer_load_ushort v67, v8, s[8:11], 0 offen offset:384
    buffer_load_ushort v68, v8, s[8:11], 0 offen offset:512
    buffer_load_ushort v69, v8, s[8:11], 0 offen offset:640
    buffer_load_ushort v70, v8, s[8:11], 0 offen offset:768
    s_lshl_b32 s53, s101, 6
    s_add_u32 s53, s53, 0
    buffer_load_dwordx4 v[72:75], v9, s[12:15], s53 offen
    s_lshl_b32 s53, s101, 6
    s_add_u32 s53, s53, 344064
    buffer_load_dwordx4 v[76:79], v9, s[12:15], s53 offen
    s_lshl_b32 s53, s101, 6
    s_add_u32 s53, s53, 688128
    buffer_load_dwordx4 v[80:83], v9, s[12:15], s53 offen
    s_lshl_b32 s53, s101, 6
    s_add_u32 s53, s53, 1032192
    buffer_load_dwordx4 v[84:87], v9, s[12:15], s53 offen
    s_lshl_b32 s53, s101, 6
    s_add_u32 s53, s53, 1376256
    buffer_load_dwordx4 v[88:91], v9, s[12:15], s53 offen
    s_lshl_b32 s53, s101, 6
    s_add_u32 s53, s53, 1720320
    buffer_load_dwordx4 v[92:95], v9, s[12:15], s53 offen
    s_lshl_b32 s53, s101, 6
    s_add_u32 s53, s53, 2064384
    buffer_load_dwordx4 v[96:99], v9, s[12:15], s53 offen
Latt_modload_ret:
    s_add_u32 s24, s46, s48
    s_addc_u32 s25, s47, 0
    s_mov_b32 s26, 14336
    s_mov_b32 s27, 0x20000
    buffer_load_dwordx4 v[128:131], v7, s[24:27], 0 offen offset:0
    buffer_load_dwordx4 v[132:135], v7, s[24:27], 0 offen offset:64
    buffer_load_dwordx4 v[136:139], v7, s[24:27], 0 offen offset:128
    buffer_load_dwordx4 v[140:143], v7, s[24:27], 0 offen offset:192
    buffer_load_dwordx4 v[144:147], v7, s[24:27], 0 offen offset:256
    buffer_load_dwordx4 v[148:151], v7, s[24:27], 0 offen offset:320
    buffer_load_dwordx4 v[152:155], v7, s[24:27], 0 offen offset:384
    buffer_load_dwordx4 v[156:159], v7, s[24:27], 0 offen offset:448
    buffer_load_dwordx4 v[160:163], v7, s[24:27], 0 offen offset:512
    buffer_load_dwordx4 v[164:167], v7, s[24:27], 0 offen offset:576
    buffer_load_dwordx4 v[168:171], v7, s[24:27], 0 offen offset:640
    buffer_load_dwordx4 v[172:175], v7, s[24:27], 0 offen offset:704
    buffer_load_dwordx4 v[176:179], v7, s[24:27], 0 offen offset:768
    buffer_load_dwordx4 v[180:183], v7, s[24:27], 0 offen offset:832
    s_add_u32 s8, s4, s50
    s_addc_u32 s9, s5, 0
    s_mov_b32 s10, 1048576
    s_mov_b32 s11, 0x20000
    s_add_u32 s12, s6, s50
    s_addc_u32 s13, s7, 0
    s_mov_b32 s14, 1048576
    s_mov_b32 s15, 0x20000
    s_lshl_b32 s50, s52, 10
    s_add_u32 s16, s32, s50
    s_addc_u32 s17, s33, 0
    s_sub_u32 s18, 3670016, s50
    s_mov_b32 s19, 0x20000
    s_mul_i32 s50, s52, 458752
    s_add_u32 s20, s34, s50
    s_addc_u32 s21, s35, 0
    s_mov_b32 s22, 458752
    s_mov_b32 s23, 0x20000
    s_lshl_b32 s50, s52, 5
    s_add_u32 s50, s50, s51
    s_mul_i32 s50, s50, 57344
    s_add_u32 s50, s50, 33554432
    s_add_u32 s28, s36, s50
    s_addc_u32 s29, s37, 0
    s_mov_b32 s30, 57344
    s_mov_b32 s31, 0x20000
    s_cmp_ge_u32 s101, 28
    s_cbranch_scc1 Latt_modcalc_ret
    s_waitcnt vmcnt(14)
    s_mov_b32 s53, 3216550459
    v_lshlrev_b32 v64, 16, v64
    v_lshlrev_b32 v65, 16, v65
    v_lshlrev_b32 v66, 16, v66
    v_lshlrev_b32 v67, 16, v67
    v_lshlrev_b32 v68, 16, v68
    v_lshlrev_b32 v69, 16, v69
    v_lshlrev_b32 v70, 16, v70
    v_mul_f32 v112, s53, v64
    v_mul_f32 v113, s53, v65
    v_mul_f32 v114, s53, v66
    v_mul_f32 v115, s53, v67
    v_mul_f32 v116, s53, v68
    v_mul_f32 v117, s53, v69
    v_mul_f32 v118, s53, v70
    v_exp_f32 v112, v112
    v_exp_f32 v113, v113
    v_exp_f32 v114, v114
    v_exp_f32 v115, v115
    v_exp_f32 v116, v116
    v_exp_f32 v117, v117
    v_exp_f32 v118, v118
    v_add_f32 v112, 1.0, v112
    v_add_f32 v113, 1.0, v113
    v_add_f32 v114, 1.0, v114
    v_add_f32 v115, 1.0, v115
    v_add_f32 v116, 1.0, v116
    v_add_f32 v117, 1.0, v117
    v_add_f32 v118, 1.0, v118
    v_rcp_f32 v112, v112
    v_rcp_f32 v113, v113
    v_rcp_f32 v114, v114
    v_rcp_f32 v115, v115
    v_rcp_f32 v116, v116
    v_rcp_f32 v117, v117
    v_rcp_f32 v118, v118
    v_mul_f32 v64, v64, v112
    v_mul_f32 v65, v65, v113
    v_mul_f32 v66, v66, v114
    v_mul_f32 v67, v67, v115
    v_mul_f32 v68, v68, v116
    v_mul_f32 v69, v69, v117
    v_mul_f32 v70, v70, v118
    v_cvt_pk_bf16_f32 v64, v64, v64
    v_and_b32 v64, 0xffff0000, v64
    v_cvt_pk_bf16_f32 v65, v65, v65
    v_and_b32 v65, 0xffff0000, v65
    v_cvt_pk_bf16_f32 v66, v66, v66
    v_and_b32 v66, 0xffff0000, v66
    v_cvt_pk_bf16_f32 v67, v67, v67
    v_and_b32 v67, 0xffff0000, v67
    v_cvt_pk_bf16_f32 v68, v68, v68
    v_and_b32 v68, 0xffff0000, v68
    v_cvt_pk_bf16_f32 v69, v69, v69
    v_and_b32 v69, 0xffff0000, v69
    v_cvt_pk_bf16_f32 v70, v70, v70
    v_and_b32 v70, 0xffff0000, v70
    v_lshlrev_b32 v112, 16, v72
    v_and_b32 v113, 0xffff0000, v72
    v_lshlrev_b32 v114, 16, v73
    v_and_b32 v115, 0xffff0000, v73
    v_lshlrev_b32 v116, 16, v74
    v_and_b32 v117, 0xffff0000, v74
    v_lshlrev_b32 v118, 16, v75
    v_and_b32 v119, 0xffff0000, v75
    v_mul_f32 v104, v64, v112
    v_mul_f32 v105, v64, v113
    v_mul_f32 v106, v64, v114
    v_mul_f32 v107, v64, v115
    v_mul_f32 v108, v64, v116
    v_mul_f32 v109, v64, v117
    v_mul_f32 v110, v64, v118
    v_mul_f32 v111, v64, v119
    v_lshlrev_b32 v112, 16, v76
    v_and_b32 v113, 0xffff0000, v76
    v_lshlrev_b32 v114, 16, v77
    v_and_b32 v115, 0xffff0000, v77
    v_lshlrev_b32 v116, 16, v78
    v_and_b32 v117, 0xffff0000, v78
    v_lshlrev_b32 v118, 16, v79
    v_and_b32 v119, 0xffff0000, v79
    v_fmac_f32 v104, v65, v112
    v_fmac_f32 v105, v65, v113
    v_fmac_f32 v106, v65, v114
    v_fmac_f32 v107, v65, v115
    v_fmac_f32 v108, v65, v116
    v_fmac_f32 v109, v65, v117
    v_fmac_f32 v110, v65, v118
    v_fmac_f32 v111, v65, v119
    v_lshlrev_b32 v112, 16, v80
    v_and_b32 v113, 0xffff0000, v80
    v_lshlrev_b32 v114, 16, v81
    v_and_b32 v115, 0xffff0000, v81
    v_lshlrev_b32 v116, 16, v82
    v_and_b32 v117, 0xffff0000, v82
    v_lshlrev_b32 v118, 16, v83
    v_and_b32 v119, 0xffff0000, v83
    v_fmac_f32 v104, v66, v112
    v_fmac_f32 v105, v66, v113
    v_fmac_f32 v106, v66, v114
    v_fmac_f32 v107, v66, v115
    v_fmac_f32 v108, v66, v116
    v_fmac_f32 v109, v66, v117
    v_fmac_f32 v110, v66, v118
    v_fmac_f32 v111, v66, v119
    v_lshlrev_b32 v112, 16, v84
    v_and_b32 v113, 0xffff0000, v84
    v_lshlrev_b32 v114, 16, v85
    v_and_b32 v115, 0xffff0000, v85
    v_lshlrev_b32 v116, 16, v86
    v_and_b32 v117, 0xffff0000, v86
    v_lshlrev_b32 v118, 16, v87
    v_and_b32 v119, 0xffff0000, v87
    v_fmac_f32 v104, v67, v112
    v_fmac_f32 v105, v67, v113
    v_fmac_f32 v106, v67, v114
    v_fmac_f32 v107, v67, v115
    v_fmac_f32 v108, v67, v116
    v_fmac_f32 v109, v67, v117
    v_fmac_f32 v110, v67, v118
    v_fmac_f32 v111, v67, v119
    v_lshlrev_b32 v112, 16, v88
    v_and_b32 v113, 0xffff0000, v88
    v_lshlrev_b32 v114, 16, v89
    v_and_b32 v115, 0xffff0000, v89
    v_lshlrev_b32 v116, 16, v90
    v_and_b32 v117, 0xffff0000, v90
    v_lshlrev_b32 v118, 16, v91
    v_and_b32 v119, 0xffff0000, v91
    v_fmac_f32 v104, v68, v112
    v_fmac_f32 v105, v68, v113
    v_fmac_f32 v106, v68, v114
    v_fmac_f32 v107, v68, v115
    v_fmac_f32 v108, v68, v116
    v_fmac_f32 v109, v68, v117
    v_fmac_f32 v110, v68, v118
    v_fmac_f32 v111, v68, v119
    v_lshlrev_b32 v112, 16, v92
    v_and_b32 v113, 0xffff0000, v92
    v_lshlrev_b32 v114, 16, v93
    v_and_b32 v115, 0xffff0000, v93
    v_lshlrev_b32 v116, 16, v94
    v_and_b32 v117, 0xffff0000, v94
    v_lshlrev_b32 v118, 16, v95
    v_and_b32 v119, 0xffff0000, v95
    v_fmac_f32 v104, v69, v112
    v_fmac_f32 v105, v69, v113
    v_fmac_f32 v106, v69, v114
    v_fmac_f32 v107, v69, v115
    v_fmac_f32 v108, v69, v116
    v_fmac_f32 v109, v69, v117
    v_fmac_f32 v110, v69, v118
    v_fmac_f32 v111, v69, v119
    v_lshlrev_b32 v112, 16, v96
    v_and_b32 v113, 0xffff0000, v96
    v_lshlrev_b32 v114, 16, v97
    v_and_b32 v115, 0xffff0000, v97
    v_lshlrev_b32 v116, 16, v98
    v_and_b32 v117, 0xffff0000, v98
    v_lshlrev_b32 v118, 16, v99
    v_and_b32 v119, 0xffff0000, v99
    v_fmac_f32 v104, v70, v112
    v_fmac_f32 v105, v70, v113
    v_fmac_f32 v106, v70, v114
    v_fmac_f32 v107, v70, v115
    v_fmac_f32 v108, v70, v116
    v_fmac_f32 v109, v70, v117
    v_fmac_f32 v110, v70, v118
    v_fmac_f32 v111, v70, v119
    v_add_f32_dpp v104, v104, v104 row_ror:4 row_mask:0xf bank_mask:0xf
    v_add_f32_dpp v105, v105, v105 row_ror:4 row_mask:0xf bank_mask:0xf
    v_add_f32_dpp v106, v106, v106 row_ror:4 row_mask:0xf bank_mask:0xf
    v_add_f32_dpp v107, v107, v107 row_ror:4 row_mask:0xf bank_mask:0xf
    v_add_f32_dpp v108, v108, v108 row_ror:4 row_mask:0xf bank_mask:0xf
    v_add_f32_dpp v109, v109, v109 row_ror:4 row_mask:0xf bank_mask:0xf
    v_add_f32_dpp v110, v110, v110 row_ror:4 row_mask:0xf bank_mask:0xf
    v_add_f32_dpp v111, v111, v111 row_ror:4 row_mask:0xf bank_mask:0xf
    v_add_f32_dpp v104, v104, v104 row_ror:8 row_mask:0xf bank_mask:0xf
    v_add_f32_dpp v105, v105, v105 row_ror:8 row_mask:0xf bank_mask:0xf
    v_add_f32_dpp v106, v106, v106 row_ror:8 row_mask:0xf bank_mask:0xf
    v_add_f32_dpp v107, v107, v107 row_ror:8 row_mask:0xf bank_mask:0xf
    v_add_f32_dpp v108, v108, v108 row_ror:8 row_mask:0xf bank_mask:0xf
    v_add_f32_dpp v109, v109, v109 row_ror:8 row_mask:0xf bank_mask:0xf
    v_add_f32_dpp v110, v110, v110 row_ror:8 row_mask:0xf bank_mask:0xf
    v_add_f32_dpp v111, v111, v111 row_ror:8 row_mask:0xf bank_mask:0xf
    v_lshrrev_b32 v8, 4, v0
    v_lshlrev_b32 v8, 7, v8
    v_lshl_add_u32 v8, v6, 5, v8
    v_add_u32 v8, 158720, v8
    ds_write_b128 v8, v[104:107]
    ds_write_b128 v8, v[108:111] offset:16
    v_and_b32 v9, 31, v2
    v_lshlrev_b32 v9, 2, v9
    v_lshlrev_b32 v8, 2, v2
    v_add_u32 v8, 158720, v8
    s_waitcnt lgkmcnt(0)
    s_barrier
    s_cmp_lg_u32 s3, 0
    s_cbranch_scc1 Latt_modcalc_ret
    ds_read_b32 v112, v8 offset:0
    ds_read_b32 v113, v8 offset:256
    ds_read_b32 v114, v8 offset:512
    ds_read_b32 v115, v8 offset:768
    ds_read_b32 v116, v8 offset:1024
    ds_read_b32 v117, v8 offset:1280
    ds_read_b32 v118, v8 offset:1536
    ds_read_b32 v119, v8 offset:1792
    s_waitcnt lgkmcnt(6)
    v_add_f32 v112, v112, v113
    s_waitcnt lgkmcnt(5)
    v_add_f32 v112, v112, v114
    s_waitcnt lgkmcnt(4)
    v_add_f32 v112, v112, v115
    s_waitcnt lgkmcnt(3)
    v_add_f32 v112, v112, v116
    s_waitcnt lgkmcnt(2)
    v_add_f32 v112, v112, v117
    s_waitcnt lgkmcnt(1)
    v_add_f32 v112, v112, v118
    s_waitcnt lgkmcnt(0)
    v_add_f32 v112, v112, v119
    v_mov_b32 v113, v112
    s_nop 1
    v_permlane32_swap_b32 v112, v113
    v_add_f32 v112, v112, v113
    v_cvt_pk_bf16_f32 v112, v112, v112
    v_and_b32 v112, 0xffff0000, v112
    s_cmp_ge_u32 s101, 14
    s_cselect_b32 s53, 1.0, 0
    v_add_f32 v112, s53, v112
    v_cvt_pk_bf16_f32 v112, v112, v112
    v_and_b32 v112, 0xffff0000, v112
    s_add_u32 s4, s36, 16384
    s_addc_u32 s5, s37, 0
    s_mov_b32 s6, 3584
    s_mov_b32 s7, 0x20000
    s_lshl_b32 s53, s101, 7
    v_mul_f32 v113, 1035512379, v112
    buffer_store_dword v113, v9, s[4:7], s53 offen sc1
Latt_modcalc_ret:
    s_mov_b32 m0, 162816
    s_lshl_b32 s50, s51, 2
    s_add_u32 s50, s50, s3
    s_lshl_b32 s53, s50, 13
    buffer_load_dwordx4 v247, s[16:19], s53 offen lds
    s_add_u32 s53, s53, 1048576
    buffer_load_dwordx4 v247, s[16:19], s53 offen lds
    s_add_u32 s53, s53, 1048576
    buffer_load_dwordx4 v247, s[16:19], s53 offen lds
    s_add_u32 s53, s53, 1048576
    buffer_load_dwordx4 v247, s[16:19], s53 offen lds
    s_lshl_b32 s47, s50, 10
    s_mul_i32 s40, s3, 8448
    s_lshl_b32 s55, s3, 13
    s_mov_b32 s45, 1602224128
    s_load_dwordx2 s[58:59], s[0:1], 72
    s_and_b32 s48, s3, 1
    s_mul_i32 s48, s48, 4224
    s_add_u32 s54, s40, s48
    s_sub_u32 s48, s40, s48
    s_add_u32 s48, s48, 4224
    v_lshlrev_b32 v8, 16, v1
    v_add_u32 v240, v8, v247
    v_lshlrev_b32 v8, 13, v1
    v_add_u32 v246, v8, v247
    s_mov_b32 s41, 0
    s_mov_b32 s42, 4096
    s_movk_i32 s53, 1056
    v_and_b32 v10, 1, v1
    v_lshrrev_b32 v14, 1, v1
    v_lshlrev_b32 v9, 4, v10
    v_and_b32 v11, 7, v4
    v_add_u32 v11, v11, v9
    v_mul_lo_u32 v11, v11, s53
    v_lshrrev_b32 v12, 2, v4
    v_lshrrev_b32 v13, 3, v4
    v_xor_b32 v12, v12, v13
    v_and_b32 v12, 1, v12
    v_lshl_add_u32 v11, v12, 9, v11
    v_lshl_add_u32 v244, v3, 4, v11
    v_and_b32 v12, 1, v3
    v_lshl_add_u32 v11, v12, 2, v5
    v_add_u32 v11, v11, v9
    v_mul_lo_u32 v11, v11, s53
    v_lshrrev_b32 v13, 1, v3
    v_xor_b32 v13, v13, v12
    v_lshl_add_u32 v11, v13, 9, v11
    v_lshl_add_u32 v11, v6, 3, v11
    v_add_u32 v245, 67584, v11
    v_lshlrev_b32 v8, 9, v10
    v_lshl_add_u32 v8, v14, 8, v8
    v_lshl_add_u32 v8, v6, 3, v8
    v_lshl_add_u32 v11, v3, 3, v5
    v_lshl_add_u32 v13, v12, 2, v11
    v_mad_u32_u24 v184, v13, s53, v8
    v_xor_b32 v13, 4, v13
    v_mad_u32_u24 v185, v13, s53, v8
    v_add_u32 v186, 67584, v184
    v_add_u32 v187, 67584, v185
    v_lshl_add_u32 v11, v12, 2, v5
    v_lshlrev_b32 v11, 6, v11
    v_lshrrev_b32 v13, 1, v3
    v_lshl_add_u32 v11, v13, 10, v11
    v_lshl_add_u32 v11, v6, 3, v11
    v_lshl_add_u32 v11, v14, 9, v11
    v_xor_b32 v8, v10, v12
    v_lshl_add_u32 v249, v8, 5, v11
    v_add_u32 v250, 67584, v249
    v_bfe_u32 v11, v2, 2, 3
    v_lshrrev_b32 v13, 2, v11
    v_lshlrev_b32 v13, 1, v13
    v_xor_b32 v13, v13, v6
    v_lshl_add_u32 v11, v1, 6, v11
    s_movk_i32 s53, 896
    v_mul_lo_u32 v11, v11, s53
    v_lshrrev_b32 v8, 5, v2
    v_lshl_add_u32 v11, v8, 6, v11
    v_lshl_add_u32 v248, v13, 4, v11
    v_lshl_add_u32 v251, v1, 10, v247
    v_lshlrev_b32 v241, 5, v3
    v_add_u32 v241, 158720, v241
    v_add_u32 v188, 101376, v251
    v_lshrrev_b32 v13, 1, v3
    v_lshlrev_b32 v11, 8, v13
    v_lshl_add_u32 v11, v4, 4, v11
    v_lshl_add_u32 v11, v12, 3, v11
    v_lshl_add_u32 v11, v10, 15, v11
    v_lshl_add_u32 v11, v14, 12, v11
    v_add_u32 v189, 67584, v11
    v_lshl_add_u32 v11, v10, 15, v247
    v_lshl_add_u32 v11, v14, 14, v11
    v_add_u32 v190, 67584, v11
    v_xor_b32 v191, 0x8000, v190
    v_mov_b32 v16, 0x3f803f80
    v_mov_b32 v20, 0
    v_mov_b32 v21, 0
    v_mov_b32 v22, 0
    v_mov_b32 v23, 0
    s_waitcnt vmcnt(17)
    v_dot2c_f32_bf16 v20, v128, v16
    v_dot2c_f32_bf16 v22, v128, v128
    v_dot2c_f32_bf16 v21, v129, v16
    v_dot2c_f32_bf16 v23, v129, v129
    v_dot2c_f32_bf16 v20, v130, v16
    v_dot2c_f32_bf16 v22, v130, v130
    v_dot2c_f32_bf16 v21, v131, v16
    v_dot2c_f32_bf16 v23, v131, v131
    s_waitcnt vmcnt(16)
    v_dot2c_f32_bf16 v20, v132, v16
    v_dot2c_f32_bf16 v22, v132, v132
    v_dot2c_f32_bf16 v21, v133, v16
    v_dot2c_f32_bf16 v23, v133, v133
    v_dot2c_f32_bf16 v20, v134, v16
    v_dot2c_f32_bf16 v22, v134, v134
    v_dot2c_f32_bf16 v21, v135, v16
    v_dot2c_f32_bf16 v23, v135, v135
    s_waitcnt vmcnt(15)
    v_dot2c_f32_bf16 v20, v136, v16
    v_dot2c_f32_bf16 v22, v136, v136
    v_dot2c_f32_bf16 v21, v137, v16
    v_dot2c_f32_bf16 v23, v137, v137
    v_dot2c_f32_bf16 v20, v138, v16
    v_dot2c_f32_bf16 v22, v138, v138
    v_dot2c_f32_bf16 v21, v139, v16
    v_dot2c_f32_bf16 v23, v139, v139
    s_waitcnt vmcnt(14)
    v_dot2c_f32_bf16 v20, v140, v16
    v_dot2c_f32_bf16 v22, v140, v140
    v_dot2c_f32_bf16 v21, v141, v16
    v_dot2c_f32_bf16 v23, v141, v141
    v_dot2c_f32_bf16 v20, v142, v16
    v_dot2c_f32_bf16 v22, v142, v142
    v_dot2c_f32_bf16 v21, v143, v16
    v_dot2c_f32_bf16 v23, v143, v143
    s_waitcnt vmcnt(13)
    v_dot2c_f32_bf16 v20, v144, v16
    v_dot2c_f32_bf16 v22, v144, v144
    v_dot2c_f32_bf16 v21, v145, v16
    v_dot2c_f32_bf16 v23, v145, v145
    v_dot2c_f32_bf16 v20, v146, v16
    v_dot2c_f32_bf16 v22, v146, v146
    v_dot2c_f32_bf16 v21, v147, v16
    v_dot2c_f32_bf16 v23, v147, v147
    s_waitcnt vmcnt(12)
    v_dot2c_f32_bf16 v20, v148, v16
    v_dot2c_f32_bf16 v22, v148, v148
    v_dot2c_f32_bf16 v21, v149, v16
    v_dot2c_f32_bf16 v23, v149, v149
    v_dot2c_f32_bf16 v20, v150, v16
    v_dot2c_f32_bf16 v22, v150, v150
    v_dot2c_f32_bf16 v21, v151, v16
    v_dot2c_f32_bf16 v23, v151, v151
    s_waitcnt vmcnt(11)
    v_dot2c_f32_bf16 v20, v152, v16
    v_dot2c_f32_bf16 v22, v152, v152
    v_dot2c_f32_bf16 v21, v153, v16
    v_dot2c_f32_bf16 v23, v153, v153
    v_dot2c_f32_bf16 v20, v154, v16
    v_dot2c_f32_bf16 v22, v154, v154
    v_dot2c_f32_bf16 v21, v155, v16
    v_dot2c_f32_bf16 v23, v155, v155
    s_waitcnt vmcnt(10)
    v_dot2c_f32_bf16 v20, v156, v16
    v_dot2c_f32_bf16 v22, v156, v156
    v_dot2c_f32_bf16 v21, v157, v16
    v_dot2c_f32_bf16 v23, v157, v157
    v_dot2c_f32_bf16 v20, v158, v16
    v_dot2c_f32_bf16 v22, v158, v158
    v_dot2c_f32_bf16 v21, v159, v16
    v_dot2c_f32_bf16 v23, v159, v159
    s_waitcnt vmcnt(9)
    v_dot2c_f32_bf16 v20, v160, v16
    v_dot2c_f32_bf16 v22, v160, v160
    v_dot2c_f32_bf16 v21, v161, v16
    v_dot2c_f32_bf16 v23, v161, v161
    v_dot2c_f32_bf16 v20, v162, v16
    v_dot2c_f32_bf16 v22, v162, v162
    v_dot2c_f32_bf16 v21, v163, v16
    v_dot2c_f32_bf16 v23, v163, v163
    s_waitcnt vmcnt(8)
    v_dot2c_f32_bf16 v20, v164, v16
    v_dot2c_f32_bf16 v22, v164, v164
    v_dot2c_f32_bf16 v21, v165, v16
    v_dot2c_f32_bf16 v23, v165, v165
    v_dot2c_f32_bf16 v20, v166, v16
    v_dot2c_f32_bf16 v22, v166, v166
    v_dot2c_f32_bf16 v21, v167, v16
    v_dot2c_f32_bf16 v23, v167, v167
    s_waitcnt vmcnt(7)
    v_dot2c_f32_bf16 v20, v168, v16
    v_dot2c_f32_bf16 v22, v168, v168
    v_dot2c_f32_bf16 v21, v169, v16
    v_dot2c_f32_bf16 v23, v169, v169
    v_dot2c_f32_bf16 v20, v170, v16
    v_dot2c_f32_bf16 v22, v170, v170
    v_dot2c_f32_bf16 v21, v171, v16
    v_dot2c_f32_bf16 v23, v171, v171
    s_waitcnt vmcnt(6)
    v_dot2c_f32_bf16 v20, v172, v16
    v_dot2c_f32_bf16 v22, v172, v172
    v_dot2c_f32_bf16 v21, v173, v16
    v_dot2c_f32_bf16 v23, v173, v173
    v_dot2c_f32_bf16 v20, v174, v16
    v_dot2c_f32_bf16 v22, v174, v174
    v_dot2c_f32_bf16 v21, v175, v16
    v_dot2c_f32_bf16 v23, v175, v175
    s_waitcnt vmcnt(5)
    v_dot2c_f32_bf16 v20, v176, v16
    v_dot2c_f32_bf16 v22, v176, v176
    v_dot2c_f32_bf16 v21, v177, v16
    v_dot2c_f32_bf16 v23, v177, v177
    v_dot2c_f32_bf16 v20, v178, v16
    v_dot2c_f32_bf16 v22, v178, v178
    v_dot2c_f32_bf16 v21, v179, v16
    v_dot2c_f32_bf16 v23, v179, v179
    s_waitcnt vmcnt(4)
    v_dot2c_f32_bf16 v20, v180, v16
    v_dot2c_f32_bf16 v22, v180, v180
    v_dot2c_f32_bf16 v21, v181, v16
    v_dot2c_f32_bf16 v23, v181, v181
    v_dot2c_f32_bf16 v20, v182, v16
    v_dot2c_f32_bf16 v22, v182, v182
    v_dot2c_f32_bf16 v21, v183, v16
    v_dot2c_f32_bf16 v23, v183, v183
    s_lshl_b32 s53, s3, 8
    s_add_u32 s49, s53, s101
    s_cmp_lt_u32 s49, 28
    s_cbranch_scc1 Latt_hook1
Latt_hook1_ret:
    s_cmp_eq_u32 s101, 255
    s_cbranch_scc1 Latt_xf
Latt_xf_ret:
    s_nop 3
    v_add_f32 v20, v20, v21
    v_add_f32 v21, v22, v23
    v_mov_b32 v22, v20
    v_mov_b32 v23, v21
    s_nop 0
    v_permlane16_swap_b32 v20, v22
    v_permlane16_swap_b32 v21, v23
    v_add_f32 v20, v20, v22
    v_add_f32 v21, v21, v23
    v_mov_b32 v22, v20
    v_mov_b32 v23, v21
    s_nop 0
    v_permlane32_swap_b32 v20, v22
    v_permlane32_swap_b32 v21, v23
    v_add_f32 v20, v20, v22
    v_add_f32 v21, v21, v23
    v_mul_f32 v20, 991054117, v20
    v_mul_f32 v21, 991054117, v21
    v_fma_f32 v21, -v20, v20, v21
    v_max_f32 v21, 0, v21
    v_add_f32 v21, 925353388, v21
    v_rsq_f32 v24, v21
    s_nop 0
    v_mov_b32 v25, v24
    v_mul_f32 v26, -v20, v24
    v_mov_b32 v27, v26
    s_add_u32 s4, s56, 128
    s_addc_u32 s5, s57, 0
    s_mov_b32 s6, 4
    s_mov_b32 s7, 0x20000
    v_lshlrev_b32 v32, 16, v128
    v_and_b32 v33, 0xffff0000, v128
    v_lshlrev_b32 v34, 16, v129
    v_and_b32 v35, 0xffff0000, v129
    v_lshlrev_b32 v36, 16, v130
    v_and_b32 v37, 0xffff0000, v130
    v_lshlrev_b32 v38, 16, v131
    v_and_b32 v39, 0xffff0000, v131
    v_pk_fma_f32 v[32:33], v[32:33], v[24:25], v[26:27]
    v_pk_fma_f32 v[34:35], v[34:35], v[24:25], v[26:27]
    v_pk_fma_f32 v[36:37], v[36:37], v[24:25], v[26:27]
    v_pk_fma_f32 v[38:39], v[38:39], v[24:25], v[26:27]
    v_cvt_pk_bf16_f32 v128, v32, v33
    v_cvt_pk_bf16_f32 v129, v34, v35
    v_cvt_pk_bf16_f32 v130, v36, v37
    v_cvt_pk_bf16_f32 v131, v38, v39
    v_lshlrev_b32 v40, 16, v132
    v_and_b32 v41, 0xffff0000, v132
    v_lshlrev_b32 v42, 16, v133
    v_and_b32 v43, 0xffff0000, v133
    v_lshlrev_b32 v44, 16, v134
    v_and_b32 v45, 0xffff0000, v134
    v_lshlrev_b32 v46, 16, v135
    v_and_b32 v47, 0xffff0000, v135
    v_pk_fma_f32 v[40:41], v[40:41], v[24:25], v[26:27]
    v_pk_fma_f32 v[42:43], v[42:43], v[24:25], v[26:27]
    v_pk_fma_f32 v[44:45], v[44:45], v[24:25], v[26:27]
    v_pk_fma_f32 v[46:47], v[46:47], v[24:25], v[26:27]
    v_cvt_pk_bf16_f32 v132, v40, v41
    v_cvt_pk_bf16_f32 v133, v42, v43
    v_cvt_pk_bf16_f32 v134, v44, v45
    v_cvt_pk_bf16_f32 v135, v46, v47
    v_lshlrev_b32 v32, 16, v136
    v_and_b32 v33, 0xffff0000, v136
    v_lshlrev_b32 v34, 16, v137
    v_and_b32 v35, 0xffff0000, v137
    v_lshlrev_b32 v36, 16, v138
    v_and_b32 v37, 0xffff0000, v138
    v_lshlrev_b32 v38, 16, v139
    v_and_b32 v39, 0xffff0000, v139
    v_pk_fma_f32 v[32:33], v[32:33], v[24:25], v[26:27]
    v_pk_fma_f32 v[34:35], v[34:35], v[24:25], v[26:27]
    v_pk_fma_f32 v[36:37], v[36:37], v[24:25], v[26:27]
    v_pk_fma_f32 v[38:39], v[38:39], v[24:25], v[26:27]
    v_cvt_pk_bf16_f32 v136, v32, v33
    v_cvt_pk_bf16_f32 v137, v34, v35
    v_cvt_pk_bf16_f32 v138, v36, v37
    v_cvt_pk_bf16_f32 v139, v38, v39
    v_lshlrev_b32 v40, 16, v140
    v_and_b32 v41, 0xffff0000, v140
    v_lshlrev_b32 v42, 16, v141
    v_and_b32 v43, 0xffff0000, v141
    v_lshlrev_b32 v44, 16, v142
    v_and_b32 v45, 0xffff0000, v142
    v_lshlrev_b32 v46, 16, v143
    v_and_b32 v47, 0xffff0000, v143
    v_pk_fma_f32 v[40:41], v[40:41], v[24:25], v[26:27]
    v_pk_fma_f32 v[42:43], v[42:43], v[24:25], v[26:27]
    v_pk_fma_f32 v[44:45], v[44:45], v[24:25], v[26:27]
    v_pk_fma_f32 v[46:47], v[46:47], v[24:25], v[26:27]
    v_cvt_pk_bf16_f32 v140, v40, v41
    v_cvt_pk_bf16_f32 v141, v42, v43
    v_cvt_pk_bf16_f32 v142, v44, v45
    v_cvt_pk_bf16_f32 v143, v46, v47
    v_lshlrev_b32 v32, 16, v144
    v_and_b32 v33, 0xffff0000, v144
    v_lshlrev_b32 v34, 16, v145
    v_and_b32 v35, 0xffff0000, v145
    v_lshlrev_b32 v36, 16, v146
    v_and_b32 v37, 0xffff0000, v146
    v_lshlrev_b32 v38, 16, v147
    v_and_b32 v39, 0xffff0000, v147
    v_pk_fma_f32 v[32:33], v[32:33], v[24:25], v[26:27]
    v_pk_fma_f32 v[34:35], v[34:35], v[24:25], v[26:27]
    v_pk_fma_f32 v[36:37], v[36:37], v[24:25], v[26:27]
    v_pk_fma_f32 v[38:39], v[38:39], v[24:25], v[26:27]
    v_cvt_pk_bf16_f32 v144, v32, v33
    v_cvt_pk_bf16_f32 v145, v34, v35
    v_cvt_pk_bf16_f32 v146, v36, v37
    v_cvt_pk_bf16_f32 v147, v38, v39
    v_lshlrev_b32 v40, 16, v148
    v_and_b32 v41, 0xffff0000, v148
    v_lshlrev_b32 v42, 16, v149
    v_and_b32 v43, 0xffff0000, v149
    v_lshlrev_b32 v44, 16, v150
    v_and_b32 v45, 0xffff0000, v150
    v_lshlrev_b32 v46, 16, v151
    v_and_b32 v47, 0xffff0000, v151
    v_pk_fma_f32 v[40:41], v[40:41], v[24:25], v[26:27]
    v_pk_fma_f32 v[42:43], v[42:43], v[24:25], v[26:27]
    v_pk_fma_f32 v[44:45], v[44:45], v[24:25], v[26:27]
    v_pk_fma_f32 v[46:47], v[46:47], v[24:25], v[26:27]
    v_cvt_pk_bf16_f32 v148, v40, v41
    v_cvt_pk_bf16_f32 v149, v42, v43
    v_cvt_pk_bf16_f32 v150, v44, v45
    v_cvt_pk_bf16_f32 v151, v46, v47
    v_lshlrev_b32 v32, 16, v152
    v_and_b32 v33, 0xffff0000, v152
    v_lshlrev_b32 v34, 16, v153
    v_and_b32 v35, 0xffff0000, v153
    v_lshlrev_b32 v36, 16, v154
    v_and_b32 v37, 0xffff0000, v154
    v_lshlrev_b32 v38, 16, v155
    v_and_b32 v39, 0xffff0000, v155
    v_pk_fma_f32 v[32:33], v[32:33], v[24:25], v[26:27]
    v_pk_fma_f32 v[34:35], v[34:35], v[24:25], v[26:27]
    v_pk_fma_f32 v[36:37], v[36:37], v[24:25], v[26:27]
    v_pk_fma_f32 v[38:39], v[38:39], v[24:25], v[26:27]
    v_cvt_pk_bf16_f32 v152, v32, v33
    v_cvt_pk_bf16_f32 v153, v34, v35
    v_cvt_pk_bf16_f32 v154, v36, v37
    v_cvt_pk_bf16_f32 v155, v38, v39
    v_lshlrev_b32 v40, 16, v156
    v_and_b32 v41, 0xffff0000, v156
    v_lshlrev_b32 v42, 16, v157
    v_and_b32 v43, 0xffff0000, v157
    v_lshlrev_b32 v44, 16, v158
    v_and_b32 v45, 0xffff0000, v158
    v_lshlrev_b32 v46, 16, v159
    v_and_b32 v47, 0xffff0000, v159
    v_pk_fma_f32 v[40:41], v[40:41], v[24:25], v[26:27]
    v_pk_fma_f32 v[42:43], v[42:43], v[24:25], v[26:27]
    v_pk_fma_f32 v[44:45], v[44:45], v[24:25], v[26:27]
    v_pk_fma_f32 v[46:47], v[46:47], v[24:25], v[26:27]
    v_cvt_pk_bf16_f32 v156, v40, v41
    v_cvt_pk_bf16_f32 v157, v42, v43
    v_cvt_pk_bf16_f32 v158, v44, v45
    v_cvt_pk_bf16_f32 v159, v46, v47
    v_lshlrev_b32 v32, 16, v160
    v_and_b32 v33, 0xffff0000, v160
    v_lshlrev_b32 v34, 16, v161
    v_and_b32 v35, 0xffff0000, v161
    v_lshlrev_b32 v36, 16, v162
    v_and_b32 v37, 0xffff0000, v162
    v_lshlrev_b32 v38, 16, v163
    v_and_b32 v39, 0xffff0000, v163
    v_pk_fma_f32 v[32:33], v[32:33], v[24:25], v[26:27]
    v_pk_fma_f32 v[34:35], v[34:35], v[24:25], v[26:27]
    v_pk_fma_f32 v[36:37], v[36:37], v[24:25], v[26:27]
    v_pk_fma_f32 v[38:39], v[38:39], v[24:25], v[26:27]
    v_cvt_pk_bf16_f32 v160, v32, v33
    v_cvt_pk_bf16_f32 v161, v34, v35
    v_cvt_pk_bf16_f32 v162, v36, v37
    v_cvt_pk_bf16_f32 v163, v38, v39
    v_lshlrev_b32 v40, 16, v164
    v_and_b32 v41, 0xffff0000, v164
    v_lshlrev_b32 v42, 16, v165
    v_and_b32 v43, 0xffff0000, v165
    v_lshlrev_b32 v44, 16, v166
    v_and_b32 v45, 0xffff0000, v166
    v_lshlrev_b32 v46, 16, v167
    v_and_b32 v47, 0xffff0000, v167
    v_pk_fma_f32 v[40:41], v[40:41], v[24:25], v[26:27]
    v_pk_fma_f32 v[42:43], v[42:43], v[24:25], v[26:27]
    v_pk_fma_f32 v[44:45], v[44:45], v[24:25], v[26:27]
    v_pk_fma_f32 v[46:47], v[46:47], v[24:25], v[26:27]
    v_cvt_pk_bf16_f32 v164, v40, v41
    v_cvt_pk_bf16_f32 v165, v42, v43
    v_cvt_pk_bf16_f32 v166, v44, v45
    v_cvt_pk_bf16_f32 v167, v46, v47
    v_lshlrev_b32 v32, 16, v168
    v_and_b32 v33, 0xffff0000, v168
    v_lshlrev_b32 v34, 16, v169
    v_and_b32 v35, 0xffff0000, v169
    v_lshlrev_b32 v36, 16, v170
    v_and_b32 v37, 0xffff0000, v170
    v_lshlrev_b32 v38, 16, v171
    v_and_b32 v39, 0xffff0000, v171
    v_pk_fma_f32 v[32:33], v[32:33], v[24:25], v[26:27]
    v_pk_fma_f32 v[34:35], v[34:35], v[24:25], v[26:27]
    v_pk_fma_f32 v[36:37], v[36:37], v[24:25], v[26:27]
    v_pk_fma_f32 v[38:39], v[38:39], v[24:25], v[26:27]
    v_cvt_pk_bf16_f32 v168, v32, v33
    v_cvt_pk_bf16_f32 v169, v34, v35
    v_cvt_pk_bf16_f32 v170, v36, v37
    v_cvt_pk_bf16_f32 v171, v38, v39
    v_lshlrev_b32 v40, 16, v172
    v_and_b32 v41, 0xffff0000, v172
    v_lshlrev_b32 v42, 16, v173
    v_and_b32 v43, 0xffff0000, v173
    v_lshlrev_b32 v44, 16, v174
    v_and_b32 v45, 0xffff0000, v174
    v_lshlrev_b32 v46, 16, v175
    v_and_b32 v47, 0xffff0000, v175
    v_pk_fma_f32 v[40:41], v[40:41], v[24:25], v[26:27]
    v_pk_fma_f32 v[42:43], v[42:43], v[24:25], v[26:27]
    v_pk_fma_f32 v[44:45], v[44:45], v[24:25], v[26:27]
    v_pk_fma_f32 v[46:47], v[46:47], v[24:25], v[26:27]
    v_cvt_pk_bf16_f32 v172, v40, v41
    v_cvt_pk_bf16_f32 v173, v42, v43
    v_cvt_pk_bf16_f32 v174, v44, v45
    v_cvt_pk_bf16_f32 v175, v46, v47
    v_lshlrev_b32 v32, 16, v176
    v_and_b32 v33, 0xffff0000, v176
    v_lshlrev_b32 v34, 16, v177
    v_and_b32 v35, 0xffff0000, v177
    v_lshlrev_b32 v36, 16, v178
    v_and_b32 v37, 0xffff0000, v178
    v_lshlrev_b32 v38, 16, v179
    v_and_b32 v39, 0xffff0000, v179
    v_pk_fma_f32 v[32:33], v[32:33], v[24:25], v[26:27]
    v_pk_fma_f32 v[34:35], v[34:35], v[24:25], v[26:27]
    v_pk_fma_f32 v[36:37], v[36:37], v[24:25], v[26:27]
    v_pk_fma_f32 v[38:39], v[38:39], v[24:25], v[26:27]
    v_cvt_pk_bf16_f32 v176, v32, v33
    v_cvt_pk_bf16_f32 v177, v34, v35
    v_cvt_pk_bf16_f32 v178, v36, v37
    v_cvt_pk_bf16_f32 v179, v38, v39
    v_lshlrev_b32 v40, 16, v180
    v_and_b32 v41, 0xffff0000, v180
    v_lshlrev_b32 v42, 16, v181
    v_and_b32 v43, 0xffff0000, v181
    v_lshlrev_b32 v44, 16, v182
    v_and_b32 v45, 0xffff0000, v182
    v_lshlrev_b32 v46, 16, v183
    v_and_b32 v47, 0xffff0000, v183
    v_pk_fma_f32 v[40:41], v[40:41], v[24:25], v[26:27]
    v_pk_fma_f32 v[42:43], v[42:43], v[24:25], v[26:27]
    v_pk_fma_f32 v[44:45], v[44:45], v[24:25], v[26:27]
    v_pk_fma_f32 v[46:47], v[46:47], v[24:25], v[26:27]
    v_cvt_pk_bf16_f32 v180, v40, v41
    v_cvt_pk_bf16_f32 v181, v42, v43
    v_cvt_pk_bf16_f32 v182, v44, v45
    v_cvt_pk_bf16_f32 v183, v46, v47
    s_cmp_lt_u32 s49, 28
    s_cbranch_scc1 Latt_hook2
Latt_hook2_ret:
    s_add_u32 m0, s54, 33792
    s_mov_b32 s50, 0
    buffer_load_dwordx4 v240, s[16:19], s50 offen lds
    s_add_u32 m0, s54, 34848
    s_mov_b32 s51, 8192
    buffer_load_dwordx4 v240, s[16:19], s51 offen lds
    s_add_u32 m0, s54, 35904
    s_mov_b32 s50, 16384
    buffer_load_dwordx4 v240, s[16:19], s50 offen lds
    s_add_u32 m0, s54, 36960
    s_mov_b32 s51, 24576
    buffer_load_dwordx4 v240, s[16:19], s51 offen lds
    s_add_u32 m0, s48, 33792
    s_mov_b32 s50, 32768
    buffer_load_dwordx4 v240, s[16:19], s50 offen lds
    s_add_u32 m0, s48, 34848
    s_mov_b32 s51, 40960
    buffer_load_dwordx4 v240, s[16:19], s51 offen lds
    s_add_u32 m0, s48, 35904
    s_mov_b32 s50, 49152
    buffer_load_dwordx4 v240, s[16:19], s50 offen lds
    s_add_u32 m0, s48, 36960
    s_mov_b32 s51, 57344
    buffer_load_dwordx4 v240, s[16:19], s51 offen lds
    s_add_u32 m0, s54, 67584
    s_mov_b32 s50, 262144
    buffer_load_dwordx4 v240, s[16:19], s50 offen lds
    s_add_u32 m0, s54, 68640
    s_mov_b32 s51, 270336
    buffer_load_dwordx4 v240, s[16:19], s51 offen lds
    s_add_u32 m0, s54, 69696
    s_mov_b32 s50, 278528
    buffer_load_dwordx4 v240, s[16:19], s50 offen lds
    s_add_u32 m0, s54, 70752
    s_mov_b32 s51, 286720
    buffer_load_dwordx4 v240, s[16:19], s51 offen lds
    s_add_u32 m0, s48, 67584
    s_mov_b32 s50, 294912
    buffer_load_dwordx4 v240, s[16:19], s50 offen lds
    s_add_u32 m0, s48, 68640
    s_mov_b32 s51, 303104
    buffer_load_dwordx4 v240, s[16:19], s51 offen lds
    s_add_u32 m0, s48, 69696
    s_mov_b32 s50, 311296
    buffer_load_dwordx4 v240, s[16:19], s50 offen lds
    s_add_u32 m0, s48, 70752
    s_mov_b32 s51, 319488
    buffer_load_dwordx4 v240, s[16:19], s51 offen lds
    s_add_u32 m0, s54, 0
    s_mov_b32 s50, 524288
    buffer_load_dwordx4 v240, s[16:19], s50 offen lds
    s_add_u32 m0, s54, 1056
    s_mov_b32 s51, 532480
    buffer_load_dwordx4 v240, s[16:19], s51 offen lds
    s_add_u32 m0, s54, 2112
    s_mov_b32 s50, 540672
    buffer_load_dwordx4 v240, s[16:19], s50 offen lds
    s_add_u32 m0, s54, 3168
    s_mov_b32 s51, 548864
    buffer_load_dwordx4 v240, s[16:19], s51 offen lds
    s_add_u32 m0, s48, 0
    s_mov_b32 s50, 557056
    buffer_load_dwordx4 v240, s[16:19], s50 offen lds
    s_add_u32 m0, s48, 1056
    s_mov_b32 s51, 565248
    buffer_load_dwordx4 v240, s[16:19], s51 offen lds
    s_add_u32 m0, s48, 2112
    s_mov_b32 s50, 573440
    buffer_load_dwordx4 v240, s[16:19], s50 offen lds
    s_add_u32 m0, s48, 3168
    s_mov_b32 s51, 581632
    buffer_load_dwordx4 v240, s[16:19], s51 offen lds
    s_sub_u32 s53, s101, 28
    s_cmp_lt_u32 s53, 105
    s_cbranch_scc1 Latt_job
Latt_job_ret:
    s_waitcnt vmcnt(16) lgkmcnt(0)
    s_barrier
    ds_read_b64_tr_b16 a[0:1], v184 offset:33792
    ds_read_b64_tr_b16 a[2:3], v185 offset:33792
    ds_read_b64_tr_b16 a[4:5], v184 offset:33824
    ds_read_b64_tr_b16 a[6:7], v185 offset:33824
    ds_read_b64_tr_b16 a[8:9], v184 offset:33856
    ds_read_b64_tr_b16 a[10:11], v185 offset:33856
    ds_read_b64_tr_b16 a[12:13], v184 offset:33888
    ds_read_b64_tr_b16 a[14:15], v185 offset:33888
    ds_read_b64_tr_b16 a[16:17], v184 offset:33920
    ds_read_b64_tr_b16 a[18:19], v185 offset:33920
    ds_read_b64_tr_b16 a[20:21], v184 offset:33952
    ds_read_b64_tr_b16 a[22:23], v185 offset:33952
    ds_read_b64_tr_b16 a[24:25], v184 offset:33984
    ds_read_b64_tr_b16 a[26:27], v185 offset:33984
    ds_read_b64_tr_b16 a[28:29], v184 offset:34016
    ds_read_b64_tr_b16 a[30:31], v185 offset:34016
    s_waitcnt vmcnt(8) lgkmcnt(0)
    s_barrier
    ds_read_b64_tr_b16 a[32:33], v186 offset:0
    ds_read_b64_tr_b16 a[34:35], v187 offset:0
    s_add_u32 m0, s54, 33792
    s_mov_b32 s50, 786432
    buffer_load_dwordx4 v240, s[16:19], s50 offen lds
    ds_read_b64_tr_b16 a[36:37], v186 offset:32
    ds_read_b64_tr_b16 a[38:39], v187 offset:32
    s_add_u32 m0, s54, 34848
    s_mov_b32 s51, 794624
    buffer_load_dwordx4 v240, s[16:19], s51 offen lds
    ds_read_b64_tr_b16 a[40:41], v186 offset:64
    ds_read_b64_tr_b16 a[42:43], v187 offset:64
    s_add_u32 m0, s54, 35904
    s_mov_b32 s50, 802816
    buffer_load_dwordx4 v240, s[16:19], s50 offen lds
    ds_read_b64_tr_b16 a[44:45], v186 offset:96
    ds_read_b64_tr_b16 a[46:47], v187 offset:96
    s_add_u32 m0, s54, 36960
    s_mov_b32 s51, 811008
    buffer_load_dwordx4 v240, s[16:19], s51 offen lds
    ds_read_b64_tr_b16 a[48:49], v186 offset:128
    ds_read_b64_tr_b16 a[50:51], v187 offset:128
    s_add_u32 m0, s48, 33792
    s_mov_b32 s50, 819200
    buffer_load_dwordx4 v240, s[16:19], s50 offen lds
    ds_read_b64_tr_b16 a[52:53], v186 offset:160
    ds_read_b64_tr_b16 a[54:55], v187 offset:160
    s_add_u32 m0, s48, 34848
    s_mov_b32 s51, 827392
    buffer_load_dwordx4 v240, s[16:19], s51 offen lds
    ds_read_b64_tr_b16 a[56:57], v186 offset:192
    ds_read_b64_tr_b16 a[58:59], v187 offset:192
    s_add_u32 m0, s48, 35904
    s_mov_b32 s50, 835584
    buffer_load_dwordx4 v240, s[16:19], s50 offen lds
    ds_read_b64_tr_b16 a[60:61], v186 offset:224
    ds_read_b64_tr_b16 a[62:63], v187 offset:224
    s_add_u32 m0, s48, 36960
    s_mov_b32 s51, 843776
    buffer_load_dwordx4 v240, s[16:19], s51 offen lds
    s_waitcnt vmcnt(8) lgkmcnt(0)
    s_barrier
    ds_read_b64_tr_b16 a[64:65], v184 offset:0
    ds_read_b64_tr_b16 a[66:67], v185 offset:0
    s_add_u32 m0, s54, 67584
    s_mov_b32 s50, 1048576
    buffer_load_dwordx4 v240, s[16:19], s50 offen lds
    ds_read_b64_tr_b16 a[68:69], v184 offset:32
    ds_read_b64_tr_b16 a[70:71], v185 offset:32
    s_add_u32 m0, s54, 68640
    s_mov_b32 s51, 1056768
    buffer_load_dwordx4 v240, s[16:19], s51 offen lds
    ds_read_b64_tr_b16 a[72:73], v184 offset:64
    ds_read_b64_tr_b16 a[74:75], v185 offset:64
    s_add_u32 m0, s54, 69696
    s_mov_b32 s50, 1064960
    buffer_load_dwordx4 v240, s[16:19], s50 offen lds
    ds_read_b64_tr_b16 a[76:77], v184 offset:96
    ds_read_b64_tr_b16 a[78:79], v185 offset:96
    s_add_u32 m0, s54, 70752
    s_mov_b32 s51, 1073152
    buffer_load_dwordx4 v240, s[16:19], s51 offen lds
    ds_read_b64_tr_b16 a[80:81], v184 offset:128
    ds_read_b64_tr_b16 a[82:83], v185 offset:128
    s_add_u32 m0, s48, 67584
    s_mov_b32 s50, 1081344
    buffer_load_dwordx4 v240, s[16:19], s50 offen lds
    ds_read_b64_tr_b16 a[84:85], v184 offset:160
    ds_read_b64_tr_b16 a[86:87], v185 offset:160
    s_add_u32 m0, s48, 68640
    s_mov_b32 s51, 1089536
    buffer_load_dwordx4 v240, s[16:19], s51 offen lds
    ds_read_b64_tr_b16 a[88:89], v184 offset:192
    ds_read_b64_tr_b16 a[90:91], v185 offset:192
    s_add_u32 m0, s48, 69696
    s_mov_b32 s50, 1097728
    buffer_load_dwordx4 v240, s[16:19], s50 offen lds
    ds_read_b64_tr_b16 a[92:93], v184 offset:224
    ds_read_b64_tr_b16 a[94:95], v185 offset:224
    s_add_u32 m0, s48, 70752
    s_mov_b32 s51, 1105920
    buffer_load_dwordx4 v240, s[16:19], s51 offen lds
    s_waitcnt vmcnt(8) lgkmcnt(0)
    s_barrier
    ds_read_b64_tr_b16 a[96:97], v184 offset:33792
    ds_read_b64_tr_b16 a[98:99], v185 offset:33792
    s_add_u32 m0, s54, 0
    s_mov_b32 s50, 1310720
    buffer_load_dwordx4 v240, s[16:19], s50 offen lds
    ds_read_b64_tr_b16 a[100:101], v184 offset:33824
    ds_read_b64_tr_b16 a[102:103], v185 offset:33824
    s_add_u32 m0, s54, 1056
    s_mov_b32 s51, 1318912
    buffer_load_dwordx4 v240, s[16:19], s51 offen lds
    ds_read_b64_tr_b16 a[104:105], v184 offset:33856
    ds_read_b64_tr_b16 a[106:107], v185 offset:33856
    s_add_u32 m0, s54, 2112
    s_mov_b32 s50, 1327104
    buffer_load_dwordx4 v240, s[16:19], s50 offen lds
    ds_read_b64_tr_b16 a[108:109], v184 offset:33888
    ds_read_b64_tr_b16 a[110:111], v185 offset:33888
    s_add_u32 m0, s54, 3168
    s_mov_b32 s51, 1335296
    buffer_load_dwordx4 v240, s[16:19], s51 offen lds
    ds_read_b64_tr_b16 a[112:113], v184 offset:33920
    ds_read_b64_tr_b16 a[114:115], v185 offset:33920
    s_add_u32 m0, s48, 0
    s_mov_b32 s50, 1343488
    buffer_load_dwordx4 v240, s[16:19], s50 offen lds
    ds_read_b64_tr_b16 a[116:117], v184 offset:33952
    ds_read_b64_tr_b16 a[118:119], v185 offset:33952
    s_add_u32 m0, s48, 1056
    s_mov_b32 s51, 1351680
    buffer_load_dwordx4 v240, s[16:19], s51 offen lds
    ds_read_b64_tr_b16 a[120:121], v184 offset:33984
    ds_read_b64_tr_b16 a[122:123], v185 offset:33984
    s_add_u32 m0, s48, 2112
    s_mov_b32 s50, 1359872
    buffer_load_dwordx4 v240, s[16:19], s50 offen lds
    ds_read_b64_tr_b16 a[124:125], v184 offset:34016
    ds_read_b64_tr_b16 a[126:127], v185 offset:34016
    s_add_u32 m0, s48, 3168
    s_mov_b32 s51, 1368064
    buffer_load_dwordx4 v240, s[16:19], s51 offen lds
    s_cmp_lg_u32 s3, 1
    s_cbranch_scc1 Latt_polled
    v_lshlrev_b32 v16, 2, v2
    s_mov_b32 s53, 0x20000
Latt_poll:
    buffer_load_dword v17, v16, s[4:7], 0 offen sc1
    s_waitcnt vmcnt(0)
    v_cmp_ne_u32 vcc, 0, v17
    s_sub_u32 s53, s53, 1
    s_cmp_eq_u32 s53, 0
    s_cbranch_scc1 Latt_polled
    s_cbranch_vccnz Latt_polled
    s_branch Latt_poll
Latt_polled:
    s_waitcnt lgkmcnt(0)
    s_barrier
    s_add_u32 s4, s36, 16384
    s_addc_u32 s5, s37, 0
    s_mov_b32 s6, 4096
    s_mov_b32 s7, 0x20000
    s_lshl_b32 s50, s3, 10
    s_add_u32 m0, s50, 158720
    s_nop 0
    buffer_load_dwordx4 v247, s[4:7], s50 offen sc1 lds
    s_waitcnt vmcnt(0)
    s_barrier
    s_sub_u32 s53, s101, 28
    s_cmp_lt_u32 s53, 113
    s_cbranch_scc1 Latt_jobst
    s_cmp_eq_u32 s101, 255
    s_cbranch_scc1 Latt_xfst
Latt_jobst_ret:
    ds_read_b128 v[0:3], v241 offset:0
    ds_read_b128 v[4:7], v241 offset:16
    ds_read_b128 v[8:11], v241 offset:1792
    ds_read_b128 v[12:15], v241 offset:1808
    ds_read_b128 v[16:19], v241 offset:128
    ds_read_b128 v[20:23], v241 offset:144
    ds_read_b128 v[24:27], v241 offset:1920
    ds_read_b128 v[28:31], v241 offset:1936
    ds_read_b128 v[32:35], v241 offset:256
    ds_read_b128 v[36:39], v241 offset:272
    ds_read_b128 v[40:43], v241 offset:2048
    ds_read_b128 v[44:47], v241 offset:2064
    v_lshlrev_b32 v48, 16, v128
    v_and_b32 v49, 0xffff0000, v128
    v_lshlrev_b32 v50, 16, v129
    v_and_b32 v51, 0xffff0000, v129
    v_lshlrev_b32 v52, 16, v130
    v_and_b32 v53, 0xffff0000, v130
    v_lshlrev_b32 v54, 16, v131
    v_and_b32 v55, 0xffff0000, v131
    s_waitcnt lgkmcnt(9)
    v_pk_fma_f32 v[48:49], v[48:49], v[8:9], v[0:1]
    v_pk_fma_f32 v[50:51], v[50:51], v[10:11], v[2:3]
    s_waitcnt lgkmcnt(8)
    v_pk_fma_f32 v[52:53], v[52:53], v[12:13], v[4:5]
    v_pk_fma_f32 v[54:55], v[54:55], v[14:15], v[6:7]
    v_cvt_pk_bf16_f32 v128, v48, v49
    v_cvt_pk_bf16_f32 v129, v50, v51
    v_cvt_pk_bf16_f32 v130, v52, v53
    v_cvt_pk_bf16_f32 v131, v54, v55
    ds_write_b128 v188, v[128:131] offset:0
    s_add_u32 m0, s54, 33792
    s_mov_b32 s50, 1572864
    buffer_load_dwordx4 v240, s[16:19], s50 offen lds
    ds_read_b128 v[0:3], v241 offset:384
    ds_read_b128 v[4:7], v241 offset:400
    ds_read_b128 v[8:11], v241 offset:2176
    ds_read_b128 v[12:15], v241 offset:2192
    v_lshlrev_b32 v56, 16, v132
    v_and_b32 v57, 0xffff0000, v132
    v_lshlrev_b32 v58, 16, v133
    v_and_b32 v59, 0xffff0000, v133
    v_lshlrev_b32 v60, 16, v134
    v_and_b32 v61, 0xffff0000, v134
    v_lshlrev_b32 v62, 16, v135
    v_and_b32 v63, 0xffff0000, v135
    s_waitcnt lgkmcnt(10)
    v_pk_fma_f32 v[56:57], v[56:57], v[24:25], v[16:17]
    v_pk_fma_f32 v[58:59], v[58:59], v[26:27], v[18:19]
    s_waitcnt lgkmcnt(9)
    v_pk_fma_f32 v[60:61], v[60:61], v[28:29], v[20:21]
    v_pk_fma_f32 v[62:63], v[62:63], v[30:31], v[22:23]
    v_cvt_pk_bf16_f32 v132, v56, v57
    v_cvt_pk_bf16_f32 v133, v58, v59
    v_cvt_pk_bf16_f32 v134, v60, v61
    v_cvt_pk_bf16_f32 v135, v62, v63
    ds_write_b128 v188, v[132:135] offset:4096
    s_add_u32 m0, s54, 34848
    s_mov_b32 s51, 1581056
    buffer_load_dwordx4 v240, s[16:19], s51 offen lds
    ds_read_b128 v[16:19], v241 offset:512
    ds_read_b128 v[20:23], v241 offset:528
    ds_read_b128 v[24:27], v241 offset:2304
    ds_read_b128 v[28:31], v241 offset:2320
    v_lshlrev_b32 v48, 16, v136
    v_and_b32 v49, 0xffff0000, v136
    v_lshlrev_b32 v50, 16, v137
    v_and_b32 v51, 0xffff0000, v137
    v_lshlrev_b32 v52, 16, v138
    v_and_b32 v53, 0xffff0000, v138
    v_lshlrev_b32 v54, 16, v139
    v_and_b32 v55, 0xffff0000, v139
    s_waitcnt lgkmcnt(11)
    v_pk_fma_f32 v[48:49], v[48:49], v[40:41], v[32:33]
    v_pk_fma_f32 v[50:51], v[50:51], v[42:43], v[34:35]
    s_waitcnt lgkmcnt(10)
    v_pk_fma_f32 v[52:53], v[52:53], v[44:45], v[36:37]
    v_pk_fma_f32 v[54:55], v[54:55], v[46:47], v[38:39]
    v_cvt_pk_bf16_f32 v136, v48, v49
    v_cvt_pk_bf16_f32 v137, v50, v51
    v_cvt_pk_bf16_f32 v138, v52, v53
    v_cvt_pk_bf16_f32 v139, v54, v55
    ds_write_b128 v188, v[136:139] offset:8192
    s_add_u32 m0, s54, 35904
    s_mov_b32 s50, 1589248
    buffer_load_dwordx4 v240, s[16:19], s50 offen lds
    ds_read_b128 v[32:35], v241 offset:640
    ds_read_b128 v[36:39], v241 offset:656
    ds_read_b128 v[40:43], v241 offset:2432
    ds_read_b128 v[44:47], v241 offset:2448
    v_lshlrev_b32 v56, 16, v140
    v_and_b32 v57, 0xffff0000, v140
    v_lshlrev_b32 v58, 16, v141
    v_and_b32 v59, 0xffff0000, v141
    v_lshlrev_b32 v60, 16, v142
    v_and_b32 v61, 0xffff0000, v142
    v_lshlrev_b32 v62, 16, v143
    v_and_b32 v63, 0xffff0000, v143
    s_waitcnt lgkmcnt(11)
    v_pk_fma_f32 v[56:57], v[56:57], v[8:9], v[0:1]
    v_pk_fma_f32 v[58:59], v[58:59], v[10:11], v[2:3]
    s_waitcnt lgkmcnt(10)
    v_pk_fma_f32 v[60:61], v[60:61], v[12:13], v[4:5]
    v_pk_fma_f32 v[62:63], v[62:63], v[14:15], v[6:7]
    v_cvt_pk_bf16_f32 v140, v56, v57
    v_cvt_pk_bf16_f32 v141, v58, v59
    v_cvt_pk_bf16_f32 v142, v60, v61
    v_cvt_pk_bf16_f32 v143, v62, v63
    ds_write_b128 v188, v[140:143] offset:12288
    s_add_u32 m0, s54, 36960
    s_mov_b32 s51, 1597440
    buffer_load_dwordx4 v240, s[16:19], s51 offen lds
    ds_read_b128 v[0:3], v241 offset:768
    ds_read_b128 v[4:7], v241 offset:784
    ds_read_b128 v[8:11], v241 offset:2560
    ds_read_b128 v[12:15], v241 offset:2576
    v_lshlrev_b32 v48, 16, v144
    v_and_b32 v49, 0xffff0000, v144
    v_lshlrev_b32 v50, 16, v145
    v_and_b32 v51, 0xffff0000, v145
    v_lshlrev_b32 v52, 16, v146
    v_and_b32 v53, 0xffff0000, v146
    v_lshlrev_b32 v54, 16, v147
    v_and_b32 v55, 0xffff0000, v147
    s_waitcnt lgkmcnt(11)
    v_pk_fma_f32 v[48:49], v[48:49], v[24:25], v[16:17]
    v_pk_fma_f32 v[50:51], v[50:51], v[26:27], v[18:19]
    s_waitcnt lgkmcnt(10)
    v_pk_fma_f32 v[52:53], v[52:53], v[28:29], v[20:21]
    v_pk_fma_f32 v[54:55], v[54:55], v[30:31], v[22:23]
    v_cvt_pk_bf16_f32 v144, v48, v49
    v_cvt_pk_bf16_f32 v145, v50, v51
    v_cvt_pk_bf16_f32 v146, v52, v53
    v_cvt_pk_bf16_f32 v147, v54, v55
    ds_write_b128 v188, v[144:147] offset:16384
    s_add_u32 m0, s48, 33792
    s_mov_b32 s50, 1605632
    buffer_load_dwordx4 v240, s[16:19], s50 offen lds
    ds_read_b128 v[16:19], v241 offset:896
    ds_read_b128 v[20:23], v241 offset:912
    ds_read_b128 v[24:27], v241 offset:2688
    ds_read_b128 v[28:31], v241 offset:2704
    v_lshlrev_b32 v56, 16, v148
    v_and_b32 v57, 0xffff0000, v148
    v_lshlrev_b32 v58, 16, v149
    v_and_b32 v59, 0xffff0000, v149
    v_lshlrev_b32 v60, 16, v150
    v_and_b32 v61, 0xffff0000, v150
    v_lshlrev_b32 v62, 16, v151
    v_and_b32 v63, 0xffff0000, v151
    s_waitcnt lgkmcnt(11)
    v_pk_fma_f32 v[56:57], v[56:57], v[40:41], v[32:33]
    v_pk_fma_f32 v[58:59], v[58:59], v[42:43], v[34:35]
    s_waitcnt lgkmcnt(10)
    v_pk_fma_f32 v[60:61], v[60:61], v[44:45], v[36:37]
    v_pk_fma_f32 v[62:63], v[62:63], v[46:47], v[38:39]
    v_cvt_pk_bf16_f32 v148, v56, v57
    v_cvt_pk_bf16_f32 v149, v58, v59
    v_cvt_pk_bf16_f32 v150, v60, v61
    v_cvt_pk_bf16_f32 v151, v62, v63
    ds_write_b128 v188, v[148:151] offset:20480
    s_add_u32 m0, s48, 34848
    s_mov_b32 s51, 1613824
    buffer_load_dwordx4 v240, s[16:19], s51 offen lds
    ds_read_b128 v[32:35], v241 offset:1024
    ds_read_b128 v[36:39], v241 offset:1040
    ds_read_b128 v[40:43], v241 offset:2816
    ds_read_b128 v[44:47], v241 offset:2832
    v_lshlrev_b32 v48, 16, v152
    v_and_b32 v49, 0xffff0000, v152
    v_lshlrev_b32 v50, 16, v153
    v_and_b32 v51, 0xffff0000, v153
    v_lshlrev_b32 v52, 16, v154
    v_and_b32 v53, 0xffff0000, v154
    v_lshlrev_b32 v54, 16, v155
    v_and_b32 v55, 0xffff0000, v155
    s_waitcnt lgkmcnt(11)
    v_pk_fma_f32 v[48:49], v[48:49], v[8:9], v[0:1]
    v_pk_fma_f32 v[50:51], v[50:51], v[10:11], v[2:3]
    s_waitcnt lgkmcnt(10)
    v_pk_fma_f32 v[52:53], v[52:53], v[12:13], v[4:5]
    v_pk_fma_f32 v[54:55], v[54:55], v[14:15], v[6:7]
    v_cvt_pk_bf16_f32 v152, v48, v49
    v_cvt_pk_bf16_f32 v153, v50, v51
    v_cvt_pk_bf16_f32 v154, v52, v53
    v_cvt_pk_bf16_f32 v155, v54, v55
    ds_write_b128 v188, v[152:155] offset:24576
    s_add_u32 m0, s48, 35904
    s_mov_b32 s50, 1622016
    buffer_load_dwordx4 v240, s[16:19], s50 offen lds
    ds_read_b128 v[0:3], v241 offset:1152
    ds_read_b128 v[4:7], v241 offset:1168
    ds_read_b128 v[8:11], v241 offset:2944
    ds_read_b128 v[12:15], v241 offset:2960
    v_lshlrev_b32 v56, 16, v156
    v_and_b32 v57, 0xffff0000, v156
    v_lshlrev_b32 v58, 16, v157
    v_and_b32 v59, 0xffff0000, v157
    v_lshlrev_b32 v60, 16, v158
    v_and_b32 v61, 0xffff0000, v158
    v_lshlrev_b32 v62, 16, v159
    v_and_b32 v63, 0xffff0000, v159
    s_waitcnt lgkmcnt(11)
    v_pk_fma_f32 v[56:57], v[56:57], v[24:25], v[16:17]
    v_pk_fma_f32 v[58:59], v[58:59], v[26:27], v[18:19]
    s_waitcnt lgkmcnt(10)
    v_pk_fma_f32 v[60:61], v[60:61], v[28:29], v[20:21]
    v_pk_fma_f32 v[62:63], v[62:63], v[30:31], v[22:23]
    v_cvt_pk_bf16_f32 v156, v56, v57
    v_cvt_pk_bf16_f32 v157, v58, v59
    v_cvt_pk_bf16_f32 v158, v60, v61
    v_cvt_pk_bf16_f32 v159, v62, v63
    ds_write_b128 v188, v[156:159] offset:28672
    s_add_u32 m0, s48, 36960
    s_mov_b32 s51, 1630208
    buffer_load_dwordx4 v240, s[16:19], s51 offen lds
    ds_read_b128 v[16:19], v241 offset:1280
    ds_read_b128 v[20:23], v241 offset:1296
    ds_read_b128 v[24:27], v241 offset:3072
    ds_read_b128 v[28:31], v241 offset:3088
    v_lshlrev_b32 v48, 16, v160
    v_and_b32 v49, 0xffff0000, v160
    v_lshlrev_b32 v50, 16, v161
    v_and_b32 v51, 0xffff0000, v161
    v_lshlrev_b32 v52, 16, v162
    v_and_b32 v53, 0xffff0000, v162
    v_lshlrev_b32 v54, 16, v163
    v_and_b32 v55, 0xffff0000, v163
    s_waitcnt lgkmcnt(11)
    v_pk_fma_f32 v[48:49], v[48:49], v[40:41], v[32:33]
    v_pk_fma_f32 v[50:51], v[50:51], v[42:43], v[34:35]
    s_waitcnt lgkmcnt(10)
    v_pk_fma_f32 v[52:53], v[52:53], v[44:45], v[36:37]
    v_pk_fma_f32 v[54:55], v[54:55], v[46:47], v[38:39]
    v_cvt_pk_bf16_f32 v160, v48, v49
    v_cvt_pk_bf16_f32 v161, v50, v51
    v_cvt_pk_bf16_f32 v162, v52, v53
    v_cvt_pk_bf16_f32 v163, v54, v55
    ds_write_b128 v188, v[160:163] offset:32768
    ds_read_b128 v[32:35], v241 offset:1408
    ds_read_b128 v[36:39], v241 offset:1424
    ds_read_b128 v[40:43], v241 offset:3200
    ds_read_b128 v[44:47], v241 offset:3216
    v_lshlrev_b32 v56, 16, v164
    v_and_b32 v57, 0xffff0000, v164
    v_lshlrev_b32 v58, 16, v165
    v_and_b32 v59, 0xffff0000, v165
    v_lshlrev_b32 v60, 16, v166
    v_and_b32 v61, 0xffff0000, v166
    v_lshlrev_b32 v62, 16, v167
    v_and_b32 v63, 0xffff0000, v167
    s_waitcnt lgkmcnt(11)
    v_pk_fma_f32 v[56:57], v[56:57], v[8:9], v[0:1]
    v_pk_fma_f32 v[58:59], v[58:59], v[10:11], v[2:3]
    s_waitcnt lgkmcnt(10)
    v_pk_fma_f32 v[60:61], v[60:61], v[12:13], v[4:5]
    v_pk_fma_f32 v[62:63], v[62:63], v[14:15], v[6:7]
    v_cvt_pk_bf16_f32 v164, v56, v57
    v_cvt_pk_bf16_f32 v165, v58, v59
    v_cvt_pk_bf16_f32 v166, v60, v61
    v_cvt_pk_bf16_f32 v167, v62, v63
    ds_write_b128 v188, v[164:167] offset:36864
    ds_read_b128 v[0:3], v241 offset:1536
    ds_read_b128 v[4:7], v241 offset:1552
    ds_read_b128 v[8:11], v241 offset:3328
    ds_read_b128 v[12:15], v241 offset:3344
    v_lshlrev_b32 v48, 16, v168
    v_and_b32 v49, 0xffff0000, v168
    v_lshlrev_b32 v50, 16, v169
    v_and_b32 v51, 0xffff0000, v169
    v_lshlrev_b32 v52, 16, v170
    v_and_b32 v53, 0xffff0000, v170
    v_lshlrev_b32 v54, 16, v171
    v_and_b32 v55, 0xffff0000, v171
    s_waitcnt lgkmcnt(11)
    v_pk_fma_f32 v[48:49], v[48:49], v[24:25], v[16:17]
    v_pk_fma_f32 v[50:51], v[50:51], v[26:27], v[18:19]
    s_waitcnt lgkmcnt(10)
    v_pk_fma_f32 v[52:53], v[52:53], v[28:29], v[20:21]
    v_pk_fma_f32 v[54:55], v[54:55], v[30:31], v[22:23]
    v_cvt_pk_bf16_f32 v168, v48, v49
    v_cvt_pk_bf16_f32 v169, v50, v51
    v_cvt_pk_bf16_f32 v170, v52, v53
    v_cvt_pk_bf16_f32 v171, v54, v55
    ds_write_b128 v188, v[168:171] offset:40960
    ds_read_b128 v[16:19], v241 offset:1664
    ds_read_b128 v[20:23], v241 offset:1680
    ds_read_b128 v[24:27], v241 offset:3456
    ds_read_b128 v[28:31], v241 offset:3472
    v_lshlrev_b32 v56, 16, v172
    v_and_b32 v57, 0xffff0000, v172
    v_lshlrev_b32 v58, 16, v173
    v_and_b32 v59, 0xffff0000, v173
    v_lshlrev_b32 v60, 16, v174
    v_and_b32 v61, 0xffff0000, v174
    v_lshlrev_b32 v62, 16, v175
    v_and_b32 v63, 0xffff0000, v175
    s_waitcnt lgkmcnt(11)
    v_pk_fma_f32 v[56:57], v[56:57], v[40:41], v[32:33]
    v_pk_fma_f32 v[58:59], v[58:59], v[42:43], v[34:35]
    s_waitcnt lgkmcnt(10)
    v_pk_fma_f32 v[60:61], v[60:61], v[44:45], v[36:37]
    v_pk_fma_f32 v[62:63], v[62:63], v[46:47], v[38:39]
    v_cvt_pk_bf16_f32 v172, v56, v57
    v_cvt_pk_bf16_f32 v173, v58, v59
    v_cvt_pk_bf16_f32 v174, v60, v61
    v_cvt_pk_bf16_f32 v175, v62, v63
    ds_write_b128 v188, v[172:175] offset:45056
    v_lshlrev_b32 v48, 16, v176
    v_and_b32 v49, 0xffff0000, v176
    v_lshlrev_b32 v50, 16, v177
    v_and_b32 v51, 0xffff0000, v177
    v_lshlrev_b32 v52, 16, v178
    v_and_b32 v53, 0xffff0000, v178
    v_lshlrev_b32 v54, 16, v179
    v_and_b32 v55, 0xffff0000, v179
    s_waitcnt lgkmcnt(7)
    v_pk_fma_f32 v[48:49], v[48:49], v[8:9], v[0:1]
    v_pk_fma_f32 v[50:51], v[50:51], v[10:11], v[2:3]
    s_waitcnt lgkmcnt(6)
    v_pk_fma_f32 v[52:53], v[52:53], v[12:13], v[4:5]
    v_pk_fma_f32 v[54:55], v[54:55], v[14:15], v[6:7]
    v_cvt_pk_bf16_f32 v176, v48, v49
    v_cvt_pk_bf16_f32 v177, v50, v51
    v_cvt_pk_bf16_f32 v178, v52, v53
    v_cvt_pk_bf16_f32 v179, v54, v55
    ds_write_b128 v188, v[176:179] offset:49152
    v_lshlrev_b32 v56, 16, v180
    v_and_b32 v57, 0xffff0000, v180
    v_lshlrev_b32 v58, 16, v181
    v_and_b32 v59, 0xffff0000, v181
    v_lshlrev_b32 v60, 16, v182
    v_and_b32 v61, 0xffff0000, v182
    v_lshlrev_b32 v62, 16, v183
    v_and_b32 v63, 0xffff0000, v183
    s_waitcnt lgkmcnt(3)
    v_pk_fma_f32 v[56:57], v[56:57], v[24:25], v[16:17]
    v_pk_fma_f32 v[58:59], v[58:59], v[26:27], v[18:19]
    s_waitcnt lgkmcnt(2)
    v_pk_fma_f32 v[60:61], v[60:61], v[28:29], v[20:21]
    v_pk_fma_f32 v[62:63], v[62:63], v[30:31], v[22:23]
    v_cvt_pk_bf16_f32 v180, v56, v57
    v_cvt_pk_bf16_f32 v181, v58, v59
    v_cvt_pk_bf16_f32 v182, v60, v61
    v_cvt_pk_bf16_f32 v183, v62, v63
    ds_write_b128 v188, v[180:183] offset:53248
    v_add_u32 v188, 101376, v247
    s_mov_b32 m0, 162816
    s_nop 0
    buffer_load_dwordx4 v247, s[8:11], s47 offen nt lds
    buffer_load_dwordx4 v247, s[12:15], s47 offen nt lds
    s_waitcnt lgkmcnt(0)
    s_barrier
    ds_read_b128 v[160:163], v188 offset:16384
    ds_read_b128 v[164:167], v188 offset:17408
    ds_read_b128 v[168:171], v188 offset:18432
    ds_read_b128 v[172:175], v188 offset:19456
    ds_read_b64_tr_b16 v[128:129], v186 offset:0
    ds_read_b64_tr_b16 v[130:131], v187 offset:0
    ds_read_b64_tr_b16 v[132:133], v186 offset:32
    ds_read_b64_tr_b16 v[134:135], v187 offset:32
    ds_read_b64_tr_b16 v[136:137], v186 offset:64
    ds_read_b64_tr_b16 v[138:139], v187 offset:64
    s_waitcnt lgkmcnt(2)
    v_mfma_f32_16x16x32_bf16 v[0:3], v[128:131], v[160:163], 0
    ds_read_b64_tr_b16 v[140:141], v186 offset:96
    ds_read_b64_tr_b16 v[142:143], v187 offset:96
    v_mfma_f32_16x16x32_bf16 v[4:7], v[128:131], v[164:167], 0
    ds_read_b64_tr_b16 v[144:145], v186 offset:128
    ds_read_b64_tr_b16 v[146:147], v187 offset:128
    v_mfma_f32_16x16x32_bf16 v[8:11], v[128:131], v[168:171], 0
    ds_read_b64_tr_b16 v[148:149], v186 offset:160
    ds_read_b64_tr_b16 v[150:151], v187 offset:160
    v_mfma_f32_16x16x32_bf16 v[12:15], v[128:131], v[172:175], 0
    ds_read_b64_tr_b16 v[152:153], v186 offset:192
    ds_read_b64_tr_b16 v[154:155], v187 offset:192
    v_mfma_f32_16x16x32_bf16 v[16:19], v[132:135], v[160:163], 0
    ds_read_b64_tr_b16 v[156:157], v186 offset:224
    ds_read_b64_tr_b16 v[158:159], v187 offset:224
    v_mfma_f32_16x16x32_bf16 v[20:23], v[132:135], v[164:167], 0
    ds_read_b128 v[192:195], v188 offset:0
    ds_read_b128 v[196:199], v188 offset:1024
    v_mfma_f32_16x16x32_bf16 v[24:27], v[132:135], v[168:171], 0
    ds_read_b128 v[200:203], v188 offset:2048
    ds_read_b128 v[204:207], v188 offset:3072
    v_mfma_f32_16x16x32_bf16 v[28:31], v[132:135], v[172:175], 0
    s_waitcnt lgkmcnt(12)
    v_mfma_f32_16x16x32_bf16 v[32:35], v[136:139], v[160:163], 0
    v_mfma_f32_16x16x32_bf16 v[36:39], v[136:139], v[164:167], 0
    v_mfma_f32_16x16x32_bf16 v[40:43], v[136:139], v[168:171], 0
    v_mfma_f32_16x16x32_bf16 v[44:47], v[136:139], v[172:175], 0
    v_mfma_f32_16x16x32_bf16 v[48:51], v[140:143], v[160:163], 0
    v_mfma_f32_16x16x32_bf16 v[52:55], v[140:143], v[164:167], 0
    v_mfma_f32_16x16x32_bf16 v[56:59], v[140:143], v[168:171], 0
    v_mfma_f32_16x16x32_bf16 v[60:63], v[140:143], v[172:175], 0
    s_waitcnt lgkmcnt(8)
    v_mfma_f32_16x16x32_bf16 v[64:67], v[144:147], v[160:163], 0
    v_mfma_f32_16x16x32_bf16 v[68:71], v[144:147], v[164:167], 0
    v_mfma_f32_16x16x32_bf16 v[72:75], v[144:147], v[168:171], 0
    v_mfma_f32_16x16x32_bf16 v[76:79], v[144:147], v[172:175], 0
    s_waitcnt lgkmcnt(0)
    s_barrier
    v_mfma_f32_16x16x32_bf16 v[80:83], v[148:151], v[160:163], 0
    s_add_u32 m0, s54, 67584
    s_mov_b32 s50, 1835008
    v_mfma_f32_16x16x32_bf16 v[84:87], v[148:151], v[164:167], 0
    buffer_load_dwordx4 v240, s[16:19], s50 offen lds
    v_mfma_f32_16x16x32_bf16 v[88:91], v[148:151], v[168:171], 0
    s_add_u32 m0, s54, 68640
    s_mov_b32 s51, 1843200
    v_mfma_f32_16x16x32_bf16 v[92:95], v[148:151], v[172:175], 0
    buffer_load_dwordx4 v240, s[16:19], s51 offen lds
    v_mfma_f32_16x16x32_bf16 v[96:99], v[152:155], v[160:163], 0
    s_add_u32 m0, s54, 69696
    s_mov_b32 s50, 1851392
    v_mfma_f32_16x16x32_bf16 v[100:103], v[152:155], v[164:167], 0
    buffer_load_dwordx4 v240, s[16:19], s50 offen lds
    v_mfma_f32_16x16x32_bf16 v[104:107], v[152:155], v[168:171], 0
    s_add_u32 m0, s54, 70752
    s_mov_b32 s51, 1859584
    v_mfma_f32_16x16x32_bf16 v[108:111], v[152:155], v[172:175], 0
    buffer_load_dwordx4 v240, s[16:19], s51 offen lds
    v_mfma_f32_16x16x32_bf16 v[112:115], v[156:159], v[160:163], 0
    s_add_u32 m0, s48, 67584
    s_mov_b32 s50, 1867776
    v_mfma_f32_16x16x32_bf16 v[116:119], v[156:159], v[164:167], 0
    buffer_load_dwordx4 v240, s[16:19], s50 offen lds
    v_mfma_f32_16x16x32_bf16 v[120:123], v[156:159], v[168:171], 0
    v_mfma_f32_16x16x32_bf16 v[124:127], v[156:159], v[172:175], 0
    v_mfma_f32_16x16x32_bf16 v[0:3], a[0:3], v[192:195], v[0:3]
    s_add_u32 m0, s48, 68640
    s_mov_b32 s51, 1875968
    v_mfma_f32_16x16x32_bf16 v[4:7], a[0:3], v[196:199], v[4:7]
    buffer_load_dwordx4 v240, s[16:19], s51 offen lds
    v_mfma_f32_16x16x32_bf16 v[8:11], a[0:3], v[200:203], v[8:11]
    s_add_u32 m0, s48, 69696
    s_mov_b32 s50, 1884160
    v_mfma_f32_16x16x32_bf16 v[12:15], a[0:3], v[204:207], v[12:15]
    buffer_load_dwordx4 v240, s[16:19], s50 offen lds
    v_mfma_f32_16x16x32_bf16 v[16:19], a[4:7], v[192:195], v[16:19]
    v_mfma_f32_16x16x32_bf16 v[20:23], a[4:7], v[196:199], v[20:23]
    ds_read_b128 v[160:163], v188 offset:20480
    ds_read_b128 v[164:167], v188 offset:21504
    v_mfma_f32_16x16x32_bf16 v[24:27], a[4:7], v[200:203], v[24:27]
    ds_read_b128 v[168:171], v188 offset:22528
    ds_read_b128 v[172:175], v188 offset:23552
    v_mfma_f32_16x16x32_bf16 v[28:31], a[4:7], v[204:207], v[28:31]
    s_add_u32 m0, s48, 70752
    s_mov_b32 s51, 1892352
    v_mfma_f32_16x16x32_bf16 v[32:35], a[8:11], v[192:195], v[32:35]
    buffer_load_dwordx4 v240, s[16:19], s51 offen lds
    v_mfma_f32_16x16x32_bf16 v[36:39], a[8:11], v[196:199], v[36:39]
    v_mfma_f32_16x16x32_bf16 v[40:43], a[8:11], v[200:203], v[40:43]
    v_mfma_f32_16x16x32_bf16 v[44:47], a[8:11], v[204:207], v[44:47]
    v_mfma_f32_16x16x32_bf16 v[48:51], a[12:15], v[192:195], v[48:51]
    v_mfma_f32_16x16x32_bf16 v[52:55], a[12:15], v[196:199], v[52:55]
    v_mfma_f32_16x16x32_bf16 v[56:59], a[12:15], v[200:203], v[56:59]
    v_mfma_f32_16x16x32_bf16 v[60:63], a[12:15], v[204:207], v[60:63]
    v_mfma_f32_16x16x32_bf16 v[64:67], a[16:19], v[192:195], v[64:67]
    v_mfma_f32_16x16x32_bf16 v[68:71], a[16:19], v[196:199], v[68:71]
    v_mfma_f32_16x16x32_bf16 v[72:75], a[16:19], v[200:203], v[72:75]
    v_mfma_f32_16x16x32_bf16 v[76:79], a[16:19], v[204:207], v[76:79]
    s_waitcnt lgkmcnt(0)
    s_barrier
    v_mfma_f32_16x16x32_bf16 v[80:83], a[20:23], v[192:195], v[80:83]
    ds_read_b64_tr_b16 v[128:129], v184 offset:0
    ds_read_b64_tr_b16 v[130:131], v185 offset:0
    v_mfma_f32_16x16x32_bf16 v[84:87], a[20:23], v[196:199], v[84:87]
    ds_read_b64_tr_b16 v[132:133], v184 offset:32
    ds_read_b64_tr_b16 v[134:135], v185 offset:32
    v_mfma_f32_16x16x32_bf16 v[88:91], a[20:23], v[200:203], v[88:91]
    ds_read_b64_tr_b16 v[136:137], v184 offset:64
    ds_read_b64_tr_b16 v[138:139], v185 offset:64
    v_mfma_f32_16x16x32_bf16 v[92:95], a[20:23], v[204:207], v[92:95]
    v_mfma_f32_16x16x32_bf16 v[96:99], a[24:27], v[192:195], v[96:99]
    v_mfma_f32_16x16x32_bf16 v[100:103], a[24:27], v[196:199], v[100:103]
    v_mfma_f32_16x16x32_bf16 v[104:107], a[24:27], v[200:203], v[104:107]
    v_mfma_f32_16x16x32_bf16 v[108:111], a[24:27], v[204:207], v[108:111]
    v_mfma_f32_16x16x32_bf16 v[112:115], a[28:31], v[192:195], v[112:115]
    v_mfma_f32_16x16x32_bf16 v[116:119], a[28:31], v[196:199], v[116:119]
    v_mfma_f32_16x16x32_bf16 v[120:123], a[28:31], v[200:203], v[120:123]
    v_mfma_f32_16x16x32_bf16 v[124:127], a[28:31], v[204:207], v[124:127]
    s_waitcnt lgkmcnt(2)
    v_mfma_f32_16x16x32_bf16 v[0:3], v[128:131], v[160:163], v[0:3]
    ds_read_b64_tr_b16 v[140:141], v184 offset:96
    ds_read_b64_tr_b16 v[142:143], v185 offset:96
    v_mfma_f32_16x16x32_bf16 v[4:7], v[128:131], v[164:167], v[4:7]
    ds_read_b64_tr_b16 v[144:145], v184 offset:128
    ds_read_b64_tr_b16 v[146:147], v185 offset:128
    v_mfma_f32_16x16x32_bf16 v[8:11], v[128:131], v[168:171], v[8:11]
    ds_read_b64_tr_b16 v[148:149], v184 offset:160
    ds_read_b64_tr_b16 v[150:151], v185 offset:160
    v_mfma_f32_16x16x32_bf16 v[12:15], v[128:131], v[172:175], v[12:15]
    ds_read_b64_tr_b16 v[152:153], v184 offset:192
    ds_read_b64_tr_b16 v[154:155], v185 offset:192
    v_mfma_f32_16x16x32_bf16 v[16:19], v[132:135], v[160:163], v[16:19]
    ds_read_b64_tr_b16 v[156:157], v184 offset:224
    ds_read_b64_tr_b16 v[158:159], v185 offset:224
    v_mfma_f32_16x16x32_bf16 v[20:23], v[132:135], v[164:167], v[20:23]
    ds_read_b128 v[192:195], v188 offset:4096
    ds_read_b128 v[196:199], v188 offset:5120
    v_mfma_f32_16x16x32_bf16 v[24:27], v[132:135], v[168:171], v[24:27]
    ds_read_b128 v[200:203], v188 offset:6144
    ds_read_b128 v[204:207], v188 offset:7168
    v_mfma_f32_16x16x32_bf16 v[28:31], v[132:135], v[172:175], v[28:31]
    s_waitcnt lgkmcnt(12)
    v_mfma_f32_16x16x32_bf16 v[32:35], v[136:139], v[160:163], v[32:35]
    v_mfma_f32_16x16x32_bf16 v[36:39], v[136:139], v[164:167], v[36:39]
    v_mfma_f32_16x16x32_bf16 v[40:43], v[136:139], v[168:171], v[40:43]
    v_mfma_f32_16x16x32_bf16 v[44:47], v[136:139], v[172:175], v[44:47]
    v_mfma_f32_16x16x32_bf16 v[48:51], v[140:143], v[160:163], v[48:51]
    v_mfma_f32_16x16x32_bf16 v[52:55], v[140:143], v[164:167], v[52:55]
    v_mfma_f32_16x16x32_bf16 v[56:59], v[140:143], v[168:171], v[56:59]
    v_mfma_f32_16x16x32_bf16 v[60:63], v[140:143], v[172:175], v[60:63]
    s_waitcnt lgkmcnt(8)
    v_mfma_f32_16x16x32_bf16 v[64:67], v[144:147], v[160:163], v[64:67]
    v_mfma_f32_16x16x32_bf16 v[68:71], v[144:147], v[164:167], v[68:71]
    v_mfma_f32_16x16x32_bf16 v[72:75], v[144:147], v[168:171], v[72:75]
    v_mfma_f32_16x16x32_bf16 v[76:79], v[144:147], v[172:175], v[76:79]
    s_waitcnt lgkmcnt(0)
    s_barrier
    v_mfma_f32_16x16x32_bf16 v[80:83], v[148:151], v[160:163], v[80:83]
    s_add_u32 m0, s54, 0
    s_mov_b32 s50, 2097152
    v_mfma_f32_16x16x32_bf16 v[84:87], v[148:151], v[164:167], v[84:87]
    buffer_load_dwordx4 v240, s[16:19], s50 offen lds
    v_mfma_f32_16x16x32_bf16 v[88:91], v[148:151], v[168:171], v[88:91]
    s_add_u32 m0, s54, 1056
    s_mov_b32 s51, 2105344
    v_mfma_f32_16x16x32_bf16 v[92:95], v[148:151], v[172:175], v[92:95]
    buffer_load_dwordx4 v240, s[16:19], s51 offen lds
    v_mfma_f32_16x16x32_bf16 v[96:99], v[152:155], v[160:163], v[96:99]
    s_add_u32 m0, s54, 2112
    s_mov_b32 s50, 2113536
    v_mfma_f32_16x16x32_bf16 v[100:103], v[152:155], v[164:167], v[100:103]
    buffer_load_dwordx4 v240, s[16:19], s50 offen lds
    v_mfma_f32_16x16x32_bf16 v[104:107], v[152:155], v[168:171], v[104:107]
    s_add_u32 m0, s54, 3168
    s_mov_b32 s51, 2121728
    v_mfma_f32_16x16x32_bf16 v[108:111], v[152:155], v[172:175], v[108:111]
    buffer_load_dwordx4 v240, s[16:19], s51 offen lds
    v_mfma_f32_16x16x32_bf16 v[112:115], v[156:159], v[160:163], v[112:115]
    s_add_u32 m0, s48, 0
    s_mov_b32 s50, 2129920
    v_mfma_f32_16x16x32_bf16 v[116:119], v[156:159], v[164:167], v[116:119]
    buffer_load_dwordx4 v240, s[16:19], s50 offen lds
    v_mfma_f32_16x16x32_bf16 v[120:123], v[156:159], v[168:171], v[120:123]
    v_mfma_f32_16x16x32_bf16 v[124:127], v[156:159], v[172:175], v[124:127]
    v_mfma_f32_16x16x32_bf16 v[0:3], a[32:35], v[192:195], v[0:3]
    s_add_u32 m0, s48, 1056
    s_mov_b32 s51, 2138112
    v_mfma_f32_16x16x32_bf16 v[4:7], a[32:35], v[196:199], v[4:7]
    buffer_load_dwordx4 v240, s[16:19], s51 offen lds
    v_mfma_f32_16x16x32_bf16 v[8:11], a[32:35], v[200:203], v[8:11]
    s_add_u32 m0, s48, 2112
    s_mov_b32 s50, 2146304
    v_mfma_f32_16x16x32_bf16 v[12:15], a[32:35], v[204:207], v[12:15]
    buffer_load_dwordx4 v240, s[16:19], s50 offen lds
    v_mfma_f32_16x16x32_bf16 v[16:19], a[36:39], v[192:195], v[16:19]
    v_mfma_f32_16x16x32_bf16 v[20:23], a[36:39], v[196:199], v[20:23]
    ds_read_b128 v[160:163], v188 offset:24576
    ds_read_b128 v[164:167], v188 offset:25600
    v_mfma_f32_16x16x32_bf16 v[24:27], a[36:39], v[200:203], v[24:27]
    ds_read_b128 v[168:171], v188 offset:26624
    ds_read_b128 v[172:175], v188 offset:27648
    v_mfma_f32_16x16x32_bf16 v[28:31], a[36:39], v[204:207], v[28:31]
    s_add_u32 m0, s48, 3168
    s_mov_b32 s51, 2154496
    v_mfma_f32_16x16x32_bf16 v[32:35], a[40:43], v[192:195], v[32:35]
    buffer_load_dwordx4 v240, s[16:19], s51 offen lds
    v_mfma_f32_16x16x32_bf16 v[36:39], a[40:43], v[196:199], v[36:39]
    v_mfma_f32_16x16x32_bf16 v[40:43], a[40:43], v[200:203], v[40:43]
    v_mfma_f32_16x16x32_bf16 v[44:47], a[40:43], v[204:207], v[44:47]
    v_mfma_f32_16x16x32_bf16 v[48:51], a[44:47], v[192:195], v[48:51]
    v_mfma_f32_16x16x32_bf16 v[52:55], a[44:47], v[196:199], v[52:55]
    v_mfma_f32_16x16x32_bf16 v[56:59], a[44:47], v[200:203], v[56:59]
    v_mfma_f32_16x16x32_bf16 v[60:63], a[44:47], v[204:207], v[60:63]
    v_mfma_f32_16x16x32_bf16 v[64:67], a[48:51], v[192:195], v[64:67]
    v_mfma_f32_16x16x32_bf16 v[68:71], a[48:51], v[196:199], v[68:71]
    v_mfma_f32_16x16x32_bf16 v[72:75], a[48:51], v[200:203], v[72:75]
    v_mfma_f32_16x16x32_bf16 v[76:79], a[48:51], v[204:207], v[76:79]
    s_waitcnt vmcnt(18) lgkmcnt(0)
    s_barrier
    v_mfma_f32_16x16x32_bf16 v[80:83], a[52:55], v[192:195], v[80:83]
    ds_read_b64_tr_b16 v[128:129], v184 offset:33792
    ds_read_b64_tr_b16 v[130:131], v185 offset:33792
    v_mfma_f32_16x16x32_bf16 v[84:87], a[52:55], v[196:199], v[84:87]
    ds_read_b64_tr_b16 v[132:133], v184 offset:33824
    ds_read_b64_tr_b16 v[134:135], v185 offset:33824
    v_mfma_f32_16x16x32_bf16 v[88:91], a[52:55], v[200:203], v[88:91]
    ds_read_b64_tr_b16 v[136:137], v184 offset:33856
    ds_read_b64_tr_b16 v[138:139], v185 offset:33856
    v_mfma_f32_16x16x32_bf16 v[92:95], a[52:55], v[204:207], v[92:95]
    v_mfma_f32_16x16x32_bf16 v[96:99], a[56:59], v[192:195], v[96:99]
    v_mfma_f32_16x16x32_bf16 v[100:103], a[56:59], v[196:199], v[100:103]
    v_mfma_f32_16x16x32_bf16 v[104:107], a[56:59], v[200:203], v[104:107]
    v_mfma_f32_16x16x32_bf16 v[108:111], a[56:59], v[204:207], v[108:111]
    v_mfma_f32_16x16x32_bf16 v[112:115], a[60:63], v[192:195], v[112:115]
    v_mfma_f32_16x16x32_bf16 v[116:119], a[60:63], v[196:199], v[116:119]
    v_mfma_f32_16x16x32_bf16 v[120:123], a[60:63], v[200:203], v[120:123]
    v_mfma_f32_16x16x32_bf16 v[124:127], a[60:63], v[204:207], v[124:127]
    s_waitcnt lgkmcnt(2)
    v_mfma_f32_16x16x32_bf16 v[0:3], v[128:131], v[160:163], v[0:3]
    ds_read_b64_tr_b16 v[140:141], v184 offset:33888
    ds_read_b64_tr_b16 v[142:143], v185 offset:33888
    v_mfma_f32_16x16x32_bf16 v[4:7], v[128:131], v[164:167], v[4:7]
    ds_read_b64_tr_b16 v[144:145], v184 offset:33920
    ds_read_b64_tr_b16 v[146:147], v185 offset:33920
    v_mfma_f32_16x16x32_bf16 v[8:11], v[128:131], v[168:171], v[8:11]
    ds_read_b64_tr_b16 v[148:149], v184 offset:33952
    ds_read_b64_tr_b16 v[150:151], v185 offset:33952
    v_mfma_f32_16x16x32_bf16 v[12:15], v[128:131], v[172:175], v[12:15]
    ds_read_b64_tr_b16 v[152:153], v184 offset:33984
    ds_read_b64_tr_b16 v[154:155], v185 offset:33984
    v_mfma_f32_16x16x32_bf16 v[16:19], v[132:135], v[160:163], v[16:19]
    ds_read_b64_tr_b16 v[156:157], v184 offset:34016
    ds_read_b64_tr_b16 v[158:159], v185 offset:34016
    v_mfma_f32_16x16x32_bf16 v[20:23], v[132:135], v[164:167], v[20:23]
    ds_read_b128 v[192:195], v188 offset:8192
    ds_read_b128 v[196:199], v188 offset:9216
    v_mfma_f32_16x16x32_bf16 v[24:27], v[132:135], v[168:171], v[24:27]
    ds_read_b128 v[200:203], v188 offset:10240
    ds_read_b128 v[204:207], v188 offset:11264
    v_mfma_f32_16x16x32_bf16 v[28:31], v[132:135], v[172:175], v[28:31]
    s_waitcnt lgkmcnt(12)
    v_mfma_f32_16x16x32_bf16 v[32:35], v[136:139], v[160:163], v[32:35]
    v_mfma_f32_16x16x32_bf16 v[36:39], v[136:139], v[164:167], v[36:39]
    v_mfma_f32_16x16x32_bf16 v[40:43], v[136:139], v[168:171], v[40:43]
    v_mfma_f32_16x16x32_bf16 v[44:47], v[136:139], v[172:175], v[44:47]
    v_mfma_f32_16x16x32_bf16 v[48:51], v[140:143], v[160:163], v[48:51]
    v_mfma_f32_16x16x32_bf16 v[52:55], v[140:143], v[164:167], v[52:55]
    v_mfma_f32_16x16x32_bf16 v[56:59], v[140:143], v[168:171], v[56:59]
    v_mfma_f32_16x16x32_bf16 v[60:63], v[140:143], v[172:175], v[60:63]
    s_waitcnt lgkmcnt(8)
    v_mfma_f32_16x16x32_bf16 v[64:67], v[144:147], v[160:163], v[64:67]
    v_mfma_f32_16x16x32_bf16 v[68:71], v[144:147], v[164:167], v[68:71]
    v_mfma_f32_16x16x32_bf16 v[72:75], v[144:147], v[168:171], v[72:75]
    v_mfma_f32_16x16x32_bf16 v[76:79], v[144:147], v[172:175], v[76:79]
    s_waitcnt lgkmcnt(0)
    s_barrier
    v_mfma_f32_16x16x32_bf16 v[80:83], v[148:151], v[160:163], v[80:83]
    s_add_u32 m0, s54, 33792
    s_mov_b32 s50, 2359296
    v_mfma_f32_16x16x32_bf16 v[84:87], v[148:151], v[164:167], v[84:87]
    buffer_load_dwordx4 v240, s[16:19], s50 offen lds
    v_mfma_f32_16x16x32_bf16 v[88:91], v[148:151], v[168:171], v[88:91]
    s_add_u32 m0, s54, 34848
    s_mov_b32 s51, 2367488
    v_mfma_f32_16x16x32_bf16 v[92:95], v[148:151], v[172:175], v[92:95]
    buffer_load_dwordx4 v240, s[16:19], s51 offen lds
    v_mfma_f32_16x16x32_bf16 v[96:99], v[152:155], v[160:163], v[96:99]
    s_add_u32 m0, s54, 35904
    s_mov_b32 s50, 2375680
    v_mfma_f32_16x16x32_bf16 v[100:103], v[152:155], v[164:167], v[100:103]
    buffer_load_dwordx4 v240, s[16:19], s50 offen lds
    v_mfma_f32_16x16x32_bf16 v[104:107], v[152:155], v[168:171], v[104:107]
    s_add_u32 m0, s54, 36960
    s_mov_b32 s51, 2383872
    v_mfma_f32_16x16x32_bf16 v[108:111], v[152:155], v[172:175], v[108:111]
    buffer_load_dwordx4 v240, s[16:19], s51 offen lds
    v_mfma_f32_16x16x32_bf16 v[112:115], v[156:159], v[160:163], v[112:115]
    s_add_u32 m0, s48, 33792
    s_mov_b32 s50, 2392064
    v_mfma_f32_16x16x32_bf16 v[116:119], v[156:159], v[164:167], v[116:119]
    buffer_load_dwordx4 v240, s[16:19], s50 offen lds
    v_mfma_f32_16x16x32_bf16 v[120:123], v[156:159], v[168:171], v[120:123]
    v_mfma_f32_16x16x32_bf16 v[124:127], v[156:159], v[172:175], v[124:127]
    v_mfma_f32_16x16x32_bf16 v[0:3], a[64:67], v[192:195], v[0:3]
    s_add_u32 m0, s48, 34848
    s_mov_b32 s51, 2400256
    v_mfma_f32_16x16x32_bf16 v[4:7], a[64:67], v[196:199], v[4:7]
    buffer_load_dwordx4 v240, s[16:19], s51 offen lds
    v_mfma_f32_16x16x32_bf16 v[8:11], a[64:67], v[200:203], v[8:11]
    s_add_u32 m0, s48, 35904
    s_mov_b32 s50, 2408448
    v_mfma_f32_16x16x32_bf16 v[12:15], a[64:67], v[204:207], v[12:15]
    buffer_load_dwordx4 v240, s[16:19], s50 offen lds
    v_mfma_f32_16x16x32_bf16 v[16:19], a[68:71], v[192:195], v[16:19]
    v_mfma_f32_16x16x32_bf16 v[20:23], a[68:71], v[196:199], v[20:23]
    ds_read_b128 v[160:163], v188 offset:28672
    ds_read_b128 v[164:167], v188 offset:29696
    v_mfma_f32_16x16x32_bf16 v[24:27], a[68:71], v[200:203], v[24:27]
    ds_read_b128 v[168:171], v188 offset:30720
    ds_read_b128 v[172:175], v188 offset:31744
    v_mfma_f32_16x16x32_bf16 v[28:31], a[68:71], v[204:207], v[28:31]
    s_add_u32 m0, s48, 36960
    s_mov_b32 s51, 2416640
    v_mfma_f32_16x16x32_bf16 v[32:35], a[72:75], v[192:195], v[32:35]
    buffer_load_dwordx4 v240, s[16:19], s51 offen lds
    v_mfma_f32_16x16x32_bf16 v[36:39], a[72:75], v[196:199], v[36:39]
    v_mfma_f32_16x16x32_bf16 v[40:43], a[72:75], v[200:203], v[40:43]
    v_mfma_f32_16x16x32_bf16 v[44:47], a[72:75], v[204:207], v[44:47]
    v_mfma_f32_16x16x32_bf16 v[48:51], a[76:79], v[192:195], v[48:51]
    v_mfma_f32_16x16x32_bf16 v[52:55], a[76:79], v[196:199], v[52:55]
    v_mfma_f32_16x16x32_bf16 v[56:59], a[76:79], v[200:203], v[56:59]
    v_mfma_f32_16x16x32_bf16 v[60:63], a[76:79], v[204:207], v[60:63]
    v_mfma_f32_16x16x32_bf16 v[64:67], a[80:83], v[192:195], v[64:67]
    v_mfma_f32_16x16x32_bf16 v[68:71], a[80:83], v[196:199], v[68:71]
    v_mfma_f32_16x16x32_bf16 v[72:75], a[80:83], v[200:203], v[72:75]
    v_mfma_f32_16x16x32_bf16 v[76:79], a[80:83], v[204:207], v[76:79]
    s_waitcnt vmcnt(16) lgkmcnt(0)
    s_barrier
    v_mfma_f32_16x16x32_bf16 v[80:83], a[84:87], v[192:195], v[80:83]
    ds_read_b64_tr_b16 v[128:129], v186 offset:0
    ds_read_b64_tr_b16 v[130:131], v187 offset:0
    v_mfma_f32_16x16x32_bf16 v[84:87], a[84:87], v[196:199], v[84:87]
    ds_read_b64_tr_b16 v[132:133], v186 offset:32
    ds_read_b64_tr_b16 v[134:135], v187 offset:32
    v_mfma_f32_16x16x32_bf16 v[88:91], a[84:87], v[200:203], v[88:91]
    ds_read_b64_tr_b16 v[136:137], v186 offset:64
    ds_read_b64_tr_b16 v[138:139], v187 offset:64
    v_mfma_f32_16x16x32_bf16 v[92:95], a[84:87], v[204:207], v[92:95]
    v_mfma_f32_16x16x32_bf16 v[96:99], a[88:91], v[192:195], v[96:99]
    v_mfma_f32_16x16x32_bf16 v[100:103], a[88:91], v[196:199], v[100:103]
    v_mfma_f32_16x16x32_bf16 v[104:107], a[88:91], v[200:203], v[104:107]
    v_mfma_f32_16x16x32_bf16 v[108:111], a[88:91], v[204:207], v[108:111]
    v_mfma_f32_16x16x32_bf16 v[112:115], a[92:95], v[192:195], v[112:115]
    v_mfma_f32_16x16x32_bf16 v[116:119], a[92:95], v[196:199], v[116:119]
    v_mfma_f32_16x16x32_bf16 v[120:123], a[92:95], v[200:203], v[120:123]
    v_mfma_f32_16x16x32_bf16 v[124:127], a[92:95], v[204:207], v[124:127]
    s_waitcnt lgkmcnt(2)
    v_mfma_f32_16x16x32_bf16 v[0:3], v[128:131], v[160:163], v[0:3]
    ds_read_b64_tr_b16 v[140:141], v186 offset:96
    ds_read_b64_tr_b16 v[142:143], v187 offset:96
    v_mfma_f32_16x16x32_bf16 v[4:7], v[128:131], v[164:167], v[4:7]
    ds_read_b64_tr_b16 v[144:145], v186 offset:128
    ds_read_b64_tr_b16 v[146:147], v187 offset:128
    v_mfma_f32_16x16x32_bf16 v[8:11], v[128:131], v[168:171], v[8:11]
    ds_read_b64_tr_b16 v[148:149], v186 offset:160
    ds_read_b64_tr_b16 v[150:151], v187 offset:160
    v_mfma_f32_16x16x32_bf16 v[12:15], v[128:131], v[172:175], v[12:15]
    ds_read_b64_tr_b16 v[152:153], v186 offset:192
    ds_read_b64_tr_b16 v[154:155], v187 offset:192
    v_mfma_f32_16x16x32_bf16 v[16:19], v[132:135], v[160:163], v[16:19]
    ds_read_b64_tr_b16 v[156:157], v186 offset:224
    ds_read_b64_tr_b16 v[158:159], v187 offset:224
    v_mfma_f32_16x16x32_bf16 v[20:23], v[132:135], v[164:167], v[20:23]
    ds_read_b128 v[192:195], v188 offset:12288
    ds_read_b128 v[196:199], v188 offset:13312
    v_mfma_f32_16x16x32_bf16 v[24:27], v[132:135], v[168:171], v[24:27]
    ds_read_b128 v[200:203], v188 offset:14336
    ds_read_b128 v[204:207], v188 offset:15360
    v_mfma_f32_16x16x32_bf16 v[28:31], v[132:135], v[172:175], v[28:31]
    s_waitcnt lgkmcnt(12)
    v_mfma_f32_16x16x32_bf16 v[32:35], v[136:139], v[160:163], v[32:35]
    v_mfma_f32_16x16x32_bf16 v[36:39], v[136:139], v[164:167], v[36:39]
    v_mfma_f32_16x16x32_bf16 v[40:43], v[136:139], v[168:171], v[40:43]
    v_mfma_f32_16x16x32_bf16 v[44:47], v[136:139], v[172:175], v[44:47]
    v_mfma_f32_16x16x32_bf16 v[48:51], v[140:143], v[160:163], v[48:51]
    v_mfma_f32_16x16x32_bf16 v[52:55], v[140:143], v[164:167], v[52:55]
    v_mfma_f32_16x16x32_bf16 v[56:59], v[140:143], v[168:171], v[56:59]
    v_mfma_f32_16x16x32_bf16 v[60:63], v[140:143], v[172:175], v[60:63]
    s_waitcnt lgkmcnt(8)
    v_mfma_f32_16x16x32_bf16 v[64:67], v[144:147], v[160:163], v[64:67]
    v_mfma_f32_16x16x32_bf16 v[68:71], v[144:147], v[164:167], v[68:71]
    v_mfma_f32_16x16x32_bf16 v[72:75], v[144:147], v[168:171], v[72:75]
    v_mfma_f32_16x16x32_bf16 v[76:79], v[144:147], v[172:175], v[76:79]
    s_waitcnt lgkmcnt(0)
    s_barrier
    v_mfma_f32_16x16x32_bf16 v[80:83], v[148:151], v[160:163], v[80:83]
    s_add_u32 m0, s54, 67584
    s_mov_b32 s50, 2621440
    v_mfma_f32_16x16x32_bf16 v[84:87], v[148:151], v[164:167], v[84:87]
    buffer_load_dwordx4 v240, s[16:19], s50 offen lds
    v_mfma_f32_16x16x32_bf16 v[88:91], v[148:151], v[168:171], v[88:91]
    s_add_u32 m0, s54, 68640
    s_mov_b32 s51, 2629632
    v_mfma_f32_16x16x32_bf16 v[92:95], v[148:151], v[172:175], v[92:95]
    buffer_load_dwordx4 v240, s[16:19], s51 offen lds
    v_mfma_f32_16x16x32_bf16 v[96:99], v[152:155], v[160:163], v[96:99]
    s_add_u32 m0, s54, 69696
    s_mov_b32 s50, 2637824
    v_mfma_f32_16x16x32_bf16 v[100:103], v[152:155], v[164:167], v[100:103]
    buffer_load_dwordx4 v240, s[16:19], s50 offen lds
    v_mfma_f32_16x16x32_bf16 v[104:107], v[152:155], v[168:171], v[104:107]
    s_add_u32 m0, s54, 70752
    s_mov_b32 s51, 2646016
    v_mfma_f32_16x16x32_bf16 v[108:111], v[152:155], v[172:175], v[108:111]
    buffer_load_dwordx4 v240, s[16:19], s51 offen lds
    v_mfma_f32_16x16x32_bf16 v[112:115], v[156:159], v[160:163], v[112:115]
    s_add_u32 m0, s48, 67584
    s_mov_b32 s50, 2654208
    v_mfma_f32_16x16x32_bf16 v[116:119], v[156:159], v[164:167], v[116:119]
    buffer_load_dwordx4 v240, s[16:19], s50 offen lds
    v_mfma_f32_16x16x32_bf16 v[120:123], v[156:159], v[168:171], v[120:123]
    v_mfma_f32_16x16x32_bf16 v[124:127], v[156:159], v[172:175], v[124:127]
    v_mfma_f32_16x16x32_bf16 v[0:3], a[96:99], v[192:195], v[0:3]
    s_add_u32 m0, s48, 68640
    s_mov_b32 s51, 2662400
    v_mfma_f32_16x16x32_bf16 v[4:7], a[96:99], v[196:199], v[4:7]
    buffer_load_dwordx4 v240, s[16:19], s51 offen lds
    v_mfma_f32_16x16x32_bf16 v[8:11], a[96:99], v[200:203], v[8:11]
    s_add_u32 m0, s48, 69696
    s_mov_b32 s50, 2670592
    v_mfma_f32_16x16x32_bf16 v[12:15], a[96:99], v[204:207], v[12:15]
    buffer_load_dwordx4 v240, s[16:19], s50 offen lds
    v_mfma_f32_16x16x32_bf16 v[16:19], a[100:103], v[192:195], v[16:19]
    v_mfma_f32_16x16x32_bf16 v[20:23], a[100:103], v[196:199], v[20:23]
    ds_read_b128 v[160:163], v188 offset:32768
    ds_read_b128 v[164:167], v188 offset:33792
    v_mfma_f32_16x16x32_bf16 v[24:27], a[100:103], v[200:203], v[24:27]
    ds_read_b128 v[168:171], v188 offset:34816
    ds_read_b128 v[172:175], v188 offset:35840
    v_mfma_f32_16x16x32_bf16 v[28:31], a[100:103], v[204:207], v[28:31]
    s_add_u32 m0, s48, 70752
    s_mov_b32 s51, 2678784
    v_mfma_f32_16x16x32_bf16 v[32:35], a[104:107], v[192:195], v[32:35]
    buffer_load_dwordx4 v240, s[16:19], s51 offen lds
    v_mfma_f32_16x16x32_bf16 v[36:39], a[104:107], v[196:199], v[36:39]
    v_mfma_f32_16x16x32_bf16 v[40:43], a[104:107], v[200:203], v[40:43]
    v_mfma_f32_16x16x32_bf16 v[44:47], a[104:107], v[204:207], v[44:47]
    v_mfma_f32_16x16x32_bf16 v[48:51], a[108:111], v[192:195], v[48:51]
    v_mfma_f32_16x16x32_bf16 v[52:55], a[108:111], v[196:199], v[52:55]
    v_mfma_f32_16x16x32_bf16 v[56:59], a[108:111], v[200:203], v[56:59]
    v_mfma_f32_16x16x32_bf16 v[60:63], a[108:111], v[204:207], v[60:63]
    v_mfma_f32_16x16x32_bf16 v[64:67], a[112:115], v[192:195], v[64:67]
    v_mfma_f32_16x16x32_bf16 v[68:71], a[112:115], v[196:199], v[68:71]
    v_mfma_f32_16x16x32_bf16 v[72:75], a[112:115], v[200:203], v[72:75]
    v_mfma_f32_16x16x32_bf16 v[76:79], a[112:115], v[204:207], v[76:79]
    s_waitcnt vmcnt(16) lgkmcnt(0)
    s_barrier
    v_mfma_f32_16x16x32_bf16 v[80:83], a[116:119], v[192:195], v[80:83]
    ds_read_b64_tr_b16 v[128:129], v184 offset:0
    ds_read_b64_tr_b16 v[130:131], v185 offset:0
    v_mfma_f32_16x16x32_bf16 v[84:87], a[116:119], v[196:199], v[84:87]
    ds_read_b64_tr_b16 v[132:133], v184 offset:32
    ds_read_b64_tr_b16 v[134:135], v185 offset:32
    v_mfma_f32_16x16x32_bf16 v[88:91], a[116:119], v[200:203], v[88:91]
    ds_read_b64_tr_b16 v[136:137], v184 offset:64
    ds_read_b64_tr_b16 v[138:139], v185 offset:64
    v_mfma_f32_16x16x32_bf16 v[92:95], a[116:119], v[204:207], v[92:95]
    v_mfma_f32_16x16x32_bf16 v[96:99], a[120:123], v[192:195], v[96:99]
    v_mfma_f32_16x16x32_bf16 v[100:103], a[120:123], v[196:199], v[100:103]
    v_mfma_f32_16x16x32_bf16 v[104:107], a[120:123], v[200:203], v[104:107]
    v_mfma_f32_16x16x32_bf16 v[108:111], a[120:123], v[204:207], v[108:111]
    v_mfma_f32_16x16x32_bf16 v[112:115], a[124:127], v[192:195], v[112:115]
    v_mfma_f32_16x16x32_bf16 v[116:119], a[124:127], v[196:199], v[116:119]
    v_mfma_f32_16x16x32_bf16 v[120:123], a[124:127], v[200:203], v[120:123]
    v_mfma_f32_16x16x32_bf16 v[124:127], a[124:127], v[204:207], v[124:127]
    s_waitcnt lgkmcnt(2)
    v_mfma_f32_16x16x32_bf16 v[0:3], v[128:131], v[160:163], v[0:3]
    ds_read_b64_tr_b16 v[140:141], v184 offset:96
    ds_read_b64_tr_b16 v[142:143], v185 offset:96
    v_mfma_f32_16x16x32_bf16 v[4:7], v[128:131], v[164:167], v[4:7]
    ds_read_b64_tr_b16 v[144:145], v184 offset:128
    ds_read_b64_tr_b16 v[146:147], v185 offset:128
    v_mfma_f32_16x16x32_bf16 v[8:11], v[128:131], v[168:171], v[8:11]
    ds_read_b64_tr_b16 v[148:149], v184 offset:160
    ds_read_b64_tr_b16 v[150:151], v185 offset:160
    v_mfma_f32_16x16x32_bf16 v[12:15], v[128:131], v[172:175], v[12:15]
    ds_read_b64_tr_b16 v[152:153], v184 offset:192
    ds_read_b64_tr_b16 v[154:155], v185 offset:192
    v_mfma_f32_16x16x32_bf16 v[16:19], v[132:135], v[160:163], v[16:19]
    ds_read_b64_tr_b16 v[156:157], v184 offset:224
    ds_read_b64_tr_b16 v[158:159], v185 offset:224
    v_mfma_f32_16x16x32_bf16 v[20:23], v[132:135], v[164:167], v[20:23]
    ds_read_b128 v[192:195], v188 offset:36864
    ds_read_b128 v[196:199], v188 offset:37888
    v_mfma_f32_16x16x32_bf16 v[24:27], v[132:135], v[168:171], v[24:27]
    ds_read_b128 v[200:203], v188 offset:38912
    ds_read_b128 v[204:207], v188 offset:39936
    v_mfma_f32_16x16x32_bf16 v[28:31], v[132:135], v[172:175], v[28:31]
    s_waitcnt lgkmcnt(12)
    v_mfma_f32_16x16x32_bf16 v[32:35], v[136:139], v[160:163], v[32:35]
    v_mfma_f32_16x16x32_bf16 v[36:39], v[136:139], v[164:167], v[36:39]
    v_mfma_f32_16x16x32_bf16 v[40:43], v[136:139], v[168:171], v[40:43]
    v_mfma_f32_16x16x32_bf16 v[44:47], v[136:139], v[172:175], v[44:47]
    v_mfma_f32_16x16x32_bf16 v[48:51], v[140:143], v[160:163], v[48:51]
    v_mfma_f32_16x16x32_bf16 v[52:55], v[140:143], v[164:167], v[52:55]
    v_mfma_f32_16x16x32_bf16 v[56:59], v[140:143], v[168:171], v[56:59]
    v_mfma_f32_16x16x32_bf16 v[60:63], v[140:143], v[172:175], v[60:63]
    s_waitcnt lgkmcnt(8)
    v_mfma_f32_16x16x32_bf16 v[64:67], v[144:147], v[160:163], v[64:67]
    v_mfma_f32_16x16x32_bf16 v[68:71], v[144:147], v[164:167], v[68:71]
    v_mfma_f32_16x16x32_bf16 v[72:75], v[144:147], v[168:171], v[72:75]
    v_mfma_f32_16x16x32_bf16 v[76:79], v[144:147], v[172:175], v[76:79]
    s_waitcnt vmcnt(8) lgkmcnt(0)
    s_barrier
    v_mfma_f32_16x16x32_bf16 v[80:83], v[148:151], v[160:163], v[80:83]
    ds_read_b64_tr_b16 v[128:129], v184 offset:33792
    ds_read_b64_tr_b16 v[130:131], v185 offset:33792
    v_mfma_f32_16x16x32_bf16 v[84:87], v[148:151], v[164:167], v[84:87]
    ds_read_b64_tr_b16 v[132:133], v184 offset:33824
    ds_read_b64_tr_b16 v[134:135], v185 offset:33824
    v_mfma_f32_16x16x32_bf16 v[88:91], v[148:151], v[168:171], v[88:91]
    ds_read_b64_tr_b16 v[136:137], v184 offset:33856
    ds_read_b64_tr_b16 v[138:139], v185 offset:33856
    v_mfma_f32_16x16x32_bf16 v[92:95], v[148:151], v[172:175], v[92:95]
    s_add_u32 m0, s54, 0
    s_mov_b32 s50, 2883584
    v_mfma_f32_16x16x32_bf16 v[96:99], v[152:155], v[160:163], v[96:99]
    buffer_load_dwordx4 v240, s[16:19], s50 offen lds
    v_mfma_f32_16x16x32_bf16 v[100:103], v[152:155], v[164:167], v[100:103]
    s_add_u32 m0, s54, 1056
    s_mov_b32 s51, 2891776
    v_mfma_f32_16x16x32_bf16 v[104:107], v[152:155], v[168:171], v[104:107]
    buffer_load_dwordx4 v240, s[16:19], s51 offen lds
    v_mfma_f32_16x16x32_bf16 v[108:111], v[152:155], v[172:175], v[108:111]
    s_add_u32 m0, s54, 2112
    s_mov_b32 s50, 2899968
    v_mfma_f32_16x16x32_bf16 v[112:115], v[156:159], v[160:163], v[112:115]
    buffer_load_dwordx4 v240, s[16:19], s50 offen lds
    v_mfma_f32_16x16x32_bf16 v[116:119], v[156:159], v[164:167], v[116:119]
    s_add_u32 m0, s54, 3168
    s_mov_b32 s51, 2908160
    v_mfma_f32_16x16x32_bf16 v[120:123], v[156:159], v[168:171], v[120:123]
    buffer_load_dwordx4 v240, s[16:19], s51 offen lds
    v_mfma_f32_16x16x32_bf16 v[124:127], v[156:159], v[172:175], v[124:127]
    s_waitcnt lgkmcnt(2)
    v_mfma_f32_16x16x32_bf16 v[0:3], v[128:131], v[192:195], v[0:3]
    ds_read_b64_tr_b16 v[140:141], v184 offset:33888
    ds_read_b64_tr_b16 v[142:143], v185 offset:33888
    v_mfma_f32_16x16x32_bf16 v[4:7], v[128:131], v[196:199], v[4:7]
    ds_read_b64_tr_b16 v[144:145], v184 offset:33920
    ds_read_b64_tr_b16 v[146:147], v185 offset:33920
    v_mfma_f32_16x16x32_bf16 v[8:11], v[128:131], v[200:203], v[8:11]
    ds_read_b64_tr_b16 v[148:149], v184 offset:33952
    ds_read_b64_tr_b16 v[150:151], v185 offset:33952
    v_mfma_f32_16x16x32_bf16 v[12:15], v[128:131], v[204:207], v[12:15]
    ds_read_b64_tr_b16 v[152:153], v184 offset:33984
    ds_read_b64_tr_b16 v[154:155], v185 offset:33984
    v_mfma_f32_16x16x32_bf16 v[16:19], v[132:135], v[192:195], v[16:19]
    ds_read_b64_tr_b16 v[156:157], v184 offset:34016
    ds_read_b64_tr_b16 v[158:159], v185 offset:34016
    v_mfma_f32_16x16x32_bf16 v[20:23], v[132:135], v[196:199], v[20:23]
    ds_read_b128 v[160:163], v188 offset:40960
    ds_read_b128 v[164:167], v188 offset:41984
    v_mfma_f32_16x16x32_bf16 v[24:27], v[132:135], v[200:203], v[24:27]
    ds_read_b128 v[168:171], v188 offset:43008
    ds_read_b128 v[172:175], v188 offset:44032
    v_mfma_f32_16x16x32_bf16 v[28:31], v[132:135], v[204:207], v[28:31]
    s_waitcnt lgkmcnt(12)
    v_mfma_f32_16x16x32_bf16 v[32:35], v[136:139], v[192:195], v[32:35]
    s_add_u32 m0, s48, 0
    s_mov_b32 s50, 2916352
    v_mfma_f32_16x16x32_bf16 v[36:39], v[136:139], v[196:199], v[36:39]
    buffer_load_dwordx4 v240, s[16:19], s50 offen lds
    v_mfma_f32_16x16x32_bf16 v[40:43], v[136:139], v[200:203], v[40:43]
    s_add_u32 m0, s48, 1056
    s_mov_b32 s51, 2924544
    v_mfma_f32_16x16x32_bf16 v[44:47], v[136:139], v[204:207], v[44:47]
    buffer_load_dwordx4 v240, s[16:19], s51 offen lds
    v_mfma_f32_16x16x32_bf16 v[48:51], v[140:143], v[192:195], v[48:51]
    s_add_u32 m0, s48, 2112
    s_mov_b32 s50, 2932736
    v_mfma_f32_16x16x32_bf16 v[52:55], v[140:143], v[196:199], v[52:55]
    buffer_load_dwordx4 v240, s[16:19], s50 offen lds
    v_mfma_f32_16x16x32_bf16 v[56:59], v[140:143], v[200:203], v[56:59]
    v_mfma_f32_16x16x32_bf16 v[60:63], v[140:143], v[204:207], v[60:63]
    s_waitcnt lgkmcnt(8)
    v_mfma_f32_16x16x32_bf16 v[64:67], v[144:147], v[192:195], v[64:67]
    s_add_u32 m0, s48, 3168
    s_mov_b32 s51, 2940928
    v_mfma_f32_16x16x32_bf16 v[68:71], v[144:147], v[196:199], v[68:71]
    buffer_load_dwordx4 v240, s[16:19], s51 offen lds
    v_mfma_f32_16x16x32_bf16 v[72:75], v[144:147], v[200:203], v[72:75]
    v_mfma_f32_16x16x32_bf16 v[76:79], v[144:147], v[204:207], v[76:79]
    s_waitcnt vmcnt(8) lgkmcnt(0)
    s_barrier
    v_mfma_f32_16x16x32_bf16 v[80:83], v[148:151], v[192:195], v[80:83]
    ds_read_b64_tr_b16 v[128:129], v186 offset:0
    ds_read_b64_tr_b16 v[130:131], v187 offset:0
    v_mfma_f32_16x16x32_bf16 v[84:87], v[148:151], v[196:199], v[84:87]
    ds_read_b64_tr_b16 v[132:133], v186 offset:32
    ds_read_b64_tr_b16 v[134:135], v187 offset:32
    v_mfma_f32_16x16x32_bf16 v[88:91], v[148:151], v[200:203], v[88:91]
    ds_read_b64_tr_b16 v[136:137], v186 offset:64
    ds_read_b64_tr_b16 v[138:139], v187 offset:64
    v_mfma_f32_16x16x32_bf16 v[92:95], v[148:151], v[204:207], v[92:95]
    s_add_u32 m0, s54, 33792
    s_mov_b32 s50, 3145728
    v_mfma_f32_16x16x32_bf16 v[96:99], v[152:155], v[192:195], v[96:99]
    buffer_load_dwordx4 v240, s[16:19], s50 offen lds
    v_mfma_f32_16x16x32_bf16 v[100:103], v[152:155], v[196:199], v[100:103]
    s_add_u32 m0, s54, 34848
    s_mov_b32 s51, 3153920
    v_mfma_f32_16x16x32_bf16 v[104:107], v[152:155], v[200:203], v[104:107]
    buffer_load_dwordx4 v240, s[16:19], s51 offen lds
    v_mfma_f32_16x16x32_bf16 v[108:111], v[152:155], v[204:207], v[108:111]
    s_add_u32 m0, s54, 35904
    s_mov_b32 s50, 3162112
    v_mfma_f32_16x16x32_bf16 v[112:115], v[156:159], v[192:195], v[112:115]
    buffer_load_dwordx4 v240, s[16:19], s50 offen lds
    v_mfma_f32_16x16x32_bf16 v[116:119], v[156:159], v[196:199], v[116:119]
    s_add_u32 m0, s54, 36960
    s_mov_b32 s51, 3170304
    v_mfma_f32_16x16x32_bf16 v[120:123], v[156:159], v[200:203], v[120:123]
    buffer_load_dwordx4 v240, s[16:19], s51 offen lds
    v_mfma_f32_16x16x32_bf16 v[124:127], v[156:159], v[204:207], v[124:127]
    s_waitcnt lgkmcnt(2)
    v_mfma_f32_16x16x32_bf16 v[0:3], v[128:131], v[160:163], v[0:3]
    ds_read_b64_tr_b16 v[140:141], v186 offset:96
    ds_read_b64_tr_b16 v[142:143], v187 offset:96
    v_mfma_f32_16x16x32_bf16 v[4:7], v[128:131], v[164:167], v[4:7]
    ds_read_b64_tr_b16 v[144:145], v186 offset:128
    ds_read_b64_tr_b16 v[146:147], v187 offset:128
    v_mfma_f32_16x16x32_bf16 v[8:11], v[128:131], v[168:171], v[8:11]
    ds_read_b64_tr_b16 v[148:149], v186 offset:160
    ds_read_b64_tr_b16 v[150:151], v187 offset:160
    v_mfma_f32_16x16x32_bf16 v[12:15], v[128:131], v[172:175], v[12:15]
    ds_read_b64_tr_b16 v[152:153], v186 offset:192
    ds_read_b64_tr_b16 v[154:155], v187 offset:192
    v_mfma_f32_16x16x32_bf16 v[16:19], v[132:135], v[160:163], v[16:19]
    ds_read_b64_tr_b16 v[156:157], v186 offset:224
    ds_read_b64_tr_b16 v[158:159], v187 offset:224
    v_mfma_f32_16x16x32_bf16 v[20:23], v[132:135], v[164:167], v[20:23]
    ds_read_b128 v[192:195], v188 offset:45056
    ds_read_b128 v[196:199], v188 offset:46080
    v_mfma_f32_16x16x32_bf16 v[24:27], v[132:135], v[168:171], v[24:27]
    ds_read_b128 v[200:203], v188 offset:47104
    ds_read_b128 v[204:207], v188 offset:48128
    v_mfma_f32_16x16x32_bf16 v[28:31], v[132:135], v[172:175], v[28:31]
    s_waitcnt lgkmcnt(12)
    v_mfma_f32_16x16x32_bf16 v[32:35], v[136:139], v[160:163], v[32:35]
    s_add_u32 m0, s48, 33792
    s_mov_b32 s50, 3178496
    v_mfma_f32_16x16x32_bf16 v[36:39], v[136:139], v[164:167], v[36:39]
    buffer_load_dwordx4 v240, s[16:19], s50 offen lds
    v_mfma_f32_16x16x32_bf16 v[40:43], v[136:139], v[168:171], v[40:43]
    s_add_u32 m0, s48, 34848
    s_mov_b32 s51, 3186688
    v_mfma_f32_16x16x32_bf16 v[44:47], v[136:139], v[172:175], v[44:47]
    buffer_load_dwordx4 v240, s[16:19], s51 offen lds
    v_mfma_f32_16x16x32_bf16 v[48:51], v[140:143], v[160:163], v[48:51]
    s_add_u32 m0, s48, 35904
    s_mov_b32 s50, 3194880
    v_mfma_f32_16x16x32_bf16 v[52:55], v[140:143], v[164:167], v[52:55]
    buffer_load_dwordx4 v240, s[16:19], s50 offen lds
    v_mfma_f32_16x16x32_bf16 v[56:59], v[140:143], v[168:171], v[56:59]
    v_mfma_f32_16x16x32_bf16 v[60:63], v[140:143], v[172:175], v[60:63]
    s_waitcnt lgkmcnt(8)
    v_mfma_f32_16x16x32_bf16 v[64:67], v[144:147], v[160:163], v[64:67]
    s_add_u32 m0, s48, 36960
    s_mov_b32 s51, 3203072
    v_mfma_f32_16x16x32_bf16 v[68:71], v[144:147], v[164:167], v[68:71]
    buffer_load_dwordx4 v240, s[16:19], s51 offen lds
    v_mfma_f32_16x16x32_bf16 v[72:75], v[144:147], v[168:171], v[72:75]
    v_mfma_f32_16x16x32_bf16 v[76:79], v[144:147], v[172:175], v[76:79]
    s_waitcnt vmcnt(8) lgkmcnt(0)
    s_barrier
    v_mfma_f32_16x16x32_bf16 v[80:83], v[148:151], v[160:163], v[80:83]
    ds_read_b64_tr_b16 v[128:129], v184 offset:0
    ds_read_b64_tr_b16 v[130:131], v185 offset:0
    v_mfma_f32_16x16x32_bf16 v[84:87], v[148:151], v[164:167], v[84:87]
    ds_read_b64_tr_b16 v[132:133], v184 offset:32
    ds_read_b64_tr_b16 v[134:135], v185 offset:32
    v_mfma_f32_16x16x32_bf16 v[88:91], v[148:151], v[168:171], v[88:91]
    ds_read_b64_tr_b16 v[136:137], v184 offset:64
    ds_read_b64_tr_b16 v[138:139], v185 offset:64
    v_mfma_f32_16x16x32_bf16 v[92:95], v[148:151], v[172:175], v[92:95]
    s_add_u32 m0, s54, 67584
    s_mov_b32 s50, 3407872
    v_mfma_f32_16x16x32_bf16 v[96:99], v[152:155], v[160:163], v[96:99]
    buffer_load_dwordx4 v240, s[16:19], s50 offen lds
    v_mfma_f32_16x16x32_bf16 v[100:103], v[152:155], v[164:167], v[100:103]
    s_add_u32 m0, s54, 68640
    s_mov_b32 s51, 3416064
    v_mfma_f32_16x16x32_bf16 v[104:107], v[152:155], v[168:171], v[104:107]
    buffer_load_dwordx4 v240, s[16:19], s51 offen lds
    v_mfma_f32_16x16x32_bf16 v[108:111], v[152:155], v[172:175], v[108:111]
    s_add_u32 m0, s54, 69696
    s_mov_b32 s50, 3424256
    v_mfma_f32_16x16x32_bf16 v[112:115], v[156:159], v[160:163], v[112:115]
    buffer_load_dwordx4 v240, s[16:19], s50 offen lds
    v_mfma_f32_16x16x32_bf16 v[116:119], v[156:159], v[164:167], v[116:119]
    s_add_u32 m0, s54, 70752
    s_mov_b32 s51, 3432448
    v_mfma_f32_16x16x32_bf16 v[120:123], v[156:159], v[168:171], v[120:123]
    buffer_load_dwordx4 v240, s[16:19], s51 offen lds
    v_mfma_f32_16x16x32_bf16 v[124:127], v[156:159], v[172:175], v[124:127]
    s_waitcnt lgkmcnt(2)
    v_mfma_f32_16x16x32_bf16 v[0:3], v[128:131], v[192:195], v[0:3]
    ds_read_b64_tr_b16 v[140:141], v184 offset:96
    ds_read_b64_tr_b16 v[142:143], v185 offset:96
    v_mfma_f32_16x16x32_bf16 v[4:7], v[128:131], v[196:199], v[4:7]
    ds_read_b64_tr_b16 v[144:145], v184 offset:128
    ds_read_b64_tr_b16 v[146:147], v185 offset:128
    v_mfma_f32_16x16x32_bf16 v[8:11], v[128:131], v[200:203], v[8:11]
    ds_read_b64_tr_b16 v[148:149], v184 offset:160
    ds_read_b64_tr_b16 v[150:151], v185 offset:160
    v_mfma_f32_16x16x32_bf16 v[12:15], v[128:131], v[204:207], v[12:15]
    ds_read_b64_tr_b16 v[152:153], v184 offset:192
    ds_read_b64_tr_b16 v[154:155], v185 offset:192
    v_mfma_f32_16x16x32_bf16 v[16:19], v[132:135], v[192:195], v[16:19]
    ds_read_b64_tr_b16 v[156:157], v184 offset:224
    ds_read_b64_tr_b16 v[158:159], v185 offset:224
    v_mfma_f32_16x16x32_bf16 v[20:23], v[132:135], v[196:199], v[20:23]
    ds_read_b128 v[160:163], v188 offset:49152
    ds_read_b128 v[164:167], v188 offset:50176
    v_mfma_f32_16x16x32_bf16 v[24:27], v[132:135], v[200:203], v[24:27]
    ds_read_b128 v[168:171], v188 offset:51200
    ds_read_b128 v[172:175], v188 offset:52224
    v_mfma_f32_16x16x32_bf16 v[28:31], v[132:135], v[204:207], v[28:31]
    s_waitcnt lgkmcnt(12)
    v_mfma_f32_16x16x32_bf16 v[32:35], v[136:139], v[192:195], v[32:35]
    s_add_u32 m0, s48, 67584
    s_mov_b32 s50, 3440640
    v_mfma_f32_16x16x32_bf16 v[36:39], v[136:139], v[196:199], v[36:39]
    buffer_load_dwordx4 v240, s[16:19], s50 offen lds
    v_mfma_f32_16x16x32_bf16 v[40:43], v[136:139], v[200:203], v[40:43]
    s_add_u32 m0, s48, 68640
    s_mov_b32 s51, 3448832
    v_mfma_f32_16x16x32_bf16 v[44:47], v[136:139], v[204:207], v[44:47]
    buffer_load_dwordx4 v240, s[16:19], s51 offen lds
    v_mfma_f32_16x16x32_bf16 v[48:51], v[140:143], v[192:195], v[48:51]
    s_add_u32 m0, s48, 69696
    s_mov_b32 s50, 3457024
    v_mfma_f32_16x16x32_bf16 v[52:55], v[140:143], v[196:199], v[52:55]
    buffer_load_dwordx4 v240, s[16:19], s50 offen lds
    v_mfma_f32_16x16x32_bf16 v[56:59], v[140:143], v[200:203], v[56:59]
    v_mfma_f32_16x16x32_bf16 v[60:63], v[140:143], v[204:207], v[60:63]
    s_waitcnt lgkmcnt(8)
    v_mfma_f32_16x16x32_bf16 v[64:67], v[144:147], v[192:195], v[64:67]
    s_add_u32 m0, s48, 70752
    s_mov_b32 s51, 3465216
    v_mfma_f32_16x16x32_bf16 v[68:71], v[144:147], v[196:199], v[68:71]
    buffer_load_dwordx4 v240, s[16:19], s51 offen lds
    v_mfma_f32_16x16x32_bf16 v[72:75], v[144:147], v[200:203], v[72:75]
    v_mfma_f32_16x16x32_bf16 v[76:79], v[144:147], v[204:207], v[76:79]
    s_waitcnt vmcnt(8) lgkmcnt(0)
    s_barrier
    v_mfma_f32_16x16x32_bf16 v[80:83], v[148:151], v[192:195], v[80:83]
    ds_read_b64_tr_b16 v[128:129], v184 offset:33792
    ds_read_b64_tr_b16 v[130:131], v185 offset:33792
    v_mfma_f32_16x16x32_bf16 v[84:87], v[148:151], v[196:199], v[84:87]
    ds_read_b64_tr_b16 v[132:133], v184 offset:33824
    ds_read_b64_tr_b16 v[134:135], v185 offset:33824
    v_mfma_f32_16x16x32_bf16 v[88:91], v[148:151], v[200:203], v[88:91]
    ds_read_b64_tr_b16 v[136:137], v184 offset:33856
    ds_read_b64_tr_b16 v[138:139], v185 offset:33856
    v_mfma_f32_16x16x32_bf16 v[92:95], v[148:151], v[204:207], v[92:95]
    s_add_u32 m0, s40, 0
    v_mfma_f32_16x16x32_bf16 v[96:99], v[152:155], v[192:195], v[96:99]
    buffer_load_dwordx4 v246, s[8:11], s41 offen offset:0 nt lds
    v_mfma_f32_16x16x32_bf16 v[100:103], v[152:155], v[196:199], v[100:103]
    s_add_u32 m0, s40, 32
    v_mfma_f32_16x16x32_bf16 v[104:107], v[152:155], v[200:203], v[104:107]
    buffer_load_dwordx4 v246, s[8:11], s41 offen offset:1024 nt lds
    v_mfma_f32_16x16x32_bf16 v[108:111], v[152:155], v[204:207], v[108:111]
    s_add_u32 m0, s40, 64
    v_mfma_f32_16x16x32_bf16 v[112:115], v[156:159], v[192:195], v[112:115]
    buffer_load_dwordx4 v246, s[8:11], s41 offen offset:2048 nt lds
    v_mfma_f32_16x16x32_bf16 v[116:119], v[156:159], v[196:199], v[116:119]
    s_add_u32 m0, s40, 96
    v_mfma_f32_16x16x32_bf16 v[120:123], v[156:159], v[200:203], v[120:123]
    buffer_load_dwordx4 v246, s[8:11], s41 offen offset:3072 nt lds
    v_mfma_f32_16x16x32_bf16 v[124:127], v[156:159], v[204:207], v[124:127]
    s_waitcnt lgkmcnt(2)
    v_mfma_f32_16x16x32_bf16 v[0:3], v[128:131], v[160:163], v[0:3]
    ds_read_b64_tr_b16 v[140:141], v184 offset:33888
    ds_read_b64_tr_b16 v[142:143], v185 offset:33888
    v_mfma_f32_16x16x32_bf16 v[4:7], v[128:131], v[164:167], v[4:7]
    ds_read_b64_tr_b16 v[144:145], v184 offset:33920
    ds_read_b64_tr_b16 v[146:147], v185 offset:33920
    v_mfma_f32_16x16x32_bf16 v[8:11], v[128:131], v[168:171], v[8:11]
    ds_read_b64_tr_b16 v[148:149], v184 offset:33952
    ds_read_b64_tr_b16 v[150:151], v185 offset:33952
    v_mfma_f32_16x16x32_bf16 v[12:15], v[128:131], v[172:175], v[12:15]
    ds_read_b64_tr_b16 v[152:153], v184 offset:33984
    ds_read_b64_tr_b16 v[154:155], v185 offset:33984
    v_mfma_f32_16x16x32_bf16 v[16:19], v[132:135], v[160:163], v[16:19]
    ds_read_b64_tr_b16 v[156:157], v184 offset:34016
    ds_read_b64_tr_b16 v[158:159], v185 offset:34016
    v_mfma_f32_16x16x32_bf16 v[20:23], v[132:135], v[164:167], v[20:23]
    ds_read_b128 v[192:195], v188 offset:53248
    ds_read_b128 v[196:199], v188 offset:54272
    v_mfma_f32_16x16x32_bf16 v[24:27], v[132:135], v[168:171], v[24:27]
    ds_read_b128 v[200:203], v188 offset:55296
    ds_read_b128 v[204:207], v188 offset:56320
    v_mfma_f32_16x16x32_bf16 v[28:31], v[132:135], v[172:175], v[28:31]
    s_add_u32 m0, s40, 4224
    s_waitcnt lgkmcnt(12)
    v_mfma_f32_16x16x32_bf16 v[32:35], v[136:139], v[160:163], v[32:35]
    buffer_load_dwordx4 v246, s[8:11], s42 offen offset:0 nt lds
    v_mfma_f32_16x16x32_bf16 v[36:39], v[136:139], v[164:167], v[36:39]
    s_add_u32 m0, s40, 4256
    v_mfma_f32_16x16x32_bf16 v[40:43], v[136:139], v[168:171], v[40:43]
    buffer_load_dwordx4 v246, s[8:11], s42 offen offset:1024 nt lds
    v_mfma_f32_16x16x32_bf16 v[44:47], v[136:139], v[172:175], v[44:47]
    s_add_u32 m0, s40, 4288
    v_mfma_f32_16x16x32_bf16 v[48:51], v[140:143], v[160:163], v[48:51]
    buffer_load_dwordx4 v246, s[8:11], s42 offen offset:2048 nt lds
    v_mfma_f32_16x16x32_bf16 v[52:55], v[140:143], v[164:167], v[52:55]
    s_add_u32 m0, s40, 4320
    v_mfma_f32_16x16x32_bf16 v[56:59], v[140:143], v[168:171], v[56:59]
    buffer_load_dwordx4 v246, s[8:11], s42 offen offset:3072 nt lds
    v_mfma_f32_16x16x32_bf16 v[60:63], v[140:143], v[172:175], v[60:63]
    s_waitcnt lgkmcnt(8)
    v_mfma_f32_16x16x32_bf16 v[64:67], v[144:147], v[160:163], v[64:67]
    v_mfma_f32_16x16x32_bf16 v[68:71], v[144:147], v[164:167], v[68:71]
    v_mfma_f32_16x16x32_bf16 v[72:75], v[144:147], v[168:171], v[72:75]
    v_mfma_f32_16x16x32_bf16 v[76:79], v[144:147], v[172:175], v[76:79]
    s_waitcnt vmcnt(8) lgkmcnt(0)
    s_barrier
    v_mfma_f32_16x16x32_bf16 v[80:83], v[148:151], v[160:163], v[80:83]
    ds_read_b64_tr_b16 v[128:129], v186 offset:0
    ds_read_b64_tr_b16 v[130:131], v187 offset:0
    v_mfma_f32_16x16x32_bf16 v[84:87], v[148:151], v[164:167], v[84:87]
    ds_read_b64_tr_b16 v[132:133], v186 offset:32
    ds_read_b64_tr_b16 v[134:135], v187 offset:32
    v_mfma_f32_16x16x32_bf16 v[88:91], v[148:151], v[168:171], v[88:91]
    ds_read_b64_tr_b16 v[136:137], v186 offset:64
    ds_read_b64_tr_b16 v[138:139], v187 offset:64
    v_mfma_f32_16x16x32_bf16 v[92:95], v[148:151], v[172:175], v[92:95]
    s_mov_b32 s41, 32768
    s_mov_b32 s42, 36864
    s_add_u32 m0, s40, 33792
    v_mfma_f32_16x16x32_bf16 v[96:99], v[152:155], v[160:163], v[96:99]
    buffer_load_dwordx4 v246, s[8:11], s41 offen offset:0 nt lds
    v_mfma_f32_16x16x32_bf16 v[100:103], v[152:155], v[164:167], v[100:103]
    s_add_u32 m0, s40, 33824
    v_mfma_f32_16x16x32_bf16 v[104:107], v[152:155], v[168:171], v[104:107]
    buffer_load_dwordx4 v246, s[8:11], s41 offen offset:1024 nt lds
    v_mfma_f32_16x16x32_bf16 v[108:111], v[152:155], v[172:175], v[108:111]
    s_add_u32 m0, s40, 33856
    v_mfma_f32_16x16x32_bf16 v[112:115], v[156:159], v[160:163], v[112:115]
    buffer_load_dwordx4 v246, s[8:11], s41 offen offset:2048 nt lds
    v_mfma_f32_16x16x32_bf16 v[116:119], v[156:159], v[164:167], v[116:119]
    s_add_u32 m0, s40, 33888
    v_mfma_f32_16x16x32_bf16 v[120:123], v[156:159], v[168:171], v[120:123]
    buffer_load_dwordx4 v246, s[8:11], s41 offen offset:3072 nt lds
    v_mfma_f32_16x16x32_bf16 v[124:127], v[156:159], v[172:175], v[124:127]
    s_waitcnt lgkmcnt(2)
    v_mfma_f32_16x16x32_bf16 v[0:3], v[128:131], v[192:195], v[0:3]
    ds_read_b64_tr_b16 v[140:141], v186 offset:96
    ds_read_b64_tr_b16 v[142:143], v187 offset:96
    v_mfma_f32_16x16x32_bf16 v[4:7], v[128:131], v[196:199], v[4:7]
    ds_read_b64_tr_b16 v[144:145], v186 offset:128
    ds_read_b64_tr_b16 v[146:147], v187 offset:128
    v_mfma_f32_16x16x32_bf16 v[8:11], v[128:131], v[200:203], v[8:11]
    ds_read_b64_tr_b16 v[148:149], v186 offset:160
    ds_read_b64_tr_b16 v[150:151], v187 offset:160
    v_mfma_f32_16x16x32_bf16 v[12:15], v[128:131], v[204:207], v[12:15]
    ds_read_b64_tr_b16 v[152:153], v186 offset:192
    ds_read_b64_tr_b16 v[154:155], v187 offset:192
    v_mfma_f32_16x16x32_bf16 v[16:19], v[132:135], v[192:195], v[16:19]
    ds_read_b64_tr_b16 v[156:157], v186 offset:224
    ds_read_b64_tr_b16 v[158:159], v187 offset:224
    v_mfma_f32_16x16x32_bf16 v[20:23], v[132:135], v[196:199], v[20:23]
    s_add_u32 m0, s40, 38016
    v_mfma_f32_16x16x32_bf16 v[24:27], v[132:135], v[200:203], v[24:27]
    buffer_load_dwordx4 v246, s[8:11], s42 offen offset:0 nt lds
    v_mfma_f32_16x16x32_bf16 v[28:31], v[132:135], v[204:207], v[28:31]
    s_add_u32 m0, s40, 38048
    s_waitcnt lgkmcnt(8)
    v_mfma_f32_16x16x32_bf16 v[32:35], v[136:139], v[192:195], v[32:35]
    buffer_load_dwordx4 v246, s[8:11], s42 offen offset:1024 nt lds
    v_mfma_f32_16x16x32_bf16 v[36:39], v[136:139], v[196:199], v[36:39]
    s_add_u32 m0, s40, 38080
    v_mfma_f32_16x16x32_bf16 v[40:43], v[136:139], v[200:203], v[40:43]
    buffer_load_dwordx4 v246, s[8:11], s42 offen offset:2048 nt lds
    v_mfma_f32_16x16x32_bf16 v[44:47], v[136:139], v[204:207], v[44:47]
    s_add_u32 m0, s40, 38112
    s_waitcnt lgkmcnt(0)
    s_barrier
    v_mfma_f32_16x16x32_bf16 v[48:51], v[140:143], v[192:195], v[48:51]
    buffer_load_dwordx4 v246, s[8:11], s42 offen offset:3072 nt lds
    v_mfma_f32_16x16x32_bf16 v[52:55], v[140:143], v[196:199], v[52:55]
    v_cvt_pk_bf16_f32 v0, v0, v1
    v_cvt_pk_bf16_f32 v1, v2, v3
    v_mfma_f32_16x16x32_bf16 v[56:59], v[140:143], v[200:203], v[56:59]
    ds_write_b64 v189, v[0:1] offset:0
    v_cvt_pk_bf16_f32 v4, v4, v5
    v_mfma_f32_16x16x32_bf16 v[60:63], v[140:143], v[204:207], v[60:63]
    v_cvt_pk_bf16_f32 v5, v6, v7
    v_mfma_f32_16x16x32_bf16 v[64:67], v[144:147], v[192:195], v[64:67]
    ds_write_b64 v189, v[4:5] offset:8192
    v_cvt_pk_bf16_f32 v8, v8, v9
    v_mfma_f32_16x16x32_bf16 v[68:71], v[144:147], v[196:199], v[68:71]
    v_cvt_pk_bf16_f32 v9, v10, v11
    ds_write_b64 v189, v[8:9] offset:16384
    v_mfma_f32_16x16x32_bf16 v[72:75], v[144:147], v[200:203], v[72:75]
    v_cvt_pk_bf16_f32 v12, v12, v13
    v_cvt_pk_bf16_f32 v13, v14, v15
    v_mfma_f32_16x16x32_bf16 v[76:79], v[144:147], v[204:207], v[76:79]
    ds_write_b64 v189, v[12:13] offset:24576
    v_cvt_pk_bf16_f32 v16, v16, v17
    v_mfma_f32_16x16x32_bf16 v[80:83], v[148:151], v[192:195], v[80:83]
    v_cvt_pk_bf16_f32 v17, v18, v19
    ds_write_b64 v189, v[16:17] offset:512
    v_mfma_f32_16x16x32_bf16 v[84:87], v[148:151], v[196:199], v[84:87]
    v_cvt_pk_bf16_f32 v20, v20, v21
    v_cvt_pk_bf16_f32 v21, v22, v23
    v_mfma_f32_16x16x32_bf16 v[88:91], v[148:151], v[200:203], v[88:91]
    ds_write_b64 v189, v[20:21] offset:8704
    v_cvt_pk_bf16_f32 v24, v24, v25
    v_mfma_f32_16x16x32_bf16 v[92:95], v[148:151], v[204:207], v[92:95]
    v_cvt_pk_bf16_f32 v25, v26, v27
    ds_write_b64 v189, v[24:25] offset:16896
    v_mfma_f32_16x16x32_bf16 v[96:99], v[152:155], v[192:195], v[96:99]
    v_cvt_pk_bf16_f32 v28, v28, v29
    v_cvt_pk_bf16_f32 v29, v30, v31
    v_mfma_f32_16x16x32_bf16 v[100:103], v[152:155], v[196:199], v[100:103]
    ds_write_b64 v189, v[28:29] offset:25088
    v_cvt_pk_bf16_f32 v32, v32, v33
    v_mfma_f32_16x16x32_bf16 v[104:107], v[152:155], v[200:203], v[104:107]
    v_cvt_pk_bf16_f32 v33, v34, v35
    ds_write_b64 v189, v[32:33] offset:1024
    v_mfma_f32_16x16x32_bf16 v[108:111], v[152:155], v[204:207], v[108:111]
    v_cvt_pk_bf16_f32 v36, v36, v37
    v_cvt_pk_bf16_f32 v37, v38, v39
    v_mfma_f32_16x16x32_bf16 v[112:115], v[156:159], v[192:195], v[112:115]
    ds_write_b64 v189, v[36:37] offset:9216
    v_cvt_pk_bf16_f32 v40, v40, v41
    v_mfma_f32_16x16x32_bf16 v[116:119], v[156:159], v[196:199], v[116:119]
    v_cvt_pk_bf16_f32 v41, v42, v43
    ds_write_b64 v189, v[40:41] offset:17408
    v_mfma_f32_16x16x32_bf16 v[120:123], v[156:159], v[200:203], v[120:123]
    v_cvt_pk_bf16_f32 v44, v44, v45
    v_cvt_pk_bf16_f32 v45, v46, v47
    v_mfma_f32_16x16x32_bf16 v[124:127], v[156:159], v[204:207], v[124:127]
    ds_write_b64 v189, v[44:45] offset:25600
    v_cvt_pk_bf16_f32 v48, v48, v49
    v_cvt_pk_bf16_f32 v49, v50, v51
    ds_write_b64 v189, v[48:49] offset:1536
    v_cvt_pk_bf16_f32 v52, v52, v53
    v_cvt_pk_bf16_f32 v53, v54, v55
    ds_write_b64 v189, v[52:53] offset:9728
    v_cvt_pk_bf16_f32 v56, v56, v57
    v_cvt_pk_bf16_f32 v57, v58, v59
    ds_write_b64 v189, v[56:57] offset:17920
    v_cvt_pk_bf16_f32 v60, v60, v61
    v_cvt_pk_bf16_f32 v61, v62, v63
    ds_write_b64 v189, v[60:61] offset:26112
    v_cvt_pk_bf16_f32 v64, v64, v65
    v_cvt_pk_bf16_f32 v65, v66, v67
    ds_write_b64 v189, v[64:65] offset:2048
    v_cvt_pk_bf16_f32 v68, v68, v69
    v_cvt_pk_bf16_f32 v69, v70, v71
    ds_write_b64 v189, v[68:69] offset:10240
    v_cvt_pk_bf16_f32 v72, v72, v73
    v_cvt_pk_bf16_f32 v73, v74, v75
    ds_write_b64 v189, v[72:73] offset:18432
    v_cvt_pk_bf16_f32 v76, v76, v77
    v_cvt_pk_bf16_f32 v77, v78, v79
    ds_write_b64 v189, v[76:77] offset:26624
    v_cvt_pk_bf16_f32 v80, v80, v81
    v_cvt_pk_bf16_f32 v81, v82, v83
    ds_write_b64 v189, v[80:81] offset:2560
    v_cvt_pk_bf16_f32 v84, v84, v85
    v_cvt_pk_bf16_f32 v85, v86, v87
    ds_write_b64 v189, v[84:85] offset:10752
    v_cvt_pk_bf16_f32 v88, v88, v89
    v_cvt_pk_bf16_f32 v89, v90, v91
    ds_write_b64 v189, v[88:89] offset:18944
    v_cvt_pk_bf16_f32 v92, v92, v93
    v_cvt_pk_bf16_f32 v93, v94, v95
    ds_write_b64 v189, v[92:93] offset:27136
    v_cvt_pk_bf16_f32 v96, v96, v97
    v_cvt_pk_bf16_f32 v97, v98, v99
    ds_write_b64 v189, v[96:97] offset:3072
    v_cvt_pk_bf16_f32 v100, v100, v101
    v_cvt_pk_bf16_f32 v101, v102, v103
    ds_write_b64 v189, v[100:101] offset:11264
    v_cvt_pk_bf16_f32 v104, v104, v105
    v_cvt_pk_bf16_f32 v105, v106, v107
    ds_write_b64 v189, v[104:105] offset:19456
    v_cvt_pk_bf16_f32 v108, v108, v109
    v_cvt_pk_bf16_f32 v109, v110, v111
    ds_write_b64 v189, v[108:109] offset:27648
    v_cvt_pk_bf16_f32 v112, v112, v113
    v_cvt_pk_bf16_f32 v113, v114, v115
    ds_write_b64 v189, v[112:113] offset:3584
    v_cvt_pk_bf16_f32 v116, v116, v117
    v_cvt_pk_bf16_f32 v117, v118, v119
    ds_write_b64 v189, v[116:117] offset:11776
    v_cvt_pk_bf16_f32 v120, v120, v121
    v_cvt_pk_bf16_f32 v121, v122, v123
    ds_write_b64 v189, v[120:121] offset:19968
    v_cvt_pk_bf16_f32 v124, v124, v125
    v_cvt_pk_bf16_f32 v125, v126, v127
    ds_write_b64 v189, v[124:125] offset:28160
    s_waitcnt vmcnt(8) lgkmcnt(0)
    s_barrier
    ds_read_b128 v[208:211], v244 offset:0
    ds_read_b128 v[212:215], v244 offset:64
    ds_read_b128 v[216:219], v244 offset:128
    ds_read_b128 v[220:223], v244 offset:192
    ds_read_b128 a[128:131], v190 offset:0
    ds_read_b128 a[132:135], v190 offset:1024
    ds_read_b128 a[136:139], v190 offset:2048
    ds_read_b128 a[140:143], v190 offset:3072
    ds_read_b128 a[160:163], v190 offset:8192
    ds_read_b128 a[164:167], v190 offset:9216
    ds_read_b128 a[168:171], v190 offset:10240
    ds_read_b128 a[172:175], v190 offset:11264
    ds_read_b128 a[192:195], v191 offset:0
    ds_read_b128 a[196:199], v191 offset:1024
    ds_read_b128 a[200:203], v191 offset:2048
    ds_read_b128 a[204:207], v191 offset:3072
    ds_read_b128 a[224:227], v191 offset:8192
    ds_read_b128 a[228:231], v191 offset:9216
    ds_read_b128 a[232:235], v191 offset:10240
    ds_read_b128 a[236:239], v191 offset:11264
    ds_read_b128 a[144:147], v190 offset:4096
    ds_read_b128 a[148:151], v190 offset:5120
    ds_read_b128 a[152:155], v190 offset:6144
    ds_read_b128 a[156:159], v190 offset:7168
    ds_read_b128 a[176:179], v190 offset:12288
    ds_read_b128 a[180:183], v190 offset:13312
    ds_read_b128 a[184:187], v190 offset:14336
    ds_read_b128 a[188:191], v190 offset:15360
    ds_read_b128 a[208:211], v191 offset:4096
    ds_read_b128 a[212:215], v191 offset:5120
    ds_read_b128 a[216:219], v191 offset:6144
    ds_read_b128 a[220:223], v191 offset:7168
    ds_read_b128 a[240:243], v191 offset:12288
    ds_read_b128 a[244:247], v191 offset:13312
    ds_read_b128 a[248:251], v191 offset:14336
    ds_read_b128 a[252:255], v191 offset:15360
    s_cmp_lg_u32 s100, 0
    s_cbranch_scc1 Latt_maxpass
Latt_restart:
    v_mov_b32 v240, 0
    v_mov_b32 v241, 0
    v_mov_b32 v242, 0
    v_mov_b32 v243, 0
    s_mov_b32 s43, 0
    s_mov_b32 s44, 4096
    s_waitcnt lgkmcnt(15)
    v_mfma_f32_16x16x32_bf16 v[128:131], v[208:211], a[128:131], 0
    ds_read_b128 v[224:227], v244 offset:8448
    ds_read_b128 v[228:231], v244 offset:8512
    v_mfma_f32_16x16x32_bf16 v[128:131], v[212:215], a[132:135], v[128:131]
    v_mfma_f32_16x16x32_bf16 v[128:131], v[216:219], a[136:139], v[128:131]
    v_mfma_f32_16x16x32_bf16 v[128:131], v[220:223], a[140:143], v[128:131]
    ds_read_b128 v[232:235], v244 offset:8576
    ds_read_b128 v[236:239], v244 offset:8640
    v_mfma_f32_16x16x32_bf16 v[136:139], v[208:211], a[160:163], 0
    v_mfma_f32_16x16x32_bf16 v[136:139], v[212:215], a[164:167], v[136:139]
    v_mfma_f32_16x16x32_bf16 v[136:139], v[216:219], a[168:171], v[136:139]
    v_mfma_f32_16x16x32_bf16 v[136:139], v[220:223], a[172:175], v[136:139]
    v_mfma_f32_16x16x32_bf16 v[144:147], v[208:211], a[192:195], 0
    v_mfma_f32_16x16x32_bf16 v[144:147], v[212:215], a[196:199], v[144:147]
    v_mfma_f32_16x16x32_bf16 v[144:147], v[216:219], a[200:203], v[144:147]
    v_mfma_f32_16x16x32_bf16 v[144:147], v[220:223], a[204:207], v[144:147]
    s_waitcnt lgkmcnt(0)
    s_barrier
    v_mfma_f32_16x16x32_bf16 v[152:155], v[208:211], a[224:227], 0
    s_add_u32 m0, s40, 67584
    v_mfma_f32_16x16x32_bf16 v[152:155], v[212:215], a[228:231], v[152:155]
    buffer_load_dwordx4 v246, s[12:15], s43 offen offset:0 nt lds
    v_mfma_f32_16x16x32_bf16 v[152:155], v[216:219], a[232:235], v[152:155]
    v_mfma_f32_16x16x32_bf16 v[152:155], v[220:223], a[236:239], v[152:155]
    s_add_u32 m0, s40, 67616
    v_mfma_f32_16x16x32_bf16 v[132:135], v[224:227], a[128:131], 0
    ds_read_b128 v[208:211], v244 offset:256
    ds_read_b128 v[212:215], v244 offset:320
    v_mfma_f32_16x16x32_bf16 v[132:135], v[228:231], a[132:135], v[132:135]
    buffer_load_dwordx4 v246, s[12:15], s43 offen offset:1024 nt lds
    v_mfma_f32_16x16x32_bf16 v[132:135], v[232:235], a[136:139], v[132:135]
    v_mfma_f32_16x16x32_bf16 v[132:135], v[236:239], a[140:143], v[132:135]
    ds_read_b128 v[216:219], v244 offset:384
    ds_read_b128 v[220:223], v244 offset:448
    v_mfma_f32_16x16x32_bf16 v[140:143], v[224:227], a[160:163], 0
    s_add_u32 m0, s40, 67648
    v_mfma_f32_16x16x32_bf16 v[140:143], v[228:231], a[164:167], v[140:143]
    buffer_load_dwordx4 v246, s[12:15], s43 offen offset:2048 nt lds
    v_mfma_f32_16x16x32_bf16 v[140:143], v[232:235], a[168:171], v[140:143]
    s_add_u32 m0, s40, 67680
    v_mfma_f32_16x16x32_bf16 v[140:143], v[236:239], a[172:175], v[140:143]
    buffer_load_dwordx4 v246, s[12:15], s43 offen offset:3072 nt lds
    v_mfma_f32_16x16x32_bf16 v[148:151], v[224:227], a[192:195], 0
    v_mfma_f32_16x16x32_bf16 v[148:151], v[228:231], a[196:199], v[148:151]
    v_mfma_f32_16x16x32_bf16 v[148:151], v[232:235], a[200:203], v[148:151]
    s_add_u32 m0, s40, 71808
    v_mfma_f32_16x16x32_bf16 v[148:151], v[236:239], a[204:207], v[148:151]
    buffer_load_dwordx4 v246, s[12:15], s44 offen offset:0 nt lds
    v_mfma_f32_16x16x32_bf16 v[156:159], v[224:227], a[224:227], 0
    v_mfma_f32_16x16x32_bf16 v[156:159], v[228:231], a[228:231], v[156:159]
    s_add_u32 m0, s40, 71840
    v_mfma_f32_16x16x32_bf16 v[156:159], v[232:235], a[232:235], v[156:159]
    buffer_load_dwordx4 v246, s[12:15], s44 offen offset:1024 nt lds
    v_mfma_f32_16x16x32_bf16 v[156:159], v[236:239], a[236:239], v[156:159]
    s_waitcnt lgkmcnt(3)
    v_mfma_f32_16x16x32_bf16 v[128:131], v[208:211], a[144:147], v[128:131]
    ds_read_b128 v[224:227], v244 offset:8704
    ds_read_b128 v[228:231], v244 offset:8768
    s_waitcnt lgkmcnt(4)
    v_mfma_f32_16x16x32_bf16 v[128:131], v[212:215], a[148:151], v[128:131]
    s_add_u32 m0, s40, 71872
    s_waitcnt lgkmcnt(3)
    v_mfma_f32_16x16x32_bf16 v[128:131], v[216:219], a[152:155], v[128:131]
    buffer_load_dwordx4 v246, s[12:15], s44 offen offset:2048 nt lds
    s_waitcnt lgkmcnt(2)
    v_mfma_f32_16x16x32_bf16 v[128:131], v[220:223], a[156:159], v[128:131]
    ds_read_b128 v[232:235], v244 offset:8832
    ds_read_b128 v[236:239], v244 offset:8896
    v_mfma_f32_16x16x32_bf16 v[136:139], v[208:211], a[176:179], v[136:139]
    s_add_u32 m0, s40, 71904
    v_mfma_f32_16x16x32_bf16 v[136:139], v[212:215], a[180:183], v[136:139]
    buffer_load_dwordx4 v246, s[12:15], s44 offen offset:3072 nt lds
    v_mfma_f32_16x16x32_bf16 v[136:139], v[216:219], a[184:187], v[136:139]
    v_mfma_f32_16x16x32_bf16 v[136:139], v[220:223], a[188:191], v[136:139]
    v_mfma_f32_16x16x32_bf16 v[144:147], v[208:211], a[208:211], v[144:147]
    v_mfma_f32_16x16x32_bf16 v[144:147], v[212:215], a[212:215], v[144:147]
    v_mfma_f32_16x16x32_bf16 v[144:147], v[216:219], a[216:219], v[144:147]
    v_mfma_f32_16x16x32_bf16 v[144:147], v[220:223], a[220:223], v[144:147]
    v_mfma_f32_16x16x32_bf16 v[152:155], v[208:211], a[240:243], v[152:155]
    v_mfma_f32_16x16x32_bf16 v[152:155], v[212:215], a[244:247], v[152:155]
    s_mov_b32 s41, 65536
    s_mov_b32 s42, 69632
    v_mfma_f32_16x16x32_bf16 v[152:155], v[216:219], a[248:251], v[152:155]
    v_mfma_f32_16x16x32_bf16 v[152:155], v[220:223], a[252:255], v[152:155]
    s_waitcnt vmcnt(8) lgkmcnt(0)
    s_barrier
    v_mfma_f32_16x16x32_bf16 v[132:135], v[224:227], a[144:147], v[132:135]
    ds_read_b128 v[208:211], v244 offset:33792
    ds_read_b128 v[212:215], v244 offset:33856
    v_mfma_f32_16x16x32_bf16 v[132:135], v[228:231], a[148:151], v[132:135]
    ds_read_b128 v[216:219], v244 offset:33920
    ds_read_b128 v[220:223], v244 offset:33984
    v_mfma_f32_16x16x32_bf16 v[132:135], v[232:235], a[152:155], v[132:135]
    s_add_u32 m0, s40, 0
    v_mfma_f32_16x16x32_bf16 v[132:135], v[236:239], a[156:159], v[132:135]
    buffer_load_dwordx4 v246, s[8:11], s41 offen offset:0 nt lds
    v_mfma_f32_16x16x32_bf16 v[140:143], v[224:227], a[176:179], v[140:143]
    s_add_u32 m0, s40, 32
    v_mfma_f32_16x16x32_bf16 v[140:143], v[228:231], a[180:183], v[140:143]
    buffer_load_dwordx4 v246, s[8:11], s41 offen offset:1024 nt lds
    v_mfma_f32_16x16x32_bf16 v[140:143], v[232:235], a[184:187], v[140:143]
    s_add_u32 m0, s40, 64
    v_mfma_f32_16x16x32_bf16 v[140:143], v[236:239], a[188:191], v[140:143]
    buffer_load_dwordx4 v246, s[8:11], s41 offen offset:2048 nt lds
    v_mfma_f32_16x16x32_bf16 v[148:151], v[224:227], a[208:211], v[148:151]
    s_add_u32 m0, s40, 96
    v_mfma_f32_16x16x32_bf16 v[148:151], v[228:231], a[212:215], v[148:151]
    buffer_load_dwordx4 v246, s[8:11], s41 offen offset:3072 nt lds
    v_mfma_f32_16x16x32_bf16 v[148:151], v[232:235], a[216:219], v[148:151]
    s_add_u32 m0, s40, 4224
    v_mfma_f32_16x16x32_bf16 v[148:151], v[236:239], a[220:223], v[148:151]
    buffer_load_dwordx4 v246, s[8:11], s42 offen offset:0 nt lds
    v_mfma_f32_16x16x32_bf16 v[156:159], v[224:227], a[240:243], v[156:159]
    s_add_u32 m0, s40, 4256
    v_mfma_f32_16x16x32_bf16 v[156:159], v[228:231], a[244:247], v[156:159]
    buffer_load_dwordx4 v246, s[8:11], s42 offen offset:1024 nt lds
    v_mfma_f32_16x16x32_bf16 v[156:159], v[232:235], a[248:251], v[156:159]
    s_add_u32 m0, s40, 4288
    v_mfma_f32_16x16x32_bf16 v[156:159], v[236:239], a[252:255], v[156:159]
    buffer_load_dwordx4 v246, s[8:11], s42 offen offset:2048 nt lds
    s_add_u32 m0, s40, 4320
    s_nop 0
    buffer_load_dwordx4 v246, s[8:11], s42 offen offset:3072 nt lds
    s_lshl_b32 s47, s2, 2
    s_add_u32 s47, s47, s3
    s_lshl_b32 s38, s47, 13
    s_mov_b32 s24, s62
    s_mov_b32 s25, s63
    s_mov_b32 s26, 8388608
    s_mov_b32 s39, 11
    s_lshr_b32 s48, s2, 3
    s_lshl_b32 s48, s48, 2
    s_add_u32 s48, s48, s3
    s_cmp_lg_u32 s100, 0
    s_cbranch_scc1 Latt_haveneg
    v_max3_f32 v192, v128, v129, v130
    v_max3_f32 v192, v192, v131, v132
    v_max3_f32 v192, v192, v133, v134
    v_max_f32 v192, v192, v135
    v_max3_f32 v196, v136, v137, v138
    v_max3_f32 v196, v196, v139, v140
    v_max3_f32 v196, v196, v141, v142
    v_max_f32 v196, v196, v143
    v_max3_f32 v200, v144, v145, v146
    v_max3_f32 v200, v200, v147, v148
    v_max3_f32 v200, v200, v149, v150
    v_max_f32 v200, v200, v151
    v_max3_f32 v204, v152, v153, v154
    v_max3_f32 v204, v204, v155, v156
    v_max3_f32 v204, v204, v157, v158
    v_max_f32 v204, v204, v159
    v_lshrrev_b32 v252, 2, v251
    v_add_u32 v252, 135168, v252
    v_xor_b32 v253, 256, v252
    ds_write_b32 v252, v192 offset:0
    ds_write_b32 v252, v196 offset:1024
    ds_write_b32 v252, v200 offset:2048
    ds_write_b32 v252, v204 offset:3072
    s_waitcnt lgkmcnt(0)
    s_barrier
    ds_read_b32 v193, v253 offset:2048
    ds_read_b32 v197, v253 offset:3072
    ds_read_b32 v201, v253 offset:0
    ds_read_b32 v205, v253 offset:1024
    s_waitcnt lgkmcnt(3)
    v_max_f32 v192, v192, v193
    s_waitcnt lgkmcnt(2)
    v_max_f32 v196, v196, v197
    s_waitcnt lgkmcnt(1)
    v_max_f32 v200, v200, v201
    s_waitcnt lgkmcnt(0)
    v_max_f32 v204, v204, v205
    s_waitcnt lgkmcnt(0)
    v_mov_b32 v193, v192
    v_mov_b32 v197, v196
    v_mov_b32 v201, v200
    v_mov_b32 v205, v204
    v_permlane16_swap_b32 v192, v193
    v_permlane16_swap_b32 v196, v197
    v_permlane16_swap_b32 v200, v201
    v_permlane16_swap_b32 v204, v205
    v_max_f32 v192, v192, v193
    v_max_f32 v196, v196, v197
    v_max_f32 v200, v200, v201
    v_max_f32 v204, v204, v205
    v_mov_b32 v193, v192
    v_mov_b32 v197, v196
    v_mov_b32 v201, v200
    v_mov_b32 v205, v204
    v_permlane32_swap_b32 v192, v193
    v_permlane32_swap_b32 v196, v197
    v_permlane32_swap_b32 v200, v201
    v_permlane32_swap_b32 v204, v205
    v_max_f32 v192, v192, v193
    v_max_f32 v196, v196, v197
    v_max_f32 v200, v200, v201
    v_max_f32 v204, v204, v205
    v_sub_f32 v192, 3267887104, v192
    v_mov_b32 v193, v192
    v_mov_b32 v194, v192
    v_mov_b32 v195, v192
    v_sub_f32 v196, 3267887104, v196
    v_mov_b32 v197, v196
    v_mov_b32 v198, v196
    v_mov_b32 v199, v196
    v_sub_f32 v200, 3267887104, v200
    v_mov_b32 v201, v200
    v_mov_b32 v202, v200
    v_mov_b32 v203, v200
    v_sub_f32 v204, 3267887104, v204
    v_mov_b32 v205, v204
    v_mov_b32 v206, v204
    v_mov_b32 v207, v204
Latt_haveneg:
    s_waitcnt lgkmcnt(0)
    v_add_f32 v128, v128, v192
    v_add_f32 v129, v129, v192
    v_add_f32 v130, v130, v192
    v_add_f32 v131, v131, v192
    v_add_f32 v132, v132, v192
    v_add_f32 v133, v133, v192
    v_add_f32 v134, v134, v192
    v_add_f32 v135, v135, v192
    v_add_f32 v136, v136, v196
    v_add_f32 v137, v137, v196
    v_add_f32 v138, v138, v196
    v_add_f32 v139, v139, v196
    v_add_f32 v140, v140, v196
    v_add_f32 v141, v141, v196
    v_add_f32 v142, v142, v196
    v_add_f32 v143, v143, v196
    v_add_f32 v144, v144, v200
    v_add_f32 v145, v145, v200
    v_add_f32 v146, v146, v200
    v_add_f32 v147, v147, v200
    v_add_f32 v148, v148, v200
    v_add_f32 v149, v149, v200
    v_add_f32 v150, v150, v200
    v_add_f32 v151, v151, v200
    v_add_f32 v152, v152, v204
    v_add_f32 v153, v153, v204
    v_add_f32 v154, v154, v204
    v_add_f32 v155, v155, v204
    v_add_f32 v156, v156, v204
    v_add_f32 v157, v157, v204
    v_add_f32 v158, v158, v204
    v_add_f32 v159, v159, v204
    v_exp_f32 v128, v128
    v_exp_f32 v129, v129
    v_exp_f32 v130, v130
    v_add_f32 v240, v240, v128
    v_add_f32 v240, v240, v129
    v_exp_f32 v131, v131
    v_cvt_pk_bf16_f32 v128, v128, v129
    v_exp_f32 v132, v132
    v_add_f32 v240, v240, v130
    v_add_f32 v240, v240, v131
    v_exp_f32 v133, v133
    v_cvt_pk_bf16_f32 v129, v130, v131
    v_exp_f32 v134, v134
    v_add_f32 v240, v240, v132
    v_add_f32 v240, v240, v133
    v_exp_f32 v135, v135
    v_cvt_pk_bf16_f32 v130, v132, v133
    v_exp_f32 v136, v136
    v_add_f32 v240, v240, v134
    v_add_f32 v240, v240, v135
    v_exp_f32 v137, v137
    v_cvt_pk_bf16_f32 v131, v134, v135
    v_exp_f32 v138, v138
    v_add_f32 v241, v241, v136
    v_add_f32 v241, v241, v137
    v_exp_f32 v139, v139
    v_cvt_pk_bf16_f32 v136, v136, v137
    v_exp_f32 v140, v140
    v_add_f32 v241, v241, v138
    v_add_f32 v241, v241, v139
    v_exp_f32 v141, v141
    v_cvt_pk_bf16_f32 v137, v138, v139
    v_exp_f32 v142, v142
    v_add_f32 v241, v241, v140
    v_add_f32 v241, v241, v141
    v_mfma_f32_16x16x32_bf16 v[160:163], v[208:211], a[128:131], v[192:195]
    ds_read_b128 v[224:227], v244 offset:42240
    ds_read_b128 v[228:231], v244 offset:42304
    v_mfma_f32_16x16x32_bf16 v[160:163], v[212:215], a[132:135], v[160:163]
    s_add_u32 s43, s43, 32768
    s_add_u32 m0, s40, 101376
    v_mfma_f32_16x16x32_bf16 v[160:163], v[216:219], a[136:139], v[160:163]
    buffer_load_dwordx4 v246, s[12:15], s43 offen offset:0 nt lds
    v_mfma_f32_16x16x32_bf16 v[160:163], v[220:223], a[140:143], v[160:163]
    ds_read_b128 v[232:235], v244 offset:42368
    ds_read_b128 v[236:239], v244 offset:42432
    v_mfma_f32_16x16x32_bf16 v[168:171], v[208:211], a[160:163], v[196:199]
    s_add_u32 m0, s40, 101408
    v_mfma_f32_16x16x32_bf16 v[168:171], v[212:215], a[164:167], v[168:171]
    buffer_load_dwordx4 v246, s[12:15], s43 offen offset:1024 nt lds
    v_mfma_f32_16x16x32_bf16 v[168:171], v[216:219], a[168:171], v[168:171]
    v_exp_f32 v143, v143
    v_mfma_f32_16x16x32_bf16 v[168:171], v[220:223], a[172:175], v[168:171]
    v_cvt_pk_bf16_f32 v138, v140, v141
    v_mfma_f32_16x16x32_bf16 v[176:179], v[208:211], a[192:195], v[200:203]
    v_exp_f32 v144, v144
    v_mfma_f32_16x16x32_bf16 v[176:179], v[212:215], a[196:199], v[176:179]
    s_add_u32 m0, s40, 101440
    v_add_f32 v241, v241, v142
    v_mfma_f32_16x16x32_bf16 v[176:179], v[216:219], a[200:203], v[176:179]
    buffer_load_dwordx4 v246, s[12:15], s43 offen offset:2048 nt lds
    v_mfma_f32_16x16x32_bf16 v[176:179], v[220:223], a[204:207], v[176:179]
    v_add_f32 v241, v241, v143
    v_mfma_f32_16x16x32_bf16 v[184:187], v[208:211], a[224:227], v[204:207]
    v_exp_f32 v145, v145
    v_mfma_f32_16x16x32_bf16 v[184:187], v[212:215], a[228:231], v[184:187]
    v_cvt_pk_bf16_f32 v139, v142, v143
    v_mfma_f32_16x16x32_bf16 v[184:187], v[216:219], a[232:235], v[184:187]
    s_add_u32 s44, s44, 32768
    s_add_u32 m0, s40, 101472
    v_mfma_f32_16x16x32_bf16 v[184:187], v[220:223], a[236:239], v[184:187]
    s_waitcnt lgkmcnt(0)
    v_mfma_f32_16x16x32_bf16 v[164:167], v[224:227], a[128:131], v[192:195]
    ds_read_b128 v[208:211], v244 offset:34048
    ds_read_b128 v[212:215], v244 offset:34112
    v_mfma_f32_16x16x32_bf16 v[164:167], v[228:231], a[132:135], v[164:167]
    buffer_load_dwordx4 v246, s[12:15], s43 offen offset:3072 nt lds
    v_mfma_f32_16x16x32_bf16 v[164:167], v[232:235], a[136:139], v[164:167]
    s_add_u32 m0, s40, 105600
    v_exp_f32 v146, v146
    v_mfma_f32_16x16x32_bf16 v[164:167], v[236:239], a[140:143], v[164:167]
    ds_read_b128 v[216:219], v244 offset:34176
    ds_read_b128 v[220:223], v244 offset:34240
    v_mfma_f32_16x16x32_bf16 v[172:175], v[224:227], a[160:163], v[196:199]
    buffer_load_dwordx4 v246, s[12:15], s44 offen offset:0 nt lds
    v_mfma_f32_16x16x32_bf16 v[172:175], v[228:231], a[164:167], v[172:175]
    v_add_f32 v242, v242, v144
    v_add_f32 v242, v242, v145
    v_mfma_f32_16x16x32_bf16 v[172:175], v[232:235], a[168:171], v[172:175]
    v_exp_f32 v147, v147
    v_mfma_f32_16x16x32_bf16 v[172:175], v[236:239], a[172:175], v[172:175]
    s_add_u32 m0, s40, 105632
    v_cvt_pk_bf16_f32 v144, v144, v145
    v_mfma_f32_16x16x32_bf16 v[180:183], v[224:227], a[192:195], v[200:203]
    buffer_load_dwordx4 v246, s[12:15], s44 offen offset:1024 nt lds
    v_mfma_f32_16x16x32_bf16 v[180:183], v[228:231], a[196:199], v[180:183]
    v_exp_f32 v148, v148
    v_mfma_f32_16x16x32_bf16 v[180:183], v[232:235], a[200:203], v[180:183]
    v_add_f32 v242, v242, v146
    v_add_f32 v242, v242, v147
    v_mfma_f32_16x16x32_bf16 v[180:183], v[236:239], a[204:207], v[180:183]
    v_exp_f32 v149, v149
    v_mfma_f32_16x16x32_bf16 v[188:191], v[224:227], a[224:227], v[204:207]
    s_add_u32 m0, s40, 105664
    v_cvt_pk_bf16_f32 v145, v146, v147
    v_mfma_f32_16x16x32_bf16 v[188:191], v[228:231], a[228:231], v[188:191]
    buffer_load_dwordx4 v246, s[12:15], s44 offen offset:2048 nt lds
    v_mfma_f32_16x16x32_bf16 v[188:191], v[232:235], a[232:235], v[188:191]
    v_exp_f32 v150, v150
    v_mfma_f32_16x16x32_bf16 v[188:191], v[236:239], a[236:239], v[188:191]
    v_add_f32 v242, v242, v148
    s_waitcnt lgkmcnt(0)
    v_mfma_f32_16x16x32_bf16 v[160:163], v[208:211], a[144:147], v[160:163]
    ds_read_b128 v[224:227], v244 offset:42496
    ds_read_b128 v[228:231], v244 offset:42560
    v_mfma_f32_16x16x32_bf16 v[160:163], v[212:215], a[148:151], v[160:163]
    s_add_u32 m0, s40, 105696
    v_add_f32 v242, v242, v149
    v_mfma_f32_16x16x32_bf16 v[160:163], v[216:219], a[152:155], v[160:163]
    buffer_load_dwordx4 v246, s[12:15], s44 offen offset:3072 nt lds
    v_mfma_f32_16x16x32_bf16 v[160:163], v[220:223], a[156:159], v[160:163]
    ds_read_b128 v[232:235], v244 offset:42624
    ds_read_b128 v[236:239], v244 offset:42688
    v_mfma_f32_16x16x32_bf16 v[168:171], v[208:211], a[176:179], v[168:171]
    v_exp_f32 v151, v151
    v_mfma_f32_16x16x32_bf16 v[168:171], v[212:215], a[180:183], v[168:171]
    s_mov_b32 m0, 143360
    v_cvt_pk_bf16_f32 v146, v148, v149
    v_mfma_f32_16x16x32_bf16 v[168:171], v[216:219], a[184:187], v[168:171]
    buffer_load_dwordx4 v247, s[24:27], s38 offen lds
    v_mfma_f32_16x16x32_bf16 v[168:171], v[220:223], a[188:191], v[168:171]
    s_add_u32 s38, s38, 1024
    v_mfma_f32_16x16x32_bf16 v[176:179], v[208:211], a[208:211], v[176:179]
    v_exp_f32 v152, v152
    v_mfma_f32_16x16x32_bf16 v[176:179], v[212:215], a[212:215], v[176:179]
    v_add_f32 v242, v242, v150
    v_add_f32 v242, v242, v151
    v_mfma_f32_16x16x32_bf16 v[176:179], v[216:219], a[216:219], v[176:179]
    v_exp_f32 v153, v153
    v_mfma_f32_16x16x32_bf16 v[176:179], v[220:223], a[220:223], v[176:179]
    v_cvt_pk_bf16_f32 v147, v150, v151
    v_mfma_f32_16x16x32_bf16 v[184:187], v[208:211], a[240:243], v[184:187]
    v_exp_f32 v154, v154
    v_mfma_f32_16x16x32_bf16 v[184:187], v[212:215], a[244:247], v[184:187]
    v_add_f32 v243, v243, v152
    v_add_f32 v243, v243, v153
    v_mfma_f32_16x16x32_bf16 v[184:187], v[216:219], a[248:251], v[184:187]
    v_exp_f32 v155, v155
    v_mfma_f32_16x16x32_bf16 v[184:187], v[220:223], a[252:255], v[184:187]
    s_waitcnt vmcnt(17) lgkmcnt(0)
    s_barrier
    v_mfma_f32_16x16x32_bf16 v[164:167], v[224:227], a[144:147], v[164:167]
    ds_read_b64_tr_b16 v[208:209], v245 offset:0
    ds_read_b64_tr_b16 v[210:211], v245 offset:8448
    v_mfma_f32_16x16x32_bf16 v[164:167], v[228:231], a[148:151], v[164:167]
    v_cvt_pk_bf16_f32 v152, v152, v153
    v_mfma_f32_16x16x32_bf16 v[164:167], v[232:235], a[152:155], v[164:167]
    v_exp_f32 v156, v156
    v_mfma_f32_16x16x32_bf16 v[164:167], v[236:239], a[156:159], v[164:167]
    ds_read_b64_tr_b16 v[212:213], v245 offset:32
    ds_read_b64_tr_b16 v[214:215], v245 offset:8480
    v_mfma_f32_16x16x32_bf16 v[172:175], v[224:227], a[176:179], v[172:175]
    v_add_f32 v243, v243, v154
    v_add_f32 v243, v243, v155
    v_mfma_f32_16x16x32_bf16 v[172:175], v[228:231], a[180:183], v[172:175]
    v_exp_f32 v157, v157
    v_mfma_f32_16x16x32_bf16 v[172:175], v[232:235], a[184:187], v[172:175]
    ds_read_b64_tr_b16 v[216:217], v245 offset:64
    ds_read_b64_tr_b16 v[218:219], v245 offset:8512
    v_mfma_f32_16x16x32_bf16 v[172:175], v[236:239], a[188:191], v[172:175]
    v_cvt_pk_bf16_f32 v153, v154, v155
    v_mfma_f32_16x16x32_bf16 v[180:183], v[224:227], a[208:211], v[180:183]
    v_exp_f32 v158, v158
    v_mfma_f32_16x16x32_bf16 v[180:183], v[228:231], a[212:215], v[180:183]
    ds_read_b64_tr_b16 v[220:221], v245 offset:96
    ds_read_b64_tr_b16 v[222:223], v245 offset:8544
    v_mfma_f32_16x16x32_bf16 v[180:183], v[232:235], a[216:219], v[180:183]
    v_add_f32 v243, v243, v156
    v_add_f32 v243, v243, v157
    v_mfma_f32_16x16x32_bf16 v[180:183], v[236:239], a[220:223], v[180:183]
    v_exp_f32 v159, v159
    v_mfma_f32_16x16x32_bf16 v[188:191], v[224:227], a[240:243], v[188:191]
    v_cvt_pk_bf16_f32 v154, v156, v157
    v_add_f32 v243, v243, v158
    v_mfma_f32_16x16x32_bf16 v[188:191], v[228:231], a[244:247], v[188:191]
    v_add_f32 v243, v243, v159
    v_cvt_pk_bf16_f32 v155, v158, v159
    v_mfma_f32_16x16x32_bf16 v[188:191], v[232:235], a[248:251], v[188:191]
    v_mfma_f32_16x16x32_bf16 v[188:191], v[236:239], a[252:255], v[188:191]
    s_waitcnt lgkmcnt(4)
    v_mfma_f32_16x16x32_bf16 v[0:3], v[208:211], v[128:131], 0
    ds_read_b64_tr_b16 v[224:225], v245 offset:128
    ds_read_b64_tr_b16 v[226:227], v245 offset:8576
    v_mfma_f32_16x16x32_bf16 v[4:7], v[208:211], v[136:139], 0
    ds_read_b64_tr_b16 v[228:229], v245 offset:160
    ds_read_b64_tr_b16 v[230:231], v245 offset:8608
    v_mfma_f32_16x16x32_bf16 a[0:3], v[208:211], v[144:147], 0
    ds_read_b64_tr_b16 v[232:233], v245 offset:192
    ds_read_b64_tr_b16 v[234:235], v245 offset:8640
    v_mfma_f32_16x16x32_bf16 a[4:7], v[208:211], v[152:155], 0
    s_add_u32 s41, s41, 32768
    s_add_u32 m0, s40, 33792
    v_mfma_f32_16x16x32_bf16 v[8:11], v[212:215], v[128:131], 0
    ds_read_b64_tr_b16 v[236:237], v245 offset:224
    ds_read_b64_tr_b16 v[238:239], v245 offset:8672
    v_mfma_f32_16x16x32_bf16 v[12:15], v[212:215], v[136:139], 0
    buffer_load_dwordx4 v246, s[8:11], s41 offen offset:0 nt lds
    v_mfma_f32_16x16x32_bf16 a[8:11], v[212:215], v[144:147], 0
    v_exp_f32 v160, v160
    v_mfma_f32_16x16x32_bf16 a[12:15], v[212:215], v[152:155], 0
    s_add_u32 m0, s40, 33824
    s_waitcnt lgkmcnt(8)
    v_mfma_f32_16x16x32_bf16 v[16:19], v[216:219], v[128:131], 0
    ds_read_b64_tr_b16 v[208:209], v245 offset:256
    ds_read_b64_tr_b16 v[210:211], v245 offset:8704
    v_mfma_f32_16x16x32_bf16 v[20:23], v[216:219], v[136:139], 0
    buffer_load_dwordx4 v246, s[8:11], s41 offen offset:1024 nt lds
    v_mfma_f32_16x16x32_bf16 a[16:19], v[216:219], v[144:147], 0
    v_exp_f32 v161, v161
    v_mfma_f32_16x16x32_bf16 a[20:23], v[216:219], v[152:155], 0
    v_mfma_f32_16x16x32_bf16 v[24:27], v[220:223], v[128:131], 0
    ds_read_b64_tr_b16 v[212:213], v245 offset:288
    ds_read_b64_tr_b16 v[214:215], v245 offset:8736
    v_mfma_f32_16x16x32_bf16 v[28:31], v[220:223], v[136:139], 0
    s_add_u32 m0, s40, 33856
    v_mfma_f32_16x16x32_bf16 a[24:27], v[220:223], v[144:147], 0
    buffer_load_dwordx4 v246, s[8:11], s41 offen offset:2048 nt lds
    v_mfma_f32_16x16x32_bf16 a[28:31], v[220:223], v[152:155], 0
    s_waitcnt lgkmcnt(8)
    v_mfma_f32_16x16x32_bf16 v[32:35], v[224:227], v[128:131], 0
    ds_read_b64_tr_b16 v[216:217], v245 offset:320
    ds_read_b64_tr_b16 v[218:219], v245 offset:8768
    v_mfma_f32_16x16x32_bf16 v[36:39], v[224:227], v[136:139], 0
    s_add_u32 s42, s42, 32768
    s_add_u32 m0, s40, 33888
    v_mfma_f32_16x16x32_bf16 a[32:35], v[224:227], v[144:147], 0
    buffer_load_dwordx4 v246, s[8:11], s41 offen offset:3072 nt lds
    v_mfma_f32_16x16x32_bf16 a[36:39], v[224:227], v[152:155], 0
    v_exp_f32 v162, v162
    v_mfma_f32_16x16x32_bf16 v[40:43], v[228:231], v[128:131], 0
    ds_read_b64_tr_b16 v[220:221], v245 offset:352
    ds_read_b64_tr_b16 v[222:223], v245 offset:8800
    v_mfma_f32_16x16x32_bf16 v[44:47], v[228:231], v[136:139], 0
    v_add_f32 v240, v240, v160
    v_add_f32 v240, v240, v161
    v_mfma_f32_16x16x32_bf16 a[40:43], v[228:231], v[144:147], 0
    s_add_u32 m0, s40, 38016
    v_mfma_f32_16x16x32_bf16 a[44:47], v[228:231], v[152:155], 0
    s_waitcnt lgkmcnt(8)
    v_mfma_f32_16x16x32_bf16 v[48:51], v[232:235], v[128:131], 0
    ds_read_b64_tr_b16 v[224:225], v245 offset:384
    ds_read_b64_tr_b16 v[226:227], v245 offset:8832
    v_mfma_f32_16x16x32_bf16 v[52:55], v[232:235], v[136:139], 0
    buffer_load_dwordx4 v246, s[8:11], s42 offen offset:0 nt lds
    v_mfma_f32_16x16x32_bf16 a[48:51], v[232:235], v[144:147], 0
    v_exp_f32 v163, v163
    v_mfma_f32_16x16x32_bf16 a[52:55], v[232:235], v[152:155], 0
    s_add_u32 m0, s40, 38048
    v_cvt_pk_bf16_f32 v160, v160, v161
    v_mfma_f32_16x16x32_bf16 v[56:59], v[236:239], v[128:131], 0
    ds_read_b64_tr_b16 v[228:229], v245 offset:416
    ds_read_b64_tr_b16 v[230:231], v245 offset:8864
    v_mfma_f32_16x16x32_bf16 v[60:63], v[236:239], v[136:139], 0
    buffer_load_dwordx4 v246, s[8:11], s42 offen offset:1024 nt lds
    v_mfma_f32_16x16x32_bf16 a[56:59], v[236:239], v[144:147], 0
    v_exp_f32 v164, v164
    v_mfma_f32_16x16x32_bf16 a[60:63], v[236:239], v[152:155], 0
    v_add_f32 v240, v240, v162
    s_waitcnt lgkmcnt(8)
    v_mfma_f32_16x16x32_bf16 v[64:67], v[208:211], v[128:131], 0
    ds_read_b64_tr_b16 v[232:233], v245 offset:448
    ds_read_b64_tr_b16 v[234:235], v245 offset:8896
    v_mfma_f32_16x16x32_bf16 v[68:71], v[208:211], v[136:139], 0
    s_add_u32 m0, s40, 38080
    v_add_f32 v240, v240, v163
    v_mfma_f32_16x16x32_bf16 a[64:67], v[208:211], v[144:147], 0
    buffer_load_dwordx4 v246, s[8:11], s42 offen offset:2048 nt lds
    v_mfma_f32_16x16x32_bf16 a[68:71], v[208:211], v[152:155], 0
    v_exp_f32 v165, v165
    v_mfma_f32_16x16x32_bf16 v[72:75], v[212:215], v[128:131], 0
    ds_read_b64_tr_b16 v[236:237], v245 offset:480
    ds_read_b64_tr_b16 v[238:239], v245 offset:8928
    v_mfma_f32_16x16x32_bf16 v[76:79], v[212:215], v[136:139], 0
    s_add_u32 m0, s40, 38112
    v_cvt_pk_bf16_f32 v161, v162, v163
    v_mfma_f32_16x16x32_bf16 a[72:75], v[212:215], v[144:147], 0
    buffer_load_dwordx4 v246, s[8:11], s42 offen offset:3072 nt lds
    v_mfma_f32_16x16x32_bf16 a[76:79], v[212:215], v[152:155], 0
    s_waitcnt lgkmcnt(8)
    v_mfma_f32_16x16x32_bf16 v[80:83], v[216:219], v[128:131], 0
    v_exp_f32 v166, v166
    v_mfma_f32_16x16x32_bf16 v[84:87], v[216:219], v[136:139], 0
    v_add_f32 v240, v240, v164
    v_add_f32 v240, v240, v165
    v_mfma_f32_16x16x32_bf16 a[80:83], v[216:219], v[144:147], 0
    v_exp_f32 v167, v167
    v_mfma_f32_16x16x32_bf16 a[84:87], v[216:219], v[152:155], 0
    v_cvt_pk_bf16_f32 v162, v164, v165
    v_mfma_f32_16x16x32_bf16 v[88:91], v[220:223], v[128:131], 0
    v_exp_f32 v168, v168
    v_mfma_f32_16x16x32_bf16 v[92:95], v[220:223], v[136:139], 0
    v_add_f32 v240, v240, v166
    v_add_f32 v240, v240, v167
    v_mfma_f32_16x16x32_bf16 a[88:91], v[220:223], v[144:147], 0
    v_mfma_f32_16x16x32_bf16 a[92:95], v[220:223], v[152:155], 0
    s_waitcnt vmcnt(17) lgkmcnt(0)
    s_barrier
    v_mfma_f32_16x16x32_bf16 v[96:99], v[224:227], v[128:131], 0
    ds_read_b128 v[208:211], v244 offset:0
    ds_read_b128 v[212:215], v244 offset:64
    v_mfma_f32_16x16x32_bf16 v[100:103], v[224:227], v[136:139], 0
    v_exp_f32 v169, v169
    v_mfma_f32_16x16x32_bf16 a[96:99], v[224:227], v[144:147], 0
    v_cvt_pk_bf16_f32 v163, v166, v167
    v_mfma_f32_16x16x32_bf16 a[100:103], v[224:227], v[152:155], 0
    ds_read_b128 v[216:219], v244 offset:128
    ds_read_b128 v[220:223], v244 offset:192
    v_mfma_f32_16x16x32_bf16 v[104:107], v[228:231], v[128:131], 0
    v_exp_f32 v170, v170
    v_mfma_f32_16x16x32_bf16 v[108:111], v[228:231], v[136:139], 0
    v_add_f32 v241, v241, v168
    v_add_f32 v241, v241, v169
    v_mfma_f32_16x16x32_bf16 a[104:107], v[228:231], v[144:147], 0
    v_exp_f32 v171, v171
    v_mfma_f32_16x16x32_bf16 a[108:111], v[228:231], v[152:155], 0
    v_cvt_pk_bf16_f32 v168, v168, v169
    v_mfma_f32_16x16x32_bf16 v[112:115], v[232:235], v[128:131], 0
    v_exp_f32 v172, v172
    v_mfma_f32_16x16x32_bf16 v[116:119], v[232:235], v[136:139], 0
    v_add_f32 v241, v241, v170
    v_mfma_f32_16x16x32_bf16 a[112:115], v[232:235], v[144:147], 0
    v_add_f32 v241, v241, v171
    v_mfma_f32_16x16x32_bf16 a[116:119], v[232:235], v[152:155], 0
    v_exp_f32 v173, v173
    v_mfma_f32_16x16x32_bf16 v[120:123], v[236:239], v[128:131], 0
    v_cvt_pk_bf16_f32 v169, v170, v171
    v_mfma_f32_16x16x32_bf16 v[124:127], v[236:239], v[136:139], 0
    v_exp_f32 v174, v174
    v_mfma_f32_16x16x32_bf16 a[120:123], v[236:239], v[144:147], 0
    v_add_f32 v241, v241, v172
    v_add_f32 v241, v241, v173
    v_mfma_f32_16x16x32_bf16 a[124:127], v[236:239], v[152:155], 0
    s_waitcnt lgkmcnt(0)
    v_mfma_f32_16x16x32_bf16 v[128:131], v[208:211], a[128:131], v[192:195]
    ds_read_b128 v[224:227], v244 offset:8448
    ds_read_b128 v[228:231], v244 offset:8512
    v_mfma_f32_16x16x32_bf16 v[128:131], v[212:215], a[132:135], v[128:131]
    s_add_u32 s43, s43, 32768
    s_add_u32 m0, s40, 67584
    v_mfma_f32_16x16x32_bf16 v[128:131], v[216:219], a[136:139], v[128:131]
    buffer_load_dwordx4 v246, s[12:15], s43 offen offset:0 nt lds
    v_mfma_f32_16x16x32_bf16 v[128:131], v[220:223], a[140:143], v[128:131]
    ds_read_b128 v[232:235], v244 offset:8576
    ds_read_b128 v[236:239], v244 offset:8640
    v_mfma_f32_16x16x32_bf16 v[136:139], v[208:211], a[160:163], v[196:199]
    s_add_u32 m0, s40, 67616
    v_mfma_f32_16x16x32_bf16 v[136:139], v[212:215], a[164:167], v[136:139]
    buffer_load_dwordx4 v246, s[12:15], s43 offen offset:1024 nt lds
    v_mfma_f32_16x16x32_bf16 v[136:139], v[216:219], a[168:171], v[136:139]
    v_exp_f32 v175, v175
    v_mfma_f32_16x16x32_bf16 v[136:139], v[220:223], a[172:175], v[136:139]
    v_cvt_pk_bf16_f32 v170, v172, v173
    v_mfma_f32_16x16x32_bf16 v[144:147], v[208:211], a[192:195], v[200:203]
    v_exp_f32 v176, v176
    v_mfma_f32_16x16x32_bf16 v[144:147], v[212:215], a[196:199], v[144:147]
    s_add_u32 m0, s40, 67648
    v_add_f32 v241, v241, v174
    v_mfma_f32_16x16x32_bf16 v[144:147], v[216:219], a[200:203], v[144:147]
    buffer_load_dwordx4 v246, s[12:15], s43 offen offset:2048 nt lds
    v_mfma_f32_16x16x32_bf16 v[144:147], v[220:223], a[204:207], v[144:147]
    v_add_f32 v241, v241, v175
    v_mfma_f32_16x16x32_bf16 v[152:155], v[208:211], a[224:227], v[204:207]
    v_exp_f32 v177, v177
    v_mfma_f32_16x16x32_bf16 v[152:155], v[212:215], a[228:231], v[152:155]
    v_cvt_pk_bf16_f32 v171, v174, v175
    v_mfma_f32_16x16x32_bf16 v[152:155], v[216:219], a[232:235], v[152:155]
    s_add_u32 s44, s44, 32768
    s_add_u32 m0, s40, 67680
    v_mfma_f32_16x16x32_bf16 v[152:155], v[220:223], a[236:239], v[152:155]
    s_waitcnt lgkmcnt(0)
    v_mfma_f32_16x16x32_bf16 v[132:135], v[224:227], a[128:131], v[192:195]
    ds_read_b128 v[208:211], v244 offset:256
    ds_read_b128 v[212:215], v244 offset:320
    v_mfma_f32_16x16x32_bf16 v[132:135], v[228:231], a[132:135], v[132:135]
    buffer_load_dwordx4 v246, s[12:15], s43 offen offset:3072 nt lds
    v_mfma_f32_16x16x32_bf16 v[132:135], v[232:235], a[136:139], v[132:135]
    s_add_u32 m0, s40, 71808
    v_exp_f32 v178, v178
    v_mfma_f32_16x16x32_bf16 v[132:135], v[236:239], a[140:143], v[132:135]
    ds_read_b128 v[216:219], v244 offset:384
    ds_read_b128 v[220:223], v244 offset:448
    v_mfma_f32_16x16x32_bf16 v[140:143], v[224:227], a[160:163], v[196:199]
    buffer_load_dwordx4 v246, s[12:15], s44 offen offset:0 nt lds
    v_mfma_f32_16x16x32_bf16 v[140:143], v[228:231], a[164:167], v[140:143]
    v_add_f32 v242, v242, v176
    v_add_f32 v242, v242, v177
    v_mfma_f32_16x16x32_bf16 v[140:143], v[232:235], a[168:171], v[140:143]
    v_exp_f32 v179, v179
    v_mfma_f32_16x16x32_bf16 v[140:143], v[236:239], a[172:175], v[140:143]
    s_add_u32 m0, s40, 71840
    v_cvt_pk_bf16_f32 v176, v176, v177
    v_mfma_f32_16x16x32_bf16 v[148:151], v[224:227], a[192:195], v[200:203]
    buffer_load_dwordx4 v246, s[12:15], s44 offen offset:1024 nt lds
    v_mfma_f32_16x16x32_bf16 v[148:151], v[228:231], a[196:199], v[148:151]
    v_exp_f32 v180, v180
    v_mfma_f32_16x16x32_bf16 v[148:151], v[232:235], a[200:203], v[148:151]
    v_add_f32 v242, v242, v178
    v_add_f32 v242, v242, v179
    v_mfma_f32_16x16x32_bf16 v[148:151], v[236:239], a[204:207], v[148:151]
    v_exp_f32 v181, v181
    v_mfma_f32_16x16x32_bf16 v[156:159], v[224:227], a[224:227], v[204:207]
    s_add_u32 m0, s40, 71872
    v_cvt_pk_bf16_f32 v177, v178, v179
    v_mfma_f32_16x16x32_bf16 v[156:159], v[228:231], a[228:231], v[156:159]
    buffer_load_dwordx4 v246, s[12:15], s44 offen offset:2048 nt lds
    v_mfma_f32_16x16x32_bf16 v[156:159], v[232:235], a[232:235], v[156:159]
    v_exp_f32 v182, v182
    v_mfma_f32_16x16x32_bf16 v[156:159], v[236:239], a[236:239], v[156:159]
    v_add_f32 v242, v242, v180
    s_waitcnt lgkmcnt(0)
    v_mfma_f32_16x16x32_bf16 v[128:131], v[208:211], a[144:147], v[128:131]
    ds_read_b128 v[224:227], v244 offset:8704
    ds_read_b128 v[228:231], v244 offset:8768
    v_mfma_f32_16x16x32_bf16 v[128:131], v[212:215], a[148:151], v[128:131]
    s_add_u32 m0, s40, 71904
    v_add_f32 v242, v242, v181
    v_mfma_f32_16x16x32_bf16 v[128:131], v[216:219], a[152:155], v[128:131]
    buffer_load_dwordx4 v246, s[12:15], s44 offen offset:3072 nt lds
    v_mfma_f32_16x16x32_bf16 v[128:131], v[220:223], a[156:159], v[128:131]
    ds_read_b128 v[232:235], v244 offset:8832
    ds_read_b128 v[236:239], v244 offset:8896
    v_mfma_f32_16x16x32_bf16 v[136:139], v[208:211], a[176:179], v[136:139]
    v_exp_f32 v183, v183
    v_mfma_f32_16x16x32_bf16 v[136:139], v[212:215], a[180:183], v[136:139]
    s_mov_b32 m0, 143360
    v_cvt_pk_bf16_f32 v178, v180, v181
    v_mfma_f32_16x16x32_bf16 v[136:139], v[216:219], a[184:187], v[136:139]
    buffer_load_dwordx4 v247, s[24:27], s38 offen lds
    v_mfma_f32_16x16x32_bf16 v[136:139], v[220:223], a[188:191], v[136:139]
    s_add_u32 s38, s38, 1024
    v_mfma_f32_16x16x32_bf16 v[144:147], v[208:211], a[208:211], v[144:147]
    v_exp_f32 v184, v184
    v_mfma_f32_16x16x32_bf16 v[144:147], v[212:215], a[212:215], v[144:147]
    v_add_f32 v242, v242, v182
    v_add_f32 v242, v242, v183
    v_mfma_f32_16x16x32_bf16 v[144:147], v[216:219], a[216:219], v[144:147]
    v_exp_f32 v185, v185
    v_mfma_f32_16x16x32_bf16 v[144:147], v[220:223], a[220:223], v[144:147]
    v_cvt_pk_bf16_f32 v179, v182, v183
    v_mfma_f32_16x16x32_bf16 v[152:155], v[208:211], a[240:243], v[152:155]
    v_exp_f32 v186, v186
    v_mfma_f32_16x16x32_bf16 v[152:155], v[212:215], a[244:247], v[152:155]
    v_add_f32 v243, v243, v184
    v_add_f32 v243, v243, v185
    v_mfma_f32_16x16x32_bf16 v[152:155], v[216:219], a[248:251], v[152:155]
    v_exp_f32 v187, v187
    v_mfma_f32_16x16x32_bf16 v[152:155], v[220:223], a[252:255], v[152:155]
    s_waitcnt vmcnt(18) lgkmcnt(0)
    s_barrier
    v_mfma_f32_16x16x32_bf16 v[132:135], v[224:227], a[144:147], v[132:135]
    ds_read_b64_tr_b16 v[208:209], v245 offset:33792
    ds_read_b64_tr_b16 v[210:211], v245 offset:42240
    v_mfma_f32_16x16x32_bf16 v[132:135], v[228:231], a[148:151], v[132:135]
    v_cvt_pk_bf16_f32 v184, v184, v185
    v_mfma_f32_16x16x32_bf16 v[132:135], v[232:235], a[152:155], v[132:135]
    v_exp_f32 v188, v188
    v_mfma_f32_16x16x32_bf16 v[132:135], v[236:239], a[156:159], v[132:135]
    ds_read_b64_tr_b16 v[212:213], v245 offset:33824
    ds_read_b64_tr_b16 v[214:215], v245 offset:42272
    v_mfma_f32_16x16x32_bf16 v[140:143], v[224:227], a[176:179], v[140:143]
    v_add_f32 v243, v243, v186
    v_add_f32 v243, v243, v187
    v_mfma_f32_16x16x32_bf16 v[140:143], v[228:231], a[180:183], v[140:143]
    v_exp_f32 v189, v189
    v_mfma_f32_16x16x32_bf16 v[140:143], v[232:235], a[184:187], v[140:143]
    ds_read_b64_tr_b16 v[216:217], v245 offset:33856
    ds_read_b64_tr_b16 v[218:219], v245 offset:42304
    v_mfma_f32_16x16x32_bf16 v[140:143], v[236:239], a[188:191], v[140:143]
    v_cvt_pk_bf16_f32 v185, v186, v187
    v_mfma_f32_16x16x32_bf16 v[148:151], v[224:227], a[208:211], v[148:151]
    v_exp_f32 v190, v190
    v_mfma_f32_16x16x32_bf16 v[148:151], v[228:231], a[212:215], v[148:151]
    ds_read_b64_tr_b16 v[220:221], v245 offset:33888
    ds_read_b64_tr_b16 v[222:223], v245 offset:42336
    v_mfma_f32_16x16x32_bf16 v[148:151], v[232:235], a[216:219], v[148:151]
    v_add_f32 v243, v243, v188
    v_add_f32 v243, v243, v189
    v_mfma_f32_16x16x32_bf16 v[148:151], v[236:239], a[220:223], v[148:151]
    v_exp_f32 v191, v191
    v_mfma_f32_16x16x32_bf16 v[156:159], v[224:227], a[240:243], v[156:159]
    v_cvt_pk_bf16_f32 v186, v188, v189
    v_add_f32 v243, v243, v190
    v_mfma_f32_16x16x32_bf16 v[156:159], v[228:231], a[244:247], v[156:159]
    v_add_f32 v243, v243, v191
    v_cvt_pk_bf16_f32 v187, v190, v191
    v_mfma_f32_16x16x32_bf16 v[156:159], v[232:235], a[248:251], v[156:159]
    v_mfma_f32_16x16x32_bf16 v[156:159], v[236:239], a[252:255], v[156:159]
    s_waitcnt lgkmcnt(4)
    v_mfma_f32_16x16x32_bf16 v[0:3], v[208:211], v[160:163], v[0:3]
    ds_read_b64_tr_b16 v[224:225], v245 offset:33920
    ds_read_b64_tr_b16 v[226:227], v245 offset:42368
    v_mfma_f32_16x16x32_bf16 v[4:7], v[208:211], v[168:171], v[4:7]
    ds_read_b64_tr_b16 v[228:229], v245 offset:33952
    ds_read_b64_tr_b16 v[230:231], v245 offset:42400
    v_mfma_f32_16x16x32_bf16 a[0:3], v[208:211], v[176:179], a[0:3]
    ds_read_b64_tr_b16 v[232:233], v245 offset:33984
    ds_read_b64_tr_b16 v[234:235], v245 offset:42432
    v_mfma_f32_16x16x32_bf16 a[4:7], v[208:211], v[184:187], a[4:7]
    s_add_u32 s41, s41, 32768
    s_add_u32 m0, s40, 0
    v_mfma_f32_16x16x32_bf16 v[8:11], v[212:215], v[160:163], v[8:11]
    ds_read_b64_tr_b16 v[236:237], v245 offset:34016
    ds_read_b64_tr_b16 v[238:239], v245 offset:42464
    v_mfma_f32_16x16x32_bf16 v[12:15], v[212:215], v[168:171], v[12:15]
    buffer_load_dwordx4 v246, s[8:11], s41 offen offset:0 nt lds
    v_mfma_f32_16x16x32_bf16 a[8:11], v[212:215], v[176:179], a[8:11]
    v_exp_f32 v128, v128
    v_mfma_f32_16x16x32_bf16 a[12:15], v[212:215], v[184:187], a[12:15]
    s_add_u32 m0, s40, 32
    s_waitcnt lgkmcnt(8)
    v_mfma_f32_16x16x32_bf16 v[16:19], v[216:219], v[160:163], v[16:19]
    ds_read_b64_tr_b16 v[208:209], v245 offset:34048
    ds_read_b64_tr_b16 v[210:211], v245 offset:42496
    v_mfma_f32_16x16x32_bf16 v[20:23], v[216:219], v[168:171], v[20:23]
    buffer_load_dwordx4 v246, s[8:11], s41 offen offset:1024 nt lds
    v_mfma_f32_16x16x32_bf16 a[16:19], v[216:219], v[176:179], a[16:19]
    v_exp_f32 v129, v129
    v_mfma_f32_16x16x32_bf16 a[20:23], v[216:219], v[184:187], a[20:23]
    v_mfma_f32_16x16x32_bf16 v[24:27], v[220:223], v[160:163], v[24:27]
    ds_read_b64_tr_b16 v[212:213], v245 offset:34080
    ds_read_b64_tr_b16 v[214:215], v245 offset:42528
    v_mfma_f32_16x16x32_bf16 v[28:31], v[220:223], v[168:171], v[28:31]
    s_add_u32 m0, s40, 64
    v_mfma_f32_16x16x32_bf16 a[24:27], v[220:223], v[176:179], a[24:27]
    buffer_load_dwordx4 v246, s[8:11], s41 offen offset:2048 nt lds
    v_mfma_f32_16x16x32_bf16 a[28:31], v[220:223], v[184:187], a[28:31]
    s_waitcnt lgkmcnt(8)
    v_mfma_f32_16x16x32_bf16 v[32:35], v[224:227], v[160:163], v[32:35]
    ds_read_b64_tr_b16 v[216:217], v245 offset:34112
    ds_read_b64_tr_b16 v[218:219], v245 offset:42560
    v_mfma_f32_16x16x32_bf16 v[36:39], v[224:227], v[168:171], v[36:39]
    s_add_u32 s42, s42, 32768
    s_add_u32 m0, s40, 96
    v_mfma_f32_16x16x32_bf16 a[32:35], v[224:227], v[176:179], a[32:35]
    buffer_load_dwordx4 v246, s[8:11], s41 offen offset:3072 nt lds
    v_mfma_f32_16x16x32_bf16 a[36:39], v[224:227], v[184:187], a[36:39]
    v_exp_f32 v130, v130
    v_mfma_f32_16x16x32_bf16 v[40:43], v[228:231], v[160:163], v[40:43]
    ds_read_b64_tr_b16 v[220:221], v245 offset:34144
    ds_read_b64_tr_b16 v[222:223], v245 offset:42592
    v_mfma_f32_16x16x32_bf16 v[44:47], v[228:231], v[168:171], v[44:47]
    v_add_f32 v240, v240, v128
    v_add_f32 v240, v240, v129
    v_mfma_f32_16x16x32_bf16 a[40:43], v[228:231], v[176:179], a[40:43]
    s_add_u32 m0, s40, 4224
    v_mfma_f32_16x16x32_bf16 a[44:47], v[228:231], v[184:187], a[44:47]
    s_waitcnt lgkmcnt(8)
    v_mfma_f32_16x16x32_bf16 v[48:51], v[232:235], v[160:163], v[48:51]
    ds_read_b64_tr_b16 v[224:225], v245 offset:34176
    ds_read_b64_tr_b16 v[226:227], v245 offset:42624
    v_mfma_f32_16x16x32_bf16 v[52:55], v[232:235], v[168:171], v[52:55]
    buffer_load_dwordx4 v246, s[8:11], s42 offen offset:0 nt lds
    v_mfma_f32_16x16x32_bf16 a[48:51], v[232:235], v[176:179], a[48:51]
    v_exp_f32 v131, v131
    v_mfma_f32_16x16x32_bf16 a[52:55], v[232:235], v[184:187], a[52:55]
    s_add_u32 m0, s40, 4256
    v_cvt_pk_bf16_f32 v128, v128, v129
    v_mfma_f32_16x16x32_bf16 v[56:59], v[236:239], v[160:163], v[56:59]
    ds_read_b64_tr_b16 v[228:229], v245 offset:34208
    ds_read_b64_tr_b16 v[230:231], v245 offset:42656
    v_mfma_f32_16x16x32_bf16 v[60:63], v[236:239], v[168:171], v[60:63]
    buffer_load_dwordx4 v246, s[8:11], s42 offen offset:1024 nt lds
    v_mfma_f32_16x16x32_bf16 a[56:59], v[236:239], v[176:179], a[56:59]
    v_exp_f32 v132, v132
    v_mfma_f32_16x16x32_bf16 a[60:63], v[236:239], v[184:187], a[60:63]
    v_add_f32 v240, v240, v130
    s_waitcnt lgkmcnt(8)
    v_mfma_f32_16x16x32_bf16 v[64:67], v[208:211], v[160:163], v[64:67]
    ds_read_b64_tr_b16 v[232:233], v245 offset:34240
    ds_read_b64_tr_b16 v[234:235], v245 offset:42688
    v_mfma_f32_16x16x32_bf16 v[68:71], v[208:211], v[168:171], v[68:71]
    s_add_u32 m0, s40, 4288
    v_add_f32 v240, v240, v131
    v_mfma_f32_16x16x32_bf16 a[64:67], v[208:211], v[176:179], a[64:67]
    buffer_load_dwordx4 v246, s[8:11], s42 offen offset:2048 nt lds
    v_mfma_f32_16x16x32_bf16 a[68:71], v[208:211], v[184:187], a[68:71]
    v_exp_f32 v133, v133
    v_mfma_f32_16x16x32_bf16 v[72:75], v[212:215], v[160:163], v[72:75]
    ds_read_b64_tr_b16 v[236:237], v245 offset:34272
    ds_read_b64_tr_b16 v[238:239], v245 offset:42720
    v_mfma_f32_16x16x32_bf16 v[76:79], v[212:215], v[168:171], v[76:79]
    s_add_u32 m0, s40, 4320
    v_cvt_pk_bf16_f32 v129, v130, v131
    v_mfma_f32_16x16x32_bf16 a[72:75], v[212:215], v[176:179], a[72:75]
    buffer_load_dwordx4 v246, s[8:11], s42 offen offset:3072 nt lds
    v_mfma_f32_16x16x32_bf16 a[76:79], v[212:215], v[184:187], a[76:79]
    s_waitcnt lgkmcnt(8)
    v_mfma_f32_16x16x32_bf16 v[80:83], v[216:219], v[160:163], v[80:83]
    v_exp_f32 v134, v134
    v_mfma_f32_16x16x32_bf16 v[84:87], v[216:219], v[168:171], v[84:87]
    v_add_f32 v240, v240, v132
    v_add_f32 v240, v240, v133
    v_mfma_f32_16x16x32_bf16 a[80:83], v[216:219], v[176:179], a[80:83]
    v_exp_f32 v135, v135
    v_mfma_f32_16x16x32_bf16 a[84:87], v[216:219], v[184:187], a[84:87]
    v_cvt_pk_bf16_f32 v130, v132, v133
    v_mfma_f32_16x16x32_bf16 v[88:91], v[220:223], v[160:163], v[88:91]
    v_exp_f32 v136, v136
    v_mfma_f32_16x16x32_bf16 v[92:95], v[220:223], v[168:171], v[92:95]
    v_add_f32 v240, v240, v134
    v_add_f32 v240, v240, v135
    v_mfma_f32_16x16x32_bf16 a[88:91], v[220:223], v[176:179], a[88:91]
    v_mfma_f32_16x16x32_bf16 a[92:95], v[220:223], v[184:187], a[92:95]
    s_waitcnt vmcnt(17) lgkmcnt(0)
    s_barrier
    v_mfma_f32_16x16x32_bf16 v[96:99], v[224:227], v[160:163], v[96:99]
    ds_read_b128 v[208:211], v244 offset:33792
    ds_read_b128 v[212:215], v244 offset:33856
    v_mfma_f32_16x16x32_bf16 v[100:103], v[224:227], v[168:171], v[100:103]
    v_exp_f32 v137, v137
    v_mfma_f32_16x16x32_bf16 a[96:99], v[224:227], v[176:179], a[96:99]
    v_cvt_pk_bf16_f32 v131, v134, v135
    v_mfma_f32_16x16x32_bf16 a[100:103], v[224:227], v[184:187], a[100:103]
    ds_read_b128 v[216:219], v244 offset:33920
    ds_read_b128 v[220:223], v244 offset:33984
    v_mfma_f32_16x16x32_bf16 v[104:107], v[228:231], v[160:163], v[104:107]
    v_exp_f32 v138, v138
    v_mfma_f32_16x16x32_bf16 v[108:111], v[228:231], v[168:171], v[108:111]
    v_add_f32 v241, v241, v136
    v_add_f32 v241, v241, v137
    v_mfma_f32_16x16x32_bf16 a[104:107], v[228:231], v[176:179], a[104:107]
    v_exp_f32 v139, v139
    v_mfma_f32_16x16x32_bf16 a[108:111], v[228:231], v[184:187], a[108:111]
    v_cvt_pk_bf16_f32 v136, v136, v137
    v_mfma_f32_16x16x32_bf16 v[112:115], v[232:235], v[160:163], v[112:115]
    v_exp_f32 v140, v140
    v_mfma_f32_16x16x32_bf16 v[116:119], v[232:235], v[168:171], v[116:119]
    v_add_f32 v241, v241, v138
    v_mfma_f32_16x16x32_bf16 a[112:115], v[232:235], v[176:179], a[112:115]
    v_add_f32 v241, v241, v139
    v_mfma_f32_16x16x32_bf16 a[116:119], v[232:235], v[184:187], a[116:119]
    v_exp_f32 v141, v141
    v_mfma_f32_16x16x32_bf16 v[120:123], v[236:239], v[160:163], v[120:123]
    v_cvt_pk_bf16_f32 v137, v138, v139
    v_mfma_f32_16x16x32_bf16 v[124:127], v[236:239], v[168:171], v[124:127]
    v_exp_f32 v142, v142
    v_mfma_f32_16x16x32_bf16 a[120:123], v[236:239], v[176:179], a[120:123]
    v_add_f32 v241, v241, v140
    v_add_f32 v241, v241, v141
    v_mfma_f32_16x16x32_bf16 a[124:127], v[236:239], v[184:187], a[124:127]
    s_mov_b32 s49, 13
.p2align 6
Latt_loop:
    s_waitcnt lgkmcnt(0)
    v_mfma_f32_16x16x32_bf16 v[160:163], v[208:211], a[128:131], v[192:195]
    ds_read_b128 v[224:227], v244 offset:42240
    ds_read_b128 v[228:231], v244 offset:42304
    v_mfma_f32_16x16x32_bf16 v[160:163], v[212:215], a[132:135], v[160:163]
    s_add_u32 s43, s43, 32768
    s_add_u32 m0, s40, 101376
    v_mfma_f32_16x16x32_bf16 v[160:163], v[216:219], a[136:139], v[160:163]
    buffer_load_dwordx4 v246, s[12:15], s43 offen offset:0 nt lds
    v_mfma_f32_16x16x32_bf16 v[160:163], v[220:223], a[140:143], v[160:163]
    ds_read_b128 v[232:235], v244 offset:42368
    ds_read_b128 v[236:239], v244 offset:42432
    v_mfma_f32_16x16x32_bf16 v[168:171], v[208:211], a[160:163], v[196:199]
    s_add_u32 m0, s40, 101408
    v_mfma_f32_16x16x32_bf16 v[168:171], v[212:215], a[164:167], v[168:171]
    buffer_load_dwordx4 v246, s[12:15], s43 offen offset:1024 nt lds
    v_mfma_f32_16x16x32_bf16 v[168:171], v[216:219], a[168:171], v[168:171]
    v_exp_f32 v143, v143
    v_mfma_f32_16x16x32_bf16 v[168:171], v[220:223], a[172:175], v[168:171]
    v_cvt_pk_bf16_f32 v138, v140, v141
    v_mfma_f32_16x16x32_bf16 v[176:179], v[208:211], a[192:195], v[200:203]
    v_exp_f32 v144, v144
    v_mfma_f32_16x16x32_bf16 v[176:179], v[212:215], a[196:199], v[176:179]
    s_add_u32 m0, s40, 101440
    v_add_f32 v241, v241, v142
    v_mfma_f32_16x16x32_bf16 v[176:179], v[216:219], a[200:203], v[176:179]
    buffer_load_dwordx4 v246, s[12:15], s43 offen offset:2048 nt lds
    v_mfma_f32_16x16x32_bf16 v[176:179], v[220:223], a[204:207], v[176:179]
    v_add_f32 v241, v241, v143
    v_mfma_f32_16x16x32_bf16 v[184:187], v[208:211], a[224:227], v[204:207]
    v_exp_f32 v145, v145
    v_mfma_f32_16x16x32_bf16 v[184:187], v[212:215], a[228:231], v[184:187]
    v_cvt_pk_bf16_f32 v139, v142, v143
    v_mfma_f32_16x16x32_bf16 v[184:187], v[216:219], a[232:235], v[184:187]
    s_add_u32 s44, s44, 32768
    s_add_u32 m0, s40, 101472
    v_mfma_f32_16x16x32_bf16 v[184:187], v[220:223], a[236:239], v[184:187]
    s_waitcnt lgkmcnt(0)
    v_mfma_f32_16x16x32_bf16 v[164:167], v[224:227], a[128:131], v[192:195]
    ds_read_b128 v[208:211], v244 offset:34048
    ds_read_b128 v[212:215], v244 offset:34112
    v_mfma_f32_16x16x32_bf16 v[164:167], v[228:231], a[132:135], v[164:167]
    buffer_load_dwordx4 v246, s[12:15], s43 offen offset:3072 nt lds
    v_mfma_f32_16x16x32_bf16 v[164:167], v[232:235], a[136:139], v[164:167]
    s_add_u32 m0, s40, 105600
    v_exp_f32 v146, v146
    v_mfma_f32_16x16x32_bf16 v[164:167], v[236:239], a[140:143], v[164:167]
    ds_read_b128 v[216:219], v244 offset:34176
    ds_read_b128 v[220:223], v244 offset:34240
    v_mfma_f32_16x16x32_bf16 v[172:175], v[224:227], a[160:163], v[196:199]
    buffer_load_dwordx4 v246, s[12:15], s44 offen offset:0 nt lds
    v_mfma_f32_16x16x32_bf16 v[172:175], v[228:231], a[164:167], v[172:175]
    v_add_f32 v242, v242, v144
    v_add_f32 v242, v242, v145
    v_mfma_f32_16x16x32_bf16 v[172:175], v[232:235], a[168:171], v[172:175]
    v_exp_f32 v147, v147
    v_mfma_f32_16x16x32_bf16 v[172:175], v[236:239], a[172:175], v[172:175]
    s_add_u32 m0, s40, 105632
    v_cvt_pk_bf16_f32 v144, v144, v145
    v_mfma_f32_16x16x32_bf16 v[180:183], v[224:227], a[192:195], v[200:203]
    buffer_load_dwordx4 v246, s[12:15], s44 offen offset:1024 nt lds
    v_mfma_f32_16x16x32_bf16 v[180:183], v[228:231], a[196:199], v[180:183]
    v_exp_f32 v148, v148
    v_mfma_f32_16x16x32_bf16 v[180:183], v[232:235], a[200:203], v[180:183]
    v_add_f32 v242, v242, v146
    v_add_f32 v242, v242, v147
    v_mfma_f32_16x16x32_bf16 v[180:183], v[236:239], a[204:207], v[180:183]
    v_exp_f32 v149, v149
    v_mfma_f32_16x16x32_bf16 v[188:191], v[224:227], a[224:227], v[204:207]
    s_add_u32 m0, s40, 105664
    v_cvt_pk_bf16_f32 v145, v146, v147
    v_mfma_f32_16x16x32_bf16 v[188:191], v[228:231], a[228:231], v[188:191]
    buffer_load_dwordx4 v246, s[12:15], s44 offen offset:2048 nt lds
    v_mfma_f32_16x16x32_bf16 v[188:191], v[232:235], a[232:235], v[188:191]
    v_exp_f32 v150, v150
    v_mfma_f32_16x16x32_bf16 v[188:191], v[236:239], a[236:239], v[188:191]
    v_add_f32 v242, v242, v148
    s_waitcnt lgkmcnt(0)
    v_mfma_f32_16x16x32_bf16 v[160:163], v[208:211], a[144:147], v[160:163]
    ds_read_b128 v[224:227], v244 offset:42496
    ds_read_b128 v[228:231], v244 offset:42560
    v_mfma_f32_16x16x32_bf16 v[160:163], v[212:215], a[148:151], v[160:163]
    s_add_u32 m0, s40, 105696
    v_add_f32 v242, v242, v149
    v_mfma_f32_16x16x32_bf16 v[160:163], v[216:219], a[152:155], v[160:163]
    buffer_load_dwordx4 v246, s[12:15], s44 offen offset:3072 nt lds
    v_mfma_f32_16x16x32_bf16 v[160:163], v[220:223], a[156:159], v[160:163]
    ds_read_b128 v[232:235], v244 offset:42624
    ds_read_b128 v[236:239], v244 offset:42688
    v_mfma_f32_16x16x32_bf16 v[168:171], v[208:211], a[176:179], v[168:171]
    v_exp_f32 v151, v151
    v_mfma_f32_16x16x32_bf16 v[168:171], v[212:215], a[180:183], v[168:171]
    s_mov_b32 m0, 143360
    v_cvt_pk_bf16_f32 v146, v148, v149
    v_mfma_f32_16x16x32_bf16 v[168:171], v[216:219], a[184:187], v[168:171]
    buffer_load_dwordx4 v247, s[24:27], s38 offen lds
    v_mfma_f32_16x16x32_bf16 v[168:171], v[220:223], a[188:191], v[168:171]
    s_add_u32 s38, s38, 1024
    v_mfma_f32_16x16x32_bf16 v[176:179], v[208:211], a[208:211], v[176:179]
    v_exp_f32 v152, v152
    v_mfma_f32_16x16x32_bf16 v[176:179], v[212:215], a[212:215], v[176:179]
    v_add_f32 v242, v242, v150
    v_add_f32 v242, v242, v151
    v_mfma_f32_16x16x32_bf16 v[176:179], v[216:219], a[216:219], v[176:179]
    v_exp_f32 v153, v153
    v_mfma_f32_16x16x32_bf16 v[176:179], v[220:223], a[220:223], v[176:179]
    v_cvt_pk_bf16_f32 v147, v150, v151
    v_mfma_f32_16x16x32_bf16 v[184:187], v[208:211], a[240:243], v[184:187]
    v_exp_f32 v154, v154
    v_mfma_f32_16x16x32_bf16 v[184:187], v[212:215], a[244:247], v[184:187]
    v_add_f32 v243, v243, v152
    v_add_f32 v243, v243, v153
    v_mfma_f32_16x16x32_bf16 v[184:187], v[216:219], a[248:251], v[184:187]
    v_exp_f32 v155, v155
    v_mfma_f32_16x16x32_bf16 v[184:187], v[220:223], a[252:255], v[184:187]
    s_waitcnt vmcnt(18) lgkmcnt(0)
    s_barrier
    v_mfma_f32_16x16x32_bf16 v[164:167], v[224:227], a[144:147], v[164:167]
    ds_read_b64_tr_b16 v[208:209], v245 offset:0
    ds_read_b64_tr_b16 v[210:211], v245 offset:8448
    v_mfma_f32_16x16x32_bf16 v[164:167], v[228:231], a[148:151], v[164:167]
    v_cvt_pk_bf16_f32 v152, v152, v153
    v_mfma_f32_16x16x32_bf16 v[164:167], v[232:235], a[152:155], v[164:167]
    v_exp_f32 v156, v156
    v_mfma_f32_16x16x32_bf16 v[164:167], v[236:239], a[156:159], v[164:167]
    ds_read_b64_tr_b16 v[212:213], v245 offset:32
    ds_read_b64_tr_b16 v[214:215], v245 offset:8480
    v_mfma_f32_16x16x32_bf16 v[172:175], v[224:227], a[176:179], v[172:175]
    v_add_f32 v243, v243, v154
    v_add_f32 v243, v243, v155
    v_mfma_f32_16x16x32_bf16 v[172:175], v[228:231], a[180:183], v[172:175]
    v_exp_f32 v157, v157
    v_mfma_f32_16x16x32_bf16 v[172:175], v[232:235], a[184:187], v[172:175]
    ds_read_b64_tr_b16 v[216:217], v245 offset:64
    ds_read_b64_tr_b16 v[218:219], v245 offset:8512
    v_mfma_f32_16x16x32_bf16 v[172:175], v[236:239], a[188:191], v[172:175]
    v_cvt_pk_bf16_f32 v153, v154, v155
    v_mfma_f32_16x16x32_bf16 v[180:183], v[224:227], a[208:211], v[180:183]
    v_exp_f32 v158, v158
    v_mfma_f32_16x16x32_bf16 v[180:183], v[228:231], a[212:215], v[180:183]
    ds_read_b64_tr_b16 v[220:221], v245 offset:96
    ds_read_b64_tr_b16 v[222:223], v245 offset:8544
    v_mfma_f32_16x16x32_bf16 v[180:183], v[232:235], a[216:219], v[180:183]
    v_add_f32 v243, v243, v156
    v_add_f32 v243, v243, v157
    v_mfma_f32_16x16x32_bf16 v[180:183], v[236:239], a[220:223], v[180:183]
    v_exp_f32 v159, v159
    v_mfma_f32_16x16x32_bf16 v[188:191], v[224:227], a[240:243], v[188:191]
    v_cvt_pk_bf16_f32 v154, v156, v157
    v_add_f32 v243, v243, v158
    v_mfma_f32_16x16x32_bf16 v[188:191], v[228:231], a[244:247], v[188:191]
    v_add_f32 v243, v243, v159
    v_cvt_pk_bf16_f32 v155, v158, v159
    v_mfma_f32_16x16x32_bf16 v[188:191], v[232:235], a[248:251], v[188:191]
    v_mfma_f32_16x16x32_bf16 v[188:191], v[236:239], a[252:255], v[188:191]
    s_waitcnt lgkmcnt(4)
    v_mfma_f32_16x16x32_bf16 v[0:3], v[208:211], v[128:131], v[0:3]
    ds_read_b64_tr_b16 v[224:225], v245 offset:128
    ds_read_b64_tr_b16 v[226:227], v245 offset:8576
    v_mfma_f32_16x16x32_bf16 v[4:7], v[208:211], v[136:139], v[4:7]
    ds_read_b64_tr_b16 v[228:229], v245 offset:160
    ds_read_b64_tr_b16 v[230:231], v245 offset:8608
    v_mfma_f32_16x16x32_bf16 a[0:3], v[208:211], v[144:147], a[0:3]
    ds_read_b64_tr_b16 v[232:233], v245 offset:192
    ds_read_b64_tr_b16 v[234:235], v245 offset:8640
    v_mfma_f32_16x16x32_bf16 a[4:7], v[208:211], v[152:155], a[4:7]
    s_add_u32 s41, s41, 32768
    s_add_u32 m0, s40, 33792
    v_mfma_f32_16x16x32_bf16 v[8:11], v[212:215], v[128:131], v[8:11]
    ds_read_b64_tr_b16 v[236:237], v245 offset:224
    ds_read_b64_tr_b16 v[238:239], v245 offset:8672
    v_mfma_f32_16x16x32_bf16 v[12:15], v[212:215], v[136:139], v[12:15]
    buffer_load_dwordx4 v246, s[8:11], s41 offen offset:0 nt lds
    v_mfma_f32_16x16x32_bf16 a[8:11], v[212:215], v[144:147], a[8:11]
    v_exp_f32 v160, v160
    v_mfma_f32_16x16x32_bf16 a[12:15], v[212:215], v[152:155], a[12:15]
    s_add_u32 m0, s40, 33824
    s_waitcnt lgkmcnt(8)
    v_mfma_f32_16x16x32_bf16 v[16:19], v[216:219], v[128:131], v[16:19]
    ds_read_b64_tr_b16 v[208:209], v245 offset:256
    ds_read_b64_tr_b16 v[210:211], v245 offset:8704
    v_mfma_f32_16x16x32_bf16 v[20:23], v[216:219], v[136:139], v[20:23]
    buffer_load_dwordx4 v246, s[8:11], s41 offen offset:1024 nt lds
    v_mfma_f32_16x16x32_bf16 a[16:19], v[216:219], v[144:147], a[16:19]
    v_exp_f32 v161, v161
    v_mfma_f32_16x16x32_bf16 a[20:23], v[216:219], v[152:155], a[20:23]
    v_mfma_f32_16x16x32_bf16 v[24:27], v[220:223], v[128:131], v[24:27]
    ds_read_b64_tr_b16 v[212:213], v245 offset:288
    ds_read_b64_tr_b16 v[214:215], v245 offset:8736
    v_mfma_f32_16x16x32_bf16 v[28:31], v[220:223], v[136:139], v[28:31]
    s_add_u32 m0, s40, 33856
    v_mfma_f32_16x16x32_bf16 a[24:27], v[220:223], v[144:147], a[24:27]
    buffer_load_dwordx4 v246, s[8:11], s41 offen offset:2048 nt lds
    v_mfma_f32_16x16x32_bf16 a[28:31], v[220:223], v[152:155], a[28:31]
    s_waitcnt lgkmcnt(8)
    v_mfma_f32_16x16x32_bf16 v[32:35], v[224:227], v[128:131], v[32:35]
    ds_read_b64_tr_b16 v[216:217], v245 offset:320
    ds_read_b64_tr_b16 v[218:219], v245 offset:8768
    v_mfma_f32_16x16x32_bf16 v[36:39], v[224:227], v[136:139], v[36:39]
    s_add_u32 s42, s42, 32768
    s_add_u32 m0, s40, 33888
    v_mfma_f32_16x16x32_bf16 a[32:35], v[224:227], v[144:147], a[32:35]
    buffer_load_dwordx4 v246, s[8:11], s41 offen offset:3072 nt lds
    v_mfma_f32_16x16x32_bf16 a[36:39], v[224:227], v[152:155], a[36:39]
    v_exp_f32 v162, v162
    v_mfma_f32_16x16x32_bf16 v[40:43], v[228:231], v[128:131], v[40:43]
    ds_read_b64_tr_b16 v[220:221], v245 offset:352
    ds_read_b64_tr_b16 v[222:223], v245 offset:8800
    v_mfma_f32_16x16x32_bf16 v[44:47], v[228:231], v[136:139], v[44:47]
    v_add_f32 v240, v240, v160
    v_add_f32 v240, v240, v161
    v_mfma_f32_16x16x32_bf16 a[40:43], v[228:231], v[144:147], a[40:43]
    s_add_u32 m0, s40, 38016
    v_mfma_f32_16x16x32_bf16 a[44:47], v[228:231], v[152:155], a[44:47]
    s_waitcnt lgkmcnt(8)
    v_mfma_f32_16x16x32_bf16 v[48:51], v[232:235], v[128:131], v[48:51]
    ds_read_b64_tr_b16 v[224:225], v245 offset:384
    ds_read_b64_tr_b16 v[226:227], v245 offset:8832
    v_mfma_f32_16x16x32_bf16 v[52:55], v[232:235], v[136:139], v[52:55]
    buffer_load_dwordx4 v246, s[8:11], s42 offen offset:0 nt lds
    v_mfma_f32_16x16x32_bf16 a[48:51], v[232:235], v[144:147], a[48:51]
    v_exp_f32 v163, v163
    v_mfma_f32_16x16x32_bf16 a[52:55], v[232:235], v[152:155], a[52:55]
    s_add_u32 m0, s40, 38048
    v_cvt_pk_bf16_f32 v160, v160, v161
    v_mfma_f32_16x16x32_bf16 v[56:59], v[236:239], v[128:131], v[56:59]
    ds_read_b64_tr_b16 v[228:229], v245 offset:416
    ds_read_b64_tr_b16 v[230:231], v245 offset:8864
    v_mfma_f32_16x16x32_bf16 v[60:63], v[236:239], v[136:139], v[60:63]
    buffer_load_dwordx4 v246, s[8:11], s42 offen offset:1024 nt lds
    v_mfma_f32_16x16x32_bf16 a[56:59], v[236:239], v[144:147], a[56:59]
    v_exp_f32 v164, v164
    v_mfma_f32_16x16x32_bf16 a[60:63], v[236:239], v[152:155], a[60:63]
    v_add_f32 v240, v240, v162
    s_waitcnt lgkmcnt(8)
    v_mfma_f32_16x16x32_bf16 v[64:67], v[208:211], v[128:131], v[64:67]
    ds_read_b64_tr_b16 v[232:233], v245 offset:448
    ds_read_b64_tr_b16 v[234:235], v245 offset:8896
    v_mfma_f32_16x16x32_bf16 v[68:71], v[208:211], v[136:139], v[68:71]
    s_add_u32 m0, s40, 38080
    v_add_f32 v240, v240, v163
    v_mfma_f32_16x16x32_bf16 a[64:67], v[208:211], v[144:147], a[64:67]
    buffer_load_dwordx4 v246, s[8:11], s42 offen offset:2048 nt lds
    v_mfma_f32_16x16x32_bf16 a[68:71], v[208:211], v[152:155], a[68:71]
    v_exp_f32 v165, v165
    v_mfma_f32_16x16x32_bf16 v[72:75], v[212:215], v[128:131], v[72:75]
    ds_read_b64_tr_b16 v[236:237], v245 offset:480
    ds_read_b64_tr_b16 v[238:239], v245 offset:8928
    v_mfma_f32_16x16x32_bf16 v[76:79], v[212:215], v[136:139], v[76:79]
    s_add_u32 m0, s40, 38112
    v_cvt_pk_bf16_f32 v161, v162, v163
    v_mfma_f32_16x16x32_bf16 a[72:75], v[212:215], v[144:147], a[72:75]
    buffer_load_dwordx4 v246, s[8:11], s42 offen offset:3072 nt lds
    v_mfma_f32_16x16x32_bf16 a[76:79], v[212:215], v[152:155], a[76:79]
    s_waitcnt lgkmcnt(8)
    v_mfma_f32_16x16x32_bf16 v[80:83], v[216:219], v[128:131], v[80:83]
    v_exp_f32 v166, v166
    v_mfma_f32_16x16x32_bf16 v[84:87], v[216:219], v[136:139], v[84:87]
    v_add_f32 v240, v240, v164
    v_add_f32 v240, v240, v165
    v_mfma_f32_16x16x32_bf16 a[80:83], v[216:219], v[144:147], a[80:83]
    v_exp_f32 v167, v167
    v_mfma_f32_16x16x32_bf16 a[84:87], v[216:219], v[152:155], a[84:87]
    v_cvt_pk_bf16_f32 v162, v164, v165
    v_mfma_f32_16x16x32_bf16 v[88:91], v[220:223], v[128:131], v[88:91]
    v_exp_f32 v168, v168
    v_mfma_f32_16x16x32_bf16 v[92:95], v[220:223], v[136:139], v[92:95]
    v_add_f32 v240, v240, v166
    v_add_f32 v240, v240, v167
    v_mfma_f32_16x16x32_bf16 a[88:91], v[220:223], v[144:147], a[88:91]
    v_mfma_f32_16x16x32_bf16 a[92:95], v[220:223], v[152:155], a[92:95]
    s_waitcnt vmcnt(17) lgkmcnt(0)
    s_barrier
    v_mfma_f32_16x16x32_bf16 v[96:99], v[224:227], v[128:131], v[96:99]
    ds_read_b128 v[208:211], v244 offset:0
    ds_read_b128 v[212:215], v244 offset:64
    v_mfma_f32_16x16x32_bf16 v[100:103], v[224:227], v[136:139], v[100:103]
    v_exp_f32 v169, v169
    v_mfma_f32_16x16x32_bf16 a[96:99], v[224:227], v[144:147], a[96:99]
    v_cvt_pk_bf16_f32 v163, v166, v167
    v_mfma_f32_16x16x32_bf16 a[100:103], v[224:227], v[152:155], a[100:103]
    ds_read_b128 v[216:219], v244 offset:128
    ds_read_b128 v[220:223], v244 offset:192
    v_mfma_f32_16x16x32_bf16 v[104:107], v[228:231], v[128:131], v[104:107]
    v_exp_f32 v170, v170
    v_mfma_f32_16x16x32_bf16 v[108:111], v[228:231], v[136:139], v[108:111]
    v_add_f32 v241, v241, v168
    v_add_f32 v241, v241, v169
    v_mfma_f32_16x16x32_bf16 a[104:107], v[228:231], v[144:147], a[104:107]
    v_exp_f32 v171, v171
    v_mfma_f32_16x16x32_bf16 a[108:111], v[228:231], v[152:155], a[108:111]
    v_cvt_pk_bf16_f32 v168, v168, v169
    v_mfma_f32_16x16x32_bf16 v[112:115], v[232:235], v[128:131], v[112:115]
    v_exp_f32 v172, v172
    v_mfma_f32_16x16x32_bf16 v[116:119], v[232:235], v[136:139], v[116:119]
    v_add_f32 v241, v241, v170
    v_mfma_f32_16x16x32_bf16 a[112:115], v[232:235], v[144:147], a[112:115]
    v_add_f32 v241, v241, v171
    v_mfma_f32_16x16x32_bf16 a[116:119], v[232:235], v[152:155], a[116:119]
    v_exp_f32 v173, v173
    v_mfma_f32_16x16x32_bf16 v[120:123], v[236:239], v[128:131], v[120:123]
    v_cvt_pk_bf16_f32 v169, v170, v171
    v_mfma_f32_16x16x32_bf16 v[124:127], v[236:239], v[136:139], v[124:127]
    v_exp_f32 v174, v174
    v_mfma_f32_16x16x32_bf16 a[120:123], v[236:239], v[144:147], a[120:123]
    v_add_f32 v241, v241, v172
    v_add_f32 v241, v241, v173
    v_mfma_f32_16x16x32_bf16 a[124:127], v[236:239], v[152:155], a[124:127]
    s_waitcnt lgkmcnt(0)
    v_mfma_f32_16x16x32_bf16 v[128:131], v[208:211], a[128:131], v[192:195]
    ds_read_b128 v[224:227], v244 offset:8448
    ds_read_b128 v[228:231], v244 offset:8512
    v_mfma_f32_16x16x32_bf16 v[128:131], v[212:215], a[132:135], v[128:131]
    s_add_u32 s43, s43, 32768
    s_add_u32 m0, s40, 67584
    v_mfma_f32_16x16x32_bf16 v[128:131], v[216:219], a[136:139], v[128:131]
    buffer_load_dwordx4 v246, s[12:15], s43 offen offset:0 nt lds
    v_mfma_f32_16x16x32_bf16 v[128:131], v[220:223], a[140:143], v[128:131]
    ds_read_b128 v[232:235], v244 offset:8576
    ds_read_b128 v[236:239], v244 offset:8640
    v_mfma_f32_16x16x32_bf16 v[136:139], v[208:211], a[160:163], v[196:199]
    s_add_u32 m0, s40, 67616
    v_mfma_f32_16x16x32_bf16 v[136:139], v[212:215], a[164:167], v[136:139]
    buffer_load_dwordx4 v246, s[12:15], s43 offen offset:1024 nt lds
    v_mfma_f32_16x16x32_bf16 v[136:139], v[216:219], a[168:171], v[136:139]
    v_exp_f32 v175, v175
    v_mfma_f32_16x16x32_bf16 v[136:139], v[220:223], a[172:175], v[136:139]
    v_cvt_pk_bf16_f32 v170, v172, v173
    v_mfma_f32_16x16x32_bf16 v[144:147], v[208:211], a[192:195], v[200:203]
    v_exp_f32 v176, v176
    v_mfma_f32_16x16x32_bf16 v[144:147], v[212:215], a[196:199], v[144:147]
    s_add_u32 m0, s40, 67648
    v_add_f32 v241, v241, v174
    v_mfma_f32_16x16x32_bf16 v[144:147], v[216:219], a[200:203], v[144:147]
    buffer_load_dwordx4 v246, s[12:15], s43 offen offset:2048 nt lds
    v_mfma_f32_16x16x32_bf16 v[144:147], v[220:223], a[204:207], v[144:147]
    v_add_f32 v241, v241, v175
    v_mfma_f32_16x16x32_bf16 v[152:155], v[208:211], a[224:227], v[204:207]
    v_exp_f32 v177, v177
    v_mfma_f32_16x16x32_bf16 v[152:155], v[212:215], a[228:231], v[152:155]
    v_cvt_pk_bf16_f32 v171, v174, v175
    v_mfma_f32_16x16x32_bf16 v[152:155], v[216:219], a[232:235], v[152:155]
    s_add_u32 s44, s44, 32768
    s_add_u32 m0, s40, 67680
    v_mfma_f32_16x16x32_bf16 v[152:155], v[220:223], a[236:239], v[152:155]
    s_waitcnt lgkmcnt(0)
    v_mfma_f32_16x16x32_bf16 v[132:135], v[224:227], a[128:131], v[192:195]
    ds_read_b128 v[208:211], v244 offset:256
    ds_read_b128 v[212:215], v244 offset:320
    v_mfma_f32_16x16x32_bf16 v[132:135], v[228:231], a[132:135], v[132:135]
    buffer_load_dwordx4 v246, s[12:15], s43 offen offset:3072 nt lds
    v_mfma_f32_16x16x32_bf16 v[132:135], v[232:235], a[136:139], v[132:135]
    s_add_u32 m0, s40, 71808
    v_exp_f32 v178, v178
    v_mfma_f32_16x16x32_bf16 v[132:135], v[236:239], a[140:143], v[132:135]
    ds_read_b128 v[216:219], v244 offset:384
    ds_read_b128 v[220:223], v244 offset:448
    v_mfma_f32_16x16x32_bf16 v[140:143], v[224:227], a[160:163], v[196:199]
    buffer_load_dwordx4 v246, s[12:15], s44 offen offset:0 nt lds
    v_mfma_f32_16x16x32_bf16 v[140:143], v[228:231], a[164:167], v[140:143]
    v_add_f32 v242, v242, v176
    v_add_f32 v242, v242, v177
    v_mfma_f32_16x16x32_bf16 v[140:143], v[232:235], a[168:171], v[140:143]
    v_exp_f32 v179, v179
    v_mfma_f32_16x16x32_bf16 v[140:143], v[236:239], a[172:175], v[140:143]
    s_add_u32 m0, s40, 71840
    v_cvt_pk_bf16_f32 v176, v176, v177
    v_mfma_f32_16x16x32_bf16 v[148:151], v[224:227], a[192:195], v[200:203]
    buffer_load_dwordx4 v246, s[12:15], s44 offen offset:1024 nt lds
    v_mfma_f32_16x16x32_bf16 v[148:151], v[228:231], a[196:199], v[148:151]
    v_exp_f32 v180, v180
    v_mfma_f32_16x16x32_bf16 v[148:151], v[232:235], a[200:203], v[148:151]
    v_add_f32 v242, v242, v178
    v_add_f32 v242, v242, v179
    v_mfma_f32_16x16x32_bf16 v[148:151], v[236:239], a[204:207], v[148:151]
    v_exp_f32 v181, v181
    v_mfma_f32_16x16x32_bf16 v[156:159], v[224:227], a[224:227], v[204:207]
    s_add_u32 m0, s40, 71872
    v_cvt_pk_bf16_f32 v177, v178, v179
    v_mfma_f32_16x16x32_bf16 v[156:159], v[228:231], a[228:231], v[156:159]
    buffer_load_dwordx4 v246, s[12:15], s44 offen offset:2048 nt lds
    v_mfma_f32_16x16x32_bf16 v[156:159], v[232:235], a[232:235], v[156:159]
    v_exp_f32 v182, v182
    v_mfma_f32_16x16x32_bf16 v[156:159], v[236:239], a[236:239], v[156:159]
    v_add_f32 v242, v242, v180
    s_waitcnt lgkmcnt(0)
    v_mfma_f32_16x16x32_bf16 v[128:131], v[208:211], a[144:147], v[128:131]
    ds_read_b128 v[224:227], v244 offset:8704
    ds_read_b128 v[228:231], v244 offset:8768
    v_mfma_f32_16x16x32_bf16 v[128:131], v[212:215], a[148:151], v[128:131]
    s_add_u32 m0, s40, 71904
    v_add_f32 v242, v242, v181
    v_mfma_f32_16x16x32_bf16 v[128:131], v[216:219], a[152:155], v[128:131]
    buffer_load_dwordx4 v246, s[12:15], s44 offen offset:3072 nt lds
    v_mfma_f32_16x16x32_bf16 v[128:131], v[220:223], a[156:159], v[128:131]
    ds_read_b128 v[232:235], v244 offset:8832
    ds_read_b128 v[236:239], v244 offset:8896
    v_mfma_f32_16x16x32_bf16 v[136:139], v[208:211], a[176:179], v[136:139]
    v_exp_f32 v183, v183
    v_mfma_f32_16x16x32_bf16 v[136:139], v[212:215], a[180:183], v[136:139]
    s_mov_b32 m0, 143360
    v_cvt_pk_bf16_f32 v178, v180, v181
    v_mfma_f32_16x16x32_bf16 v[136:139], v[216:219], a[184:187], v[136:139]
    buffer_load_dwordx4 v247, s[24:27], s38 offen lds
    v_mfma_f32_16x16x32_bf16 v[136:139], v[220:223], a[188:191], v[136:139]
    s_add_u32 s38, s38, 1024
    v_mfma_f32_16x16x32_bf16 v[144:147], v[208:211], a[208:211], v[144:147]
    v_exp_f32 v184, v184
    v_mfma_f32_16x16x32_bf16 v[144:147], v[212:215], a[212:215], v[144:147]
    v_add_f32 v242, v242, v182
    v_add_f32 v242, v242, v183
    v_mfma_f32_16x16x32_bf16 v[144:147], v[216:219], a[216:219], v[144:147]
    v_exp_f32 v185, v185
    v_mfma_f32_16x16x32_bf16 v[144:147], v[220:223], a[220:223], v[144:147]
    v_cvt_pk_bf16_f32 v179, v182, v183
    v_mfma_f32_16x16x32_bf16 v[152:155], v[208:211], a[240:243], v[152:155]
    v_exp_f32 v186, v186
    v_mfma_f32_16x16x32_bf16 v[152:155], v[212:215], a[244:247], v[152:155]
    v_add_f32 v243, v243, v184
    v_add_f32 v243, v243, v185
    v_mfma_f32_16x16x32_bf16 v[152:155], v[216:219], a[248:251], v[152:155]
    v_exp_f32 v187, v187
    v_mfma_f32_16x16x32_bf16 v[152:155], v[220:223], a[252:255], v[152:155]
    s_waitcnt vmcnt(18) lgkmcnt(0)
    s_barrier
    v_mfma_f32_16x16x32_bf16 v[132:135], v[224:227], a[144:147], v[132:135]
    ds_read_b64_tr_b16 v[208:209], v245 offset:33792
    ds_read_b64_tr_b16 v[210:211], v245 offset:42240
    v_mfma_f32_16x16x32_bf16 v[132:135], v[228:231], a[148:151], v[132:135]
    v_cvt_pk_bf16_f32 v184, v184, v185
    v_mfma_f32_16x16x32_bf16 v[132:135], v[232:235], a[152:155], v[132:135]
    v_exp_f32 v188, v188
    v_mfma_f32_16x16x32_bf16 v[132:135], v[236:239], a[156:159], v[132:135]
    ds_read_b64_tr_b16 v[212:213], v245 offset:33824
    ds_read_b64_tr_b16 v[214:215], v245 offset:42272
    v_mfma_f32_16x16x32_bf16 v[140:143], v[224:227], a[176:179], v[140:143]
    v_add_f32 v243, v243, v186
    v_add_f32 v243, v243, v187
    v_mfma_f32_16x16x32_bf16 v[140:143], v[228:231], a[180:183], v[140:143]
    v_exp_f32 v189, v189
    v_mfma_f32_16x16x32_bf16 v[140:143], v[232:235], a[184:187], v[140:143]
    ds_read_b64_tr_b16 v[216:217], v245 offset:33856
    ds_read_b64_tr_b16 v[218:219], v245 offset:42304
    v_mfma_f32_16x16x32_bf16 v[140:143], v[236:239], a[188:191], v[140:143]
    v_cvt_pk_bf16_f32 v185, v186, v187
    v_mfma_f32_16x16x32_bf16 v[148:151], v[224:227], a[208:211], v[148:151]
    v_exp_f32 v190, v190
    v_mfma_f32_16x16x32_bf16 v[148:151], v[228:231], a[212:215], v[148:151]
    ds_read_b64_tr_b16 v[220:221], v245 offset:33888
    ds_read_b64_tr_b16 v[222:223], v245 offset:42336
    v_mfma_f32_16x16x32_bf16 v[148:151], v[232:235], a[216:219], v[148:151]
    v_add_f32 v243, v243, v188
    v_add_f32 v243, v243, v189
    v_mfma_f32_16x16x32_bf16 v[148:151], v[236:239], a[220:223], v[148:151]
    v_exp_f32 v191, v191
    v_mfma_f32_16x16x32_bf16 v[156:159], v[224:227], a[240:243], v[156:159]
    v_cvt_pk_bf16_f32 v186, v188, v189
    v_add_f32 v243, v243, v190
    v_mfma_f32_16x16x32_bf16 v[156:159], v[228:231], a[244:247], v[156:159]
    v_add_f32 v243, v243, v191
    v_cvt_pk_bf16_f32 v187, v190, v191
    v_mfma_f32_16x16x32_bf16 v[156:159], v[232:235], a[248:251], v[156:159]
    v_mfma_f32_16x16x32_bf16 v[156:159], v[236:239], a[252:255], v[156:159]
    s_waitcnt lgkmcnt(4)
    v_mfma_f32_16x16x32_bf16 v[0:3], v[208:211], v[160:163], v[0:3]
    ds_read_b64_tr_b16 v[224:225], v245 offset:33920
    ds_read_b64_tr_b16 v[226:227], v245 offset:42368
    v_mfma_f32_16x16x32_bf16 v[4:7], v[208:211], v[168:171], v[4:7]
    ds_read_b64_tr_b16 v[228:229], v245 offset:33952
    ds_read_b64_tr_b16 v[230:231], v245 offset:42400
    v_mfma_f32_16x16x32_bf16 a[0:3], v[208:211], v[176:179], a[0:3]
    ds_read_b64_tr_b16 v[232:233], v245 offset:33984
    ds_read_b64_tr_b16 v[234:235], v245 offset:42432
    v_mfma_f32_16x16x32_bf16 a[4:7], v[208:211], v[184:187], a[4:7]
    s_add_u32 s41, s41, 32768
    s_add_u32 m0, s40, 0
    v_mfma_f32_16x16x32_bf16 v[8:11], v[212:215], v[160:163], v[8:11]
    ds_read_b64_tr_b16 v[236:237], v245 offset:34016
    ds_read_b64_tr_b16 v[238:239], v245 offset:42464
    v_mfma_f32_16x16x32_bf16 v[12:15], v[212:215], v[168:171], v[12:15]
    buffer_load_dwordx4 v246, s[8:11], s41 offen offset:0 nt lds
    v_mfma_f32_16x16x32_bf16 a[8:11], v[212:215], v[176:179], a[8:11]
    v_exp_f32 v128, v128
    v_mfma_f32_16x16x32_bf16 a[12:15], v[212:215], v[184:187], a[12:15]
    s_add_u32 m0, s40, 32
    s_waitcnt lgkmcnt(8)
    v_mfma_f32_16x16x32_bf16 v[16:19], v[216:219], v[160:163], v[16:19]
    ds_read_b64_tr_b16 v[208:209], v245 offset:34048
    ds_read_b64_tr_b16 v[210:211], v245 offset:42496
    v_mfma_f32_16x16x32_bf16 v[20:23], v[216:219], v[168:171], v[20:23]
    buffer_load_dwordx4 v246, s[8:11], s41 offen offset:1024 nt lds
    v_mfma_f32_16x16x32_bf16 a[16:19], v[216:219], v[176:179], a[16:19]
    v_exp_f32 v129, v129
    v_mfma_f32_16x16x32_bf16 a[20:23], v[216:219], v[184:187], a[20:23]
    v_mfma_f32_16x16x32_bf16 v[24:27], v[220:223], v[160:163], v[24:27]
    ds_read_b64_tr_b16 v[212:213], v245 offset:34080
    ds_read_b64_tr_b16 v[214:215], v245 offset:42528
    v_mfma_f32_16x16x32_bf16 v[28:31], v[220:223], v[168:171], v[28:31]
    s_add_u32 m0, s40, 64
    v_mfma_f32_16x16x32_bf16 a[24:27], v[220:223], v[176:179], a[24:27]
    buffer_load_dwordx4 v246, s[8:11], s41 offen offset:2048 nt lds
    v_mfma_f32_16x16x32_bf16 a[28:31], v[220:223], v[184:187], a[28:31]
    s_waitcnt lgkmcnt(8)
    v_mfma_f32_16x16x32_bf16 v[32:35], v[224:227], v[160:163], v[32:35]
    ds_read_b64_tr_b16 v[216:217], v245 offset:34112
    ds_read_b64_tr_b16 v[218:219], v245 offset:42560
    v_mfma_f32_16x16x32_bf16 v[36:39], v[224:227], v[168:171], v[36:39]
    s_add_u32 s42, s42, 32768
    s_add_u32 m0, s40, 96
    v_mfma_f32_16x16x32_bf16 a[32:35], v[224:227], v[176:179], a[32:35]
    buffer_load_dwordx4 v246, s[8:11], s41 offen offset:3072 nt lds
    v_mfma_f32_16x16x32_bf16 a[36:39], v[224:227], v[184:187], a[36:39]
    v_exp_f32 v130, v130
    v_mfma_f32_16x16x32_bf16 v[40:43], v[228:231], v[160:163], v[40:43]
    ds_read_b64_tr_b16 v[220:221], v245 offset:34144
    ds_read_b64_tr_b16 v[222:223], v245 offset:42592
    v_mfma_f32_16x16x32_bf16 v[44:47], v[228:231], v[168:171], v[44:47]
    v_add_f32 v240, v240, v128
    v_add_f32 v240, v240, v129
    v_mfma_f32_16x16x32_bf16 a[40:43], v[228:231], v[176:179], a[40:43]
    s_add_u32 m0, s40, 4224
    v_mfma_f32_16x16x32_bf16 a[44:47], v[228:231], v[184:187], a[44:47]
    s_waitcnt lgkmcnt(8)
    v_mfma_f32_16x16x32_bf16 v[48:51], v[232:235], v[160:163], v[48:51]
    ds_read_b64_tr_b16 v[224:225], v245 offset:34176
    ds_read_b64_tr_b16 v[226:227], v245 offset:42624
    v_mfma_f32_16x16x32_bf16 v[52:55], v[232:235], v[168:171], v[52:55]
    buffer_load_dwordx4 v246, s[8:11], s42 offen offset:0 nt lds
    v_mfma_f32_16x16x32_bf16 a[48:51], v[232:235], v[176:179], a[48:51]
    v_exp_f32 v131, v131
    v_mfma_f32_16x16x32_bf16 a[52:55], v[232:235], v[184:187], a[52:55]
    s_add_u32 m0, s40, 4256
    v_cvt_pk_bf16_f32 v128, v128, v129
    v_mfma_f32_16x16x32_bf16 v[56:59], v[236:239], v[160:163], v[56:59]
    ds_read_b64_tr_b16 v[228:229], v245 offset:34208
    ds_read_b64_tr_b16 v[230:231], v245 offset:42656
    v_mfma_f32_16x16x32_bf16 v[60:63], v[236:239], v[168:171], v[60:63]
    buffer_load_dwordx4 v246, s[8:11], s42 offen offset:1024 nt lds
    v_mfma_f32_16x16x32_bf16 a[56:59], v[236:239], v[176:179], a[56:59]
    v_exp_f32 v132, v132
    v_mfma_f32_16x16x32_bf16 a[60:63], v[236:239], v[184:187], a[60:63]
    v_add_f32 v240, v240, v130
    s_waitcnt lgkmcnt(8)
    v_mfma_f32_16x16x32_bf16 v[64:67], v[208:211], v[160:163], v[64:67]
    ds_read_b64_tr_b16 v[232:233], v245 offset:34240
    ds_read_b64_tr_b16 v[234:235], v245 offset:42688
    v_mfma_f32_16x16x32_bf16 v[68:71], v[208:211], v[168:171], v[68:71]
    s_add_u32 m0, s40, 4288
    v_add_f32 v240, v240, v131
    v_mfma_f32_16x16x32_bf16 a[64:67], v[208:211], v[176:179], a[64:67]
    buffer_load_dwordx4 v246, s[8:11], s42 offen offset:2048 nt lds
    v_mfma_f32_16x16x32_bf16 a[68:71], v[208:211], v[184:187], a[68:71]
    v_exp_f32 v133, v133
    v_mfma_f32_16x16x32_bf16 v[72:75], v[212:215], v[160:163], v[72:75]
    ds_read_b64_tr_b16 v[236:237], v245 offset:34272
    ds_read_b64_tr_b16 v[238:239], v245 offset:42720
    v_mfma_f32_16x16x32_bf16 v[76:79], v[212:215], v[168:171], v[76:79]
    s_add_u32 m0, s40, 4320
    v_cvt_pk_bf16_f32 v129, v130, v131
    v_mfma_f32_16x16x32_bf16 a[72:75], v[212:215], v[176:179], a[72:75]
    buffer_load_dwordx4 v246, s[8:11], s42 offen offset:3072 nt lds
    v_mfma_f32_16x16x32_bf16 a[76:79], v[212:215], v[184:187], a[76:79]
    s_waitcnt lgkmcnt(8)
    v_mfma_f32_16x16x32_bf16 v[80:83], v[216:219], v[160:163], v[80:83]
    v_exp_f32 v134, v134
    v_mfma_f32_16x16x32_bf16 v[84:87], v[216:219], v[168:171], v[84:87]
    v_add_f32 v240, v240, v132
    v_add_f32 v240, v240, v133
    v_mfma_f32_16x16x32_bf16 a[80:83], v[216:219], v[176:179], a[80:83]
    v_exp_f32 v135, v135
    v_mfma_f32_16x16x32_bf16 a[84:87], v[216:219], v[184:187], a[84:87]
    v_cvt_pk_bf16_f32 v130, v132, v133
    v_mfma_f32_16x16x32_bf16 v[88:91], v[220:223], v[160:163], v[88:91]
    v_exp_f32 v136, v136
    v_mfma_f32_16x16x32_bf16 v[92:95], v[220:223], v[168:171], v[92:95]
    v_add_f32 v240, v240, v134
    v_add_f32 v240, v240, v135
    v_mfma_f32_16x16x32_bf16 a[88:91], v[220:223], v[176:179], a[88:91]
    v_mfma_f32_16x16x32_bf16 a[92:95], v[220:223], v[184:187], a[92:95]
    s_waitcnt vmcnt(17) lgkmcnt(0)
    s_barrier
    v_mfma_f32_16x16x32_bf16 v[96:99], v[224:227], v[160:163], v[96:99]
    ds_read_b128 v[208:211], v244 offset:33792
    ds_read_b128 v[212:215], v244 offset:33856
    v_mfma_f32_16x16x32_bf16 v[100:103], v[224:227], v[168:171], v[100:103]
    v_exp_f32 v137, v137
    v_mfma_f32_16x16x32_bf16 a[96:99], v[224:227], v[176:179], a[96:99]
    v_cvt_pk_bf16_f32 v131, v134, v135
    v_mfma_f32_16x16x32_bf16 a[100:103], v[224:227], v[184:187], a[100:103]
    ds_read_b128 v[216:219], v244 offset:33920
    ds_read_b128 v[220:223], v244 offset:33984
    v_mfma_f32_16x16x32_bf16 v[104:107], v[228:231], v[160:163], v[104:107]
    v_exp_f32 v138, v138
    v_mfma_f32_16x16x32_bf16 v[108:111], v[228:231], v[168:171], v[108:111]
    v_add_f32 v241, v241, v136
    v_add_f32 v241, v241, v137
    v_mfma_f32_16x16x32_bf16 a[104:107], v[228:231], v[176:179], a[104:107]
    v_exp_f32 v139, v139
    v_mfma_f32_16x16x32_bf16 a[108:111], v[228:231], v[184:187], a[108:111]
    v_cvt_pk_bf16_f32 v136, v136, v137
    v_mfma_f32_16x16x32_bf16 v[112:115], v[232:235], v[160:163], v[112:115]
    v_exp_f32 v140, v140
    v_mfma_f32_16x16x32_bf16 v[116:119], v[232:235], v[168:171], v[116:119]
    v_add_f32 v241, v241, v138
    v_mfma_f32_16x16x32_bf16 a[112:115], v[232:235], v[176:179], a[112:115]
    v_add_f32 v241, v241, v139
    v_mfma_f32_16x16x32_bf16 a[116:119], v[232:235], v[184:187], a[116:119]
    v_exp_f32 v141, v141
    v_mfma_f32_16x16x32_bf16 v[120:123], v[236:239], v[160:163], v[120:123]
    v_cvt_pk_bf16_f32 v137, v138, v139
    v_mfma_f32_16x16x32_bf16 v[124:127], v[236:239], v[168:171], v[124:127]
    v_exp_f32 v142, v142
    v_mfma_f32_16x16x32_bf16 a[120:123], v[236:239], v[176:179], a[120:123]
    v_add_f32 v241, v241, v140
    v_add_f32 v241, v241, v141
    v_mfma_f32_16x16x32_bf16 a[124:127], v[236:239], v[184:187], a[124:127]
    s_cmp_eq_u32 s49, s39
    s_cbranch_scc1 Latt_touch
Latt_touch_ret:
    s_sub_u32 s49, s49, 1
    s_cmp_lg_u32 s49, 0
    s_cbranch_scc1 Latt_loop
    s_waitcnt lgkmcnt(0)
    v_mfma_f32_16x16x32_bf16 v[160:163], v[208:211], a[128:131], v[192:195]
    ds_read_b128 v[224:227], v244 offset:42240
    ds_read_b128 v[228:231], v244 offset:42304
    v_mfma_f32_16x16x32_bf16 v[160:163], v[212:215], a[132:135], v[160:163]
    s_add_u32 s43, s43, 32768
    s_add_u32 m0, s40, 101376
    v_mfma_f32_16x16x32_bf16 v[160:163], v[216:219], a[136:139], v[160:163]
    buffer_load_dwordx4 v246, s[12:15], s43 offen offset:0 nt lds
    v_mfma_f32_16x16x32_bf16 v[160:163], v[220:223], a[140:143], v[160:163]
    ds_read_b128 v[232:235], v244 offset:42368
    ds_read_b128 v[236:239], v244 offset:42432
    v_mfma_f32_16x16x32_bf16 v[168:171], v[208:211], a[160:163], v[196:199]
    s_add_u32 m0, s40, 101408
    v_mfma_f32_16x16x32_bf16 v[168:171], v[212:215], a[164:167], v[168:171]
    buffer_load_dwordx4 v246, s[12:15], s43 offen offset:1024 nt lds
    v_mfma_f32_16x16x32_bf16 v[168:171], v[216:219], a[168:171], v[168:171]
    v_exp_f32 v143, v143
    v_mfma_f32_16x16x32_bf16 v[168:171], v[220:223], a[172:175], v[168:171]
    v_cvt_pk_bf16_f32 v138, v140, v141
    v_mfma_f32_16x16x32_bf16 v[176:179], v[208:211], a[192:195], v[200:203]
    v_exp_f32 v144, v144
    v_mfma_f32_16x16x32_bf16 v[176:179], v[212:215], a[196:199], v[176:179]
    s_add_u32 m0, s40, 101440
    v_add_f32 v241, v241, v142
    v_mfma_f32_16x16x32_bf16 v[176:179], v[216:219], a[200:203], v[176:179]
    buffer_load_dwordx4 v246, s[12:15], s43 offen offset:2048 nt lds
    v_mfma_f32_16x16x32_bf16 v[176:179], v[220:223], a[204:207], v[176:179]
    v_add_f32 v241, v241, v143
    v_mfma_f32_16x16x32_bf16 v[184:187], v[208:211], a[224:227], v[204:207]
    v_exp_f32 v145, v145
    v_mfma_f32_16x16x32_bf16 v[184:187], v[212:215], a[228:231], v[184:187]
    v_cvt_pk_bf16_f32 v139, v142, v143
    v_mfma_f32_16x16x32_bf16 v[184:187], v[216:219], a[232:235], v[184:187]
    s_add_u32 s44, s44, 32768
    s_add_u32 m0, s40, 101472
    v_mfma_f32_16x16x32_bf16 v[184:187], v[220:223], a[236:239], v[184:187]
    s_waitcnt lgkmcnt(0)
    v_mfma_f32_16x16x32_bf16 v[164:167], v[224:227], a[128:131], v[192:195]
    ds_read_b128 v[208:211], v244 offset:34048
    ds_read_b128 v[212:215], v244 offset:34112
    v_mfma_f32_16x16x32_bf16 v[164:167], v[228:231], a[132:135], v[164:167]
    buffer_load_dwordx4 v246, s[12:15], s43 offen offset:3072 nt lds
    v_mfma_f32_16x16x32_bf16 v[164:167], v[232:235], a[136:139], v[164:167]
    s_add_u32 m0, s40, 105600
    v_exp_f32 v146, v146
    v_mfma_f32_16x16x32_bf16 v[164:167], v[236:239], a[140:143], v[164:167]
    ds_read_b128 v[216:219], v244 offset:34176
    ds_read_b128 v[220:223], v244 offset:34240
    v_mfma_f32_16x16x32_bf16 v[172:175], v[224:227], a[160:163], v[196:199]
    buffer_load_dwordx4 v246, s[12:15], s44 offen offset:0 nt lds
    v_mfma_f32_16x16x32_bf16 v[172:175], v[228:231], a[164:167], v[172:175]
    v_add_f32 v242, v242, v144
    v_add_f32 v242, v242, v145
    v_mfma_f32_16x16x32_bf16 v[172:175], v[232:235], a[168:171], v[172:175]
    v_exp_f32 v147, v147
    v_mfma_f32_16x16x32_bf16 v[172:175], v[236:239], a[172:175], v[172:175]
    s_add_u32 m0, s40, 105632
    v_cvt_pk_bf16_f32 v144, v144, v145
    v_mfma_f32_16x16x32_bf16 v[180:183], v[224:227], a[192:195], v[200:203]
    buffer_load_dwordx4 v246, s[12:15], s44 offen offset:1024 nt lds
    v_mfma_f32_16x16x32_bf16 v[180:183], v[228:231], a[196:199], v[180:183]
    v_exp_f32 v148, v148
    v_mfma_f32_16x16x32_bf16 v[180:183], v[232:235], a[200:203], v[180:183]
    v_add_f32 v242, v242, v146
    v_add_f32 v242, v242, v147
    v_mfma_f32_16x16x32_bf16 v[180:183], v[236:239], a[204:207], v[180:183]
    v_exp_f32 v149, v149
    v_mfma_f32_16x16x32_bf16 v[188:191], v[224:227], a[224:227], v[204:207]
    s_add_u32 m0, s40, 105664
    v_cvt_pk_bf16_f32 v145, v146, v147
    v_mfma_f32_16x16x32_bf16 v[188:191], v[228:231], a[228:231], v[188:191]
    buffer_load_dwordx4 v246, s[12:15], s44 offen offset:2048 nt lds
    v_mfma_f32_16x16x32_bf16 v[188:191], v[232:235], a[232:235], v[188:191]
    v_exp_f32 v150, v150
    v_mfma_f32_16x16x32_bf16 v[188:191], v[236:239], a[236:239], v[188:191]
    v_add_f32 v242, v242, v148
    s_waitcnt lgkmcnt(0)
    v_mfma_f32_16x16x32_bf16 v[160:163], v[208:211], a[144:147], v[160:163]
    ds_read_b128 v[224:227], v244 offset:42496
    ds_read_b128 v[228:231], v244 offset:42560
    v_mfma_f32_16x16x32_bf16 v[160:163], v[212:215], a[148:151], v[160:163]
    s_add_u32 m0, s40, 105696
    v_add_f32 v242, v242, v149
    v_mfma_f32_16x16x32_bf16 v[160:163], v[216:219], a[152:155], v[160:163]
    buffer_load_dwordx4 v246, s[12:15], s44 offen offset:3072 nt lds
    v_mfma_f32_16x16x32_bf16 v[160:163], v[220:223], a[156:159], v[160:163]
    ds_read_b128 v[232:235], v244 offset:42624
    ds_read_b128 v[236:239], v244 offset:42688
    v_mfma_f32_16x16x32_bf16 v[168:171], v[208:211], a[176:179], v[168:171]
    v_exp_f32 v151, v151
    v_mfma_f32_16x16x32_bf16 v[168:171], v[212:215], a[180:183], v[168:171]
    s_mov_b32 m0, 143360
    v_cvt_pk_bf16_f32 v146, v148, v149
    v_mfma_f32_16x16x32_bf16 v[168:171], v[216:219], a[184:187], v[168:171]
    global_load_lds_dwordx4 v[254:255], off
    v_mfma_f32_16x16x32_bf16 v[168:171], v[220:223], a[188:191], v[168:171]
    v_exp_f32 v152, v152
    v_mfma_f32_16x16x32_bf16 v[176:179], v[208:211], a[208:211], v[176:179]
    v_add_f32 v242, v242, v150
    v_add_f32 v242, v242, v151
    v_mfma_f32_16x16x32_bf16 v[176:179], v[212:215], a[212:215], v[176:179]
    v_mfma_f32_16x16x32_bf16 v[176:179], v[216:219], a[216:219], v[176:179]
    v_exp_f32 v153, v153
    v_mfma_f32_16x16x32_bf16 v[176:179], v[220:223], a[220:223], v[176:179]
    v_cvt_pk_bf16_f32 v147, v150, v151
    v_mfma_f32_16x16x32_bf16 v[184:187], v[208:211], a[240:243], v[184:187]
    v_exp_f32 v154, v154
    v_mfma_f32_16x16x32_bf16 v[184:187], v[212:215], a[244:247], v[184:187]
    v_add_f32 v243, v243, v152
    v_add_f32 v243, v243, v153
    v_mfma_f32_16x16x32_bf16 v[184:187], v[216:219], a[248:251], v[184:187]
    v_exp_f32 v155, v155
    v_mfma_f32_16x16x32_bf16 v[184:187], v[220:223], a[252:255], v[184:187]
    s_waitcnt vmcnt(18) lgkmcnt(0)
    s_barrier
    v_mfma_f32_16x16x32_bf16 v[164:167], v[224:227], a[144:147], v[164:167]
    ds_read_b64_tr_b16 v[208:209], v245 offset:0
    ds_read_b64_tr_b16 v[210:211], v245 offset:8448
    v_mfma_f32_16x16x32_bf16 v[164:167], v[228:231], a[148:151], v[164:167]
    v_cvt_pk_bf16_f32 v152, v152, v153
    v_mfma_f32_16x16x32_bf16 v[164:167], v[232:235], a[152:155], v[164:167]
    v_exp_f32 v156, v156
    v_mfma_f32_16x16x32_bf16 v[164:167], v[236:239], a[156:159], v[164:167]
    ds_read_b64_tr_b16 v[212:213], v245 offset:32
    ds_read_b64_tr_b16 v[214:215], v245 offset:8480
    v_mfma_f32_16x16x32_bf16 v[172:175], v[224:227], a[176:179], v[172:175]
    v_add_f32 v243, v243, v154
    v_add_f32 v243, v243, v155
    v_mfma_f32_16x16x32_bf16 v[172:175], v[228:231], a[180:183], v[172:175]
    v_exp_f32 v157, v157
    v_mfma_f32_16x16x32_bf16 v[172:175], v[232:235], a[184:187], v[172:175]
    ds_read_b64_tr_b16 v[216:217], v245 offset:64
    ds_read_b64_tr_b16 v[218:219], v245 offset:8512
    v_mfma_f32_16x16x32_bf16 v[172:175], v[236:239], a[188:191], v[172:175]
    v_cvt_pk_bf16_f32 v153, v154, v155
    v_mfma_f32_16x16x32_bf16 v[180:183], v[224:227], a[208:211], v[180:183]
    v_exp_f32 v158, v158
    v_mfma_f32_16x16x32_bf16 v[180:183], v[228:231], a[212:215], v[180:183]
    ds_read_b64_tr_b16 v[220:221], v245 offset:96
    ds_read_b64_tr_b16 v[222:223], v245 offset:8544
    v_mfma_f32_16x16x32_bf16 v[180:183], v[232:235], a[216:219], v[180:183]
    v_add_f32 v243, v243, v156
    v_add_f32 v243, v243, v157
    v_mfma_f32_16x16x32_bf16 v[180:183], v[236:239], a[220:223], v[180:183]
    v_exp_f32 v159, v159
    v_mfma_f32_16x16x32_bf16 v[188:191], v[224:227], a[240:243], v[188:191]
    v_cvt_pk_bf16_f32 v154, v156, v157
    v_add_f32 v243, v243, v158
    v_mfma_f32_16x16x32_bf16 v[188:191], v[228:231], a[244:247], v[188:191]
    v_add_f32 v243, v243, v159
    v_cvt_pk_bf16_f32 v155, v158, v159
    v_mfma_f32_16x16x32_bf16 v[188:191], v[232:235], a[248:251], v[188:191]
    v_mfma_f32_16x16x32_bf16 v[188:191], v[236:239], a[252:255], v[188:191]
    s_waitcnt lgkmcnt(4)
    v_mfma_f32_16x16x32_bf16 v[0:3], v[208:211], v[128:131], v[0:3]
    ds_read_b64_tr_b16 v[224:225], v245 offset:128
    ds_read_b64_tr_b16 v[226:227], v245 offset:8576
    v_mfma_f32_16x16x32_bf16 v[4:7], v[208:211], v[136:139], v[4:7]
    ds_read_b64_tr_b16 v[228:229], v245 offset:160
    ds_read_b64_tr_b16 v[230:231], v245 offset:8608
    v_mfma_f32_16x16x32_bf16 a[0:3], v[208:211], v[144:147], a[0:3]
    ds_read_b64_tr_b16 v[232:233], v245 offset:192
    ds_read_b64_tr_b16 v[234:235], v245 offset:8640
    v_mfma_f32_16x16x32_bf16 a[4:7], v[208:211], v[152:155], a[4:7]
    s_add_u32 s41, s41, 32768
    s_add_u32 m0, s40, 33792
    v_mfma_f32_16x16x32_bf16 v[8:11], v[212:215], v[128:131], v[8:11]
    ds_read_b64_tr_b16 v[236:237], v245 offset:224
    ds_read_b64_tr_b16 v[238:239], v245 offset:8672
    v_mfma_f32_16x16x32_bf16 v[12:15], v[212:215], v[136:139], v[12:15]
    buffer_load_dwordx4 v246, s[8:11], s41 offen offset:0 nt lds
    v_mfma_f32_16x16x32_bf16 a[8:11], v[212:215], v[144:147], a[8:11]
    v_exp_f32 v160, v160
    v_mfma_f32_16x16x32_bf16 a[12:15], v[212:215], v[152:155], a[12:15]
    s_add_u32 m0, s40, 33824
    s_waitcnt lgkmcnt(8)
    v_mfma_f32_16x16x32_bf16 v[16:19], v[216:219], v[128:131], v[16:19]
    ds_read_b64_tr_b16 v[208:209], v245 offset:256
    ds_read_b64_tr_b16 v[210:211], v245 offset:8704
    v_mfma_f32_16x16x32_bf16 v[20:23], v[216:219], v[136:139], v[20:23]
    buffer_load_dwordx4 v246, s[8:11], s41 offen offset:1024 nt lds
    v_mfma_f32_16x16x32_bf16 a[16:19], v[216:219], v[144:147], a[16:19]
    v_exp_f32 v161, v161
    v_mfma_f32_16x16x32_bf16 a[20:23], v[216:219], v[152:155], a[20:23]
    v_mfma_f32_16x16x32_bf16 v[24:27], v[220:223], v[128:131], v[24:27]
    ds_read_b64_tr_b16 v[212:213], v245 offset:288
    ds_read_b64_tr_b16 v[214:215], v245 offset:8736
    v_mfma_f32_16x16x32_bf16 v[28:31], v[220:223], v[136:139], v[28:31]
    s_add_u32 m0, s40, 33856
    v_mfma_f32_16x16x32_bf16 a[24:27], v[220:223], v[144:147], a[24:27]
    buffer_load_dwordx4 v246, s[8:11], s41 offen offset:2048 nt lds
    v_mfma_f32_16x16x32_bf16 a[28:31], v[220:223], v[152:155], a[28:31]
    s_waitcnt lgkmcnt(8)
    v_mfma_f32_16x16x32_bf16 v[32:35], v[224:227], v[128:131], v[32:35]
    ds_read_b64_tr_b16 v[216:217], v245 offset:320
    ds_read_b64_tr_b16 v[218:219], v245 offset:8768
    v_mfma_f32_16x16x32_bf16 v[36:39], v[224:227], v[136:139], v[36:39]
    s_add_u32 s42, s42, 32768
    s_add_u32 m0, s40, 33888
    v_mfma_f32_16x16x32_bf16 a[32:35], v[224:227], v[144:147], a[32:35]
    buffer_load_dwordx4 v246, s[8:11], s41 offen offset:3072 nt lds
    v_mfma_f32_16x16x32_bf16 a[36:39], v[224:227], v[152:155], a[36:39]
    v_exp_f32 v162, v162
    v_mfma_f32_16x16x32_bf16 v[40:43], v[228:231], v[128:131], v[40:43]
    ds_read_b64_tr_b16 v[220:221], v245 offset:352
    ds_read_b64_tr_b16 v[222:223], v245 offset:8800
    v_mfma_f32_16x16x32_bf16 v[44:47], v[228:231], v[136:139], v[44:47]
    v_add_f32 v240, v240, v160
    v_add_f32 v240, v240, v161
    v_mfma_f32_16x16x32_bf16 a[40:43], v[228:231], v[144:147], a[40:43]
    s_add_u32 m0, s40, 38016
    v_mfma_f32_16x16x32_bf16 a[44:47], v[228:231], v[152:155], a[44:47]
    s_waitcnt lgkmcnt(8)
    v_mfma_f32_16x16x32_bf16 v[48:51], v[232:235], v[128:131], v[48:51]
    ds_read_b64_tr_b16 v[224:225], v245 offset:384
    ds_read_b64_tr_b16 v[226:227], v245 offset:8832
    v_mfma_f32_16x16x32_bf16 v[52:55], v[232:235], v[136:139], v[52:55]
    buffer_load_dwordx4 v246, s[8:11], s42 offen offset:0 nt lds
    v_mfma_f32_16x16x32_bf16 a[48:51], v[232:235], v[144:147], a[48:51]
    v_exp_f32 v163, v163
    v_mfma_f32_16x16x32_bf16 a[52:55], v[232:235], v[152:155], a[52:55]
    s_add_u32 m0, s40, 38048
    v_cvt_pk_bf16_f32 v160, v160, v161
    v_mfma_f32_16x16x32_bf16 v[56:59], v[236:239], v[128:131], v[56:59]
    ds_read_b64_tr_b16 v[228:229], v245 offset:416
    ds_read_b64_tr_b16 v[230:231], v245 offset:8864
    v_mfma_f32_16x16x32_bf16 v[60:63], v[236:239], v[136:139], v[60:63]
    buffer_load_dwordx4 v246, s[8:11], s42 offen offset:1024 nt lds
    v_mfma_f32_16x16x32_bf16 a[56:59], v[236:239], v[144:147], a[56:59]
    v_exp_f32 v164, v164
    v_mfma_f32_16x16x32_bf16 a[60:63], v[236:239], v[152:155], a[60:63]
    v_add_f32 v240, v240, v162
    s_waitcnt lgkmcnt(8)
    v_mfma_f32_16x16x32_bf16 v[64:67], v[208:211], v[128:131], v[64:67]
    ds_read_b64_tr_b16 v[232:233], v245 offset:448
    ds_read_b64_tr_b16 v[234:235], v245 offset:8896
    v_mfma_f32_16x16x32_bf16 v[68:71], v[208:211], v[136:139], v[68:71]
    s_add_u32 m0, s40, 38080
    v_add_f32 v240, v240, v163
    v_mfma_f32_16x16x32_bf16 a[64:67], v[208:211], v[144:147], a[64:67]
    buffer_load_dwordx4 v246, s[8:11], s42 offen offset:2048 nt lds
    v_mfma_f32_16x16x32_bf16 a[68:71], v[208:211], v[152:155], a[68:71]
    v_exp_f32 v165, v165
    v_mfma_f32_16x16x32_bf16 v[72:75], v[212:215], v[128:131], v[72:75]
    ds_read_b64_tr_b16 v[236:237], v245 offset:480
    ds_read_b64_tr_b16 v[238:239], v245 offset:8928
    v_mfma_f32_16x16x32_bf16 v[76:79], v[212:215], v[136:139], v[76:79]
    s_add_u32 m0, s40, 38112
    v_cvt_pk_bf16_f32 v161, v162, v163
    v_mfma_f32_16x16x32_bf16 a[72:75], v[212:215], v[144:147], a[72:75]
    buffer_load_dwordx4 v246, s[8:11], s42 offen offset:3072 nt lds
    v_mfma_f32_16x16x32_bf16 a[76:79], v[212:215], v[152:155], a[76:79]
    s_waitcnt lgkmcnt(8)
    v_mfma_f32_16x16x32_bf16 v[80:83], v[216:219], v[128:131], v[80:83]
    v_exp_f32 v166, v166
    v_mfma_f32_16x16x32_bf16 v[84:87], v[216:219], v[136:139], v[84:87]
    v_add_f32 v240, v240, v164
    v_add_f32 v240, v240, v165
    v_mfma_f32_16x16x32_bf16 a[80:83], v[216:219], v[144:147], a[80:83]
    v_exp_f32 v167, v167
    v_mfma_f32_16x16x32_bf16 a[84:87], v[216:219], v[152:155], a[84:87]
    v_cvt_pk_bf16_f32 v162, v164, v165
    v_mfma_f32_16x16x32_bf16 v[88:91], v[220:223], v[128:131], v[88:91]
    v_exp_f32 v168, v168
    v_mfma_f32_16x16x32_bf16 v[92:95], v[220:223], v[136:139], v[92:95]
    v_add_f32 v240, v240, v166
    v_add_f32 v240, v240, v167
    v_mfma_f32_16x16x32_bf16 a[88:91], v[220:223], v[144:147], a[88:91]
    v_mfma_f32_16x16x32_bf16 a[92:95], v[220:223], v[152:155], a[92:95]
    s_waitcnt vmcnt(17) lgkmcnt(0)
    s_barrier
    v_mfma_f32_16x16x32_bf16 v[96:99], v[224:227], v[128:131], v[96:99]
    ds_read_b128 v[208:211], v244 offset:0
    ds_read_b128 v[212:215], v244 offset:64
    v_mfma_f32_16x16x32_bf16 v[100:103], v[224:227], v[136:139], v[100:103]
    v_exp_f32 v169, v169
    v_mfma_f32_16x16x32_bf16 a[96:99], v[224:227], v[144:147], a[96:99]
    v_cvt_pk_bf16_f32 v163, v166, v167
    v_mfma_f32_16x16x32_bf16 a[100:103], v[224:227], v[152:155], a[100:103]
    ds_read_b128 v[216:219], v244 offset:128
    ds_read_b128 v[220:223], v244 offset:192
    v_mfma_f32_16x16x32_bf16 v[104:107], v[228:231], v[128:131], v[104:107]
    v_exp_f32 v170, v170
    v_mfma_f32_16x16x32_bf16 v[108:111], v[228:231], v[136:139], v[108:111]
    v_add_f32 v241, v241, v168
    v_add_f32 v241, v241, v169
    v_mfma_f32_16x16x32_bf16 a[104:107], v[228:231], v[144:147], a[104:107]
    v_exp_f32 v171, v171
    v_mfma_f32_16x16x32_bf16 a[108:111], v[228:231], v[152:155], a[108:111]
    v_cvt_pk_bf16_f32 v168, v168, v169
    v_mfma_f32_16x16x32_bf16 v[112:115], v[232:235], v[128:131], v[112:115]
    v_exp_f32 v172, v172
    v_mfma_f32_16x16x32_bf16 v[116:119], v[232:235], v[136:139], v[116:119]
    v_add_f32 v241, v241, v170
    v_mfma_f32_16x16x32_bf16 a[112:115], v[232:235], v[144:147], a[112:115]
    v_add_f32 v241, v241, v171
    v_mfma_f32_16x16x32_bf16 a[116:119], v[232:235], v[152:155], a[116:119]
    v_exp_f32 v173, v173
    v_mfma_f32_16x16x32_bf16 v[120:123], v[236:239], v[128:131], v[120:123]
    v_cvt_pk_bf16_f32 v169, v170, v171
    v_mfma_f32_16x16x32_bf16 v[124:127], v[236:239], v[136:139], v[124:127]
    v_exp_f32 v174, v174
    v_mfma_f32_16x16x32_bf16 a[120:123], v[236:239], v[144:147], a[120:123]
    v_add_f32 v241, v241, v172
    v_add_f32 v241, v241, v173
    v_mfma_f32_16x16x32_bf16 a[124:127], v[236:239], v[152:155], a[124:127]
    s_waitcnt lgkmcnt(0)
    v_mfma_f32_16x16x32_bf16 v[128:131], v[208:211], a[128:131], v[192:195]
    ds_read_b128 v[224:227], v244 offset:8448
    ds_read_b128 v[228:231], v244 offset:8512
    v_mfma_f32_16x16x32_bf16 v[128:131], v[212:215], a[132:135], v[128:131]
    s_add_u32 s43, s43, 32768
    s_add_u32 m0, s40, 67584
    v_mfma_f32_16x16x32_bf16 v[128:131], v[216:219], a[136:139], v[128:131]
    buffer_load_dwordx4 v246, s[12:15], s43 offen offset:0 nt lds
    v_mfma_f32_16x16x32_bf16 v[128:131], v[220:223], a[140:143], v[128:131]
    ds_read_b128 v[232:235], v244 offset:8576
    ds_read_b128 v[236:239], v244 offset:8640
    v_mfma_f32_16x16x32_bf16 v[136:139], v[208:211], a[160:163], v[196:199]
    v_exp_f32 v175, v175
    v_mfma_f32_16x16x32_bf16 v[136:139], v[212:215], a[164:167], v[136:139]
    s_add_u32 m0, s40, 67616
    v_cvt_pk_bf16_f32 v170, v172, v173
    v_mfma_f32_16x16x32_bf16 v[136:139], v[216:219], a[168:171], v[136:139]
    buffer_load_dwordx4 v246, s[12:15], s43 offen offset:1024 nt lds
    v_mfma_f32_16x16x32_bf16 v[136:139], v[220:223], a[172:175], v[136:139]
    v_exp_f32 v176, v176
    v_mfma_f32_16x16x32_bf16 v[144:147], v[208:211], a[192:195], v[200:203]
    v_add_f32 v241, v241, v174
    v_mfma_f32_16x16x32_bf16 v[144:147], v[212:215], a[196:199], v[144:147]
    v_add_f32 v241, v241, v175
    v_mfma_f32_16x16x32_bf16 v[144:147], v[216:219], a[200:203], v[144:147]
    s_add_u32 m0, s40, 67648
    v_mfma_f32_16x16x32_bf16 v[144:147], v[220:223], a[204:207], v[144:147]
    buffer_load_dwordx4 v246, s[12:15], s43 offen offset:2048 nt lds
    v_mfma_f32_16x16x32_bf16 v[152:155], v[208:211], a[224:227], v[204:207]
    v_exp_f32 v177, v177
    v_mfma_f32_16x16x32_bf16 v[152:155], v[212:215], a[228:231], v[152:155]
    v_cvt_pk_bf16_f32 v171, v174, v175
    v_mfma_f32_16x16x32_bf16 v[152:155], v[216:219], a[232:235], v[152:155]
    v_exp_f32 v178, v178
    v_mfma_f32_16x16x32_bf16 v[152:155], v[220:223], a[236:239], v[152:155]
    s_add_u32 s44, s44, 32768
    s_waitcnt lgkmcnt(0)
    v_mfma_f32_16x16x32_bf16 v[132:135], v[224:227], a[128:131], v[192:195]
    ds_read_b128 v[208:211], v244 offset:256
    ds_read_b128 v[212:215], v244 offset:320
    v_mfma_f32_16x16x32_bf16 v[132:135], v[228:231], a[132:135], v[132:135]
    s_add_u32 m0, s40, 67680
    v_add_f32 v242, v242, v176
    v_mfma_f32_16x16x32_bf16 v[132:135], v[232:235], a[136:139], v[132:135]
    buffer_load_dwordx4 v246, s[12:15], s43 offen offset:3072 nt lds
    v_mfma_f32_16x16x32_bf16 v[132:135], v[236:239], a[140:143], v[132:135]
    ds_read_b128 v[216:219], v244 offset:384
    ds_read_b128 v[220:223], v244 offset:448
    v_mfma_f32_16x16x32_bf16 v[140:143], v[224:227], a[160:163], v[196:199]
    v_add_f32 v242, v242, v177
    v_mfma_f32_16x16x32_bf16 v[140:143], v[228:231], a[164:167], v[140:143]
    s_add_u32 m0, s40, 71808
    v_mfma_f32_16x16x32_bf16 v[140:143], v[232:235], a[168:171], v[140:143]
    buffer_load_dwordx4 v246, s[12:15], s44 offen offset:0 nt lds
    v_mfma_f32_16x16x32_bf16 v[140:143], v[236:239], a[172:175], v[140:143]
    v_exp_f32 v179, v179
    v_mfma_f32_16x16x32_bf16 v[148:151], v[224:227], a[192:195], v[200:203]
    v_cvt_pk_bf16_f32 v176, v176, v177
    v_mfma_f32_16x16x32_bf16 v[148:151], v[228:231], a[196:199], v[148:151]
    v_exp_f32 v180, v180
    v_add_f32 v242, v242, v178
    v_mfma_f32_16x16x32_bf16 v[148:151], v[232:235], a[200:203], v[148:151]
    s_add_u32 m0, s40, 71840
    v_add_f32 v242, v242, v179
    v_mfma_f32_16x16x32_bf16 v[148:151], v[236:239], a[204:207], v[148:151]
    buffer_load_dwordx4 v246, s[12:15], s44 offen offset:1024 nt lds
    v_mfma_f32_16x16x32_bf16 v[156:159], v[224:227], a[224:227], v[204:207]
    v_exp_f32 v181, v181
    v_mfma_f32_16x16x32_bf16 v[156:159], v[228:231], a[228:231], v[156:159]
    v_cvt_pk_bf16_f32 v177, v178, v179
    v_mfma_f32_16x16x32_bf16 v[156:159], v[232:235], a[232:235], v[156:159]
    v_exp_f32 v182, v182
    v_mfma_f32_16x16x32_bf16 v[156:159], v[236:239], a[236:239], v[156:159]
    s_add_u32 m0, s40, 71872
    s_waitcnt lgkmcnt(0)
    v_mfma_f32_16x16x32_bf16 v[128:131], v[208:211], a[144:147], v[128:131]
    ds_read_b128 v[224:227], v244 offset:8704
    ds_read_b128 v[228:231], v244 offset:8768
    v_mfma_f32_16x16x32_bf16 v[128:131], v[212:215], a[148:151], v[128:131]
    buffer_load_dwordx4 v246, s[12:15], s44 offen offset:2048 nt lds
    v_mfma_f32_16x16x32_bf16 v[128:131], v[216:219], a[152:155], v[128:131]
    v_add_f32 v242, v242, v180
    v_add_f32 v242, v242, v181
    v_mfma_f32_16x16x32_bf16 v[128:131], v[220:223], a[156:159], v[128:131]
    ds_read_b128 v[232:235], v244 offset:8832
    ds_read_b128 v[236:239], v244 offset:8896
    v_mfma_f32_16x16x32_bf16 v[136:139], v[208:211], a[176:179], v[136:139]
    s_add_u32 m0, s40, 71904
    v_mfma_f32_16x16x32_bf16 v[136:139], v[212:215], a[180:183], v[136:139]
    buffer_load_dwordx4 v246, s[12:15], s44 offen offset:3072 nt lds
    v_mfma_f32_16x16x32_bf16 v[136:139], v[216:219], a[184:187], v[136:139]
    v_exp_f32 v183, v183
    v_mfma_f32_16x16x32_bf16 v[136:139], v[220:223], a[188:191], v[136:139]
    v_cvt_pk_bf16_f32 v178, v180, v181
    v_mfma_f32_16x16x32_bf16 v[144:147], v[208:211], a[208:211], v[144:147]
    v_exp_f32 v184, v184
    v_mfma_f32_16x16x32_bf16 v[144:147], v[212:215], a[212:215], v[144:147]
    v_add_f32 v242, v242, v182
    v_add_f32 v242, v242, v183
    v_mfma_f32_16x16x32_bf16 v[144:147], v[216:219], a[216:219], v[144:147]
    v_exp_f32 v185, v185
    v_mfma_f32_16x16x32_bf16 v[144:147], v[220:223], a[220:223], v[144:147]
    v_cvt_pk_bf16_f32 v179, v182, v183
    v_mfma_f32_16x16x32_bf16 v[152:155], v[208:211], a[240:243], v[152:155]
    v_exp_f32 v186, v186
    v_mfma_f32_16x16x32_bf16 v[152:155], v[212:215], a[244:247], v[152:155]
    v_add_f32 v243, v243, v184
    v_add_f32 v243, v243, v185
    v_mfma_f32_16x16x32_bf16 v[152:155], v[216:219], a[248:251], v[152:155]
    v_exp_f32 v187, v187
    v_mfma_f32_16x16x32_bf16 v[152:155], v[220:223], a[252:255], v[152:155]
    s_waitcnt vmcnt(17) lgkmcnt(0)
    s_barrier
    v_mfma_f32_16x16x32_bf16 v[132:135], v[224:227], a[144:147], v[132:135]
    ds_read_b64_tr_b16 v[208:209], v245 offset:33792
    ds_read_b64_tr_b16 v[210:211], v245 offset:42240
    v_mfma_f32_16x16x32_bf16 v[132:135], v[228:231], a[148:151], v[132:135]
    v_cvt_pk_bf16_f32 v184, v184, v185
    v_mfma_f32_16x16x32_bf16 v[132:135], v[232:235], a[152:155], v[132:135]
    v_exp_f32 v188, v188
    v_mfma_f32_16x16x32_bf16 v[132:135], v[236:239], a[156:159], v[132:135]
    ds_read_b64_tr_b16 v[212:213], v245 offset:33824
    ds_read_b64_tr_b16 v[214:215], v245 offset:42272
    v_mfma_f32_16x16x32_bf16 v[140:143], v[224:227], a[176:179], v[140:143]
    v_add_f32 v243, v243, v186
    v_add_f32 v243, v243, v187
    v_mfma_f32_16x16x32_bf16 v[140:143], v[228:231], a[180:183], v[140:143]
    v_exp_f32 v189, v189
    v_mfma_f32_16x16x32_bf16 v[140:143], v[232:235], a[184:187], v[140:143]
    ds_read_b64_tr_b16 v[216:217], v245 offset:33856
    ds_read_b64_tr_b16 v[218:219], v245 offset:42304
    v_mfma_f32_16x16x32_bf16 v[140:143], v[236:239], a[188:191], v[140:143]
    v_cvt_pk_bf16_f32 v185, v186, v187
    v_mfma_f32_16x16x32_bf16 v[148:151], v[224:227], a[208:211], v[148:151]
    v_exp_f32 v190, v190
    v_mfma_f32_16x16x32_bf16 v[148:151], v[228:231], a[212:215], v[148:151]
    ds_read_b64_tr_b16 v[220:221], v245 offset:33888
    ds_read_b64_tr_b16 v[222:223], v245 offset:42336
    v_mfma_f32_16x16x32_bf16 v[148:151], v[232:235], a[216:219], v[148:151]
    v_add_f32 v243, v243, v188
    v_add_f32 v243, v243, v189
    v_mfma_f32_16x16x32_bf16 v[148:151], v[236:239], a[220:223], v[148:151]
    v_exp_f32 v191, v191
    v_mfma_f32_16x16x32_bf16 v[156:159], v[224:227], a[240:243], v[156:159]
    v_cvt_pk_bf16_f32 v186, v188, v189
    v_add_f32 v243, v243, v190
    v_mfma_f32_16x16x32_bf16 v[156:159], v[228:231], a[244:247], v[156:159]
    v_add_f32 v243, v243, v191
    v_cvt_pk_bf16_f32 v187, v190, v191
    v_mfma_f32_16x16x32_bf16 v[156:159], v[232:235], a[248:251], v[156:159]
    v_mfma_f32_16x16x32_bf16 v[156:159], v[236:239], a[252:255], v[156:159]
    s_waitcnt lgkmcnt(4)
    v_mfma_f32_16x16x32_bf16 v[0:3], v[208:211], v[160:163], v[0:3]
    ds_read_b64_tr_b16 v[224:225], v245 offset:33920
    ds_read_b64_tr_b16 v[226:227], v245 offset:42368
    v_mfma_f32_16x16x32_bf16 v[4:7], v[208:211], v[168:171], v[4:7]
    ds_read_b64_tr_b16 v[228:229], v245 offset:33952
    ds_read_b64_tr_b16 v[230:231], v245 offset:42400
    v_mfma_f32_16x16x32_bf16 a[0:3], v[208:211], v[176:179], a[0:3]
    ds_read_b64_tr_b16 v[232:233], v245 offset:33984
    ds_read_b64_tr_b16 v[234:235], v245 offset:42432
    v_mfma_f32_16x16x32_bf16 a[4:7], v[208:211], v[184:187], a[4:7]
    s_add_u32 m0, s55, 0
    s_mov_b32 s50, 0
    v_mfma_f32_16x16x32_bf16 v[8:11], v[212:215], v[160:163], v[8:11]
    ds_read_b64_tr_b16 v[236:237], v245 offset:34016
    ds_read_b64_tr_b16 v[238:239], v245 offset:42464
    v_mfma_f32_16x16x32_bf16 v[12:15], v[212:215], v[168:171], v[12:15]
    buffer_load_dwordx4 v248, s[20:23], s50 offen lds
    v_mfma_f32_16x16x32_bf16 a[8:11], v[212:215], v[176:179], a[8:11]
    v_exp_f32 v128, v128
    v_mfma_f32_16x16x32_bf16 a[12:15], v[212:215], v[184:187], a[12:15]
    s_add_u32 m0, s55, 1024
    s_waitcnt lgkmcnt(8)
    v_mfma_f32_16x16x32_bf16 v[16:19], v[216:219], v[160:163], v[16:19]
    ds_read_b64_tr_b16 v[208:209], v245 offset:34048
    ds_read_b64_tr_b16 v[210:211], v245 offset:42496
    v_mfma_f32_16x16x32_bf16 v[20:23], v[216:219], v[168:171], v[20:23]
    s_mov_b32 s51, 7168
    v_mfma_f32_16x16x32_bf16 a[16:19], v[216:219], v[176:179], a[16:19]
    buffer_load_dwordx4 v248, s[20:23], s51 offen lds
    v_mfma_f32_16x16x32_bf16 a[20:23], v[216:219], v[184:187], a[20:23]
    v_exp_f32 v129, v129
    v_mfma_f32_16x16x32_bf16 v[24:27], v[220:223], v[160:163], v[24:27]
    ds_read_b64_tr_b16 v[212:213], v245 offset:34080
    ds_read_b64_tr_b16 v[214:215], v245 offset:42528
    v_mfma_f32_16x16x32_bf16 v[28:31], v[220:223], v[168:171], v[28:31]
    s_add_u32 m0, s55, 2048
    s_mov_b32 s50, 14336
    v_mfma_f32_16x16x32_bf16 a[24:27], v[220:223], v[176:179], a[24:27]
    buffer_load_dwordx4 v248, s[20:23], s50 offen lds
    v_mfma_f32_16x16x32_bf16 a[28:31], v[220:223], v[184:187], a[28:31]
    s_waitcnt lgkmcnt(8)
    v_mfma_f32_16x16x32_bf16 v[32:35], v[224:227], v[160:163], v[32:35]
    ds_read_b64_tr_b16 v[216:217], v245 offset:34112
    ds_read_b64_tr_b16 v[218:219], v245 offset:42560
    v_mfma_f32_16x16x32_bf16 v[36:39], v[224:227], v[168:171], v[36:39]
    s_add_u32 m0, s55, 3072
    s_mov_b32 s51, 21504
    v_mfma_f32_16x16x32_bf16 a[32:35], v[224:227], v[176:179], a[32:35]
    buffer_load_dwordx4 v248, s[20:23], s51 offen lds
    v_mfma_f32_16x16x32_bf16 a[36:39], v[224:227], v[184:187], a[36:39]
    v_exp_f32 v130, v130
    v_mfma_f32_16x16x32_bf16 v[40:43], v[228:231], v[160:163], v[40:43]
    ds_read_b64_tr_b16 v[220:221], v245 offset:34144
    ds_read_b64_tr_b16 v[222:223], v245 offset:42592
    v_mfma_f32_16x16x32_bf16 v[44:47], v[228:231], v[168:171], v[44:47]
    v_add_f32 v240, v240, v128
    v_add_f32 v240, v240, v129
    v_mfma_f32_16x16x32_bf16 a[40:43], v[228:231], v[176:179], a[40:43]
    s_add_u32 m0, s55, 4096
    s_mov_b32 s50, 28672
    v_mfma_f32_16x16x32_bf16 a[44:47], v[228:231], v[184:187], a[44:47]
    s_waitcnt lgkmcnt(8)
    v_mfma_f32_16x16x32_bf16 v[48:51], v[232:235], v[160:163], v[48:51]
    ds_read_b64_tr_b16 v[224:225], v245 offset:34176
    ds_read_b64_tr_b16 v[226:227], v245 offset:42624
    v_mfma_f32_16x16x32_bf16 v[52:55], v[232:235], v[168:171], v[52:55]
    buffer_load_dwordx4 v248, s[20:23], s50 offen lds
    v_mfma_f32_16x16x32_bf16 a[48:51], v[232:235], v[176:179], a[48:51]
    v_exp_f32 v131, v131
    v_mfma_f32_16x16x32_bf16 a[52:55], v[232:235], v[184:187], a[52:55]
    s_add_u32 m0, s55, 5120
    s_mov_b32 s51, 35840
    v_mfma_f32_16x16x32_bf16 v[56:59], v[236:239], v[160:163], v[56:59]
    ds_read_b64_tr_b16 v[228:229], v245 offset:34208
    ds_read_b64_tr_b16 v[230:231], v245 offset:42656
    v_mfma_f32_16x16x32_bf16 v[60:63], v[236:239], v[168:171], v[60:63]
    buffer_load_dwordx4 v248, s[20:23], s51 offen lds
    v_mfma_f32_16x16x32_bf16 a[56:59], v[236:239], v[176:179], a[56:59]
    v_cvt_pk_bf16_f32 v128, v128, v129
    v_mfma_f32_16x16x32_bf16 a[60:63], v[236:239], v[184:187], a[60:63]
    s_waitcnt lgkmcnt(8)
    v_mfma_f32_16x16x32_bf16 v[64:67], v[208:211], v[160:163], v[64:67]
    ds_read_b64_tr_b16 v[232:233], v245 offset:34240
    ds_read_b64_tr_b16 v[234:235], v245 offset:42688
    v_mfma_f32_16x16x32_bf16 v[68:71], v[208:211], v[168:171], v[68:71]
    s_add_u32 m0, s55, 6144
    s_mov_b32 s50, 43008
    v_mfma_f32_16x16x32_bf16 a[64:67], v[208:211], v[176:179], a[64:67]
    buffer_load_dwordx4 v248, s[20:23], s50 offen lds
    v_mfma_f32_16x16x32_bf16 a[68:71], v[208:211], v[184:187], a[68:71]
    v_exp_f32 v132, v132
    v_mfma_f32_16x16x32_bf16 v[72:75], v[212:215], v[160:163], v[72:75]
    ds_read_b64_tr_b16 v[236:237], v245 offset:34272
    ds_read_b64_tr_b16 v[238:239], v245 offset:42720
    v_mfma_f32_16x16x32_bf16 v[76:79], v[212:215], v[168:171], v[76:79]
    s_add_u32 m0, s55, 7168
    s_mov_b32 s51, 50176
    v_mfma_f32_16x16x32_bf16 a[72:75], v[212:215], v[176:179], a[72:75]
    buffer_load_dwordx4 v248, s[20:23], s51 offen lds
    v_mfma_f32_16x16x32_bf16 a[76:79], v[212:215], v[184:187], a[76:79]
    v_add_f32 v240, v240, v130
    s_waitcnt lgkmcnt(8)
    v_mfma_f32_16x16x32_bf16 v[80:83], v[216:219], v[160:163], v[80:83]
    v_add_f32 v240, v240, v131
    v_mfma_f32_16x16x32_bf16 v[84:87], v[216:219], v[168:171], v[84:87]
    v_exp_f32 v133, v133
    v_mfma_f32_16x16x32_bf16 a[80:83], v[216:219], v[176:179], a[80:83]
    v_cvt_pk_bf16_f32 v129, v130, v131
    v_mfma_f32_16x16x32_bf16 a[84:87], v[216:219], v[184:187], a[84:87]
    v_exp_f32 v134, v134
    v_add_f32 v240, v240, v132
    v_mfma_f32_16x16x32_bf16 v[88:91], v[220:223], v[160:163], v[88:91]
    v_add_f32 v240, v240, v133
    v_mfma_f32_16x16x32_bf16 v[92:95], v[220:223], v[168:171], v[92:95]
    v_exp_f32 v135, v135
    v_mfma_f32_16x16x32_bf16 a[88:91], v[220:223], v[176:179], a[88:91]
    v_cvt_pk_bf16_f32 v130, v132, v133
    v_mfma_f32_16x16x32_bf16 a[92:95], v[220:223], v[184:187], a[92:95]
    s_waitcnt vmcnt(16) lgkmcnt(0)
    s_barrier
    v_mfma_f32_16x16x32_bf16 v[96:99], v[224:227], v[160:163], v[96:99]
    ds_read_b128 v[208:211], v244 offset:33792
    ds_read_b128 v[212:215], v244 offset:33856
    v_mfma_f32_16x16x32_bf16 v[100:103], v[224:227], v[168:171], v[100:103]
    v_exp_f32 v136, v136
    v_mfma_f32_16x16x32_bf16 a[96:99], v[224:227], v[176:179], a[96:99]
    v_add_f32 v240, v240, v134
    v_add_f32 v240, v240, v135
    v_mfma_f32_16x16x32_bf16 a[100:103], v[224:227], v[184:187], a[100:103]
    ds_read_b128 v[216:219], v244 offset:33920
    ds_read_b128 v[220:223], v244 offset:33984
    v_mfma_f32_16x16x32_bf16 v[104:107], v[228:231], v[160:163], v[104:107]
    v_exp_f32 v137, v137
    v_mfma_f32_16x16x32_bf16 v[108:111], v[228:231], v[168:171], v[108:111]
    v_cvt_pk_bf16_f32 v131, v134, v135
    v_mfma_f32_16x16x32_bf16 a[104:107], v[228:231], v[176:179], a[104:107]
    v_exp_f32 v138, v138
    v_mfma_f32_16x16x32_bf16 a[108:111], v[228:231], v[184:187], a[108:111]
    v_add_f32 v241, v241, v136
    v_add_f32 v241, v241, v137
    v_mfma_f32_16x16x32_bf16 v[112:115], v[232:235], v[160:163], v[112:115]
    v_exp_f32 v139, v139
    v_mfma_f32_16x16x32_bf16 v[116:119], v[232:235], v[168:171], v[116:119]
    v_cvt_pk_bf16_f32 v136, v136, v137
    v_mfma_f32_16x16x32_bf16 a[112:115], v[232:235], v[176:179], a[112:115]
    v_exp_f32 v140, v140
    v_mfma_f32_16x16x32_bf16 a[116:119], v[232:235], v[184:187], a[116:119]
    v_add_f32 v241, v241, v138
    v_add_f32 v241, v241, v139
    v_mfma_f32_16x16x32_bf16 v[120:123], v[236:239], v[160:163], v[120:123]
    v_exp_f32 v141, v141
    v_mfma_f32_16x16x32_bf16 v[124:127], v[236:239], v[168:171], v[124:127]
    v_cvt_pk_bf16_f32 v137, v138, v139
    v_mfma_f32_16x16x32_bf16 a[120:123], v[236:239], v[176:179], a[120:123]
    v_exp_f32 v142, v142
    v_mfma_f32_16x16x32_bf16 a[124:127], v[236:239], v[184:187], a[124:127]
    v_add_f32 v241, v241, v140
    v_add_f32 v241, v241, v141
    s_waitcnt lgkmcnt(0)
    v_mfma_f32_16x16x32_bf16 v[160:163], v[208:211], a[128:131], v[192:195]
    ds_read_b128 v[224:227], v244 offset:42240
    ds_read_b128 v[228:231], v244 offset:42304
    v_mfma_f32_16x16x32_bf16 v[160:163], v[212:215], a[132:135], v[160:163]
    s_add_u32 s43, s43, 32768
    s_add_u32 m0, s40, 101376
    v_mfma_f32_16x16x32_bf16 v[160:163], v[216:219], a[136:139], v[160:163]
    buffer_load_dwordx4 v246, s[12:15], s43 offen offset:0 nt lds
    v_mfma_f32_16x16x32_bf16 v[160:163], v[220:223], a[140:143], v[160:163]
    ds_read_b128 v[232:235], v244 offset:42368
    ds_read_b128 v[236:239], v244 offset:42432
    v_mfma_f32_16x16x32_bf16 v[168:171], v[208:211], a[160:163], v[196:199]
    v_exp_f32 v143, v143
    v_mfma_f32_16x16x32_bf16 v[168:171], v[212:215], a[164:167], v[168:171]
    s_add_u32 m0, s40, 101408
    v_cvt_pk_bf16_f32 v138, v140, v141
    v_mfma_f32_16x16x32_bf16 v[168:171], v[216:219], a[168:171], v[168:171]
    buffer_load_dwordx4 v246, s[12:15], s43 offen offset:1024 nt lds
    v_mfma_f32_16x16x32_bf16 v[168:171], v[220:223], a[172:175], v[168:171]
    v_exp_f32 v144, v144
    v_mfma_f32_16x16x32_bf16 v[176:179], v[208:211], a[192:195], v[200:203]
    v_add_f32 v241, v241, v142
    v_mfma_f32_16x16x32_bf16 v[176:179], v[212:215], a[196:199], v[176:179]
    v_add_f32 v241, v241, v143
    v_mfma_f32_16x16x32_bf16 v[176:179], v[216:219], a[200:203], v[176:179]
    s_add_u32 m0, s40, 101440
    v_mfma_f32_16x16x32_bf16 v[176:179], v[220:223], a[204:207], v[176:179]
    buffer_load_dwordx4 v246, s[12:15], s43 offen offset:2048 nt lds
    v_mfma_f32_16x16x32_bf16 v[184:187], v[208:211], a[224:227], v[204:207]
    v_exp_f32 v145, v145
    v_mfma_f32_16x16x32_bf16 v[184:187], v[212:215], a[228:231], v[184:187]
    v_cvt_pk_bf16_f32 v139, v142, v143
    v_mfma_f32_16x16x32_bf16 v[184:187], v[216:219], a[232:235], v[184:187]
    v_exp_f32 v146, v146
    v_mfma_f32_16x16x32_bf16 v[184:187], v[220:223], a[236:239], v[184:187]
    s_add_u32 s44, s44, 32768
    s_waitcnt lgkmcnt(0)
    v_mfma_f32_16x16x32_bf16 v[164:167], v[224:227], a[128:131], v[192:195]
    ds_read_b128 v[208:211], v244 offset:34048
    ds_read_b128 v[212:215], v244 offset:34112
    v_mfma_f32_16x16x32_bf16 v[164:167], v[228:231], a[132:135], v[164:167]
    s_add_u32 m0, s40, 101472
    v_add_f32 v242, v242, v144
    v_mfma_f32_16x16x32_bf16 v[164:167], v[232:235], a[136:139], v[164:167]
    buffer_load_dwordx4 v246, s[12:15], s43 offen offset:3072 nt lds
    v_mfma_f32_16x16x32_bf16 v[164:167], v[236:239], a[140:143], v[164:167]
    ds_read_b128 v[216:219], v244 offset:34176
    ds_read_b128 v[220:223], v244 offset:34240
    v_mfma_f32_16x16x32_bf16 v[172:175], v[224:227], a[160:163], v[196:199]
    v_add_f32 v242, v242, v145
    v_mfma_f32_16x16x32_bf16 v[172:175], v[228:231], a[164:167], v[172:175]
    s_add_u32 m0, s40, 105600
    v_mfma_f32_16x16x32_bf16 v[172:175], v[232:235], a[168:171], v[172:175]
    buffer_load_dwordx4 v246, s[12:15], s44 offen offset:0 nt lds
    v_mfma_f32_16x16x32_bf16 v[172:175], v[236:239], a[172:175], v[172:175]
    v_exp_f32 v147, v147
    v_mfma_f32_16x16x32_bf16 v[180:183], v[224:227], a[192:195], v[200:203]
    v_cvt_pk_bf16_f32 v144, v144, v145
    v_mfma_f32_16x16x32_bf16 v[180:183], v[228:231], a[196:199], v[180:183]
    v_exp_f32 v148, v148
    v_add_f32 v242, v242, v146
    v_mfma_f32_16x16x32_bf16 v[180:183], v[232:235], a[200:203], v[180:183]
    s_add_u32 m0, s40, 105632
    v_add_f32 v242, v242, v147
    v_mfma_f32_16x16x32_bf16 v[180:183], v[236:239], a[204:207], v[180:183]
    buffer_load_dwordx4 v246, s[12:15], s44 offen offset:1024 nt lds
    v_mfma_f32_16x16x32_bf16 v[188:191], v[224:227], a[224:227], v[204:207]
    v_exp_f32 v149, v149
    v_mfma_f32_16x16x32_bf16 v[188:191], v[228:231], a[228:231], v[188:191]
    v_cvt_pk_bf16_f32 v145, v146, v147
    v_mfma_f32_16x16x32_bf16 v[188:191], v[232:235], a[232:235], v[188:191]
    v_exp_f32 v150, v150
    v_mfma_f32_16x16x32_bf16 v[188:191], v[236:239], a[236:239], v[188:191]
    s_add_u32 m0, s40, 105664
    s_waitcnt lgkmcnt(0)
    v_mfma_f32_16x16x32_bf16 v[160:163], v[208:211], a[144:147], v[160:163]
    ds_read_b128 v[224:227], v244 offset:42496
    ds_read_b128 v[228:231], v244 offset:42560
    v_mfma_f32_16x16x32_bf16 v[160:163], v[212:215], a[148:151], v[160:163]
    buffer_load_dwordx4 v246, s[12:15], s44 offen offset:2048 nt lds
    v_mfma_f32_16x16x32_bf16 v[160:163], v[216:219], a[152:155], v[160:163]
    v_add_f32 v242, v242, v148
    v_add_f32 v242, v242, v149
    v_mfma_f32_16x16x32_bf16 v[160:163], v[220:223], a[156:159], v[160:163]
    ds_read_b128 v[232:235], v244 offset:42624
    ds_read_b128 v[236:239], v244 offset:42688
    v_mfma_f32_16x16x32_bf16 v[168:171], v[208:211], a[176:179], v[168:171]
    s_add_u32 m0, s40, 105696
    v_mfma_f32_16x16x32_bf16 v[168:171], v[212:215], a[180:183], v[168:171]
    buffer_load_dwordx4 v246, s[12:15], s44 offen offset:3072 nt lds
    v_mfma_f32_16x16x32_bf16 v[168:171], v[216:219], a[184:187], v[168:171]
    v_exp_f32 v151, v151
    v_mfma_f32_16x16x32_bf16 v[168:171], v[220:223], a[188:191], v[168:171]
    v_cvt_pk_bf16_f32 v146, v148, v149
    v_mfma_f32_16x16x32_bf16 v[176:179], v[208:211], a[208:211], v[176:179]
    v_exp_f32 v152, v152
    v_mfma_f32_16x16x32_bf16 v[176:179], v[212:215], a[212:215], v[176:179]
    v_add_f32 v242, v242, v150
    v_add_f32 v242, v242, v151
    v_mfma_f32_16x16x32_bf16 v[176:179], v[216:219], a[216:219], v[176:179]
    v_exp_f32 v153, v153
    v_mfma_f32_16x16x32_bf16 v[176:179], v[220:223], a[220:223], v[176:179]
    v_cvt_pk_bf16_f32 v147, v150, v151
    v_mfma_f32_16x16x32_bf16 v[184:187], v[208:211], a[240:243], v[184:187]
    v_exp_f32 v154, v154
    v_mfma_f32_16x16x32_bf16 v[184:187], v[212:215], a[244:247], v[184:187]
    v_add_f32 v243, v243, v152
    v_add_f32 v243, v243, v153
    v_mfma_f32_16x16x32_bf16 v[184:187], v[216:219], a[248:251], v[184:187]
    v_exp_f32 v155, v155
    v_mfma_f32_16x16x32_bf16 v[184:187], v[220:223], a[252:255], v[184:187]
    s_waitcnt vmcnt(8) lgkmcnt(0)
    s_barrier
    v_mfma_f32_16x16x32_bf16 v[164:167], v[224:227], a[144:147], v[164:167]
    ds_read_b64_tr_b16 v[208:209], v245 offset:0
    ds_read_b64_tr_b16 v[210:211], v245 offset:8448
    v_mfma_f32_16x16x32_bf16 v[164:167], v[228:231], a[148:151], v[164:167]
    v_cvt_pk_bf16_f32 v152, v152, v153
    v_mfma_f32_16x16x32_bf16 v[164:167], v[232:235], a[152:155], v[164:167]
    v_exp_f32 v156, v156
    v_mfma_f32_16x16x32_bf16 v[164:167], v[236:239], a[156:159], v[164:167]
    ds_read_b64_tr_b16 v[212:213], v245 offset:32
    ds_read_b64_tr_b16 v[214:215], v245 offset:8480
    v_mfma_f32_16x16x32_bf16 v[172:175], v[224:227], a[176:179], v[172:175]
    v_add_f32 v243, v243, v154
    v_add_f32 v243, v243, v155
    v_mfma_f32_16x16x32_bf16 v[172:175], v[228:231], a[180:183], v[172:175]
    v_exp_f32 v157, v157
    v_mfma_f32_16x16x32_bf16 v[172:175], v[232:235], a[184:187], v[172:175]
    ds_read_b64_tr_b16 v[216:217], v245 offset:64
    ds_read_b64_tr_b16 v[218:219], v245 offset:8512
    v_mfma_f32_16x16x32_bf16 v[172:175], v[236:239], a[188:191], v[172:175]
    v_cvt_pk_bf16_f32 v153, v154, v155
    v_mfma_f32_16x16x32_bf16 v[180:183], v[224:227], a[208:211], v[180:183]
    v_exp_f32 v158, v158
    v_mfma_f32_16x16x32_bf16 v[180:183], v[228:231], a[212:215], v[180:183]
    ds_read_b64_tr_b16 v[220:221], v245 offset:96
    ds_read_b64_tr_b16 v[222:223], v245 offset:8544
    v_mfma_f32_16x16x32_bf16 v[180:183], v[232:235], a[216:219], v[180:183]
    v_add_f32 v243, v243, v156
    v_add_f32 v243, v243, v157
    v_mfma_f32_16x16x32_bf16 v[180:183], v[236:239], a[220:223], v[180:183]
    v_exp_f32 v159, v159
    v_mfma_f32_16x16x32_bf16 v[188:191], v[224:227], a[240:243], v[188:191]
    v_cvt_pk_bf16_f32 v154, v156, v157
    v_add_f32 v243, v243, v158
    v_mfma_f32_16x16x32_bf16 v[188:191], v[228:231], a[244:247], v[188:191]
    v_add_f32 v243, v243, v159
    v_cvt_pk_bf16_f32 v155, v158, v159
    v_mfma_f32_16x16x32_bf16 v[188:191], v[232:235], a[248:251], v[188:191]
    v_mfma_f32_16x16x32_bf16 v[188:191], v[236:239], a[252:255], v[188:191]
    s_waitcnt lgkmcnt(4)
    v_mfma_f32_16x16x32_bf16 v[0:3], v[208:211], v[128:131], v[0:3]
    ds_read_b64_tr_b16 v[224:225], v245 offset:128
    ds_read_b64_tr_b16 v[226:227], v245 offset:8576
    v_mfma_f32_16x16x32_bf16 v[4:7], v[208:211], v[136:139], v[4:7]
    ds_read_b64_tr_b16 v[228:229], v245 offset:160
    ds_read_b64_tr_b16 v[230:231], v245 offset:8608
    v_mfma_f32_16x16x32_bf16 a[0:3], v[208:211], v[144:147], a[0:3]
    ds_read_b64_tr_b16 v[232:233], v245 offset:192
    ds_read_b64_tr_b16 v[234:235], v245 offset:8640
    v_mfma_f32_16x16x32_bf16 a[4:7], v[208:211], v[152:155], a[4:7]
    s_add_u32 m0, s55, 33792
    s_mov_b32 s50, 229376
    v_mfma_f32_16x16x32_bf16 v[8:11], v[212:215], v[128:131], v[8:11]
    ds_read_b64_tr_b16 v[236:237], v245 offset:224
    ds_read_b64_tr_b16 v[238:239], v245 offset:8672
    v_mfma_f32_16x16x32_bf16 v[12:15], v[212:215], v[136:139], v[12:15]
    buffer_load_dwordx4 v248, s[20:23], s50 offen lds
    v_mfma_f32_16x16x32_bf16 a[8:11], v[212:215], v[144:147], a[8:11]
    ds_read_b64_tr_b16 a[128:129], v249 offset:0
    ds_read_b64_tr_b16 a[130:131], v249 offset:2048
    v_mfma_f32_16x16x32_bf16 a[12:15], v[212:215], v[152:155], a[12:15]
    s_add_u32 m0, s55, 34816
    s_waitcnt lgkmcnt(10)
    v_mfma_f32_16x16x32_bf16 v[16:19], v[216:219], v[128:131], v[16:19]
    ds_read_b64_tr_b16 v[208:209], v245 offset:256
    ds_read_b64_tr_b16 v[210:211], v245 offset:8704
    v_mfma_f32_16x16x32_bf16 v[20:23], v[216:219], v[136:139], v[20:23]
    s_mov_b32 s51, 236544
    ds_read_b64_tr_b16 a[132:133], v249 offset:4096
    v_mfma_f32_16x16x32_bf16 a[16:19], v[216:219], v[144:147], a[16:19]
    buffer_load_dwordx4 v248, s[20:23], s51 offen lds
    v_mfma_f32_16x16x32_bf16 a[20:23], v[216:219], v[152:155], a[20:23]
    ds_read_b64_tr_b16 a[134:135], v249 offset:6144
    ds_read_b64_tr_b16 a[136:137], v249 offset:8192
    v_mfma_f32_16x16x32_bf16 v[24:27], v[220:223], v[128:131], v[24:27]
    ds_read_b64_tr_b16 v[212:213], v245 offset:288
    ds_read_b64_tr_b16 v[214:215], v245 offset:8736
    v_mfma_f32_16x16x32_bf16 v[28:31], v[220:223], v[136:139], v[28:31]
    s_add_u32 m0, s55, 35840
    s_mov_b32 s50, 243712
    v_mfma_f32_16x16x32_bf16 a[24:27], v[220:223], v[144:147], a[24:27]
    buffer_load_dwordx4 v248, s[20:23], s50 offen lds
    v_mfma_f32_16x16x32_bf16 a[28:31], v[220:223], v[152:155], a[28:31]
    ds_read_b64_tr_b16 a[138:139], v249 offset:10240
    s_waitcnt lgkmcnt(14)
    v_mfma_f32_16x16x32_bf16 v[32:35], v[224:227], v[128:131], v[32:35]
    ds_read_b64_tr_b16 v[216:217], v245 offset:320
    ds_read_b64_tr_b16 v[218:219], v245 offset:8768
    v_mfma_f32_16x16x32_bf16 v[36:39], v[224:227], v[136:139], v[36:39]
    s_add_u32 m0, s55, 36864
    s_mov_b32 s51, 250880
    v_mfma_f32_16x16x32_bf16 a[32:35], v[224:227], v[144:147], a[32:35]
    buffer_load_dwordx4 v248, s[20:23], s51 offen lds
    v_mfma_f32_16x16x32_bf16 a[36:39], v[224:227], v[152:155], a[36:39]
    ds_read_b64_tr_b16 a[140:141], v249 offset:12288
    ds_read_b64_tr_b16 a[142:143], v249 offset:14336
    v_mfma_f32_16x16x32_bf16 v[40:43], v[228:231], v[128:131], v[40:43]
    ds_read_b64_tr_b16 v[220:221], v245 offset:352
    ds_read_b64_tr_b16 v[222:223], v245 offset:8800
    v_mfma_f32_16x16x32_bf16 v[44:47], v[228:231], v[136:139], v[44:47]
    ds_read_b64_tr_b16 a[144:145], v249 offset:16384
    ds_read_b64_tr_b16 a[146:147], v249 offset:18432
    v_mfma_f32_16x16x32_bf16 a[40:43], v[228:231], v[144:147], a[40:43]
    s_add_u32 m0, s55, 37888
    s_mov_b32 s50, 258048
    v_mfma_f32_16x16x32_bf16 a[44:47], v[228:231], v[152:155], a[44:47]
    ds_read_b64_tr_b16 a[148:149], v249 offset:20480
    s_waitcnt lgkmcnt(15)
    v_mfma_f32_16x16x32_bf16 v[48:51], v[232:235], v[128:131], v[48:51]
    ds_read_b64_tr_b16 v[224:225], v245 offset:384
    ds_read_b64_tr_b16 v[226:227], v245 offset:8832
    v_mfma_f32_16x16x32_bf16 v[52:55], v[232:235], v[136:139], v[52:55]
    buffer_load_dwordx4 v248, s[20:23], s50 offen lds
    v_mfma_f32_16x16x32_bf16 a[48:51], v[232:235], v[144:147], a[48:51]
    ds_read_b64_tr_b16 a[150:151], v249 offset:22528
    ds_read_b64_tr_b16 a[152:153], v249 offset:24576
    v_mfma_f32_16x16x32_bf16 a[52:55], v[232:235], v[152:155], a[52:55]
    s_add_u32 m0, s55, 38912
    s_mov_b32 s51, 265216
    v_mfma_f32_16x16x32_bf16 v[56:59], v[236:239], v[128:131], v[56:59]
    ds_read_b64_tr_b16 v[228:229], v245 offset:416
    ds_read_b64_tr_b16 v[230:231], v245 offset:8864
    v_mfma_f32_16x16x32_bf16 v[60:63], v[236:239], v[136:139], v[60:63]
    buffer_load_dwordx4 v248, s[20:23], s51 offen lds
    v_mfma_f32_16x16x32_bf16 a[56:59], v[236:239], v[144:147], a[56:59]
    ds_read_b64_tr_b16 a[154:155], v249 offset:26624
    ds_read_b64_tr_b16 a[156:157], v249 offset:28672
    v_mfma_f32_16x16x32_bf16 a[60:63], v[236:239], v[152:155], a[60:63]
    ds_read_b64_tr_b16 a[158:159], v249 offset:30720
    s_waitcnt lgkmcnt(15)
    v_mfma_f32_16x16x32_bf16 v[64:67], v[208:211], v[128:131], v[64:67]
    ds_read_b64_tr_b16 v[232:233], v245 offset:448
    ds_read_b64_tr_b16 v[234:235], v245 offset:8896
    v_mfma_f32_16x16x32_bf16 v[68:71], v[208:211], v[136:139], v[68:71]
    s_add_u32 m0, s55, 39936
    s_mov_b32 s50, 272384
    v_mfma_f32_16x16x32_bf16 a[64:67], v[208:211], v[144:147], a[64:67]
    buffer_load_dwordx4 v248, s[20:23], s50 offen lds
    v_mfma_f32_16x16x32_bf16 a[68:71], v[208:211], v[152:155], a[68:71]
    v_exp_f32 v160, v160
    v_exp_f32 v161, v161
    v_mfma_f32_16x16x32_bf16 v[72:75], v[212:215], v[128:131], v[72:75]
    ds_read_b64_tr_b16 v[236:237], v245 offset:480
    ds_read_b64_tr_b16 v[238:239], v245 offset:8928
    v_mfma_f32_16x16x32_bf16 v[76:79], v[212:215], v[136:139], v[76:79]
    s_add_u32 m0, s55, 40960
    s_mov_b32 s51, 279552
    v_mfma_f32_16x16x32_bf16 a[72:75], v[212:215], v[144:147], a[72:75]
    buffer_load_dwordx4 v248, s[20:23], s51 offen lds
    v_mfma_f32_16x16x32_bf16 a[76:79], v[212:215], v[152:155], a[76:79]
    v_exp_f32 v162, v162
    v_add_f32 v240, v240, v160
    s_waitcnt lgkmcnt(15)
    v_mfma_f32_16x16x32_bf16 v[80:83], v[216:219], v[128:131], v[80:83]
    v_add_f32 v240, v240, v161
    v_exp_f32 v163, v163
    v_cvt_pk_bf16_f32 v160, v160, v161
    v_exp_f32 v164, v164
    v_mfma_f32_16x16x32_bf16 v[84:87], v[216:219], v[136:139], v[84:87]
    v_add_f32 v240, v240, v162
    v_add_f32 v240, v240, v163
    v_exp_f32 v165, v165
    v_cvt_pk_bf16_f32 v161, v162, v163
    v_mfma_f32_16x16x32_bf16 a[80:83], v[216:219], v[144:147], a[80:83]
    v_exp_f32 v166, v166
    v_add_f32 v240, v240, v164
    v_add_f32 v240, v240, v165
    v_exp_f32 v167, v167
    v_mfma_f32_16x16x32_bf16 a[84:87], v[216:219], v[152:155], a[84:87]
    v_cvt_pk_bf16_f32 v162, v164, v165
    v_exp_f32 v168, v168
    v_add_f32 v240, v240, v166
    v_add_f32 v240, v240, v167
    v_mfma_f32_16x16x32_bf16 v[88:91], v[220:223], v[128:131], v[88:91]
    v_exp_f32 v169, v169
    v_cvt_pk_bf16_f32 v163, v166, v167
    v_exp_f32 v170, v170
    v_add_f32 v241, v241, v168
    v_add_f32 v241, v241, v169
    v_mfma_f32_16x16x32_bf16 v[92:95], v[220:223], v[136:139], v[92:95]
    v_exp_f32 v171, v171
    v_cvt_pk_bf16_f32 v168, v168, v169
    v_exp_f32 v172, v172
    v_add_f32 v241, v241, v170
    v_mfma_f32_16x16x32_bf16 a[88:91], v[220:223], v[144:147], a[88:91]
    v_add_f32 v241, v241, v171
    v_exp_f32 v173, v173
    v_cvt_pk_bf16_f32 v169, v170, v171
    v_exp_f32 v174, v174
    v_mfma_f32_16x16x32_bf16 a[92:95], v[220:223], v[152:155], a[92:95]
    s_waitcnt lgkmcnt(0)
    s_barrier
    v_mfma_f32_16x16x32_bf16 v[96:99], v[224:227], v[128:131], v[96:99]
    s_add_u32 m0, s55, 0
    s_mov_b32 s50, 128
    v_mfma_f32_16x16x32_bf16 v[100:103], v[224:227], v[136:139], v[100:103]
    buffer_load_dwordx4 v248, s[20:23], s50 offen lds
    v_mfma_f32_16x16x32_bf16 a[96:99], v[224:227], v[144:147], a[96:99]
    s_add_u32 m0, s55, 1024
    s_mov_b32 s51, 7296
    v_mfma_f32_16x16x32_bf16 a[100:103], v[224:227], v[152:155], a[100:103]
    buffer_load_dwordx4 v248, s[20:23], s51 offen lds
    v_mfma_f32_16x16x32_bf16 v[104:107], v[228:231], v[128:131], v[104:107]
    s_add_u32 m0, s55, 2048
    s_mov_b32 s50, 14464
    v_mfma_f32_16x16x32_bf16 v[108:111], v[228:231], v[136:139], v[108:111]
    buffer_load_dwordx4 v248, s[20:23], s50 offen lds
    v_mfma_f32_16x16x32_bf16 a[104:107], v[228:231], v[144:147], a[104:107]
    s_add_u32 m0, s55, 3072
    s_mov_b32 s51, 21632
    v_mfma_f32_16x16x32_bf16 a[108:111], v[228:231], v[152:155], a[108:111]
    buffer_load_dwordx4 v248, s[20:23], s51 offen lds
    v_mfma_f32_16x16x32_bf16 v[112:115], v[232:235], v[128:131], v[112:115]
    s_add_u32 m0, s55, 4096
    s_mov_b32 s50, 28800
    v_mfma_f32_16x16x32_bf16 v[116:119], v[232:235], v[136:139], v[116:119]
    buffer_load_dwordx4 v248, s[20:23], s50 offen lds
    v_mfma_f32_16x16x32_bf16 a[112:115], v[232:235], v[144:147], a[112:115]
    s_add_u32 m0, s55, 5120
    s_mov_b32 s51, 35968
    v_mfma_f32_16x16x32_bf16 a[116:119], v[232:235], v[152:155], a[116:119]
    buffer_load_dwordx4 v248, s[20:23], s51 offen lds
    v_mfma_f32_16x16x32_bf16 v[120:123], v[236:239], v[128:131], v[120:123]
    s_add_u32 m0, s55, 6144
    s_mov_b32 s50, 43136
    v_mfma_f32_16x16x32_bf16 v[124:127], v[236:239], v[136:139], v[124:127]
    buffer_load_dwordx4 v248, s[20:23], s50 offen lds
    v_mfma_f32_16x16x32_bf16 a[120:123], v[236:239], v[144:147], a[120:123]
    s_add_u32 m0, s55, 7168
    s_mov_b32 s51, 50304
    v_mfma_f32_16x16x32_bf16 a[124:127], v[236:239], v[152:155], a[124:127]
    buffer_load_dwordx4 v248, s[20:23], s51 offen lds
    v_add_f32 v241, v241, v172
    v_add_f32 v241, v241, v173
    s_lshl_b32 s52, s3, 10
    s_add_u32 s52, s52, 135168
    s_waitcnt vmcnt(8) lgkmcnt(0)
    s_barrier
    ds_read_b64_tr_b16 v[208:209], v245 offset:33792
    ds_read_b64_tr_b16 v[210:211], v245 offset:42240
    ds_read_b64_tr_b16 v[212:213], v245 offset:33824
    ds_read_b64_tr_b16 v[214:215], v245 offset:42272
    ds_read_b64_tr_b16 v[216:217], v245 offset:33856
    ds_read_b64_tr_b16 v[218:219], v245 offset:42304
    ds_read_b64_tr_b16 v[220:221], v245 offset:33888
    ds_read_b64_tr_b16 v[222:223], v245 offset:42336
    v_exp_f32 v175, v175
    s_add_u32 m0, s55, 67584
    v_cvt_pk_bf16_f32 v170, v172, v173
    s_mov_b32 s50, 229504
    v_exp_f32 v176, v176
    buffer_load_dwordx4 v248, s[20:23], s50 offen lds
    v_add_f32 v241, v241, v174
    s_add_u32 m0, s55, 68608
    v_add_f32 v241, v241, v175
    s_mov_b32 s51, 236672
    v_exp_f32 v177, v177
    buffer_load_dwordx4 v248, s[20:23], s51 offen lds
    v_cvt_pk_bf16_f32 v171, v174, v175
    s_add_u32 m0, s55, 69632
    v_exp_f32 v178, v178
    s_mov_b32 s50, 243840
    v_add_f32 v242, v242, v176
    buffer_load_dwordx4 v248, s[20:23], s50 offen lds
    v_add_f32 v242, v242, v177
    s_add_u32 m0, s55, 70656
    v_exp_f32 v179, v179
    s_mov_b32 s51, 251008
    v_cvt_pk_bf16_f32 v176, v176, v177
    buffer_load_dwordx4 v248, s[20:23], s51 offen lds
    v_exp_f32 v180, v180
    s_add_u32 m0, s55, 71680
    v_add_f32 v242, v242, v178
    s_mov_b32 s50, 258176
    v_add_f32 v242, v242, v179
    buffer_load_dwordx4 v248, s[20:23], s50 offen lds
    v_exp_f32 v181, v181
    s_add_u32 m0, s55, 72704
    v_cvt_pk_bf16_f32 v177, v178, v179
    s_mov_b32 s51, 265344
    v_exp_f32 v182, v182
    buffer_load_dwordx4 v248, s[20:23], s51 offen lds
    v_add_f32 v242, v242, v180
    s_add_u32 m0, s55, 73728
    v_add_f32 v242, v242, v181
    s_mov_b32 s50, 272512
    v_exp_f32 v183, v183
    buffer_load_dwordx4 v248, s[20:23], s50 offen lds
    v_cvt_pk_bf16_f32 v178, v180, v181
    s_add_u32 m0, s55, 74752
    v_exp_f32 v184, v184
    s_mov_b32 s51, 279680
    v_add_f32 v242, v242, v182
    buffer_load_dwordx4 v248, s[20:23], s51 offen lds
    v_add_f32 v242, v242, v183
    ds_read_b64_tr_b16 a[160:161], v249 offset:33792
    v_exp_f32 v185, v185
    ds_read_b64_tr_b16 a[162:163], v249 offset:35840
    v_cvt_pk_bf16_f32 v179, v182, v183
    ds_read_b64_tr_b16 a[164:165], v249 offset:37888
    v_exp_f32 v186, v186
    ds_read_b64_tr_b16 a[166:167], v249 offset:39936
    v_add_f32 v243, v243, v184
    ds_read_b64_tr_b16 a[168:169], v249 offset:41984
    v_add_f32 v243, v243, v185
    ds_read_b64_tr_b16 a[170:171], v249 offset:44032
    v_exp_f32 v187, v187
    ds_read_b64_tr_b16 a[172:173], v249 offset:46080
    v_cvt_pk_bf16_f32 v184, v184, v185
    ds_read_b64_tr_b16 a[174:175], v249 offset:48128
    v_exp_f32 v188, v188
    ds_read_b64_tr_b16 a[176:177], v249 offset:50176
    v_add_f32 v243, v243, v186
    ds_read_b64_tr_b16 a[178:179], v249 offset:52224
    v_add_f32 v243, v243, v187
    ds_read_b64_tr_b16 a[180:181], v249 offset:54272
    v_exp_f32 v189, v189
    ds_read_b64_tr_b16 a[182:183], v249 offset:56320
    v_cvt_pk_bf16_f32 v185, v186, v187
    ds_read_b64_tr_b16 a[184:185], v249 offset:58368
    v_exp_f32 v190, v190
    ds_read_b64_tr_b16 a[186:187], v249 offset:60416
    v_add_f32 v243, v243, v188
    ds_read_b64_tr_b16 a[188:189], v249 offset:62464
    v_add_f32 v243, v243, v189
    ds_read_b64_tr_b16 a[190:191], v249 offset:64512
    v_exp_f32 v191, v191
    v_cvt_pk_bf16_f32 v186, v188, v189
    v_add_f32 v243, v243, v190
    v_add_f32 v243, v243, v191
    v_cvt_pk_bf16_f32 v187, v190, v191
    s_waitcnt lgkmcnt(15)
    v_mfma_f32_16x16x32_bf16 v[0:3], v[208:211], v[160:163], v[0:3]
    ds_read_b64_tr_b16 v[224:225], v245 offset:33920
    ds_read_b64_tr_b16 v[226:227], v245 offset:42368
    v_mfma_f32_16x16x32_bf16 v[4:7], v[208:211], v[168:171], v[4:7]
    ds_read_b64_tr_b16 v[228:229], v245 offset:33952
    ds_read_b64_tr_b16 v[230:231], v245 offset:42400
    v_mfma_f32_16x16x32_bf16 a[0:3], v[208:211], v[176:179], a[0:3]
    ds_read_b64_tr_b16 v[232:233], v245 offset:33984
    ds_read_b64_tr_b16 v[234:235], v245 offset:42432
    v_mfma_f32_16x16x32_bf16 a[4:7], v[208:211], v[184:187], a[4:7]
    v_add_u32 v152, 32768, v251
    v_add_u32 v153, 98304, v251
    v_mfma_f32_16x16x32_bf16 v[8:11], v[212:215], v[160:163], v[8:11]
    ds_read_b64_tr_b16 v[236:237], v245 offset:34016
    ds_read_b64_tr_b16 v[238:239], v245 offset:42464
    v_mfma_f32_16x16x32_bf16 v[12:15], v[212:215], v[168:171], v[12:15]
    v_mov_b32 v252, v240
    v_mov_b32 v253, v241
    v_mfma_f32_16x16x32_bf16 a[8:11], v[212:215], v[176:179], a[8:11]
    v_mov_b32 v254, v242
    v_mov_b32 v255, v243
    v_mfma_f32_16x16x32_bf16 a[12:15], v[212:215], v[184:187], a[12:15]
    v_permlane16_swap_b32 v240, v252
    v_mfma_f32_16x16x32_bf16 v[16:19], v[216:219], v[160:163], v[16:19]
    ds_read_b64_tr_b16 v[208:209], v245 offset:34048
    ds_read_b64_tr_b16 v[210:211], v245 offset:42496
    v_mfma_f32_16x16x32_bf16 v[20:23], v[216:219], v[168:171], v[20:23]
    v_permlane16_swap_b32 v241, v253
    v_permlane16_swap_b32 v242, v254
    v_mfma_f32_16x16x32_bf16 a[16:19], v[216:219], v[176:179], a[16:19]
    v_permlane16_swap_b32 v243, v255
    v_add_f32 v240, v240, v252
    v_mfma_f32_16x16x32_bf16 a[20:23], v[216:219], v[184:187], a[20:23]
    v_add_f32 v241, v241, v253
    v_mfma_f32_16x16x32_bf16 v[24:27], v[220:223], v[160:163], v[24:27]
    ds_read_b64_tr_b16 v[212:213], v245 offset:34080
    ds_read_b64_tr_b16 v[214:215], v245 offset:42528
    v_mfma_f32_16x16x32_bf16 v[28:31], v[220:223], v[168:171], v[28:31]
    v_add_f32 v242, v242, v254
    v_add_f32 v243, v243, v255
    v_mfma_f32_16x16x32_bf16 a[24:27], v[220:223], v[176:179], a[24:27]
    v_mov_b32 v252, v240
    v_mov_b32 v253, v241
    v_mfma_f32_16x16x32_bf16 a[28:31], v[220:223], v[184:187], a[28:31]
    s_waitcnt lgkmcnt(8)
    s_waitcnt vmcnt(8)
    s_barrier
    v_mfma_f32_16x16x32_bf16 v[32:35], v[224:227], v[160:163], v[32:35]
    ds_read_b64_tr_b16 v[216:217], v245 offset:34112
    ds_read_b64_tr_b16 v[218:219], v245 offset:42560
    v_mfma_f32_16x16x32_bf16 v[36:39], v[224:227], v[168:171], v[36:39]
    ds_read_b64_tr_b16 a[192:193], v249 offset:0
    ds_read_b64_tr_b16 a[194:195], v249 offset:2048
    v_mfma_f32_16x16x32_bf16 a[32:35], v[224:227], v[176:179], a[32:35]
    ds_read_b64_tr_b16 a[196:197], v249 offset:4096
    ds_read_b64_tr_b16 a[198:199], v249 offset:6144
    v_mfma_f32_16x16x32_bf16 a[36:39], v[224:227], v[184:187], a[36:39]
    ds_read_b64_tr_b16 a[200:201], v249 offset:8192
    ds_read_b64_tr_b16 a[202:203], v249 offset:10240
    v_mfma_f32_16x16x32_bf16 v[40:43], v[228:231], v[160:163], v[40:43]
    ds_read_b64_tr_b16 v[220:221], v245 offset:34144
    ds_read_b64_tr_b16 v[222:223], v245 offset:42592
    v_mfma_f32_16x16x32_bf16 v[44:47], v[228:231], v[168:171], v[44:47]
    ds_read_b64_tr_b16 a[204:205], v249 offset:12288
    ds_read_b64_tr_b16 a[206:207], v249 offset:14336
    v_mfma_f32_16x16x32_bf16 a[40:43], v[228:231], v[176:179], a[40:43]
    ds_read_b64_tr_b16 a[208:209], v249 offset:16384
    ds_read_b64_tr_b16 a[210:211], v249 offset:18432
    v_mfma_f32_16x16x32_bf16 a[44:47], v[228:231], v[184:187], a[44:47]
    ds_read_b64_tr_b16 a[212:213], v249 offset:20480
    s_waitcnt lgkmcnt(15)
    v_mfma_f32_16x16x32_bf16 v[48:51], v[232:235], v[160:163], v[48:51]
    ds_read_b64_tr_b16 v[224:225], v245 offset:34176
    ds_read_b64_tr_b16 v[226:227], v245 offset:42624
    ds_write_b128 v152, a[0:3] offset:0
    v_mfma_f32_16x16x32_bf16 v[52:55], v[232:235], v[168:171], v[52:55]
    ds_read_b64_tr_b16 a[214:215], v249 offset:22528
    ds_read_b64_tr_b16 a[216:217], v249 offset:24576
    v_mfma_f32_16x16x32_bf16 a[48:51], v[232:235], v[176:179], a[48:51]
    ds_read_b64_tr_b16 a[218:219], v249 offset:26624
    ds_read_b64_tr_b16 a[220:221], v249 offset:28672
    v_mfma_f32_16x16x32_bf16 a[52:55], v[232:235], v[184:187], a[52:55]
    ds_read_b64_tr_b16 a[222:223], v249 offset:30720
    ds_write_b128 v152, a[4:7] offset:4096
    v_mfma_f32_16x16x32_bf16 v[56:59], v[236:239], v[160:163], v[56:59]
    ds_read_b64_tr_b16 v[228:229], v245 offset:34208
    ds_read_b64_tr_b16 v[230:231], v245 offset:42656
    v_mfma_f32_16x16x32_bf16 v[60:63], v[236:239], v[168:171], v[60:63]
    v_mov_b32 v254, v242
    v_mov_b32 v255, v243
    v_mfma_f32_16x16x32_bf16 a[56:59], v[236:239], v[176:179], a[56:59]
    ds_write_b128 v152, a[8:11] offset:8192
    v_permlane32_swap_b32 v240, v252
    v_mfma_f32_16x16x32_bf16 a[60:63], v[236:239], v[184:187], a[60:63]
    v_mfma_f32_16x16x32_bf16 v[64:67], v[208:211], v[160:163], v[64:67]
    ds_read_b64_tr_b16 v[232:233], v245 offset:34240
    ds_read_b64_tr_b16 v[234:235], v245 offset:42688
    v_mfma_f32_16x16x32_bf16 v[68:71], v[208:211], v[168:171], v[68:71]
    ds_write_b128 v152, a[12:15] offset:12288
    v_permlane32_swap_b32 v241, v253
    v_mfma_f32_16x16x32_bf16 a[64:67], v[208:211], v[176:179], a[64:67]
    v_permlane32_swap_b32 v242, v254
    v_permlane32_swap_b32 v243, v255
    v_mfma_f32_16x16x32_bf16 a[68:71], v[208:211], v[184:187], a[68:71]
    v_add_f32 v240, v240, v252
    v_add_f32 v241, v241, v253
    v_mfma_f32_16x16x32_bf16 v[72:75], v[212:215], v[160:163], v[72:75]
    ds_read_b64_tr_b16 v[236:237], v245 offset:34272
    ds_read_b64_tr_b16 v[238:239], v245 offset:42720
    ds_write_b128 v152, a[16:19] offset:16384
    v_mfma_f32_16x16x32_bf16 v[76:79], v[212:215], v[168:171], v[76:79]
    v_add_f32 v242, v242, v254
    v_add_f32 v243, v243, v255
    v_mfma_f32_16x16x32_bf16 a[72:75], v[212:215], v[176:179], a[72:75]
    v_add_f32 v253, v240, v241
    v_add_f32 v254, v242, v243
    v_mfma_f32_16x16x32_bf16 a[76:79], v[212:215], v[184:187], a[76:79]
    ds_write_b128 v152, a[20:23] offset:20480
    s_waitcnt lgkmcnt(15)
    v_mfma_f32_16x16x32_bf16 v[80:83], v[216:219], v[160:163], v[80:83]
    v_add_f32 v252, v253, v254
    v_mfma_f32_16x16x32_bf16 v[84:87], v[216:219], v[168:171], v[84:87]
    v_lshrrev_b32 v253, 2, v247
    v_add_u32 v253, s52, v253
    v_mfma_f32_16x16x32_bf16 a[80:83], v[216:219], v[176:179], a[80:83]
    ds_write_b128 v152, a[24:27] offset:24576
    ds_write_b32 v253, v200
    v_mfma_f32_16x16x32_bf16 a[84:87], v[216:219], v[184:187], a[84:87]
    ds_write_b32 v253, v204 offset:256
    ds_write_b32 v253, v242 offset:512
    v_mfma_f32_16x16x32_bf16 v[88:91], v[220:223], v[160:163], v[88:91]
    ds_write_b32 v253, v243 offset:768
    ds_write_b32 v253, v252 offset:4096
    v_mfma_f32_16x16x32_bf16 v[92:95], v[220:223], v[168:171], v[92:95]
    ds_write_b128 v152, a[28:31] offset:28672
    v_mfma_f32_16x16x32_bf16 a[88:91], v[220:223], v[176:179], a[88:91]
    v_mfma_f32_16x16x32_bf16 a[92:95], v[220:223], v[184:187], a[92:95]
    s_waitcnt vmcnt(0) lgkmcnt(0)
    s_barrier
    v_mfma_f32_16x16x32_bf16 v[96:99], v[224:227], v[160:163], v[96:99]
    v_xor_b32 v254, 1024, v253
    v_lshrrev_b32 v255, 2, v247
    ds_write_b128 v153, a[32:35] offset:4096
    v_mfma_f32_16x16x32_bf16 v[100:103], v[224:227], v[168:171], v[100:103]
    v_add_u32 v255, 139264, v255
    v_mfma_f32_16x16x32_bf16 a[96:99], v[224:227], v[176:179], a[96:99]
    ds_read_b32 v128, v254 offset:0
    ds_read_b32 v132, v255 offset:0
    ds_write_b128 v153, a[36:39] offset:8192
    v_mfma_f32_16x16x32_bf16 a[100:103], v[224:227], v[184:187], a[100:103]
    ds_read_b32 v129, v254 offset:256
    ds_read_b32 v133, v255 offset:1024
    v_mfma_f32_16x16x32_bf16 v[104:107], v[228:231], v[160:163], v[104:107]
    ds_read_b32 v130, v254 offset:512
    ds_read_b32 v134, v255 offset:2048
    ds_write_b128 v153, a[40:43] offset:12288
    v_mfma_f32_16x16x32_bf16 v[108:111], v[228:231], v[168:171], v[108:111]
    ds_read_b32 v131, v254 offset:768
    ds_read_b32 v135, v255 offset:3072
    v_mfma_f32_16x16x32_bf16 a[104:107], v[228:231], v[176:179], a[104:107]
    ds_read_b64_tr_b16 a[224:225], v250 offset:0
    ds_read_b64_tr_b16 a[226:227], v250 offset:2048
    ds_write_b128 v153, a[44:47] offset:16384
    v_mfma_f32_16x16x32_bf16 a[108:111], v[228:231], v[184:187], a[108:111]
    ds_read_b64_tr_b16 a[228:229], v250 offset:4096
    ds_read_b64_tr_b16 a[230:231], v250 offset:6144
    v_mfma_f32_16x16x32_bf16 v[112:115], v[232:235], v[160:163], v[112:115]
    ds_read_b64_tr_b16 a[232:233], v250 offset:8192
    ds_read_b64_tr_b16 a[234:235], v250 offset:10240
    ds_write_b128 v153, a[48:51] offset:20480
    v_mfma_f32_16x16x32_bf16 v[116:119], v[232:235], v[168:171], v[116:119]
    ds_read_b64_tr_b16 a[236:237], v250 offset:12288
    ds_read_b64_tr_b16 a[238:239], v250 offset:14336
    v_mfma_f32_16x16x32_bf16 a[112:115], v[232:235], v[176:179], a[112:115]
    ds_read_b64_tr_b16 a[240:241], v250 offset:16384
    ds_read_b64_tr_b16 a[242:243], v250 offset:18432
    ds_write_b128 v153, a[52:55] offset:24576
    v_mfma_f32_16x16x32_bf16 a[116:119], v[232:235], v[184:187], a[116:119]
    ds_read_b64_tr_b16 a[244:245], v250 offset:20480
    ds_read_b64_tr_b16 a[246:247], v250 offset:22528
    v_mfma_f32_16x16x32_bf16 v[120:123], v[236:239], v[160:163], v[120:123]
    ds_read_b64_tr_b16 a[248:249], v250 offset:24576
    ds_read_b64_tr_b16 a[250:251], v250 offset:26624
    ds_write_b128 v153, a[56:59] offset:28672
    v_mfma_f32_16x16x32_bf16 v[124:127], v[236:239], v[168:171], v[124:127]
    ds_read_b64_tr_b16 a[252:253], v250 offset:28672
    ds_read_b64_tr_b16 a[254:255], v250 offset:30720
    v_mfma_f32_16x16x32_bf16 a[120:123], v[236:239], v[176:179], a[120:123]
    ds_write_b128 v153, a[60:63] offset:32768
    v_mfma_f32_16x16x32_bf16 a[124:127], v[236:239], v[184:187], a[124:127]
    s_add_u32 m0, s55, 0
    s_mov_b32 s50, 256
    buffer_load_dwordx4 v248, s[20:23], s50 offen lds
    s_add_u32 m0, s55, 1024
    s_mov_b32 s51, 7424
    buffer_load_dwordx4 v248, s[20:23], s51 offen lds
    s_add_u32 m0, s55, 2048
    s_mov_b32 s50, 14592
    buffer_load_dwordx4 v248, s[20:23], s50 offen lds
    s_add_u32 m0, s55, 3072
    s_mov_b32 s51, 21760
    buffer_load_dwordx4 v248, s[20:23], s51 offen lds
    s_add_u32 m0, s55, 4096
    s_mov_b32 s50, 28928
    buffer_load_dwordx4 v248, s[20:23], s50 offen lds
    s_add_u32 m0, s55, 5120
    s_mov_b32 s51, 36096
    buffer_load_dwordx4 v248, s[20:23], s51 offen lds
    s_add_u32 m0, s55, 6144
    s_mov_b32 s50, 43264
    buffer_load_dwordx4 v248, s[20:23], s50 offen lds
    s_add_u32 m0, s55, 7168
    s_mov_b32 s51, 50432
    buffer_load_dwordx4 v248, s[20:23], s51 offen lds
    s_waitcnt lgkmcnt(15)
    v_add_f32 v133, v133, v134
    v_add_f32 v132, v132, v135
    v_add_f32 v132, v132, v133
    v_xor_b32 v252, 1024, v152
    v_cmp_nge_f32 vcc, s45, v132
    v_xor_b32 v253, 1024, v153
    s_cbranch_vccnz Latt_fallback
Latt_fallback_ret:
    s_waitcnt lgkmcnt(0)
    s_barrier
    ds_write_b128 v152, a[64:67] offset:32768
    v_min_f32 v136, v192, v128
    v_sub_f32 v137, v136, v192
    v_sub_f32 v138, v136, v128
    v_exp_f32 v137, v137
    v_exp_f32 v138, v138
    ds_write_b128 v152, a[68:71] offset:36864
    v_mul_f32 v136, v137, v240
    v_fmac_f32 v136, v138, v130
    v_rcp_f32 v136, v136
    s_nop 0
    v_mul_f32 v240, v137, v136
    v_mul_f32 v242, v138, v136
    ds_write_b128 v152, a[72:75] offset:40960
    v_min_f32 v140, v196, v129
    v_sub_f32 v141, v140, v196
    v_sub_f32 v142, v140, v129
    v_exp_f32 v141, v141
    v_exp_f32 v142, v142
    ds_write_b128 v152, a[76:79] offset:45056
    v_mul_f32 v140, v141, v241
    v_fmac_f32 v140, v142, v131
    v_rcp_f32 v140, v140
    s_nop 0
    v_mul_f32 v241, v141, v140
    v_mul_f32 v243, v142, v140
    ds_write_b128 v152, a[80:83] offset:49152
    v_mul_f32 v0, v0, v240
    v_mul_f32 v1, v1, v240
    v_mul_f32 v2, v2, v240
    v_mul_f32 v3, v3, v240
    v_mul_f32 v4, v4, v241
    ds_write_b128 v152, a[84:87] offset:53248
    v_mul_f32 v5, v5, v241
    v_mul_f32 v6, v6, v241
    v_mul_f32 v7, v7, v241
    v_mul_f32 v8, v8, v240
    v_mul_f32 v9, v9, v240
    ds_write_b128 v152, a[88:91] offset:57344
    v_mul_f32 v10, v10, v240
    v_mul_f32 v11, v11, v240
    v_mul_f32 v12, v12, v241
    v_mul_f32 v13, v13, v241
    v_mul_f32 v14, v14, v241
    ds_write_b128 v152, a[92:95] offset:61440
    v_mul_f32 v15, v15, v241
    v_mul_f32 v16, v16, v240
    v_mul_f32 v17, v17, v240
    v_mul_f32 v18, v18, v240
    v_mul_f32 v19, v19, v240
    ds_write_b128 v153, a[96:99] offset:0
    v_mul_f32 v20, v20, v241
    v_mul_f32 v21, v21, v241
    v_mul_f32 v22, v22, v241
    v_mul_f32 v23, v23, v241
    v_mul_f32 v24, v24, v240
    ds_write_b128 v153, a[100:103] offset:36864
    v_mul_f32 v25, v25, v240
    v_mul_f32 v26, v26, v240
    v_mul_f32 v27, v27, v240
    v_mul_f32 v28, v28, v241
    v_mul_f32 v29, v29, v241
    ds_write_b128 v153, a[104:107] offset:40960
    v_mul_f32 v30, v30, v241
    v_mul_f32 v31, v31, v241
    v_mul_f32 v32, v32, v240
    v_mul_f32 v33, v33, v240
    v_mul_f32 v34, v34, v240
    ds_write_b128 v153, a[108:111] offset:45056
    v_mul_f32 v35, v35, v240
    v_mul_f32 v36, v36, v241
    v_mul_f32 v37, v37, v241
    v_mul_f32 v38, v38, v241
    v_mul_f32 v39, v39, v241
    ds_write_b128 v153, a[112:115] offset:49152
    v_mul_f32 v40, v40, v240
    v_mul_f32 v41, v41, v240
    v_mul_f32 v42, v42, v240
    v_mul_f32 v43, v43, v240
    v_mul_f32 v44, v44, v241
    ds_write_b128 v153, a[116:119] offset:53248
    v_mul_f32 v45, v45, v241
    v_mul_f32 v46, v46, v241
    v_mul_f32 v47, v47, v241
    v_mul_f32 v48, v48, v240
    v_mul_f32 v49, v49, v240
    ds_write_b128 v153, a[120:123] offset:57344
    v_mul_f32 v50, v50, v240
    v_mul_f32 v51, v51, v240
    v_mul_f32 v52, v52, v241
    v_mul_f32 v53, v53, v241
    v_mul_f32 v54, v54, v241
    ds_write_b128 v153, a[124:127] offset:61440
    v_mul_f32 v55, v55, v241
    v_mul_f32 v56, v56, v240
    v_mul_f32 v57, v57, v240
    v_mul_f32 v58, v58, v240
    v_mul_f32 v59, v59, v240
    s_waitcnt lgkmcnt(0)
    s_barrier
    ds_read_b128 v[128:131], v252 offset:0
    v_mul_f32 v60, v60, v241
    v_mul_f32 v61, v61, v241
    ds_read_b128 v[132:135], v252 offset:4096
    v_mul_f32 v62, v62, v241
    v_mul_f32 v63, v63, v241
    ds_read_b128 v[136:139], v252 offset:8192
    v_mul_f32 v64, v64, v240
    v_mul_f32 v65, v65, v240
    ds_read_b128 v[140:143], v252 offset:12288
    v_mul_f32 v66, v66, v240
    v_mul_f32 v67, v67, v240
    ds_read_b128 v[144:147], v252 offset:16384
    v_mul_f32 v68, v68, v241
    v_mul_f32 v69, v69, v241
    ds_read_b128 v[148:151], v252 offset:20480
    v_mul_f32 v70, v70, v241
    v_mul_f32 v71, v71, v241
    ds_read_b128 v[152:155], v252 offset:24576
    v_mul_f32 v72, v72, v240
    v_mul_f32 v73, v73, v240
    ds_read_b128 v[156:159], v252 offset:28672
    v_mul_f32 v74, v74, v240
    v_mul_f32 v75, v75, v240
    ds_read_b128 v[160:163], v253 offset:4096
    v_mul_f32 v76, v76, v241
    v_mul_f32 v77, v77, v241
    ds_read_b128 v[164:167], v253 offset:8192
    v_mul_f32 v78, v78, v241
    v_mul_f32 v79, v79, v241
    ds_read_b128 v[168:171], v253 offset:12288
    v_mul_f32 v80, v80, v240
    v_mul_f32 v81, v81, v240
    ds_read_b128 v[172:175], v253 offset:16384
    v_mul_f32 v82, v82, v240
    v_mul_f32 v83, v83, v240
    ds_read_b128 v[176:179], v253 offset:20480
    v_mul_f32 v84, v84, v241
    v_mul_f32 v85, v85, v241
    ds_read_b128 v[180:183], v253 offset:24576
    v_mul_f32 v86, v86, v241
    v_mul_f32 v87, v87, v241
    ds_read_b128 v[184:187], v253 offset:28672
    v_mul_f32 v88, v88, v240
    v_mul_f32 v89, v89, v240
    ds_read_b128 v[188:191], v253 offset:32768
    v_mul_f32 v90, v90, v240
    v_mul_f32 v91, v91, v240
    ds_read_b128 v[192:195], v252 offset:32768
    v_mul_f32 v92, v92, v241
    v_mul_f32 v93, v93, v241
    ds_read_b128 v[196:199], v252 offset:36864
    v_mul_f32 v94, v94, v241
    v_mul_f32 v95, v95, v241
    ds_read_b128 v[200:203], v252 offset:40960
    v_mul_f32 v96, v96, v240
    v_mul_f32 v97, v97, v240
    ds_read_b128 v[204:207], v252 offset:45056
    v_mul_f32 v98, v98, v240
    v_mul_f32 v99, v99, v240
    ds_read_b128 v[208:211], v252 offset:49152
    v_mul_f32 v100, v100, v241
    v_mul_f32 v101, v101, v241
    ds_read_b128 v[212:215], v252 offset:53248
    v_mul_f32 v102, v102, v241
    v_mul_f32 v103, v103, v241
    ds_read_b128 v[216:219], v252 offset:57344
    v_mul_f32 v104, v104, v240
    v_mul_f32 v105, v105, v240
    ds_read_b128 v[220:223], v252 offset:61440
    v_mul_f32 v106, v106, v240
    v_mul_f32 v107, v107, v240
    ds_read_b128 v[224:227], v253 offset:0
    v_mul_f32 v108, v108, v241
    v_mul_f32 v109, v109, v241
    ds_read_b128 v[228:231], v253 offset:36864
    v_mul_f32 v110, v110, v241
    v_mul_f32 v111, v111, v241
    ds_read_b128 v[232:235], v253 offset:40960
    v_mul_f32 v112, v112, v240
    v_mul_f32 v113, v113, v240
    ds_read_b128 v[236:239], v253 offset:45056
    v_mul_f32 v114, v114, v240
    v_mul_f32 v115, v115, v240
    ds_read_b128 a[0:3], v253 offset:49152
    v_mul_f32 v116, v116, v241
    v_mul_f32 v117, v117, v241
    ds_read_b128 a[4:7], v253 offset:53248
    v_mul_f32 v118, v118, v241
    v_mul_f32 v119, v119, v241
    ds_read_b128 a[8:11], v253 offset:57344
    v_mul_f32 v120, v120, v240
    v_mul_f32 v121, v121, v240
    ds_read_b128 a[12:15], v253 offset:61440
    v_mul_f32 v122, v122, v240
    v_mul_f32 v123, v123, v240
    v_mul_f32 v124, v124, v241
    v_mul_f32 v125, v125, v241
    v_mul_f32 v126, v126, v241
    v_mul_f32 v127, v127, v241
    s_waitcnt lgkmcnt(0)
    s_barrier
    s_and_b32 s52, s3, 1
    s_lshl_b32 s52, s52, 15
    s_lshr_b32 s53, s3, 1
    s_lshl_b32 s53, s53, 11
    s_add_u32 s52, s52, s53
    s_add_u32 s52, s52, 98304
    v_add_u32 v252, s52, v247
    v_add_u32 v253, 98304, v247
    v_fmac_f32 v0, v128, v242
    s_add_u32 m0, s55, 32768
    s_mov_b32 s50, 229632
    buffer_load_dwordx4 v248, s[20:23], s50 offen lds
    v_fmac_f32 v1, v129, v242
    v_fmac_f32 v2, v130, v242
    v_fmac_f32 v3, v131, v242
    v_fmac_f32 v4, v132, v243
    s_add_u32 m0, s55, 33792
    s_mov_b32 s51, 236800
    buffer_load_dwordx4 v248, s[20:23], s51 offen lds
    v_fmac_f32 v5, v133, v243
    v_fmac_f32 v6, v134, v243
    v_fmac_f32 v7, v135, v243
    v_fmac_f32 v8, v136, v242
    s_add_u32 m0, s55, 34816
    s_mov_b32 s50, 243968
    buffer_load_dwordx4 v248, s[20:23], s50 offen lds
    v_fmac_f32 v9, v137, v242
    v_fmac_f32 v10, v138, v242
    v_fmac_f32 v11, v139, v242
    v_fmac_f32 v12, v140, v243
    s_add_u32 m0, s55, 35840
    s_mov_b32 s51, 251136
    buffer_load_dwordx4 v248, s[20:23], s51 offen lds
    v_fmac_f32 v13, v141, v243
    v_fmac_f32 v14, v142, v243
    v_fmac_f32 v15, v143, v243
    v_max3_f32 v136, abs(v0), abs(v1), abs(v2)
    v_max3_f32 v136, v136, abs(v3), abs(v8)
    v_max3_f32 v136, v136, abs(v9), abs(v10)
    v_max_f32 v136, v136, abs(v11)
    v_max_f32 v140, v240, v242
    v_mul_f32 v140, 176160768, v140
    v_max3_f32 v137, abs(v4), abs(v5), abs(v6)
    v_max3_f32 v137, v137, abs(v7), abs(v12)
    v_max3_f32 v137, v137, abs(v13), abs(v14)
    v_max_f32 v137, v137, abs(v15)
    v_max_f32 v141, v241, v243
    v_mul_f32 v141, 176160768, v141
    v_mov_b32 v138, v136
    v_mov_b32 v139, v137
    s_nop 0
    v_permlane16_swap_b32 v136, v138
    v_permlane16_swap_b32 v137, v139
    v_max_f32 v136, v136, v138
    v_max_f32 v137, v137, v139
    v_mov_b32 v138, v136
    v_mov_b32 v139, v137
    s_nop 0
    v_permlane32_swap_b32 v136, v138
    v_permlane32_swap_b32 v137, v139
    v_max_f32 v136, v136, v138
    v_max_f32 v137, v137, v139
    v_cmp_nge_f32 vcc, v136, v140
    v_cmp_nge_f32 s[4:5], v137, v141
    s_nop 0
    s_or_b64 vcc, vcc, s[4:5]
    s_or_b32 s48, vcc_lo, vcc_hi
    v_cvt_pk_bf16_f32 v128, v0, v1
    v_cvt_pk_bf16_f32 v129, v2, v3
    v_cvt_pk_bf16_f32 v130, v8, v9
    v_cvt_pk_bf16_f32 v131, v10, v11
    v_cvt_pk_bf16_f32 v132, v4, v5
    v_cvt_pk_bf16_f32 v133, v6, v7
    v_cvt_pk_bf16_f32 v134, v12, v13
    v_cvt_pk_bf16_f32 v135, v14, v15
    ds_write_b128 v252, v[128:131] offset:0
    ds_write_b128 v252, v[132:135] offset:1024
    v_fmac_f32 v16, v144, v242
    s_add_u32 m0, s55, 36864
    s_mov_b32 s50, 258304
    buffer_load_dwordx4 v248, s[20:23], s50 offen lds
    v_fmac_f32 v17, v145, v242
    v_fmac_f32 v18, v146, v242
    v_fmac_f32 v19, v147, v242
    v_fmac_f32 v20, v148, v243
    s_add_u32 m0, s55, 37888
    s_mov_b32 s51, 265472
    buffer_load_dwordx4 v248, s[20:23], s51 offen lds
    v_fmac_f32 v21, v149, v243
    v_fmac_f32 v22, v150, v243
    v_fmac_f32 v23, v151, v243
    v_fmac_f32 v24, v152, v242
    s_add_u32 m0, s55, 38912
    s_mov_b32 s50, 272640
    buffer_load_dwordx4 v248, s[20:23], s50 offen lds
    v_fmac_f32 v25, v153, v242
    v_fmac_f32 v26, v154, v242
    v_fmac_f32 v27, v155, v242
    v_fmac_f32 v28, v156, v243
    s_add_u32 m0, s55, 39936
    s_mov_b32 s51, 279808
    buffer_load_dwordx4 v248, s[20:23], s51 offen lds
    v_fmac_f32 v29, v157, v243
    v_fmac_f32 v30, v158, v243
    v_fmac_f32 v31, v159, v243
    v_cvt_pk_bf16_f32 v8, v16, v17
    v_cvt_pk_bf16_f32 v9, v18, v19
    v_cvt_pk_bf16_f32 v10, v24, v25
    v_cvt_pk_bf16_f32 v11, v26, v27
    v_cvt_pk_bf16_f32 v12, v20, v21
    v_cvt_pk_bf16_f32 v13, v22, v23
    v_cvt_pk_bf16_f32 v14, v28, v29
    v_cvt_pk_bf16_f32 v15, v30, v31
    ds_write_b128 v252, v[8:11] offset:4096
    ds_write_b128 v252, v[12:15] offset:5120
    v_fmac_f32 v32, v160, v242
    s_add_u32 m0, s55, 65536
    s_mov_b32 s50, 384
    buffer_load_dwordx4 v248, s[20:23], s50 offen lds
    v_fmac_f32 v33, v161, v242
    v_fmac_f32 v34, v162, v242
    v_fmac_f32 v35, v163, v242
    v_fmac_f32 v36, v164, v243
    s_add_u32 m0, s55, 66560
    s_mov_b32 s51, 7552
    buffer_load_dwordx4 v248, s[20:23], s51 offen lds
    v_fmac_f32 v37, v165, v243
    v_fmac_f32 v38, v166, v243
    v_fmac_f32 v39, v167, v243
    v_fmac_f32 v40, v168, v242
    s_add_u32 m0, s55, 67584
    s_mov_b32 s50, 14720
    buffer_load_dwordx4 v248, s[20:23], s50 offen lds
    v_fmac_f32 v41, v169, v242
    v_fmac_f32 v42, v170, v242
    v_fmac_f32 v43, v171, v242
    v_fmac_f32 v44, v172, v243
    s_add_u32 m0, s55, 68608
    s_mov_b32 s51, 21888
    buffer_load_dwordx4 v248, s[20:23], s51 offen lds
    v_fmac_f32 v45, v173, v243
    v_fmac_f32 v46, v174, v243
    v_fmac_f32 v47, v175, v243
    v_cvt_pk_bf16_f32 v16, v32, v33
    v_cvt_pk_bf16_f32 v17, v34, v35
    v_cvt_pk_bf16_f32 v18, v40, v41
    v_cvt_pk_bf16_f32 v19, v42, v43
    v_cvt_pk_bf16_f32 v20, v36, v37
    v_cvt_pk_bf16_f32 v21, v38, v39
    v_cvt_pk_bf16_f32 v22, v44, v45
    v_cvt_pk_bf16_f32 v23, v46, v47
    ds_write_b128 v252, v[16:19] offset:8192
    ds_write_b128 v252, v[20:23] offset:9216
    v_fmac_f32 v48, v176, v242
    s_add_u32 m0, s55, 69632
    s_mov_b32 s50, 29056
    buffer_load_dwordx4 v248, s[20:23], s50 offen lds
    v_fmac_f32 v49, v177, v242
    v_fmac_f32 v50, v178, v242
    v_fmac_f32 v51, v179, v242
    v_fmac_f32 v52, v180, v243
    s_add_u32 m0, s55, 70656
    s_mov_b32 s51, 36224
    buffer_load_dwordx4 v248, s[20:23], s51 offen lds
    v_fmac_f32 v53, v181, v243
    v_fmac_f32 v54, v182, v243
    v_fmac_f32 v55, v183, v243
    v_fmac_f32 v56, v184, v242
    s_add_u32 m0, s55, 71680
    s_mov_b32 s50, 43392
    buffer_load_dwordx4 v248, s[20:23], s50 offen lds
    v_fmac_f32 v57, v185, v242
    v_fmac_f32 v58, v186, v242
    v_fmac_f32 v59, v187, v242
    v_fmac_f32 v60, v188, v243
    s_add_u32 m0, s55, 72704
    s_mov_b32 s51, 50560
    buffer_load_dwordx4 v248, s[20:23], s51 offen lds
    v_fmac_f32 v61, v189, v243
    v_fmac_f32 v62, v190, v243
    v_fmac_f32 v63, v191, v243
    v_cvt_pk_bf16_f32 v24, v48, v49
    v_cvt_pk_bf16_f32 v25, v50, v51
    v_cvt_pk_bf16_f32 v26, v56, v57
    v_cvt_pk_bf16_f32 v27, v58, v59
    v_cvt_pk_bf16_f32 v28, v52, v53
    v_cvt_pk_bf16_f32 v29, v54, v55
    v_cvt_pk_bf16_f32 v30, v60, v61
    v_cvt_pk_bf16_f32 v31, v62, v63
    ds_write_b128 v252, v[24:27] offset:12288
    ds_write_b128 v252, v[28:31] offset:13312
    v_fmac_f32 v64, v192, v242
    v_fmac_f32 v65, v193, v242
    v_fmac_f32 v66, v194, v242
    v_fmac_f32 v67, v195, v242
    v_fmac_f32 v68, v196, v243
    v_fmac_f32 v69, v197, v243
    v_fmac_f32 v70, v198, v243
    v_fmac_f32 v71, v199, v243
    v_fmac_f32 v72, v200, v242
    v_fmac_f32 v73, v201, v242
    v_fmac_f32 v74, v202, v242
    v_fmac_f32 v75, v203, v242
    v_fmac_f32 v76, v204, v243
    v_fmac_f32 v77, v205, v243
    v_fmac_f32 v78, v206, v243
    v_fmac_f32 v79, v207, v243
    v_cvt_pk_bf16_f32 v32, v64, v65
    v_cvt_pk_bf16_f32 v33, v66, v67
    v_cvt_pk_bf16_f32 v34, v72, v73
    v_cvt_pk_bf16_f32 v35, v74, v75
    v_cvt_pk_bf16_f32 v36, v68, v69
    v_cvt_pk_bf16_f32 v37, v70, v71
    v_cvt_pk_bf16_f32 v38, v76, v77
    v_cvt_pk_bf16_f32 v39, v78, v79
    ds_write_b128 v252, v[32:35] offset:16384
    ds_write_b128 v252, v[36:39] offset:17408
    v_fmac_f32 v80, v208, v242
    v_fmac_f32 v81, v209, v242
    v_fmac_f32 v82, v210, v242
    v_fmac_f32 v83, v211, v242
    v_fmac_f32 v84, v212, v243
    v_fmac_f32 v85, v213, v243
    v_fmac_f32 v86, v214, v243
    v_fmac_f32 v87, v215, v243
    v_fmac_f32 v88, v216, v242
    v_fmac_f32 v89, v217, v242
    v_fmac_f32 v90, v218, v242
    v_fmac_f32 v91, v219, v242
    v_fmac_f32 v92, v220, v243
    v_fmac_f32 v93, v221, v243
    v_fmac_f32 v94, v222, v243
    v_fmac_f32 v95, v223, v243
    v_cvt_pk_bf16_f32 v40, v80, v81
    v_cvt_pk_bf16_f32 v41, v82, v83
    v_cvt_pk_bf16_f32 v42, v88, v89
    v_cvt_pk_bf16_f32 v43, v90, v91
    v_cvt_pk_bf16_f32 v44, v84, v85
    v_cvt_pk_bf16_f32 v45, v86, v87
    v_cvt_pk_bf16_f32 v46, v92, v93
    v_cvt_pk_bf16_f32 v47, v94, v95
    ds_write_b128 v252, v[40:43] offset:20480
    ds_write_b128 v252, v[44:47] offset:21504
    v_fmac_f32 v96, v224, v242
    v_fmac_f32 v97, v225, v242
    v_fmac_f32 v98, v226, v242
    v_fmac_f32 v99, v227, v242
    v_fmac_f32 v100, v228, v243
    v_fmac_f32 v101, v229, v243
    v_fmac_f32 v102, v230, v243
    v_fmac_f32 v103, v231, v243
    v_fmac_f32 v104, v232, v242
    v_fmac_f32 v105, v233, v242
    v_fmac_f32 v106, v234, v242
    v_fmac_f32 v107, v235, v242
    v_fmac_f32 v108, v236, v243
    v_fmac_f32 v109, v237, v243
    v_fmac_f32 v110, v238, v243
    v_fmac_f32 v111, v239, v243
    v_cvt_pk_bf16_f32 v48, v96, v97
    v_cvt_pk_bf16_f32 v49, v98, v99
    v_cvt_pk_bf16_f32 v50, v104, v105
    v_cvt_pk_bf16_f32 v51, v106, v107
    v_cvt_pk_bf16_f32 v52, v100, v101
    v_cvt_pk_bf16_f32 v53, v102, v103
    v_cvt_pk_bf16_f32 v54, v108, v109
    v_cvt_pk_bf16_f32 v55, v110, v111
    ds_write_b128 v252, v[48:51] offset:24576
    ds_write_b128 v252, v[52:55] offset:25600
    v_accvgpr_read_b32 v128, a0
    v_accvgpr_read_b32 v129, a1
    v_accvgpr_read_b32 v130, a2
    v_accvgpr_read_b32 v131, a3
    v_accvgpr_read_b32 v132, a4
    v_accvgpr_read_b32 v133, a5
    v_accvgpr_read_b32 v134, a6
    v_accvgpr_read_b32 v135, a7
    v_accvgpr_read_b32 v136, a8
    v_accvgpr_read_b32 v137, a9
    v_accvgpr_read_b32 v138, a10
    v_accvgpr_read_b32 v139, a11
    v_accvgpr_read_b32 v140, a12
    v_accvgpr_read_b32 v141, a13
    v_accvgpr_read_b32 v142, a14
    v_accvgpr_read_b32 v143, a15
    v_fmac_f32 v112, v128, v242
    v_fmac_f32 v113, v129, v242
    v_fmac_f32 v114, v130, v242
    v_fmac_f32 v115, v131, v242
    v_fmac_f32 v116, v132, v243
    v_fmac_f32 v117, v133, v243
    v_fmac_f32 v118, v134, v243
    v_fmac_f32 v119, v135, v243
    v_fmac_f32 v120, v136, v242
    v_fmac_f32 v121, v137, v242
    v_fmac_f32 v122, v138, v242
    v_fmac_f32 v123, v139, v242
    v_fmac_f32 v124, v140, v243
    v_fmac_f32 v125, v141, v243
    v_fmac_f32 v126, v142, v243
    v_fmac_f32 v127, v143, v243
    v_cvt_pk_bf16_f32 v56, v112, v113
    v_cvt_pk_bf16_f32 v57, v114, v115
    v_cvt_pk_bf16_f32 v58, v120, v121
    v_cvt_pk_bf16_f32 v59, v122, v123
    v_cvt_pk_bf16_f32 v60, v116, v117
    v_cvt_pk_bf16_f32 v61, v118, v119
    v_cvt_pk_bf16_f32 v62, v124, v125
    v_cvt_pk_bf16_f32 v63, v126, v127
    ds_write_b128 v252, v[56:59] offset:28672
    ds_write_b128 v252, v[60:63] offset:29696
    s_waitcnt vmcnt(16) lgkmcnt(0)
    s_barrier
    v_add_u32 v254, 0, v249
    ds_read_b128 a[0:3], v253 offset:0
    ds_read_b128 a[4:7], v253 offset:1024
    ds_read_b128 a[8:11], v253 offset:2048
    ds_read_b128 a[12:15], v253 offset:3072
    ds_read_b128 a[16:19], v253 offset:4096
    ds_read_b128 a[20:23], v253 offset:5120
    ds_read_b128 a[24:27], v253 offset:6144
    ds_read_b128 a[28:31], v253 offset:7168
    ds_read_b64_tr_b16 v[32:33], v254 offset:0
    ds_read_b64_tr_b16 v[34:35], v254 offset:2048
    ds_read_b64_tr_b16 v[36:37], v254 offset:4096
    ds_read_b64_tr_b16 v[38:39], v254 offset:6144
    ds_read_b64_tr_b16 v[40:41], v254 offset:8192
    ds_read_b64_tr_b16 v[42:43], v254 offset:10240
    s_waitcnt lgkmcnt(4)
    v_mfma_f32_16x16x32_bf16 v[0:3], v[32:35], a[0:3], 0
    ds_read_b64_tr_b16 v[44:45], v254 offset:12288
    ds_read_b64_tr_b16 v[46:47], v254 offset:14336
    v_mfma_f32_16x16x32_bf16 v[4:7], v[32:35], a[4:7], 0
    ds_read_b64_tr_b16 v[48:49], v254 offset:16384
    ds_read_b64_tr_b16 v[50:51], v254 offset:18432
    v_mfma_f32_16x16x32_bf16 v[8:11], v[32:35], a[8:11], 0
    ds_read_b64_tr_b16 v[52:53], v254 offset:20480
    ds_read_b64_tr_b16 v[54:55], v254 offset:22528
    v_mfma_f32_16x16x32_bf16 v[12:15], v[32:35], a[12:15], 0
    ds_read_b64_tr_b16 v[56:57], v254 offset:24576
    ds_read_b64_tr_b16 v[58:59], v254 offset:26624
    s_waitcnt lgkmcnt(10)
    v_mfma_f32_16x16x32_bf16 v[0:3], v[36:39], a[16:19], v[0:3]
    ds_read_b64_tr_b16 v[60:61], v254 offset:28672
    ds_read_b64_tr_b16 v[62:63], v254 offset:30720
    v_mfma_f32_16x16x32_bf16 v[4:7], v[36:39], a[20:23], v[4:7]
    ds_read_b128 a[32:35], v253 offset:8192
    ds_read_b128 a[36:39], v253 offset:9216
    v_mfma_f32_16x16x32_bf16 v[8:11], v[36:39], a[24:27], v[8:11]
    ds_read_b128 a[40:43], v253 offset:10240
    ds_read_b128 a[44:47], v253 offset:11264
    ds_read_b128 a[48:51], v253 offset:12288
    ds_read_b128 a[52:55], v253 offset:13312
    v_mfma_f32_16x16x32_bf16 v[12:15], v[36:39], a[28:31], v[12:15]
    ds_read_b128 a[56:59], v253 offset:14336
    ds_read_b128 a[60:63], v253 offset:15360
    ds_read_b128 a[64:67], v253 offset:16384
    ds_read_b128 a[68:71], v253 offset:17408
    s_waitcnt lgkmcnt(9)
    v_mfma_f32_16x16x32_bf16 v[0:3], v[40:43], a[32:35], v[0:3]
    ds_read_b128 a[72:75], v253 offset:18432
    ds_read_b128 a[76:79], v253 offset:19456
    ds_read_b128 a[80:83], v253 offset:20480
    ds_read_b128 a[84:87], v253 offset:21504
    ds_read_b128 a[88:91], v253 offset:22528
    s_waitcnt lgkmcnt(13)
    v_mfma_f32_16x16x32_bf16 v[4:7], v[40:43], a[36:39], v[4:7]
    ds_read_b128 a[92:95], v253 offset:23552
    ds_read_b128 a[96:99], v253 offset:24576
    ds_read_b128 a[100:103], v253 offset:25600
    ds_read_b128 a[104:107], v253 offset:26624
    s_waitcnt lgkmcnt(15)
    v_mfma_f32_16x16x32_bf16 v[8:11], v[40:43], a[40:43], v[8:11]
    ds_read_b128 a[108:111], v253 offset:27648
    ds_read_b128 a[112:115], v253 offset:28672
    ds_read_b128 a[116:119], v253 offset:29696
    ds_read_b128 a[120:123], v253 offset:30720
    v_mfma_f32_16x16x32_bf16 v[12:15], v[40:43], a[44:47], v[12:15]
    ds_read_b128 a[124:127], v253 offset:31744
    ds_read_b128 v[112:115], v253 offset:32768
    ds_read_b128 v[116:119], v253 offset:33792
    ds_read_b128 v[120:123], v253 offset:34816
    s_waitcnt lgkmcnt(15)
    v_mfma_f32_16x16x32_bf16 v[0:3], v[44:47], a[48:51], v[0:3]
    ds_read_b128 v[124:127], v253 offset:35840
    ds_read_b128 v[128:131], v253 offset:36864
    ds_read_b128 v[132:135], v253 offset:37888
    ds_read_b128 v[136:139], v253 offset:38912
    v_mfma_f32_16x16x32_bf16 v[4:7], v[44:47], a[52:55], v[4:7]
    ds_read_b128 v[140:143], v253 offset:39936
    ds_read_b128 v[144:147], v253 offset:40960
    ds_read_b128 v[148:151], v253 offset:41984
    ds_read_b128 v[152:155], v253 offset:43008
    v_mfma_f32_16x16x32_bf16 v[8:11], v[44:47], a[56:59], v[8:11]
    ds_read_b128 v[156:159], v253 offset:44032
    ds_read_b128 v[160:163], v253 offset:45056
    ds_read_b128 v[164:167], v253 offset:46080
    ds_read_b128 v[168:171], v253 offset:47104
    v_mfma_f32_16x16x32_bf16 v[12:15], v[44:47], a[60:63], v[12:15]
    ds_read_b128 v[172:175], v253 offset:48128
    ds_read_b128 v[176:179], v253 offset:49152
    ds_read_b128 v[180:183], v253 offset:50176
    ds_read_b128 v[184:187], v253 offset:51200
    ds_read_b128 v[188:191], v253 offset:52224
    v_mfma_f32_16x16x32_bf16 v[0:3], v[48:51], a[64:67], v[0:3]
    ds_read_b128 v[192:195], v253 offset:53248
    ds_read_b128 v[196:199], v253 offset:54272
    ds_read_b128 v[200:203], v253 offset:55296
    ds_read_b128 v[204:207], v253 offset:56320
    v_mfma_f32_16x16x32_bf16 v[4:7], v[48:51], a[68:71], v[4:7]
    ds_read_b128 v[208:211], v253 offset:57344
    ds_read_b128 v[212:215], v253 offset:58368
    ds_read_b128 v[216:219], v253 offset:59392
    ds_read_b128 v[220:223], v253 offset:60416
    v_mfma_f32_16x16x32_bf16 v[8:11], v[48:51], a[72:75], v[8:11]
    v_add_u32 v255, 32768, v249
    ds_read_b128 v[224:227], v253 offset:61440
    ds_read_b128 v[228:231], v253 offset:62464
    ds_read_b128 v[232:235], v253 offset:63488
    ds_read_b128 v[236:239], v253 offset:64512
    v_mfma_f32_16x16x32_bf16 v[12:15], v[48:51], a[76:79], v[12:15]
    s_waitcnt vmcnt(8) lgkmcnt(0)
    s_barrier
    v_mfma_f32_16x16x32_bf16 v[0:3], v[52:55], a[80:83], v[0:3]
    ds_read_b64_tr_b16 v[32:33], v255 offset:0
    ds_read_b64_tr_b16 v[34:35], v255 offset:2048
    v_mfma_f32_16x16x32_bf16 v[4:7], v[52:55], a[84:87], v[4:7]
    ds_read_b64_tr_b16 v[36:37], v255 offset:4096
    ds_read_b64_tr_b16 v[38:39], v255 offset:6144
    v_mfma_f32_16x16x32_bf16 v[8:11], v[52:55], a[88:91], v[8:11]
    ds_read_b64_tr_b16 v[40:41], v255 offset:8192
    ds_read_b64_tr_b16 v[42:43], v255 offset:10240
    v_mfma_f32_16x16x32_bf16 v[12:15], v[52:55], a[92:95], v[12:15]
    s_add_u32 m0, s55, 98304
    s_mov_b32 s50, 229760
    v_mfma_f32_16x16x32_bf16 v[0:3], v[56:59], a[96:99], v[0:3]
    buffer_load_dwordx4 v248, s[20:23], s50 offen lds
    v_mfma_f32_16x16x32_bf16 v[4:7], v[56:59], a[100:103], v[4:7]
    v_mfma_f32_16x16x32_bf16 v[8:11], v[56:59], a[104:107], v[8:11]
    s_add_u32 m0, s55, 99328
    s_mov_b32 s51, 236928
    v_mfma_f32_16x16x32_bf16 v[12:15], v[56:59], a[108:111], v[12:15]
    buffer_load_dwordx4 v248, s[20:23], s51 offen lds
    v_mfma_f32_16x16x32_bf16 v[0:3], v[60:63], a[112:115], v[0:3]
    v_mfma_f32_16x16x32_bf16 v[4:7], v[60:63], a[116:119], v[4:7]
    s_add_u32 m0, s55, 100352
    s_mov_b32 s50, 244096
    v_mfma_f32_16x16x32_bf16 v[8:11], v[60:63], a[120:123], v[8:11]
    buffer_load_dwordx4 v248, s[20:23], s50 offen lds
    v_mfma_f32_16x16x32_bf16 v[12:15], v[60:63], a[124:127], v[12:15]
    s_waitcnt lgkmcnt(2)
    v_mfma_f32_16x16x32_bf16 v[0:3], v[32:35], v[112:115], v[0:3]
    ds_read_b64_tr_b16 v[44:45], v255 offset:12288
    ds_read_b64_tr_b16 v[46:47], v255 offset:14336
    v_mfma_f32_16x16x32_bf16 v[0:3], v[36:39], v[128:131], v[0:3]
    ds_read_b64_tr_b16 v[48:49], v255 offset:16384
    ds_read_b64_tr_b16 v[50:51], v255 offset:18432
    v_mfma_f32_16x16x32_bf16 v[4:7], v[32:35], v[116:119], v[4:7]
    ds_read_b64_tr_b16 v[52:53], v255 offset:20480
    ds_read_b64_tr_b16 v[54:55], v255 offset:22528
    v_mfma_f32_16x16x32_bf16 v[4:7], v[36:39], v[132:135], v[4:7]
    ds_read_b64_tr_b16 v[56:57], v255 offset:24576
    ds_read_b64_tr_b16 v[58:59], v255 offset:26624
    v_mfma_f32_16x16x32_bf16 v[8:11], v[32:35], v[120:123], v[8:11]
    ds_read_b64_tr_b16 v[60:61], v255 offset:28672
    ds_read_b64_tr_b16 v[62:63], v255 offset:30720
    v_mfma_f32_16x16x32_bf16 v[8:11], v[36:39], v[136:139], v[8:11]
    s_add_u32 m0, s55, 101376
    s_mov_b32 s51, 251264
    v_mfma_f32_16x16x32_bf16 v[12:15], v[32:35], v[124:127], v[12:15]
    buffer_load_dwordx4 v248, s[20:23], s51 offen lds
    v_mfma_f32_16x16x32_bf16 v[12:15], v[36:39], v[140:143], v[12:15]
    s_waitcnt lgkmcnt(8)
    v_mfma_f32_16x16x32_bf16 v[0:3], v[40:43], v[144:147], v[0:3]
    s_add_u32 m0, s55, 102400
    s_mov_b32 s50, 258432
    v_mfma_f32_16x16x32_bf16 v[0:3], v[44:47], v[160:163], v[0:3]
    buffer_load_dwordx4 v248, s[20:23], s50 offen lds
    v_mfma_f32_16x16x32_bf16 v[4:7], v[40:43], v[148:151], v[4:7]
    v_mfma_f32_16x16x32_bf16 v[4:7], v[44:47], v[164:167], v[4:7]
    s_add_u32 m0, s55, 103424
    s_mov_b32 s51, 265600
    v_mfma_f32_16x16x32_bf16 v[8:11], v[40:43], v[152:155], v[8:11]
    buffer_load_dwordx4 v248, s[20:23], s51 offen lds
    v_mfma_f32_16x16x32_bf16 v[8:11], v[44:47], v[168:171], v[8:11]
    v_mfma_f32_16x16x32_bf16 v[12:15], v[40:43], v[156:159], v[12:15]
    v_mfma_f32_16x16x32_bf16 v[12:15], v[44:47], v[172:175], v[12:15]
    s_waitcnt lgkmcnt(4)
    v_mfma_f32_16x16x32_bf16 v[0:3], v[48:51], v[176:179], v[0:3]
    s_add_u32 m0, s55, 104448
    s_mov_b32 s50, 272768
    v_mfma_f32_16x16x32_bf16 v[0:3], v[52:55], v[192:195], v[0:3]
    buffer_load_dwordx4 v248, s[20:23], s50 offen lds
    v_mfma_f32_16x16x32_bf16 v[4:7], v[48:51], v[180:183], v[4:7]
    v_mfma_f32_16x16x32_bf16 v[4:7], v[52:55], v[196:199], v[4:7]
    s_waitcnt lgkmcnt(0)
    s_barrier
    v_mfma_f32_16x16x32_bf16 v[8:11], v[48:51], v[184:187], v[8:11]
    s_add_u32 m0, s55, 105472
    s_mov_b32 s51, 279936
    v_mfma_f32_16x16x32_bf16 v[8:11], v[52:55], v[200:203], v[8:11]
    buffer_load_dwordx4 v248, s[20:23], s51 offen lds
    v_mfma_f32_16x16x32_bf16 v[12:15], v[48:51], v[188:191], v[12:15]
    v_mfma_f32_16x16x32_bf16 v[12:15], v[52:55], v[204:207], v[12:15]
    s_add_u32 m0, s55, 131072
    s_mov_b32 s50, 512
    v_mfma_f32_16x16x32_bf16 v[0:3], v[56:59], v[208:211], v[0:3]
    buffer_load_dwordx4 v248, s[20:23], s50 offen lds
    v_mfma_f32_16x16x32_bf16 v[0:3], v[60:63], v[224:227], v[0:3]
    v_mfma_f32_16x16x32_bf16 v[4:7], v[56:59], v[212:215], v[4:7]
    s_add_u32 m0, s55, 132096
    s_mov_b32 s51, 7680
    v_mfma_f32_16x16x32_bf16 v[4:7], v[60:63], v[228:231], v[4:7]
    buffer_load_dwordx4 v248, s[20:23], s51 offen lds
    v_mfma_f32_16x16x32_bf16 v[8:11], v[56:59], v[216:219], v[8:11]
    v_mfma_f32_16x16x32_bf16 v[8:11], v[60:63], v[232:235], v[8:11]
    s_add_u32 m0, s55, 133120
    s_mov_b32 s50, 14848
    v_mfma_f32_16x16x32_bf16 v[12:15], v[56:59], v[220:223], v[12:15]
    buffer_load_dwordx4 v248, s[20:23], s50 offen lds
    v_mfma_f32_16x16x32_bf16 v[12:15], v[60:63], v[236:239], v[12:15]
    v_mfma_f32_16x16x32_bf16 v[16:19], a[128:131], a[0:3], 0
    s_add_u32 m0, s55, 134144
    s_mov_b32 s51, 22016
    v_mfma_f32_16x16x32_bf16 v[16:19], a[132:135], a[16:19], v[16:19]
    buffer_load_dwordx4 v248, s[20:23], s51 offen lds
    v_mfma_f32_16x16x32_bf16 v[16:19], a[136:139], a[32:35], v[16:19]
    v_mfma_f32_16x16x32_bf16 v[16:19], a[140:143], a[48:51], v[16:19]
    s_add_u32 m0, s55, 135168
    s_mov_b32 s50, 29184
    v_mfma_f32_16x16x32_bf16 v[16:19], a[144:147], a[64:67], v[16:19]
    buffer_load_dwordx4 v248, s[20:23], s50 offen lds
    v_mfma_f32_16x16x32_bf16 v[16:19], a[148:151], a[80:83], v[16:19]
    v_mfma_f32_16x16x32_bf16 v[16:19], a[152:155], a[96:99], v[16:19]
    s_add_u32 m0, s55, 136192
    s_mov_b32 s51, 36352
    v_mfma_f32_16x16x32_bf16 v[16:19], a[156:159], a[112:115], v[16:19]
    buffer_load_dwordx4 v248, s[20:23], s51 offen lds
    v_mfma_f32_16x16x32_bf16 v[20:23], a[128:131], a[4:7], 0
    s_mov_b32 s52, 8192
    s_mov_b32 s53, 36864
    v_mfma_f32_16x16x32_bf16 v[20:23], a[132:135], a[20:23], v[20:23]
    s_add_u32 m0, s55, 137216
    s_mov_b32 s50, 43520
    v_mfma_f32_16x16x32_bf16 v[20:23], a[136:139], a[36:39], v[20:23]
    buffer_load_dwordx4 v248, s[20:23], s50 offen lds
    v_mfma_f32_16x16x32_bf16 v[20:23], a[140:143], a[52:55], v[20:23]
    v_cvt_pk_bf16_f32 v64, v0, v1
    v_mfma_f32_16x16x32_bf16 v[20:23], a[144:147], a[68:71], v[20:23]
    s_add_u32 m0, s55, 138240
    s_mov_b32 s51, 50688
    v_mfma_f32_16x16x32_bf16 v[20:23], a[148:151], a[84:87], v[20:23]
    buffer_load_dwordx4 v248, s[20:23], s51 offen lds
    v_mfma_f32_16x16x32_bf16 v[20:23], a[152:155], a[100:103], v[20:23]
    v_cvt_pk_bf16_f32 v65, v2, v3
    v_mfma_f32_16x16x32_bf16 v[20:23], a[156:159], a[116:119], v[20:23]
    s_add_u32 m0, s55, 0
    s_mov_b32 s50, 229888
    v_mfma_f32_16x16x32_bf16 v[24:27], a[128:131], a[8:11], 0
    buffer_load_dwordx4 v248, s[20:23], s50 offen lds
    v_mfma_f32_16x16x32_bf16 v[24:27], a[132:135], a[24:27], v[24:27]
    v_cvt_pk_bf16_f32 v66, v4, v5
    v_cvt_pk_bf16_f32 v67, v6, v7
    v_mfma_f32_16x16x32_bf16 v[24:27], a[136:139], a[40:43], v[24:27]
    s_add_u32 m0, s55, 1024
    s_mov_b32 s51, 237056
    v_mfma_f32_16x16x32_bf16 v[24:27], a[140:143], a[56:59], v[24:27]
    buffer_load_dwordx4 v248, s[20:23], s51 offen lds
    v_mfma_f32_16x16x32_bf16 v[24:27], a[144:147], a[72:75], v[24:27]
    buffer_store_dwordx4 v[64:67], v251, s[28:31], s52 offen sc1
    v_mfma_f32_16x16x32_bf16 v[24:27], a[148:151], a[88:91], v[24:27]
    s_add_u32 m0, s55, 2048
    s_mov_b32 s50, 244224
    v_mfma_f32_16x16x32_bf16 v[24:27], a[152:155], a[104:107], v[24:27]
    buffer_load_dwordx4 v248, s[20:23], s50 offen lds
    v_mfma_f32_16x16x32_bf16 v[24:27], a[156:159], a[120:123], v[24:27]
    v_cvt_pk_bf16_f32 v68, v8, v9
    v_mfma_f32_16x16x32_bf16 v[28:31], a[128:131], a[12:15], 0
    s_add_u32 m0, s55, 3072
    s_mov_b32 s51, 251392
    v_mfma_f32_16x16x32_bf16 v[28:31], a[132:135], a[28:31], v[28:31]
    buffer_load_dwordx4 v248, s[20:23], s51 offen lds
    v_mfma_f32_16x16x32_bf16 v[28:31], a[136:139], a[44:47], v[28:31]
    v_cvt_pk_bf16_f32 v69, v10, v11
    v_mfma_f32_16x16x32_bf16 v[28:31], a[140:143], a[60:63], v[28:31]
    s_add_u32 m0, s55, 4096
    s_mov_b32 s50, 258560
    v_mfma_f32_16x16x32_bf16 v[28:31], a[144:147], a[76:79], v[28:31]
    buffer_load_dwordx4 v248, s[20:23], s50 offen lds
    v_mfma_f32_16x16x32_bf16 v[28:31], a[148:151], a[92:95], v[28:31]
    v_cvt_pk_bf16_f32 v70, v12, v13
    v_cvt_pk_bf16_f32 v71, v14, v15
    v_mfma_f32_16x16x32_bf16 v[28:31], a[152:155], a[108:111], v[28:31]
    buffer_store_dwordx4 v[68:71], v251, s[28:31], s53 offen sc1
    v_mfma_f32_16x16x32_bf16 v[28:31], a[156:159], a[124:127], v[28:31]
    v_mfma_f32_16x16x32_bf16 v[16:19], a[160:163], v[112:115], v[16:19]
    s_add_u32 m0, s55, 5120
    s_mov_b32 s51, 265728
    v_mfma_f32_16x16x32_bf16 v[16:19], a[164:167], v[128:131], v[16:19]
    buffer_load_dwordx4 v248, s[20:23], s51 offen lds
    v_mfma_f32_16x16x32_bf16 v[16:19], a[168:171], v[144:147], v[16:19]
    v_mfma_f32_16x16x32_bf16 v[16:19], a[172:175], v[160:163], v[16:19]
    s_add_u32 m0, s55, 6144
    s_mov_b32 s50, 272896
    v_mfma_f32_16x16x32_bf16 v[16:19], a[176:179], v[176:179], v[16:19]
    buffer_load_dwordx4 v248, s[20:23], s50 offen lds
    v_mfma_f32_16x16x32_bf16 v[16:19], a[180:183], v[192:195], v[16:19]
    v_mfma_f32_16x16x32_bf16 v[16:19], a[184:187], v[208:211], v[16:19]
    s_add_u32 m0, s55, 7168
    s_mov_b32 s51, 280064
    v_mfma_f32_16x16x32_bf16 v[16:19], a[188:191], v[224:227], v[16:19]
    buffer_load_dwordx4 v248, s[20:23], s51 offen lds
    v_mfma_f32_16x16x32_bf16 v[20:23], a[160:163], v[116:119], v[20:23]
    v_mfma_f32_16x16x32_bf16 v[20:23], a[164:167], v[132:135], v[20:23]
    s_add_u32 m0, s55, 32768
    s_mov_b32 s50, 640
    v_mfma_f32_16x16x32_bf16 v[20:23], a[168:171], v[148:151], v[20:23]
    buffer_load_dwordx4 v248, s[20:23], s50 offen lds
    v_mfma_f32_16x16x32_bf16 v[20:23], a[172:175], v[164:167], v[20:23]
    v_mfma_f32_16x16x32_bf16 v[20:23], a[176:179], v[180:183], v[20:23]
    s_add_u32 m0, s55, 33792
    s_mov_b32 s51, 7808
    v_mfma_f32_16x16x32_bf16 v[20:23], a[180:183], v[196:199], v[20:23]
    buffer_load_dwordx4 v248, s[20:23], s51 offen lds
    v_mfma_f32_16x16x32_bf16 v[20:23], a[184:187], v[212:215], v[20:23]
    v_mfma_f32_16x16x32_bf16 v[20:23], a[188:191], v[228:231], v[20:23]
    s_add_u32 m0, s55, 34816
    s_mov_b32 s50, 14976
    v_mfma_f32_16x16x32_bf16 v[24:27], a[160:163], v[120:123], v[24:27]
    buffer_load_dwordx4 v248, s[20:23], s50 offen lds
    v_mfma_f32_16x16x32_bf16 v[24:27], a[164:167], v[136:139], v[24:27]
    v_mfma_f32_16x16x32_bf16 v[24:27], a[168:171], v[152:155], v[24:27]
    v_add_u32 v254, 65536, v249
    v_mfma_f32_16x16x32_bf16 v[24:27], a[172:175], v[168:171], v[24:27]
    s_waitcnt vmcnt(29) lgkmcnt(0)
    s_barrier
    v_mfma_f32_16x16x32_bf16 v[24:27], a[176:179], v[184:187], v[24:27]
    ds_read_b64_tr_b16 v[32:33], v254 offset:0
    ds_read_b64_tr_b16 v[34:35], v254 offset:2048
    v_mfma_f32_16x16x32_bf16 v[24:27], a[180:183], v[200:203], v[24:27]
    ds_read_b64_tr_b16 v[36:37], v254 offset:4096
    ds_read_b64_tr_b16 v[38:39], v254 offset:6144
    v_mfma_f32_16x16x32_bf16 v[24:27], a[184:187], v[216:219], v[24:27]
    ds_read_b64_tr_b16 v[40:41], v254 offset:8192
    ds_read_b64_tr_b16 v[42:43], v254 offset:10240
    v_mfma_f32_16x16x32_bf16 v[24:27], a[188:191], v[232:235], v[24:27]
    s_add_u32 m0, s55, 35840
    s_mov_b32 s51, 22144
    v_mfma_f32_16x16x32_bf16 v[28:31], a[160:163], v[124:127], v[28:31]
    buffer_load_dwordx4 v248, s[20:23], s51 offen lds
    v_mfma_f32_16x16x32_bf16 v[28:31], a[164:167], v[140:143], v[28:31]
    v_mfma_f32_16x16x32_bf16 v[28:31], a[168:171], v[156:159], v[28:31]
    s_add_u32 m0, s55, 36864
    s_mov_b32 s50, 29312
    v_mfma_f32_16x16x32_bf16 v[28:31], a[172:175], v[172:175], v[28:31]
    buffer_load_dwordx4 v248, s[20:23], s50 offen lds
    v_mfma_f32_16x16x32_bf16 v[28:31], a[176:179], v[188:191], v[28:31]
    v_mfma_f32_16x16x32_bf16 v[28:31], a[180:183], v[204:207], v[28:31]
    s_add_u32 m0, s55, 37888
    s_mov_b32 s51, 36480
    v_mfma_f32_16x16x32_bf16 v[28:31], a[184:187], v[220:223], v[28:31]
    buffer_load_dwordx4 v248, s[20:23], s51 offen lds
    v_mfma_f32_16x16x32_bf16 v[28:31], a[188:191], v[236:239], v[28:31]
    s_waitcnt lgkmcnt(2)
    v_mfma_f32_16x16x32_bf16 v[0:3], v[32:35], a[0:3], 0
    ds_read_b64_tr_b16 v[44:45], v254 offset:12288
    ds_read_b64_tr_b16 v[46:47], v254 offset:14336
    v_mfma_f32_16x16x32_bf16 v[0:3], v[36:39], a[16:19], v[0:3]
    ds_read_b64_tr_b16 v[48:49], v254 offset:16384
    ds_read_b64_tr_b16 v[50:51], v254 offset:18432
    v_mfma_f32_16x16x32_bf16 v[4:7], v[32:35], a[4:7], 0
    ds_read_b64_tr_b16 v[52:53], v254 offset:20480
    ds_read_b64_tr_b16 v[54:55], v254 offset:22528
    v_mfma_f32_16x16x32_bf16 v[4:7], v[36:39], a[20:23], v[4:7]
    ds_read_b64_tr_b16 v[56:57], v254 offset:24576
    ds_read_b64_tr_b16 v[58:59], v254 offset:26624
    v_mfma_f32_16x16x32_bf16 v[8:11], v[32:35], a[8:11], 0
    ds_read_b64_tr_b16 v[60:61], v254 offset:28672
    ds_read_b64_tr_b16 v[62:63], v254 offset:30720
    v_mfma_f32_16x16x32_bf16 v[8:11], v[36:39], a[24:27], v[8:11]
    s_add_u32 m0, s55, 38912
    s_mov_b32 s50, 43648
    v_mfma_f32_16x16x32_bf16 v[12:15], v[32:35], a[12:15], 0
    buffer_load_dwordx4 v248, s[20:23], s50 offen lds
    v_mfma_f32_16x16x32_bf16 v[12:15], v[36:39], a[28:31], v[12:15]
    s_waitcnt lgkmcnt(8)
    v_mfma_f32_16x16x32_bf16 v[0:3], v[40:43], a[32:35], v[0:3]
    s_add_u32 m0, s55, 39936
    s_mov_b32 s51, 50816
    v_mfma_f32_16x16x32_bf16 v[0:3], v[44:47], a[48:51], v[0:3]
    buffer_load_dwordx4 v248, s[20:23], s51 offen lds
    v_mfma_f32_16x16x32_bf16 v[4:7], v[40:43], a[36:39], v[4:7]
    s_mov_b32 s52, 0
    s_mov_b32 s53, 28672
    v_mfma_f32_16x16x32_bf16 v[4:7], v[44:47], a[52:55], v[4:7]
    v_cvt_pk_bf16_f32 v64, v16, v17
    v_mfma_f32_16x16x32_bf16 v[8:11], v[40:43], a[40:43], v[8:11]
    v_cvt_pk_bf16_f32 v65, v18, v19
    v_mfma_f32_16x16x32_bf16 v[8:11], v[44:47], a[56:59], v[8:11]
    v_cvt_pk_bf16_f32 v66, v20, v21
    v_mfma_f32_16x16x32_bf16 v[12:15], v[40:43], a[44:47], v[12:15]
    v_cvt_pk_bf16_f32 v67, v22, v23
    v_mfma_f32_16x16x32_bf16 v[12:15], v[44:47], a[60:63], v[12:15]
    buffer_store_dwordx4 v[64:67], v251, s[28:31], s52 offen sc1
    s_waitcnt lgkmcnt(4)
    v_mfma_f32_16x16x32_bf16 v[0:3], v[48:51], a[64:67], v[0:3]
    v_cvt_pk_bf16_f32 v68, v24, v25
    v_mfma_f32_16x16x32_bf16 v[0:3], v[52:55], a[80:83], v[0:3]
    v_cvt_pk_bf16_f32 v69, v26, v27
    v_mfma_f32_16x16x32_bf16 v[4:7], v[48:51], a[68:71], v[4:7]
    v_add_u32 v255, 98304, v249
    v_cvt_pk_bf16_f32 v70, v28, v29
    v_mfma_f32_16x16x32_bf16 v[4:7], v[52:55], a[84:87], v[4:7]
    s_waitcnt vmcnt(27) lgkmcnt(0)
    s_barrier
    v_mfma_f32_16x16x32_bf16 v[8:11], v[48:51], a[72:75], v[8:11]
    ds_read_b64_tr_b16 v[32:33], v255 offset:0
    ds_read_b64_tr_b16 v[34:35], v255 offset:2048
    v_mfma_f32_16x16x32_bf16 v[8:11], v[52:55], a[88:91], v[8:11]
    ds_read_b64_tr_b16 v[36:37], v255 offset:4096
    ds_read_b64_tr_b16 v[38:39], v255 offset:6144
    v_mfma_f32_16x16x32_bf16 v[12:15], v[48:51], a[76:79], v[12:15]
    ds_read_b64_tr_b16 v[40:41], v255 offset:8192
    ds_read_b64_tr_b16 v[42:43], v255 offset:10240
    v_mfma_f32_16x16x32_bf16 v[12:15], v[52:55], a[92:95], v[12:15]
    s_add_u32 m0, s55, 65536
    s_mov_b32 s50, 230016
    v_mfma_f32_16x16x32_bf16 v[0:3], v[56:59], a[96:99], v[0:3]
    buffer_load_dwordx4 v248, s[20:23], s50 offen lds
    v_mfma_f32_16x16x32_bf16 v[0:3], v[60:63], a[112:115], v[0:3]
    v_cvt_pk_bf16_f32 v71, v30, v31
    v_mfma_f32_16x16x32_bf16 v[4:7], v[56:59], a[100:103], v[4:7]
    s_add_u32 m0, s55, 66560
    s_mov_b32 s51, 237184
    v_mfma_f32_16x16x32_bf16 v[4:7], v[60:63], a[116:119], v[4:7]
    buffer_load_dwordx4 v248, s[20:23], s51 offen lds
    v_mfma_f32_16x16x32_bf16 v[8:11], v[56:59], a[104:107], v[8:11]
    buffer_store_dwordx4 v[68:71], v251, s[28:31], s53 offen sc1
    v_mfma_f32_16x16x32_bf16 v[8:11], v[60:63], a[120:123], v[8:11]
    s_add_u32 m0, s55, 67584
    s_mov_b32 s50, 244352
    v_mfma_f32_16x16x32_bf16 v[12:15], v[56:59], a[108:111], v[12:15]
    buffer_load_dwordx4 v248, s[20:23], s50 offen lds
    v_mfma_f32_16x16x32_bf16 v[12:15], v[60:63], a[124:127], v[12:15]
    s_waitcnt lgkmcnt(2)
    v_mfma_f32_16x16x32_bf16 v[0:3], v[32:35], v[112:115], v[0:3]
    ds_read_b64_tr_b16 v[44:45], v255 offset:12288
    ds_read_b64_tr_b16 v[46:47], v255 offset:14336
    v_mfma_f32_16x16x32_bf16 v[0:3], v[36:39], v[128:131], v[0:3]
    ds_read_b64_tr_b16 v[48:49], v255 offset:16384
    ds_read_b64_tr_b16 v[50:51], v255 offset:18432
    v_mfma_f32_16x16x32_bf16 v[4:7], v[32:35], v[116:119], v[4:7]
    ds_read_b64_tr_b16 v[52:53], v255 offset:20480
    ds_read_b64_tr_b16 v[54:55], v255 offset:22528
    v_mfma_f32_16x16x32_bf16 v[4:7], v[36:39], v[132:135], v[4:7]
    ds_read_b64_tr_b16 v[56:57], v255 offset:24576
    ds_read_b64_tr_b16 v[58:59], v255 offset:26624
    v_mfma_f32_16x16x32_bf16 v[8:11], v[32:35], v[120:123], v[8:11]
    ds_read_b64_tr_b16 v[60:61], v255 offset:28672
    ds_read_b64_tr_b16 v[62:63], v255 offset:30720
    v_mfma_f32_16x16x32_bf16 v[8:11], v[36:39], v[136:139], v[8:11]
    s_add_u32 m0, s55, 68608
    s_mov_b32 s51, 251520
    v_mfma_f32_16x16x32_bf16 v[12:15], v[32:35], v[124:127], v[12:15]
    buffer_load_dwordx4 v248, s[20:23], s51 offen lds
    v_mfma_f32_16x16x32_bf16 v[12:15], v[36:39], v[140:143], v[12:15]
    s_waitcnt lgkmcnt(8)
    v_mfma_f32_16x16x32_bf16 v[0:3], v[40:43], v[144:147], v[0:3]
    s_add_u32 m0, s55, 69632
    s_mov_b32 s50, 258688
    v_mfma_f32_16x16x32_bf16 v[0:3], v[44:47], v[160:163], v[0:3]
    buffer_load_dwordx4 v248, s[20:23], s50 offen lds
    v_mfma_f32_16x16x32_bf16 v[4:7], v[40:43], v[148:151], v[4:7]
    v_mfma_f32_16x16x32_bf16 v[4:7], v[44:47], v[164:167], v[4:7]
    s_add_u32 m0, s55, 70656
    s_mov_b32 s51, 265856
    v_mfma_f32_16x16x32_bf16 v[8:11], v[40:43], v[152:155], v[8:11]
    buffer_load_dwordx4 v248, s[20:23], s51 offen lds
    v_mfma_f32_16x16x32_bf16 v[8:11], v[44:47], v[168:171], v[8:11]
    v_mfma_f32_16x16x32_bf16 v[12:15], v[40:43], v[156:159], v[12:15]
    v_mfma_f32_16x16x32_bf16 v[12:15], v[44:47], v[172:175], v[12:15]
    s_waitcnt lgkmcnt(4)
    v_mfma_f32_16x16x32_bf16 v[0:3], v[48:51], v[176:179], v[0:3]
    s_add_u32 m0, s55, 71680
    s_mov_b32 s50, 273024
    v_mfma_f32_16x16x32_bf16 v[0:3], v[52:55], v[192:195], v[0:3]
    buffer_load_dwordx4 v248, s[20:23], s50 offen lds
    v_mfma_f32_16x16x32_bf16 v[4:7], v[48:51], v[180:183], v[4:7]
    v_mfma_f32_16x16x32_bf16 v[4:7], v[52:55], v[196:199], v[4:7]
    s_waitcnt lgkmcnt(0)
    s_barrier
    v_mfma_f32_16x16x32_bf16 v[8:11], v[48:51], v[184:187], v[8:11]
    s_add_u32 m0, s55, 72704
    s_mov_b32 s51, 280192
    v_mfma_f32_16x16x32_bf16 v[8:11], v[52:55], v[200:203], v[8:11]
    buffer_load_dwordx4 v248, s[20:23], s51 offen lds
    v_mfma_f32_16x16x32_bf16 v[12:15], v[48:51], v[188:191], v[12:15]
    v_mfma_f32_16x16x32_bf16 v[12:15], v[52:55], v[204:207], v[12:15]
    s_add_u32 m0, s55, 98304
    s_mov_b32 s50, 768
    v_mfma_f32_16x16x32_bf16 v[0:3], v[56:59], v[208:211], v[0:3]
    buffer_load_dwordx4 v248, s[20:23], s50 offen lds
    v_mfma_f32_16x16x32_bf16 v[0:3], v[60:63], v[224:227], v[0:3]
    v_mfma_f32_16x16x32_bf16 v[4:7], v[56:59], v[212:215], v[4:7]
    s_add_u32 m0, s55, 99328
    s_mov_b32 s51, 7936
    v_mfma_f32_16x16x32_bf16 v[4:7], v[60:63], v[228:231], v[4:7]
    buffer_load_dwordx4 v248, s[20:23], s51 offen lds
    v_mfma_f32_16x16x32_bf16 v[8:11], v[56:59], v[216:219], v[8:11]
    v_mfma_f32_16x16x32_bf16 v[8:11], v[60:63], v[232:235], v[8:11]
    s_add_u32 m0, s55, 100352
    s_mov_b32 s50, 15104
    v_mfma_f32_16x16x32_bf16 v[12:15], v[56:59], v[220:223], v[12:15]
    buffer_load_dwordx4 v248, s[20:23], s50 offen lds
    v_mfma_f32_16x16x32_bf16 v[12:15], v[60:63], v[236:239], v[12:15]
    v_mfma_f32_16x16x32_bf16 v[16:19], a[192:195], a[0:3], 0
    s_add_u32 m0, s55, 101376
    s_mov_b32 s51, 22272
    v_mfma_f32_16x16x32_bf16 v[16:19], a[196:199], a[16:19], v[16:19]
    buffer_load_dwordx4 v248, s[20:23], s51 offen lds
    v_mfma_f32_16x16x32_bf16 v[16:19], a[200:203], a[32:35], v[16:19]
    v_mfma_f32_16x16x32_bf16 v[16:19], a[204:207], a[48:51], v[16:19]
    s_add_u32 m0, s55, 102400
    s_mov_b32 s50, 29440
    v_mfma_f32_16x16x32_bf16 v[16:19], a[208:211], a[64:67], v[16:19]
    buffer_load_dwordx4 v248, s[20:23], s50 offen lds
    v_mfma_f32_16x16x32_bf16 v[16:19], a[212:215], a[80:83], v[16:19]
    v_mfma_f32_16x16x32_bf16 v[16:19], a[216:219], a[96:99], v[16:19]
    s_add_u32 m0, s55, 103424
    s_mov_b32 s51, 36608
    v_mfma_f32_16x16x32_bf16 v[16:19], a[220:223], a[112:115], v[16:19]
    buffer_load_dwordx4 v248, s[20:23], s51 offen lds
    v_mfma_f32_16x16x32_bf16 v[20:23], a[192:195], a[4:7], 0
    s_mov_b32 s52, 12288
    v_mfma_f32_16x16x32_bf16 v[20:23], a[196:199], a[20:23], v[20:23]
    s_add_u32 m0, s55, 104448
    s_mov_b32 s50, 43776
    v_mfma_f32_16x16x32_bf16 v[20:23], a[200:203], a[36:39], v[20:23]
    buffer_load_dwordx4 v248, s[20:23], s50 offen lds
    v_mfma_f32_16x16x32_bf16 v[20:23], a[204:207], a[52:55], v[20:23]
    s_mov_b32 s53, 40960
    v_mfma_f32_16x16x32_bf16 v[20:23], a[208:211], a[68:71], v[20:23]
    s_add_u32 m0, s55, 105472
    s_mov_b32 s51, 50944
    v_mfma_f32_16x16x32_bf16 v[20:23], a[212:215], a[84:87], v[20:23]
    buffer_load_dwordx4 v248, s[20:23], s51 offen lds
    v_mfma_f32_16x16x32_bf16 v[20:23], a[216:219], a[100:103], v[20:23]
    v_mfma_f32_16x16x32_bf16 v[20:23], a[220:223], a[116:119], v[20:23]
    v_cvt_pk_bf16_f32 v64, v0, v1
    v_mfma_f32_16x16x32_bf16 v[24:27], a[192:195], a[8:11], 0
    v_cvt_pk_bf16_f32 v65, v2, v3
    v_mfma_f32_16x16x32_bf16 v[24:27], a[196:199], a[24:27], v[24:27]
    v_mfma_f32_16x16x32_bf16 v[24:27], a[200:203], a[40:43], v[24:27]
    v_cvt_pk_bf16_f32 v66, v4, v5
    v_mfma_f32_16x16x32_bf16 v[24:27], a[204:207], a[56:59], v[24:27]
    v_mfma_f32_16x16x32_bf16 v[24:27], a[208:211], a[72:75], v[24:27]
    v_cvt_pk_bf16_f32 v67, v6, v7
    v_mfma_f32_16x16x32_bf16 v[24:27], a[212:215], a[88:91], v[24:27]
    buffer_store_dwordx4 v[64:67], v251, s[28:31], s52 offen sc1
    v_mfma_f32_16x16x32_bf16 v[24:27], a[216:219], a[104:107], v[24:27]
    v_mfma_f32_16x16x32_bf16 v[24:27], a[220:223], a[120:123], v[24:27]
    v_cvt_pk_bf16_f32 v68, v8, v9
    v_mfma_f32_16x16x32_bf16 v[28:31], a[192:195], a[12:15], 0
    v_mfma_f32_16x16x32_bf16 v[28:31], a[196:199], a[28:31], v[28:31]
    v_cvt_pk_bf16_f32 v69, v10, v11
    v_mfma_f32_16x16x32_bf16 v[28:31], a[200:203], a[44:47], v[28:31]
    v_cvt_pk_bf16_f32 v70, v12, v13
    v_mfma_f32_16x16x32_bf16 v[28:31], a[204:207], a[60:63], v[28:31]
    v_mfma_f32_16x16x32_bf16 v[28:31], a[208:211], a[76:79], v[28:31]
    v_cvt_pk_bf16_f32 v71, v14, v15
    v_mfma_f32_16x16x32_bf16 v[28:31], a[212:215], a[92:95], v[28:31]
    buffer_store_dwordx4 v[68:71], v251, s[28:31], s53 offen sc1
    v_mfma_f32_16x16x32_bf16 v[28:31], a[216:219], a[108:111], v[28:31]
    v_mfma_f32_16x16x32_bf16 v[28:31], a[220:223], a[124:127], v[28:31]
    v_mfma_f32_16x16x32_bf16 v[16:19], a[224:227], v[112:115], v[16:19]
    v_mfma_f32_16x16x32_bf16 v[16:19], a[228:231], v[128:131], v[16:19]
    v_mfma_f32_16x16x32_bf16 v[16:19], a[232:235], v[144:147], v[16:19]
    v_mfma_f32_16x16x32_bf16 v[16:19], a[236:239], v[160:163], v[16:19]
    v_mfma_f32_16x16x32_bf16 v[16:19], a[240:243], v[176:179], v[16:19]
    v_mfma_f32_16x16x32_bf16 v[16:19], a[244:247], v[192:195], v[16:19]
    v_mfma_f32_16x16x32_bf16 v[16:19], a[248:251], v[208:211], v[16:19]
    v_mfma_f32_16x16x32_bf16 v[16:19], a[252:255], v[224:227], v[16:19]
    v_mfma_f32_16x16x32_bf16 v[20:23], a[224:227], v[116:119], v[20:23]
    v_mfma_f32_16x16x32_bf16 v[20:23], a[228:231], v[132:135], v[20:23]
    v_mfma_f32_16x16x32_bf16 v[20:23], a[232:235], v[148:151], v[20:23]
    v_mfma_f32_16x16x32_bf16 v[20:23], a[236:239], v[164:167], v[20:23]
    v_mfma_f32_16x16x32_bf16 v[20:23], a[240:243], v[180:183], v[20:23]
    v_mfma_f32_16x16x32_bf16 v[20:23], a[244:247], v[196:199], v[20:23]
    v_mfma_f32_16x16x32_bf16 v[20:23], a[248:251], v[212:215], v[20:23]
    v_mfma_f32_16x16x32_bf16 v[20:23], a[252:255], v[228:231], v[20:23]
    v_mfma_f32_16x16x32_bf16 v[24:27], a[224:227], v[120:123], v[24:27]
    v_mfma_f32_16x16x32_bf16 v[24:27], a[228:231], v[136:139], v[24:27]
    v_mfma_f32_16x16x32_bf16 v[24:27], a[232:235], v[152:155], v[24:27]
    v_add_u32 v254, 131072, v249
    v_mfma_f32_16x16x32_bf16 v[24:27], a[236:239], v[168:171], v[24:27]
    s_waitcnt vmcnt(38) lgkmcnt(0)
    s_barrier
    v_mfma_f32_16x16x32_bf16 v[24:27], a[240:243], v[184:187], v[24:27]
    ds_read_b64_tr_b16 v[32:33], v254 offset:0
    ds_read_b64_tr_b16 v[34:35], v254 offset:2048
    v_mfma_f32_16x16x32_bf16 v[24:27], a[244:247], v[200:203], v[24:27]
    ds_read_b64_tr_b16 v[36:37], v254 offset:4096
    ds_read_b64_tr_b16 v[38:39], v254 offset:6144
    v_mfma_f32_16x16x32_bf16 v[24:27], a[248:251], v[216:219], v[24:27]
    ds_read_b64_tr_b16 v[40:41], v254 offset:8192
    ds_read_b64_tr_b16 v[42:43], v254 offset:10240
    v_mfma_f32_16x16x32_bf16 v[24:27], a[252:255], v[232:235], v[24:27]
    v_mfma_f32_16x16x32_bf16 v[28:31], a[224:227], v[124:127], v[28:31]
    v_mfma_f32_16x16x32_bf16 v[28:31], a[228:231], v[140:143], v[28:31]
    v_mfma_f32_16x16x32_bf16 v[28:31], a[232:235], v[156:159], v[28:31]
    v_mfma_f32_16x16x32_bf16 v[28:31], a[236:239], v[172:175], v[28:31]
    v_mfma_f32_16x16x32_bf16 v[28:31], a[240:243], v[188:191], v[28:31]
    v_mfma_f32_16x16x32_bf16 v[28:31], a[244:247], v[204:207], v[28:31]
    v_mfma_f32_16x16x32_bf16 v[28:31], a[248:251], v[220:223], v[28:31]
    v_mfma_f32_16x16x32_bf16 v[28:31], a[252:255], v[236:239], v[28:31]
    s_waitcnt lgkmcnt(2)
    v_mfma_f32_16x16x32_bf16 v[0:3], v[32:35], a[0:3], 0
    ds_read_b64_tr_b16 v[44:45], v254 offset:12288
    ds_read_b64_tr_b16 v[46:47], v254 offset:14336
    v_mfma_f32_16x16x32_bf16 v[0:3], v[36:39], a[16:19], v[0:3]
    ds_read_b64_tr_b16 v[48:49], v254 offset:16384
    ds_read_b64_tr_b16 v[50:51], v254 offset:18432
    v_mfma_f32_16x16x32_bf16 v[4:7], v[32:35], a[4:7], 0
    ds_read_b64_tr_b16 v[52:53], v254 offset:20480
    ds_read_b64_tr_b16 v[54:55], v254 offset:22528
    v_mfma_f32_16x16x32_bf16 v[4:7], v[36:39], a[20:23], v[4:7]
    ds_read_b64_tr_b16 v[56:57], v254 offset:24576
    ds_read_b64_tr_b16 v[58:59], v254 offset:26624
    v_mfma_f32_16x16x32_bf16 v[8:11], v[32:35], a[8:11], 0
    ds_read_b64_tr_b16 v[60:61], v254 offset:28672
    ds_read_b64_tr_b16 v[62:63], v254 offset:30720
    v_mfma_f32_16x16x32_bf16 v[8:11], v[36:39], a[24:27], v[8:11]
    v_mfma_f32_16x16x32_bf16 v[12:15], v[32:35], a[12:15], 0
    v_mfma_f32_16x16x32_bf16 v[12:15], v[36:39], a[28:31], v[12:15]
    s_waitcnt lgkmcnt(8)
    v_mfma_f32_16x16x32_bf16 v[0:3], v[40:43], a[32:35], v[0:3]
    s_mov_b32 s52, 4096
    v_mfma_f32_16x16x32_bf16 v[0:3], v[44:47], a[48:51], v[0:3]
    s_mov_b32 s53, 32768
    v_mfma_f32_16x16x32_bf16 v[4:7], v[40:43], a[36:39], v[4:7]
    v_cvt_pk_bf16_f32 v64, v16, v17
    v_mfma_f32_16x16x32_bf16 v[4:7], v[44:47], a[52:55], v[4:7]
    v_cvt_pk_bf16_f32 v65, v18, v19
    v_mfma_f32_16x16x32_bf16 v[8:11], v[40:43], a[40:43], v[8:11]
    v_cvt_pk_bf16_f32 v66, v20, v21
    v_mfma_f32_16x16x32_bf16 v[8:11], v[44:47], a[56:59], v[8:11]
    v_cvt_pk_bf16_f32 v67, v22, v23
    v_mfma_f32_16x16x32_bf16 v[12:15], v[40:43], a[44:47], v[12:15]
    buffer_store_dwordx4 v[64:67], v251, s[28:31], s52 offen sc1
    v_mfma_f32_16x16x32_bf16 v[12:15], v[44:47], a[60:63], v[12:15]
    v_cvt_pk_bf16_f32 v68, v24, v25
    s_waitcnt lgkmcnt(4)
    v_mfma_f32_16x16x32_bf16 v[0:3], v[48:51], a[64:67], v[0:3]
    v_cvt_pk_bf16_f32 v69, v26, v27
    v_mfma_f32_16x16x32_bf16 v[0:3], v[52:55], a[80:83], v[0:3]
    v_cvt_pk_bf16_f32 v70, v28, v29
    v_mfma_f32_16x16x32_bf16 v[4:7], v[48:51], a[68:71], v[4:7]
    v_add_u32 v255, 0, v249
    v_mfma_f32_16x16x32_bf16 v[4:7], v[52:55], a[84:87], v[4:7]
    s_waitcnt vmcnt(29) lgkmcnt(0)
    s_barrier
    v_mfma_f32_16x16x32_bf16 v[8:11], v[48:51], a[72:75], v[8:11]
    ds_read_b64_tr_b16 v[32:33], v255 offset:0
    ds_read_b64_tr_b16 v[34:35], v255 offset:2048
    v_mfma_f32_16x16x32_bf16 v[8:11], v[52:55], a[88:91], v[8:11]
    ds_read_b64_tr_b16 v[36:37], v255 offset:4096
    ds_read_b64_tr_b16 v[38:39], v255 offset:6144
    v_mfma_f32_16x16x32_bf16 v[12:15], v[48:51], a[76:79], v[12:15]
    ds_read_b64_tr_b16 v[40:41], v255 offset:8192
    ds_read_b64_tr_b16 v[42:43], v255 offset:10240
    v_mfma_f32_16x16x32_bf16 v[12:15], v[52:55], a[92:95], v[12:15]
    s_add_u32 m0, s55, 131072
    s_mov_b32 s50, 230144
    v_mfma_f32_16x16x32_bf16 v[0:3], v[56:59], a[96:99], v[0:3]
    buffer_load_dwordx4 v248, s[20:23], s50 offen lds
    v_mfma_f32_16x16x32_bf16 v[0:3], v[60:63], a[112:115], v[0:3]
    v_cvt_pk_bf16_f32 v71, v30, v31
    v_mfma_f32_16x16x32_bf16 v[4:7], v[56:59], a[100:103], v[4:7]
    s_add_u32 m0, s55, 132096
    s_mov_b32 s51, 237312
    v_mfma_f32_16x16x32_bf16 v[4:7], v[60:63], a[116:119], v[4:7]
    buffer_load_dwordx4 v248, s[20:23], s51 offen lds
    v_mfma_f32_16x16x32_bf16 v[8:11], v[56:59], a[104:107], v[8:11]
    buffer_store_dwordx4 v[68:71], v251, s[28:31], s53 offen sc1
    v_mfma_f32_16x16x32_bf16 v[8:11], v[60:63], a[120:123], v[8:11]
    s_add_u32 m0, s55, 133120
    s_mov_b32 s50, 244480
    v_mfma_f32_16x16x32_bf16 v[12:15], v[56:59], a[108:111], v[12:15]
    buffer_load_dwordx4 v248, s[20:23], s50 offen lds
    v_mfma_f32_16x16x32_bf16 v[12:15], v[60:63], a[124:127], v[12:15]
    s_waitcnt lgkmcnt(2)
    v_mfma_f32_16x16x32_bf16 v[0:3], v[32:35], v[112:115], v[0:3]
    ds_read_b64_tr_b16 v[44:45], v255 offset:12288
    ds_read_b64_tr_b16 v[46:47], v255 offset:14336
    v_mfma_f32_16x16x32_bf16 v[0:3], v[36:39], v[128:131], v[0:3]
    ds_read_b64_tr_b16 v[48:49], v255 offset:16384
    ds_read_b64_tr_b16 v[50:51], v255 offset:18432
    v_mfma_f32_16x16x32_bf16 v[4:7], v[32:35], v[116:119], v[4:7]
    ds_read_b64_tr_b16 v[52:53], v255 offset:20480
    ds_read_b64_tr_b16 v[54:55], v255 offset:22528
    v_mfma_f32_16x16x32_bf16 v[4:7], v[36:39], v[132:135], v[4:7]
    ds_read_b64_tr_b16 v[56:57], v255 offset:24576
    ds_read_b64_tr_b16 v[58:59], v255 offset:26624
    v_mfma_f32_16x16x32_bf16 v[8:11], v[32:35], v[120:123], v[8:11]
    ds_read_b64_tr_b16 v[60:61], v255 offset:28672
    ds_read_b64_tr_b16 v[62:63], v255 offset:30720
    v_mfma_f32_16x16x32_bf16 v[8:11], v[36:39], v[136:139], v[8:11]
    s_add_u32 m0, s55, 134144
    s_mov_b32 s51, 251648
    v_mfma_f32_16x16x32_bf16 v[12:15], v[32:35], v[124:127], v[12:15]
    buffer_load_dwordx4 v248, s[20:23], s51 offen lds
    v_mfma_f32_16x16x32_bf16 v[12:15], v[36:39], v[140:143], v[12:15]
    s_waitcnt lgkmcnt(8)
    v_mfma_f32_16x16x32_bf16 v[0:3], v[40:43], v[144:147], v[0:3]
    s_add_u32 m0, s55, 135168
    s_mov_b32 s50, 258816
    v_mfma_f32_16x16x32_bf16 v[0:3], v[44:47], v[160:163], v[0:3]
    buffer_load_dwordx4 v248, s[20:23], s50 offen lds
    v_mfma_f32_16x16x32_bf16 v[4:7], v[40:43], v[148:151], v[4:7]
    v_mfma_f32_16x16x32_bf16 v[4:7], v[44:47], v[164:167], v[4:7]
    s_add_u32 m0, s55, 136192
    s_mov_b32 s51, 265984
    v_mfma_f32_16x16x32_bf16 v[8:11], v[40:43], v[152:155], v[8:11]
    buffer_load_dwordx4 v248, s[20:23], s51 offen lds
    v_mfma_f32_16x16x32_bf16 v[8:11], v[44:47], v[168:171], v[8:11]
    v_mfma_f32_16x16x32_bf16 v[12:15], v[40:43], v[156:159], v[12:15]
    v_mfma_f32_16x16x32_bf16 v[12:15], v[44:47], v[172:175], v[12:15]
    s_waitcnt lgkmcnt(4)
    v_mfma_f32_16x16x32_bf16 v[0:3], v[48:51], v[176:179], v[0:3]
    s_add_u32 m0, s55, 137216
    s_mov_b32 s50, 273152
    v_mfma_f32_16x16x32_bf16 v[0:3], v[52:55], v[192:195], v[0:3]
    buffer_load_dwordx4 v248, s[20:23], s50 offen lds
    v_mfma_f32_16x16x32_bf16 v[4:7], v[48:51], v[180:183], v[4:7]
    v_add_u32 v254, 32768, v249
    v_mfma_f32_16x16x32_bf16 v[4:7], v[52:55], v[196:199], v[4:7]
    s_waitcnt vmcnt(29) lgkmcnt(0)
    s_barrier
    v_mfma_f32_16x16x32_bf16 v[8:11], v[48:51], v[184:187], v[8:11]
    ds_read_b64_tr_b16 v[32:33], v254 offset:0
    ds_read_b64_tr_b16 v[34:35], v254 offset:2048
    v_mfma_f32_16x16x32_bf16 v[8:11], v[52:55], v[200:203], v[8:11]
    ds_read_b64_tr_b16 v[36:37], v254 offset:4096
    ds_read_b64_tr_b16 v[38:39], v254 offset:6144
    v_mfma_f32_16x16x32_bf16 v[12:15], v[48:51], v[188:191], v[12:15]
    ds_read_b64_tr_b16 v[40:41], v254 offset:8192
    ds_read_b64_tr_b16 v[42:43], v254 offset:10240
    v_mfma_f32_16x16x32_bf16 v[12:15], v[52:55], v[204:207], v[12:15]
    s_add_u32 m0, s55, 138240
    s_mov_b32 s51, 280320
    v_mfma_f32_16x16x32_bf16 v[0:3], v[56:59], v[208:211], v[0:3]
    buffer_load_dwordx4 v248, s[20:23], s51 offen lds
    v_mfma_f32_16x16x32_bf16 v[0:3], v[60:63], v[224:227], v[0:3]
    v_mfma_f32_16x16x32_bf16 v[4:7], v[56:59], v[212:215], v[4:7]
    v_mfma_f32_16x16x32_bf16 v[4:7], v[60:63], v[228:231], v[4:7]
    v_mfma_f32_16x16x32_bf16 v[8:11], v[56:59], v[216:219], v[8:11]
    v_mfma_f32_16x16x32_bf16 v[8:11], v[60:63], v[232:235], v[8:11]
    v_mfma_f32_16x16x32_bf16 v[12:15], v[56:59], v[220:223], v[12:15]
    v_mfma_f32_16x16x32_bf16 v[12:15], v[60:63], v[236:239], v[12:15]
    s_waitcnt lgkmcnt(2)
    v_mfma_f32_16x16x32_bf16 v[16:19], v[32:35], a[0:3], 0
    ds_read_b64_tr_b16 v[44:45], v254 offset:12288
    ds_read_b64_tr_b16 v[46:47], v254 offset:14336
    v_mfma_f32_16x16x32_bf16 v[16:19], v[36:39], a[16:19], v[16:19]
    ds_read_b64_tr_b16 v[48:49], v254 offset:16384
    ds_read_b64_tr_b16 v[50:51], v254 offset:18432
    v_mfma_f32_16x16x32_bf16 v[20:23], v[32:35], a[4:7], 0
    ds_read_b64_tr_b16 v[52:53], v254 offset:20480
    ds_read_b64_tr_b16 v[54:55], v254 offset:22528
    v_mfma_f32_16x16x32_bf16 v[20:23], v[36:39], a[20:23], v[20:23]
    ds_read_b64_tr_b16 v[56:57], v254 offset:24576
    ds_read_b64_tr_b16 v[58:59], v254 offset:26624
    v_mfma_f32_16x16x32_bf16 v[24:27], v[32:35], a[8:11], 0
    ds_read_b64_tr_b16 v[60:61], v254 offset:28672
    ds_read_b64_tr_b16 v[62:63], v254 offset:30720
    v_mfma_f32_16x16x32_bf16 v[24:27], v[36:39], a[24:27], v[24:27]
    v_mfma_f32_16x16x32_bf16 v[28:31], v[32:35], a[12:15], 0
    v_mfma_f32_16x16x32_bf16 v[28:31], v[36:39], a[28:31], v[28:31]
    s_waitcnt lgkmcnt(8)
    v_mfma_f32_16x16x32_bf16 v[16:19], v[40:43], a[32:35], v[16:19]
    s_mov_b32 s52, 16384
    v_mfma_f32_16x16x32_bf16 v[16:19], v[44:47], a[48:51], v[16:19]
    s_mov_b32 s53, 45056
    v_mfma_f32_16x16x32_bf16 v[20:23], v[40:43], a[36:39], v[20:23]
    v_mfma_f32_16x16x32_bf16 v[20:23], v[44:47], a[52:55], v[20:23]
    v_cvt_pk_bf16_f32 v64, v0, v1
    v_mfma_f32_16x16x32_bf16 v[24:27], v[40:43], a[40:43], v[24:27]
    v_cvt_pk_bf16_f32 v65, v2, v3
    v_mfma_f32_16x16x32_bf16 v[24:27], v[44:47], a[56:59], v[24:27]
    v_mfma_f32_16x16x32_bf16 v[28:31], v[40:43], a[44:47], v[28:31]
    v_cvt_pk_bf16_f32 v66, v4, v5
    v_mfma_f32_16x16x32_bf16 v[28:31], v[44:47], a[60:63], v[28:31]
    s_waitcnt lgkmcnt(4)
    v_mfma_f32_16x16x32_bf16 v[16:19], v[48:51], a[64:67], v[16:19]
    v_cvt_pk_bf16_f32 v67, v6, v7
    v_mfma_f32_16x16x32_bf16 v[16:19], v[52:55], a[80:83], v[16:19]
    buffer_store_dwordx4 v[64:67], v251, s[28:31], s52 offen sc1
    v_mfma_f32_16x16x32_bf16 v[20:23], v[48:51], a[68:71], v[20:23]
    v_add_u32 v255, 65536, v249
    v_mfma_f32_16x16x32_bf16 v[20:23], v[52:55], a[84:87], v[20:23]
    s_waitcnt vmcnt(21) lgkmcnt(0)
    s_barrier
    v_mfma_f32_16x16x32_bf16 v[24:27], v[48:51], a[72:75], v[24:27]
    ds_read_b64_tr_b16 v[32:33], v255 offset:0
    ds_read_b64_tr_b16 v[34:35], v255 offset:2048
    v_mfma_f32_16x16x32_bf16 v[24:27], v[52:55], a[88:91], v[24:27]
    ds_read_b64_tr_b16 v[36:37], v255 offset:4096
    ds_read_b64_tr_b16 v[38:39], v255 offset:6144
    v_mfma_f32_16x16x32_bf16 v[28:31], v[48:51], a[76:79], v[28:31]
    ds_read_b64_tr_b16 v[40:41], v255 offset:8192
    ds_read_b64_tr_b16 v[42:43], v255 offset:10240
    v_mfma_f32_16x16x32_bf16 v[28:31], v[52:55], a[92:95], v[28:31]
    v_cvt_pk_bf16_f32 v68, v8, v9
    v_mfma_f32_16x16x32_bf16 v[16:19], v[56:59], a[96:99], v[16:19]
    v_mfma_f32_16x16x32_bf16 v[16:19], v[60:63], a[112:115], v[16:19]
    v_cvt_pk_bf16_f32 v69, v10, v11
    v_mfma_f32_16x16x32_bf16 v[20:23], v[56:59], a[100:103], v[20:23]
    v_cvt_pk_bf16_f32 v70, v12, v13
    v_mfma_f32_16x16x32_bf16 v[20:23], v[60:63], a[116:119], v[20:23]
    v_mfma_f32_16x16x32_bf16 v[24:27], v[56:59], a[104:107], v[24:27]
    v_cvt_pk_bf16_f32 v71, v14, v15
    v_mfma_f32_16x16x32_bf16 v[24:27], v[60:63], a[120:123], v[24:27]
    buffer_store_dwordx4 v[68:71], v251, s[28:31], s53 offen sc1
    v_mfma_f32_16x16x32_bf16 v[28:31], v[56:59], a[108:111], v[28:31]
    v_mfma_f32_16x16x32_bf16 v[28:31], v[60:63], a[124:127], v[28:31]
    s_waitcnt lgkmcnt(2)
    v_mfma_f32_16x16x32_bf16 v[16:19], v[32:35], v[112:115], v[16:19]
    ds_read_b64_tr_b16 v[44:45], v255 offset:12288
    ds_read_b64_tr_b16 v[46:47], v255 offset:14336
    v_mfma_f32_16x16x32_bf16 v[16:19], v[36:39], v[128:131], v[16:19]
    ds_read_b64_tr_b16 v[48:49], v255 offset:16384
    ds_read_b64_tr_b16 v[50:51], v255 offset:18432
    v_mfma_f32_16x16x32_bf16 v[20:23], v[32:35], v[116:119], v[20:23]
    ds_read_b64_tr_b16 v[52:53], v255 offset:20480
    ds_read_b64_tr_b16 v[54:55], v255 offset:22528
    v_mfma_f32_16x16x32_bf16 v[20:23], v[36:39], v[132:135], v[20:23]
    ds_read_b64_tr_b16 v[56:57], v255 offset:24576
    ds_read_b64_tr_b16 v[58:59], v255 offset:26624
    v_mfma_f32_16x16x32_bf16 v[24:27], v[32:35], v[120:123], v[24:27]
    ds_read_b64_tr_b16 v[60:61], v255 offset:28672
    ds_read_b64_tr_b16 v[62:63], v255 offset:30720
    v_mfma_f32_16x16x32_bf16 v[24:27], v[36:39], v[136:139], v[24:27]
    v_mfma_f32_16x16x32_bf16 v[28:31], v[32:35], v[124:127], v[28:31]
    v_mfma_f32_16x16x32_bf16 v[28:31], v[36:39], v[140:143], v[28:31]
    s_waitcnt lgkmcnt(8)
    v_mfma_f32_16x16x32_bf16 v[16:19], v[40:43], v[144:147], v[16:19]
    v_mov_b32 v72, s48
    v_lshrrev_b32 v73, 8, v251
    v_mfma_f32_16x16x32_bf16 v[16:19], v[44:47], v[160:163], v[16:19]
    v_and_b32 v73, 12, v73
    v_mov_b32 v74, 0
    v_mfma_f32_16x16x32_bf16 v[20:23], v[40:43], v[148:151], v[20:23]
    ds_write_b32 v73, v72
    v_mfma_f32_16x16x32_bf16 v[20:23], v[44:47], v[164:167], v[20:23]
    v_mfma_f32_16x16x32_bf16 v[24:27], v[40:43], v[152:155], v[24:27]
    v_mfma_f32_16x16x32_bf16 v[24:27], v[44:47], v[168:171], v[24:27]
    v_mfma_f32_16x16x32_bf16 v[28:31], v[40:43], v[156:159], v[28:31]
    v_mfma_f32_16x16x32_bf16 v[28:31], v[44:47], v[172:175], v[28:31]
    s_waitcnt lgkmcnt(5)
    v_mfma_f32_16x16x32_bf16 v[16:19], v[48:51], v[176:179], v[16:19]
    v_mfma_f32_16x16x32_bf16 v[16:19], v[52:55], v[192:195], v[16:19]
    v_mfma_f32_16x16x32_bf16 v[20:23], v[48:51], v[180:183], v[20:23]
    v_add_u32 v254, 98304, v249
    v_mfma_f32_16x16x32_bf16 v[20:23], v[52:55], v[196:199], v[20:23]
    s_waitcnt vmcnt(14) lgkmcnt(0)
    s_barrier
    v_mfma_f32_16x16x32_bf16 v[24:27], v[48:51], v[184:187], v[24:27]
    ds_read_b64_tr_b16 v[32:33], v254 offset:0
    ds_read_b64_tr_b16 v[34:35], v254 offset:2048
    v_mfma_f32_16x16x32_bf16 v[24:27], v[52:55], v[200:203], v[24:27]
    ds_read_b64_tr_b16 v[36:37], v254 offset:4096
    ds_read_b64_tr_b16 v[38:39], v254 offset:6144
    v_mfma_f32_16x16x32_bf16 v[28:31], v[48:51], v[188:191], v[28:31]
    ds_read_b64_tr_b16 v[40:41], v254 offset:8192
    ds_read_b64_tr_b16 v[42:43], v254 offset:10240
    v_mfma_f32_16x16x32_bf16 v[28:31], v[52:55], v[204:207], v[28:31]
    v_mfma_f32_16x16x32_bf16 v[16:19], v[56:59], v[208:211], v[16:19]
    ds_read_b128 v[76:79], v74
    v_mfma_f32_16x16x32_bf16 v[16:19], v[60:63], v[224:227], v[16:19]
    v_mfma_f32_16x16x32_bf16 v[20:23], v[56:59], v[212:215], v[20:23]
    v_mfma_f32_16x16x32_bf16 v[20:23], v[60:63], v[228:231], v[20:23]
    v_mfma_f32_16x16x32_bf16 v[24:27], v[56:59], v[216:219], v[24:27]
    v_mfma_f32_16x16x32_bf16 v[24:27], v[60:63], v[232:235], v[24:27]
    v_mfma_f32_16x16x32_bf16 v[28:31], v[56:59], v[220:223], v[28:31]
    v_mfma_f32_16x16x32_bf16 v[28:31], v[60:63], v[236:239], v[28:31]
    s_waitcnt lgkmcnt(3)
    v_mfma_f32_16x16x32_bf16 v[0:3], v[32:35], a[0:3], 0
    ds_read_b64_tr_b16 v[44:45], v254 offset:12288
    ds_read_b64_tr_b16 v[46:47], v254 offset:14336
    v_mfma_f32_16x16x32_bf16 v[0:3], v[36:39], a[16:19], v[0:3]
    ds_read_b64_tr_b16 v[48:49], v254 offset:16384
    ds_read_b64_tr_b16 v[50:51], v254 offset:18432
    v_mfma_f32_16x16x32_bf16 v[4:7], v[32:35], a[4:7], 0
    ds_read_b64_tr_b16 v[52:53], v254 offset:20480
    ds_read_b64_tr_b16 v[54:55], v254 offset:22528
    v_mfma_f32_16x16x32_bf16 v[4:7], v[36:39], a[20:23], v[4:7]
    ds_read_b64_tr_b16 v[56:57], v254 offset:24576
    ds_read_b64_tr_b16 v[58:59], v254 offset:26624
    v_mfma_f32_16x16x32_bf16 v[8:11], v[32:35], a[8:11], 0
    ds_read_b64_tr_b16 v[60:61], v254 offset:28672
    ds_read_b64_tr_b16 v[62:63], v254 offset:30720
    v_mfma_f32_16x16x32_bf16 v[8:11], v[36:39], a[24:27], v[8:11]
    v_mfma_f32_16x16x32_bf16 v[12:15], v[32:35], a[12:15], 0
    v_mfma_f32_16x16x32_bf16 v[12:15], v[36:39], a[28:31], v[12:15]
    s_waitcnt lgkmcnt(8)
    v_mfma_f32_16x16x32_bf16 v[0:3], v[40:43], a[32:35], v[0:3]
    s_mov_b32 s52, 20480
    v_mfma_f32_16x16x32_bf16 v[0:3], v[44:47], a[48:51], v[0:3]
    s_mov_b32 s53, 49152
    v_mfma_f32_16x16x32_bf16 v[4:7], v[40:43], a[36:39], v[4:7]
    v_mfma_f32_16x16x32_bf16 v[4:7], v[44:47], a[52:55], v[4:7]
    v_cvt_pk_bf16_f32 v64, v16, v17
    v_mfma_f32_16x16x32_bf16 v[8:11], v[40:43], a[40:43], v[8:11]
    v_cvt_pk_bf16_f32 v65, v18, v19
    v_mfma_f32_16x16x32_bf16 v[8:11], v[44:47], a[56:59], v[8:11]
    v_mfma_f32_16x16x32_bf16 v[12:15], v[40:43], a[44:47], v[12:15]
    v_cvt_pk_bf16_f32 v66, v20, v21
    v_mfma_f32_16x16x32_bf16 v[12:15], v[44:47], a[60:63], v[12:15]
    s_waitcnt lgkmcnt(4)
    v_mfma_f32_16x16x32_bf16 v[0:3], v[48:51], a[64:67], v[0:3]
    v_cvt_pk_bf16_f32 v67, v22, v23
    v_mfma_f32_16x16x32_bf16 v[0:3], v[52:55], a[80:83], v[0:3]
    buffer_store_dwordx4 v[64:67], v251, s[28:31], s52 offen sc1
    v_mfma_f32_16x16x32_bf16 v[4:7], v[48:51], a[68:71], v[4:7]
    v_add_u32 v255, 131072, v249
    v_mfma_f32_16x16x32_bf16 v[4:7], v[52:55], a[84:87], v[4:7]
    s_waitcnt vmcnt(3) lgkmcnt(0)
    s_barrier
    v_mfma_f32_16x16x32_bf16 v[8:11], v[48:51], a[72:75], v[8:11]
    ds_read_b64_tr_b16 v[32:33], v255 offset:0
    ds_read_b64_tr_b16 v[34:35], v255 offset:2048
    v_mfma_f32_16x16x32_bf16 v[8:11], v[52:55], a[88:91], v[8:11]
    ds_read_b64_tr_b16 v[36:37], v255 offset:4096
    ds_read_b64_tr_b16 v[38:39], v255 offset:6144
    v_mfma_f32_16x16x32_bf16 v[12:15], v[48:51], a[76:79], v[12:15]
    ds_read_b64_tr_b16 v[40:41], v255 offset:8192
    ds_read_b64_tr_b16 v[42:43], v255 offset:10240
    v_mfma_f32_16x16x32_bf16 v[12:15], v[52:55], a[92:95], v[12:15]
    v_cvt_pk_bf16_f32 v68, v24, v25
    v_mfma_f32_16x16x32_bf16 v[0:3], v[56:59], a[96:99], v[0:3]
    v_mfma_f32_16x16x32_bf16 v[0:3], v[60:63], a[112:115], v[0:3]
    v_cvt_pk_bf16_f32 v69, v26, v27
    v_mfma_f32_16x16x32_bf16 v[4:7], v[56:59], a[100:103], v[4:7]
    v_cvt_pk_bf16_f32 v70, v28, v29
    v_mfma_f32_16x16x32_bf16 v[4:7], v[60:63], a[116:119], v[4:7]
    v_mfma_f32_16x16x32_bf16 v[8:11], v[56:59], a[104:107], v[8:11]
    v_cvt_pk_bf16_f32 v71, v30, v31
    v_mfma_f32_16x16x32_bf16 v[8:11], v[60:63], a[120:123], v[8:11]
    buffer_store_dwordx4 v[68:71], v251, s[28:31], s53 offen sc1
    v_mfma_f32_16x16x32_bf16 v[12:15], v[56:59], a[108:111], v[12:15]
    v_mfma_f32_16x16x32_bf16 v[12:15], v[60:63], a[124:127], v[12:15]
    s_waitcnt lgkmcnt(2)
    v_mfma_f32_16x16x32_bf16 v[0:3], v[32:35], v[112:115], v[0:3]
    ds_read_b64_tr_b16 v[44:45], v255 offset:12288
    ds_read_b64_tr_b16 v[46:47], v255 offset:14336
    v_mfma_f32_16x16x32_bf16 v[0:3], v[36:39], v[128:131], v[0:3]
    ds_read_b64_tr_b16 v[48:49], v255 offset:16384
    ds_read_b64_tr_b16 v[50:51], v255 offset:18432
    v_mfma_f32_16x16x32_bf16 v[4:7], v[32:35], v[116:119], v[4:7]
    ds_read_b64_tr_b16 v[52:53], v255 offset:20480
    ds_read_b64_tr_b16 v[54:55], v255 offset:22528
    v_mfma_f32_16x16x32_bf16 v[4:7], v[36:39], v[132:135], v[4:7]
    ds_read_b64_tr_b16 v[56:57], v255 offset:24576
    ds_read_b64_tr_b16 v[58:59], v255 offset:26624
    v_mfma_f32_16x16x32_bf16 v[8:11], v[32:35], v[120:123], v[8:11]
    ds_read_b64_tr_b16 v[60:61], v255 offset:28672
    ds_read_b64_tr_b16 v[62:63], v255 offset:30720
    v_mfma_f32_16x16x32_bf16 v[8:11], v[36:39], v[136:139], v[8:11]
    v_mfma_f32_16x16x32_bf16 v[12:15], v[32:35], v[124:127], v[12:15]
    v_mfma_f32_16x16x32_bf16 v[12:15], v[36:39], v[140:143], v[12:15]
    s_waitcnt lgkmcnt(8)
    v_mfma_f32_16x16x32_bf16 v[0:3], v[40:43], v[144:147], v[0:3]
    v_mfma_f32_16x16x32_bf16 v[0:3], v[44:47], v[160:163], v[0:3]
    v_mfma_f32_16x16x32_bf16 v[4:7], v[40:43], v[148:151], v[4:7]
    v_mfma_f32_16x16x32_bf16 v[4:7], v[44:47], v[164:167], v[4:7]
    v_mfma_f32_16x16x32_bf16 v[8:11], v[40:43], v[152:155], v[8:11]
    v_mfma_f32_16x16x32_bf16 v[8:11], v[44:47], v[168:171], v[8:11]
    v_mfma_f32_16x16x32_bf16 v[12:15], v[40:43], v[156:159], v[12:15]
    v_mfma_f32_16x16x32_bf16 v[12:15], v[44:47], v[172:175], v[12:15]
    s_waitcnt lgkmcnt(4)
    v_mfma_f32_16x16x32_bf16 v[0:3], v[48:51], v[176:179], v[0:3]
    v_mfma_f32_16x16x32_bf16 v[0:3], v[52:55], v[192:195], v[0:3]
    v_mfma_f32_16x16x32_bf16 v[4:7], v[48:51], v[180:183], v[4:7]
    v_mfma_f32_16x16x32_bf16 v[4:7], v[52:55], v[196:199], v[4:7]
    v_mfma_f32_16x16x32_bf16 v[8:11], v[48:51], v[184:187], v[8:11]
    v_mfma_f32_16x16x32_bf16 v[8:11], v[52:55], v[200:203], v[8:11]
    v_mfma_f32_16x16x32_bf16 v[12:15], v[48:51], v[188:191], v[12:15]
    v_mfma_f32_16x16x32_bf16 v[12:15], v[52:55], v[204:207], v[12:15]
    s_waitcnt lgkmcnt(2)
    v_mfma_f32_16x16x32_bf16 v[0:3], v[56:59], v[208:211], v[0:3]
    s_waitcnt lgkmcnt(0)
    v_mfma_f32_16x16x32_bf16 v[0:3], v[60:63], v[224:227], v[0:3]
    v_mfma_f32_16x16x32_bf16 v[4:7], v[56:59], v[212:215], v[4:7]
    v_mfma_f32_16x16x32_bf16 v[4:7], v[60:63], v[228:231], v[4:7]
    v_mfma_f32_16x16x32_bf16 v[8:11], v[56:59], v[216:219], v[8:11]
    v_mfma_f32_16x16x32_bf16 v[8:11], v[60:63], v[232:235], v[8:11]
    v_mfma_f32_16x16x32_bf16 v[12:15], v[56:59], v[220:223], v[12:15]
    v_mfma_f32_16x16x32_bf16 v[12:15], v[60:63], v[236:239], v[12:15]
    s_mov_b32 s52, 24576
    s_mov_b32 s53, 53248
    v_cvt_pk_bf16_f32 v64, v0, v1
    v_cvt_pk_bf16_f32 v65, v2, v3
    v_cvt_pk_bf16_f32 v66, v4, v5
    v_cvt_pk_bf16_f32 v67, v6, v7
    buffer_store_dwordx4 v[64:67], v251, s[28:31], s52 offen sc1
    v_cvt_pk_bf16_f32 v68, v8, v9
    v_cvt_pk_bf16_f32 v69, v10, v11
    v_cvt_pk_bf16_f32 v70, v12, v13
    v_cvt_pk_bf16_f32 v71, v14, v15
    buffer_store_dwordx4 v[68:71], v251, s[28:31], s53 offen sc1
    v_or3_b32 v76, v76, v77, v78
    v_or_b32 v76, v76, v79
    v_cmp_ne_u32 vcc, 0, v76
    s_cmp_lg_u32 s100, 0
    s_cbranch_scc1 Latt_fin
    s_cbranch_vccnz Latt_fallback
Latt_fin:
Latt_done:
    s_endpgm
Latt_touch:
    s_cmp_eq_u32 s49, 11
    s_cbranch_scc0 Latt_touch2
    s_mov_b32 s24, s58
    s_mov_b32 s25, s59
    s_mov_b32 s26, 802816
    s_lshl_b32 s38, s47, 11
    s_mov_b32 s39, 10
    s_branch Latt_touch_ret
Latt_touch2:
    s_cmp_eq_u32 s49, 10
    s_cbranch_scc0 Latt_touch3
    s_add_u32 s24, s36, 29360128
    s_addc_u32 s25, s37, 0
    s_mov_b32 s26, 1605632
    s_mul_i32 s38, s48, 14336
    s_mov_b32 s39, 3
    s_branch Latt_touch_ret
Latt_touch3:
    s_mov_b32 s24, s20
    s_mov_b32 s25, s21
    s_mov_b32 s26, 458752
    s_lshl_b32 s38, s48, 12
    s_mov_b32 s39, 0
    s_branch Latt_touch_ret
Latt_xf:
    v_mov_b32 v64, v128
    v_mov_b32 v65, v129
    v_mov_b32 v66, v130
    v_mov_b32 v67, v131
    v_mov_b32 v68, v132
    v_mov_b32 v69, v133
    v_mov_b32 v70, v134
    v_mov_b32 v71, v135
    v_mov_b32 v72, v136
    v_mov_b32 v73, v137
    v_mov_b32 v74, v138
    v_mov_b32 v75, v139
    v_mov_b32 v76, v140
    v_mov_b32 v77, v141
    v_mov_b32 v78, v142
    v_mov_b32 v79, v143
    v_mov_b32 v80, v144
    v_mov_b32 v81, v145
    v_mov_b32 v82, v146
    v_mov_b32 v83, v147
    v_mov_b32 v84, v148
    v_mov_b32 v85, v149
    v_mov_b32 v86, v150
    v_mov_b32 v87, v151
    v_mov_b32 v88, v152
    v_mov_b32 v89, v153
    v_mov_b32 v90, v154
    v_mov_b32 v91, v155
    v_mov_b32 v92, v156
    v_mov_b32 v93, v157
    v_mov_b32 v94, v158
    v_mov_b32 v95, v159
    v_mov_b32 v96, v160
    v_mov_b32 v97, v161
    v_mov_b32 v98, v162
    v_mov_b32 v99, v163
    v_mov_b32 v100, v164
    v_mov_b32 v101, v165
    v_mov_b32 v102, v166
    v_mov_b32 v103, v167
    v_mov_b32 v104, v168
    v_mov_b32 v105, v169
    v_mov_b32 v106, v170
    v_mov_b32 v107, v171
    v_mov_b32 v108, v172
    v_mov_b32 v109, v173
    v_mov_b32 v110, v174
    v_mov_b32 v111, v175
    v_mov_b32 v112, v176
    v_mov_b32 v113, v177
    v_mov_b32 v114, v178
    v_mov_b32 v115, v179
    v_mov_b32 v116, v180
    v_mov_b32 v117, v181
    v_mov_b32 v118, v182
    v_mov_b32 v119, v183
    s_branch Latt_xf_ret
Latt_xfst:
    v_lshlrev_b32 v120, 9, v3
    v_lshl_add_u32 v120, v4, 4, v120
    v_lshl_add_u32 v120, v10, 8, v120
    s_lshr_b32 s53, s2, 3
    s_lshl_b32 s53, s53, 1
    s_lshr_b32 s52, s3, 1
    s_add_u32 s53, s53, s52
    s_mul_i32 s53, s53, 28672
    s_add_u32 s53, s53, 65536
    s_add_u32 s4, s36, s53
    s_addc_u32 s5, s37, 0
    s_mov_b32 s6, 28672
    s_mov_b32 s7, 0x20000
    s_mov_b32 s53, 0
    buffer_store_dwordx4 v[64:67], v120, s[4:7], s53 offen offset:0 sc1
    buffer_store_dwordx4 v[68:71], v120, s[4:7], s53 offen offset:2048 sc1
    s_mov_b32 s53, 4096
    buffer_store_dwordx4 v[72:75], v120, s[4:7], s53 offen offset:0 sc1
    buffer_store_dwordx4 v[76:79], v120, s[4:7], s53 offen offset:2048 sc1
    s_mov_b32 s53, 8192
    buffer_store_dwordx4 v[80:83], v120, s[4:7], s53 offen offset:0 sc1
    buffer_store_dwordx4 v[84:87], v120, s[4:7], s53 offen offset:2048 sc1
    s_mov_b32 s53, 12288
    buffer_store_dwordx4 v[88:91], v120, s[4:7], s53 offen offset:0 sc1
    buffer_store_dwordx4 v[92:95], v120, s[4:7], s53 offen offset:2048 sc1
    s_mov_b32 s53, 16384
    buffer_store_dwordx4 v[96:99], v120, s[4:7], s53 offen offset:0 sc1
    buffer_store_dwordx4 v[100:103], v120, s[4:7], s53 offen offset:2048 sc1
    s_mov_b32 s53, 20480
    buffer_store_dwordx4 v[104:107], v120, s[4:7], s53 offen offset:0 sc1
    buffer_store_dwordx4 v[108:111], v120, s[4:7], s53 offen offset:2048 sc1
    s_mov_b32 s53, 24576
    buffer_store_dwordx4 v[112:115], v120, s[4:7], s53 offen offset:0 sc1
    buffer_store_dwordx4 v[116:119], v120, s[4:7], s53 offen offset:2048 sc1
    s_branch Latt_jobst_ret
Latt_hook1:
    s_mov_b32 s84, s56
    s_mov_b32 s85, s57
    s_mov_b32 s86, 4
    s_mov_b32 s87, 0x20000
    v_mov_b32 v64, 1
    s_waitcnt vmcnt(4)
    buffer_atomic_add v64, v247, s[84:87], 0 offen sc0 sc1
    s_branch Latt_hook1_ret
Latt_hook2:
    s_waitcnt vmcnt(0)
    v_readfirstlane_b32 s53, v64
    v_mov_b32 v65, 1
    s_cmp_lg_u32 s53, 27
    s_cbranch_scc1 Latt_hook2_ret
    buffer_store_dword v65, v247, s[4:7], 0 offen sc1
    s_branch Latt_hook2_ret
Latt_wload:
    s_cmp_ge_u32 s101, 133
    s_cbranch_scc1 Latt_modload_ret
    s_sub_u32 s16, s101, 84
    s_lshl_b32 s16, s16, 2
    s_add_u32 s16, s16, s3
    s_mul_i32 s17, s16, 18725
    s_lshr_b32 s17, s17, 18
    s_mul_i32 s18, s17, 14
    s_sub_u32 s18, s16, s18
    s_mul_i32 s18, s18, 114688
    s_lshl_b32 s17, s17, 8
    s_add_u32 s18, s18, s17
    s_movk_i32 s17, 28672
    v_mul_lo_u32 v8, v3, s17
    v_lshl_add_u32 v8, v4, 4, v8
    s_mov_b32 s8, s60
    s_mov_b32 s9, s61
    s_mov_b32 s10, 1605632
    s_mov_b32 s11, 0x20000
    buffer_load_dwordx4 v[64:67], v8, s[8:11], s18 offen offset:0
    buffer_load_dwordx4 v[68:71], v8, s[8:11], s18 offen offset:3584
    s_add_u32 s18, s18, 7168
    buffer_load_dwordx4 v[72:75], v8, s[8:11], s18 offen offset:0
    buffer_load_dwordx4 v[76:79], v8, s[8:11], s18 offen offset:3584
    s_add_u32 s18, s18, 7168
    buffer_load_dwordx4 v[80:83], v8, s[8:11], s18 offen offset:0
    buffer_load_dwordx4 v[84:87], v8, s[8:11], s18 offen offset:3584
    s_add_u32 s18, s18, 7168
    buffer_load_dwordx4 v[88:91], v8, s[8:11], s18 offen offset:0
    buffer_load_dwordx4 v[92:95], v8, s[8:11], s18 offen offset:3584
    s_add_u32 s18, s18, 7168
    s_branch Latt_modload_ret
Latt_job:
    s_cmp_ge_u32 s101, 84
    s_cbranch_scc1 Latt_jobw
    s_mov_b32 s53, 3216550459
    v_lshlrev_b32 v64, 16, v64
    v_lshlrev_b32 v65, 16, v65
    v_lshlrev_b32 v66, 16, v66
    v_lshlrev_b32 v67, 16, v67
    v_lshlrev_b32 v68, 16, v68
    v_lshlrev_b32 v69, 16, v69
    v_lshlrev_b32 v70, 16, v70
    v_mul_f32 v112, s53, v64
    v_mul_f32 v113, s53, v65
    v_mul_f32 v114, s53, v66
    v_mul_f32 v115, s53, v67
    v_mul_f32 v116, s53, v68
    v_mul_f32 v117, s53, v69
    v_mul_f32 v118, s53, v70
    v_exp_f32 v112, v112
    v_exp_f32 v113, v113
    v_exp_f32 v114, v114
    v_exp_f32 v115, v115
    v_exp_f32 v116, v116
    v_exp_f32 v117, v117
    v_exp_f32 v118, v118
    v_add_f32 v112, 1.0, v112
    v_add_f32 v113, 1.0, v113
    v_add_f32 v114, 1.0, v114
    v_add_f32 v115, 1.0, v115
    v_add_f32 v116, 1.0, v116
    v_add_f32 v117, 1.0, v117
    v_add_f32 v118, 1.0, v118
    v_rcp_f32 v112, v112
    v_rcp_f32 v113, v113
    v_rcp_f32 v114, v114
    v_rcp_f32 v115, v115
    v_rcp_f32 v116, v116
    v_rcp_f32 v117, v117
    v_rcp_f32 v118, v118
    v_mul_f32 v64, v64, v112
    v_mul_f32 v65, v65, v113
    v_mul_f32 v66, v66, v114
    v_mul_f32 v67, v67, v115
    v_mul_f32 v68, v68, v116
    v_mul_f32 v69, v69, v117
    v_mul_f32 v70, v70, v118
    v_cvt_pk_bf16_f32 v64, v64, v64
    v_and_b32 v64, 0xffff0000, v64
    v_cvt_pk_bf16_f32 v65, v65, v65
    v_and_b32 v65, 0xffff0000, v65
    v_cvt_pk_bf16_f32 v66, v66, v66
    v_and_b32 v66, 0xffff0000, v66
    v_cvt_pk_bf16_f32 v67, v67, v67
    v_and_b32 v67, 0xffff0000, v67
    v_cvt_pk_bf16_f32 v68, v68, v68
    v_and_b32 v68, 0xffff0000, v68
    v_cvt_pk_bf16_f32 v69, v69, v69
    v_and_b32 v69, 0xffff0000, v69
    v_cvt_pk_bf16_f32 v70, v70, v70
    v_and_b32 v70, 0xffff0000, v70
    v_lshlrev_b32 v112, 16, v72
    v_and_b32 v113, 0xffff0000, v72
    v_lshlrev_b32 v114, 16, v73
    v_and_b32 v115, 0xffff0000, v73
    v_lshlrev_b32 v116, 16, v74
    v_and_b32 v117, 0xffff0000, v74
    v_lshlrev_b32 v118, 16, v75
    v_and_b32 v119, 0xffff0000, v75
    v_mul_f32 v104, v64, v112
    v_mul_f32 v105, v64, v113
    v_mul_f32 v106, v64, v114
    v_mul_f32 v107, v64, v115
    v_mul_f32 v108, v64, v116
    v_mul_f32 v109, v64, v117
    v_mul_f32 v110, v64, v118
    v_mul_f32 v111, v64, v119
    v_lshlrev_b32 v112, 16, v76
    v_and_b32 v113, 0xffff0000, v76
    v_lshlrev_b32 v114, 16, v77
    v_and_b32 v115, 0xffff0000, v77
    v_lshlrev_b32 v116, 16, v78
    v_and_b32 v117, 0xffff0000, v78
    v_lshlrev_b32 v118, 16, v79
    v_and_b32 v119, 0xffff0000, v79
    v_fmac_f32 v104, v65, v112
    v_fmac_f32 v105, v65, v113
    v_fmac_f32 v106, v65, v114
    v_fmac_f32 v107, v65, v115
    v_fmac_f32 v108, v65, v116
    v_fmac_f32 v109, v65, v117
    v_fmac_f32 v110, v65, v118
    v_fmac_f32 v111, v65, v119
    v_lshlrev_b32 v112, 16, v80
    v_and_b32 v113, 0xffff0000, v80
    v_lshlrev_b32 v114, 16, v81
    v_and_b32 v115, 0xffff0000, v81
    v_lshlrev_b32 v116, 16, v82
    v_and_b32 v117, 0xffff0000, v82
    v_lshlrev_b32 v118, 16, v83
    v_and_b32 v119, 0xffff0000, v83
    v_fmac_f32 v104, v66, v112
    v_fmac_f32 v105, v66, v113
    v_fmac_f32 v106, v66, v114
    v_fmac_f32 v107, v66, v115
    v_fmac_f32 v108, v66, v116
    v_fmac_f32 v109, v66, v117
    v_fmac_f32 v110, v66, v118
    v_fmac_f32 v111, v66, v119
    v_lshlrev_b32 v112, 16, v84
    v_and_b32 v113, 0xffff0000, v84
    v_lshlrev_b32 v114, 16, v85
    v_and_b32 v115, 0xffff0000, v85
    v_lshlrev_b32 v116, 16, v86
    v_and_b32 v117, 0xffff0000, v86
    v_lshlrev_b32 v118, 16, v87
    v_and_b32 v119, 0xffff0000, v87
    v_fmac_f32 v104, v67, v112
    v_fmac_f32 v105, v67, v113
    v_fmac_f32 v106, v67, v114
    v_fmac_f32 v107, v67, v115
    v_fmac_f32 v108, v67, v116
    v_fmac_f32 v109, v67, v117
    v_fmac_f32 v110, v67, v118
    v_fmac_f32 v111, v67, v119
    v_lshlrev_b32 v112, 16, v88
    v_and_b32 v113, 0xffff0000, v88
    v_lshlrev_b32 v114, 16, v89
    v_and_b32 v115, 0xffff0000, v89
    v_lshlrev_b32 v116, 16, v90
    v_and_b32 v117, 0xffff0000, v90
    v_lshlrev_b32 v118, 16, v91
    v_and_b32 v119, 0xffff0000, v91
    v_fmac_f32 v104, v68, v112
    v_fmac_f32 v105, v68, v113
    v_fmac_f32 v106, v68, v114
    v_fmac_f32 v107, v68, v115
    v_fmac_f32 v108, v68, v116
    v_fmac_f32 v109, v68, v117
    v_fmac_f32 v110, v68, v118
    v_fmac_f32 v111, v68, v119
    v_lshlrev_b32 v112, 16, v92
    v_and_b32 v113, 0xffff0000, v92
    v_lshlrev_b32 v114, 16, v93
    v_and_b32 v115, 0xffff0000, v93
    v_lshlrev_b32 v116, 16, v94
    v_and_b32 v117, 0xffff0000, v94
    v_lshlrev_b32 v118, 16, v95
    v_and_b32 v119, 0xffff0000, v95
    v_fmac_f32 v104, v69, v112
    v_fmac_f32 v105, v69, v113
    v_fmac_f32 v106, v69, v114
    v_fmac_f32 v107, v69, v115
    v_fmac_f32 v108, v69, v116
    v_fmac_f32 v109, v69, v117
    v_fmac_f32 v110, v69, v118
    v_fmac_f32 v111, v69, v119
    v_lshlrev_b32 v112, 16, v96
    v_and_b32 v113, 0xffff0000, v96
    v_lshlrev_b32 v114, 16, v97
    v_and_b32 v115, 0xffff0000, v97
    v_lshlrev_b32 v116, 16, v98
    v_and_b32 v117, 0xffff0000, v98
    v_lshlrev_b32 v118, 16, v99
    v_and_b32 v119, 0xffff0000, v99
    v_fmac_f32 v104, v70, v112
    v_fmac_f32 v105, v70, v113
    v_fmac_f32 v106, v70, v114
    v_fmac_f32 v107, v70, v115
    v_fmac_f32 v108, v70, v116
    v_fmac_f32 v109, v70, v117
    v_fmac_f32 v110, v70, v118
    v_fmac_f32 v111, v70, v119
    v_add_f32_dpp v104, v104, v104 row_ror:4 row_mask:0xf bank_mask:0xf
    v_add_f32_dpp v105, v105, v105 row_ror:4 row_mask:0xf bank_mask:0xf
    v_add_f32_dpp v106, v106, v106 row_ror:4 row_mask:0xf bank_mask:0xf
    v_add_f32_dpp v107, v107, v107 row_ror:4 row_mask:0xf bank_mask:0xf
    v_add_f32_dpp v108, v108, v108 row_ror:4 row_mask:0xf bank_mask:0xf
    v_add_f32_dpp v109, v109, v109 row_ror:4 row_mask:0xf bank_mask:0xf
    v_add_f32_dpp v110, v110, v110 row_ror:4 row_mask:0xf bank_mask:0xf
    v_add_f32_dpp v111, v111, v111 row_ror:4 row_mask:0xf bank_mask:0xf
    v_add_f32_dpp v104, v104, v104 row_ror:8 row_mask:0xf bank_mask:0xf
    v_add_f32_dpp v105, v105, v105 row_ror:8 row_mask:0xf bank_mask:0xf
    v_add_f32_dpp v106, v106, v106 row_ror:8 row_mask:0xf bank_mask:0xf
    v_add_f32_dpp v107, v107, v107 row_ror:8 row_mask:0xf bank_mask:0xf
    v_add_f32_dpp v108, v108, v108 row_ror:8 row_mask:0xf bank_mask:0xf
    v_add_f32_dpp v109, v109, v109 row_ror:8 row_mask:0xf bank_mask:0xf
    v_add_f32_dpp v110, v110, v110 row_ror:8 row_mask:0xf bank_mask:0xf
    v_add_f32_dpp v111, v111, v111 row_ror:8 row_mask:0xf bank_mask:0xf
    v_lshrrev_b32 v8, 4, v0
    v_lshlrev_b32 v8, 7, v8
    v_lshl_add_u32 v8, v6, 5, v8
    v_add_u32 v8, 158720, v8
    ds_write_b128 v8, v[104:107]
    ds_write_b128 v8, v[108:111] offset:16
    v_and_b32 v9, 31, v2
    v_lshlrev_b32 v9, 2, v9
    v_lshlrev_b32 v8, 2, v2
    v_add_u32 v8, 158720, v8
    s_waitcnt lgkmcnt(0)
    s_barrier
    s_cmp_lg_u32 s3, 0
    s_cbranch_scc1 Latt_job_ret
    ds_read_b32 v112, v8 offset:0
    ds_read_b32 v113, v8 offset:256
    ds_read_b32 v114, v8 offset:512
    ds_read_b32 v115, v8 offset:768
    ds_read_b32 v116, v8 offset:1024
    ds_read_b32 v117, v8 offset:1280
    ds_read_b32 v118, v8 offset:1536
    ds_read_b32 v119, v8 offset:1792
    s_waitcnt lgkmcnt(6)
    v_add_f32 v112, v112, v113
    s_waitcnt lgkmcnt(5)
    v_add_f32 v112, v112, v114
    s_waitcnt lgkmcnt(4)
    v_add_f32 v112, v112, v115
    s_waitcnt lgkmcnt(3)
    v_add_f32 v112, v112, v116
    s_waitcnt lgkmcnt(2)
    v_add_f32 v112, v112, v117
    s_waitcnt lgkmcnt(1)
    v_add_f32 v112, v112, v118
    s_waitcnt lgkmcnt(0)
    v_add_f32 v112, v112, v119
    v_mov_b32 v113, v112
    s_nop 1
    v_permlane32_swap_b32 v112, v113
    v_add_f32 v112, v112, v113
    v_cvt_pk_bf16_f32 v112, v112, v112
    v_and_b32 v112, 0xffff0000, v112
    s_mov_b32 s53, 0
    s_cmp_ge_u32 s101, 56
    s_cselect_b32 s53, 1.0, s53
    s_cmp_ge_u32 s101, 70
    s_cselect_b32 s53, 0, s53
    v_add_f32 v112, s53, v112
    v_cvt_pk_bf16_f32 v112, v112, v112
    v_and_b32 v112, 0xffff0000, v112
    s_branch Latt_job_ret
Latt_jobw:
    s_mov_b32 s50, 0x05040100
    s_mov_b32 s51, 0x07060302
    v_perm_b32 v96, v68, v64, s50
    v_perm_b32 v97, v76, v72, s50
    v_perm_b32 v98, v84, v80, s50
    v_perm_b32 v99, v92, v88, s50
    v_perm_b32 v100, v68, v64, s51
    v_perm_b32 v101, v76, v72, s51
    v_perm_b32 v102, v84, v80, s51
    v_perm_b32 v103, v92, v88, s51
    v_perm_b32 v104, v69, v65, s50
    v_perm_b32 v105, v77, v73, s50
    v_perm_b32 v106, v85, v81, s50
    v_perm_b32 v107, v93, v89, s50
    v_perm_b32 v108, v69, v65, s51
    v_perm_b32 v109, v77, v73, s51
    v_perm_b32 v110, v85, v81, s51
    v_perm_b32 v111, v93, v89, s51
    v_perm_b32 v112, v70, v66, s50
    v_perm_b32 v113, v78, v74, s50
    v_perm_b32 v114, v86, v82, s50
    v_perm_b32 v115, v94, v90, s50
    v_perm_b32 v116, v70, v66, s51
    v_perm_b32 v117, v78, v74, s51
    v_perm_b32 v118, v86, v82, s51
    v_perm_b32 v119, v94, v90, s51
    v_perm_b32 v120, v71, v67, s50
    v_perm_b32 v121, v79, v75, s50
    v_perm_b32 v122, v87, v83, s50
    v_perm_b32 v123, v95, v91, s50
    v_perm_b32 v124, v71, v67, s51
    v_perm_b32 v125, v79, v75, s51
    v_perm_b32 v126, v87, v83, s51
    v_perm_b32 v127, v95, v91, s51
    s_branch Latt_job_ret
Latt_jobst:
    s_cmp_ge_u32 s101, 84
    s_cbranch_scc1 Latt_jobst2
    s_cmp_lg_u32 s3, 0
    s_cbranch_scc1 Latt_jobst_ret
    s_mov_b32 s4, s36
    s_mov_b32 s5, s37
    s_mov_b32 s6, 10752
    s_mov_b32 s7, 0x20000
    s_lshl_b32 s53, s101, 7
    v_bfe_u32 v113, v247, 2, 7
    buffer_store_dword v112, v113, s[4:7], s53 offen sc1
    s_branch Latt_jobst_ret
Latt_jobst2:
    s_cmp_ge_u32 s101, 133
    s_cbranch_scc1 Latt_jobst3
    s_sub_u32 s53, s101, 84
    s_lshl_b32 s53, s53, 2
    s_add_u32 s53, s53, s3
    s_lshl_b32 s53, s53, 13
    s_add_u32 s53, s53, 29360128
    s_add_u32 s4, s36, s53
    s_addc_u32 s5, s37, 0
    s_mov_b32 s6, 8192
    s_mov_b32 s7, 0x20000
    s_movk_i32 s53, 4096
    buffer_store_dwordx4 v[96:99], v247, s[4:7], 0 offen offset:0 sc1
    buffer_store_dwordx4 v[100:103], v247, s[4:7], 0 offen offset:1024 sc1
    buffer_store_dwordx4 v[104:107], v247, s[4:7], 0 offen offset:2048 sc1
    buffer_store_dwordx4 v[108:111], v247, s[4:7], 0 offen offset:3072 sc1
    buffer_store_dwordx4 v[112:115], v247, s[4:7], s53 offen offset:0 sc1
    buffer_store_dwordx4 v[116:119], v247, s[4:7], s53 offen offset:1024 sc1
    buffer_store_dwordx4 v[120:123], v247, s[4:7], s53 offen offset:2048 sc1
    buffer_store_dwordx4 v[124:127], v247, s[4:7], s53 offen offset:3072 sc1
    s_branch Latt_jobst_ret
Latt_jobst3:
    s_sub_u32 s53, s101, 133
    s_lshl_b32 s53, s53, 12
    v_mov_b32 v64, -1
    v_mov_b32 v65, -1
    v_mov_b32 v66, -1
    v_mov_b32 v67, -1
    s_add_u32 s4, s36, 32768
    s_addc_u32 s5, s37, 0
    s_mov_b32 s6, 32768
    s_mov_b32 s7, 0x20000
    buffer_store_dwordx4 v[64:67], v251, s[4:7], s53 offen sc1
    s_branch Latt_jobst_ret
Latt_fallback:
    s_cmp_lg_u32 s100, 0
    s_cbranch_scc1 Latt_fallback_ret
    s_mov_b32 s100, 1
    s_nop 15
    s_waitcnt vmcnt(0) lgkmcnt(0)
    s_barrier
    v_lshrrev_b32 v0, 4, v251
    s_branch Latt_top
Latt_maxpass:
    s_waitcnt vmcnt(0) lgkmcnt(0)
    s_barrier
    s_mov_b32 s41, 0
    s_mov_b32 s42, 4096
    v_mov_b32 v192, 0xff7fffff
    v_mov_b32 v196, 0xff7fffff
    v_mov_b32 v200, 0xff7fffff
    v_mov_b32 v204, 0xff7fffff
Latt_fb_loop:
    s_add_u32 m0, s40, 0
    s_nop 0
    buffer_load_dwordx4 v246, s[8:11], s41 offen offset:0 nt lds
    s_add_u32 m0, s40, 32
    s_nop 0
    buffer_load_dwordx4 v246, s[8:11], s41 offen offset:1024 nt lds
    s_add_u32 m0, s40, 64
    s_nop 0
    buffer_load_dwordx4 v246, s[8:11], s41 offen offset:2048 nt lds
    s_add_u32 m0, s40, 96
    s_nop 0
    buffer_load_dwordx4 v246, s[8:11], s41 offen offset:3072 nt lds
    s_add_u32 m0, s40, 4224
    s_nop 0
    buffer_load_dwordx4 v246, s[8:11], s42 offen offset:0 nt lds
    s_add_u32 m0, s40, 4256
    s_nop 0
    buffer_load_dwordx4 v246, s[8:11], s42 offen offset:1024 nt lds
    s_add_u32 m0, s40, 4288
    s_nop 0
    buffer_load_dwordx4 v246, s[8:11], s42 offen offset:2048 nt lds
    s_add_u32 m0, s40, 4320
    s_nop 0
    buffer_load_dwordx4 v246, s[8:11], s42 offen offset:3072 nt lds
    s_waitcnt vmcnt(0)
    s_barrier
    ds_read_b128 v[208:211], v244 offset:0
    ds_read_b128 v[212:215], v244 offset:64
    ds_read_b128 v[216:219], v244 offset:128
    ds_read_b128 v[220:223], v244 offset:192
    ds_read_b128 v[224:227], v244 offset:8448
    ds_read_b128 v[228:231], v244 offset:8512
    ds_read_b128 v[232:235], v244 offset:8576
    ds_read_b128 v[236:239], v244 offset:8640
    s_waitcnt lgkmcnt(7)
    v_mfma_f32_16x16x32_bf16 v[128:131], v[208:211], a[128:131], 0
    s_waitcnt lgkmcnt(6)
    v_mfma_f32_16x16x32_bf16 v[128:131], v[212:215], a[132:135], v[128:131]
    s_waitcnt lgkmcnt(5)
    v_mfma_f32_16x16x32_bf16 v[128:131], v[216:219], a[136:139], v[128:131]
    s_waitcnt lgkmcnt(4)
    v_mfma_f32_16x16x32_bf16 v[128:131], v[220:223], a[140:143], v[128:131]
    v_mfma_f32_16x16x32_bf16 v[136:139], v[208:211], a[160:163], 0
    v_mfma_f32_16x16x32_bf16 v[136:139], v[212:215], a[164:167], v[136:139]
    v_mfma_f32_16x16x32_bf16 v[136:139], v[216:219], a[168:171], v[136:139]
    v_mfma_f32_16x16x32_bf16 v[136:139], v[220:223], a[172:175], v[136:139]
    v_mfma_f32_16x16x32_bf16 v[144:147], v[208:211], a[192:195], 0
    v_mfma_f32_16x16x32_bf16 v[144:147], v[212:215], a[196:199], v[144:147]
    v_mfma_f32_16x16x32_bf16 v[144:147], v[216:219], a[200:203], v[144:147]
    v_mfma_f32_16x16x32_bf16 v[144:147], v[220:223], a[204:207], v[144:147]
    v_mfma_f32_16x16x32_bf16 v[152:155], v[208:211], a[224:227], 0
    v_mfma_f32_16x16x32_bf16 v[152:155], v[212:215], a[228:231], v[152:155]
    v_mfma_f32_16x16x32_bf16 v[152:155], v[216:219], a[232:235], v[152:155]
    v_mfma_f32_16x16x32_bf16 v[152:155], v[220:223], a[236:239], v[152:155]
    s_waitcnt lgkmcnt(3)
    v_mfma_f32_16x16x32_bf16 v[132:135], v[224:227], a[128:131], 0
    s_waitcnt lgkmcnt(2)
    v_mfma_f32_16x16x32_bf16 v[132:135], v[228:231], a[132:135], v[132:135]
    s_waitcnt lgkmcnt(1)
    v_mfma_f32_16x16x32_bf16 v[132:135], v[232:235], a[136:139], v[132:135]
    s_waitcnt lgkmcnt(0)
    v_mfma_f32_16x16x32_bf16 v[132:135], v[236:239], a[140:143], v[132:135]
    v_mfma_f32_16x16x32_bf16 v[140:143], v[224:227], a[160:163], 0
    v_mfma_f32_16x16x32_bf16 v[140:143], v[228:231], a[164:167], v[140:143]
    v_mfma_f32_16x16x32_bf16 v[140:143], v[232:235], a[168:171], v[140:143]
    v_mfma_f32_16x16x32_bf16 v[140:143], v[236:239], a[172:175], v[140:143]
    v_mfma_f32_16x16x32_bf16 v[148:151], v[224:227], a[192:195], 0
    v_mfma_f32_16x16x32_bf16 v[148:151], v[228:231], a[196:199], v[148:151]
    v_mfma_f32_16x16x32_bf16 v[148:151], v[232:235], a[200:203], v[148:151]
    v_mfma_f32_16x16x32_bf16 v[148:151], v[236:239], a[204:207], v[148:151]
    v_mfma_f32_16x16x32_bf16 v[156:159], v[224:227], a[224:227], 0
    v_mfma_f32_16x16x32_bf16 v[156:159], v[228:231], a[228:231], v[156:159]
    v_mfma_f32_16x16x32_bf16 v[156:159], v[232:235], a[232:235], v[156:159]
    v_mfma_f32_16x16x32_bf16 v[156:159], v[236:239], a[236:239], v[156:159]
    ds_read_b128 v[208:211], v244 offset:256
    ds_read_b128 v[212:215], v244 offset:320
    ds_read_b128 v[216:219], v244 offset:384
    ds_read_b128 v[220:223], v244 offset:448
    ds_read_b128 v[224:227], v244 offset:8704
    ds_read_b128 v[228:231], v244 offset:8768
    ds_read_b128 v[232:235], v244 offset:8832
    ds_read_b128 v[236:239], v244 offset:8896
    s_waitcnt lgkmcnt(7)
    v_mfma_f32_16x16x32_bf16 v[128:131], v[208:211], a[144:147], v[128:131]
    s_waitcnt lgkmcnt(6)
    v_mfma_f32_16x16x32_bf16 v[128:131], v[212:215], a[148:151], v[128:131]
    s_waitcnt lgkmcnt(5)
    v_mfma_f32_16x16x32_bf16 v[128:131], v[216:219], a[152:155], v[128:131]
    s_waitcnt lgkmcnt(4)
    v_mfma_f32_16x16x32_bf16 v[128:131], v[220:223], a[156:159], v[128:131]
    v_mfma_f32_16x16x32_bf16 v[136:139], v[208:211], a[176:179], v[136:139]
    v_mfma_f32_16x16x32_bf16 v[136:139], v[212:215], a[180:183], v[136:139]
    v_mfma_f32_16x16x32_bf16 v[136:139], v[216:219], a[184:187], v[136:139]
    v_mfma_f32_16x16x32_bf16 v[136:139], v[220:223], a[188:191], v[136:139]
    v_mfma_f32_16x16x32_bf16 v[144:147], v[208:211], a[208:211], v[144:147]
    v_mfma_f32_16x16x32_bf16 v[144:147], v[212:215], a[212:215], v[144:147]
    v_mfma_f32_16x16x32_bf16 v[144:147], v[216:219], a[216:219], v[144:147]
    v_mfma_f32_16x16x32_bf16 v[144:147], v[220:223], a[220:223], v[144:147]
    v_mfma_f32_16x16x32_bf16 v[152:155], v[208:211], a[240:243], v[152:155]
    v_mfma_f32_16x16x32_bf16 v[152:155], v[212:215], a[244:247], v[152:155]
    v_mfma_f32_16x16x32_bf16 v[152:155], v[216:219], a[248:251], v[152:155]
    v_mfma_f32_16x16x32_bf16 v[152:155], v[220:223], a[252:255], v[152:155]
    s_waitcnt lgkmcnt(3)
    v_mfma_f32_16x16x32_bf16 v[132:135], v[224:227], a[144:147], v[132:135]
    s_waitcnt lgkmcnt(2)
    v_mfma_f32_16x16x32_bf16 v[132:135], v[228:231], a[148:151], v[132:135]
    s_waitcnt lgkmcnt(1)
    v_mfma_f32_16x16x32_bf16 v[132:135], v[232:235], a[152:155], v[132:135]
    s_waitcnt lgkmcnt(0)
    v_mfma_f32_16x16x32_bf16 v[132:135], v[236:239], a[156:159], v[132:135]
    v_mfma_f32_16x16x32_bf16 v[140:143], v[224:227], a[176:179], v[140:143]
    v_mfma_f32_16x16x32_bf16 v[140:143], v[228:231], a[180:183], v[140:143]
    v_mfma_f32_16x16x32_bf16 v[140:143], v[232:235], a[184:187], v[140:143]
    v_mfma_f32_16x16x32_bf16 v[140:143], v[236:239], a[188:191], v[140:143]
    v_mfma_f32_16x16x32_bf16 v[148:151], v[224:227], a[208:211], v[148:151]
    v_mfma_f32_16x16x32_bf16 v[148:151], v[228:231], a[212:215], v[148:151]
    v_mfma_f32_16x16x32_bf16 v[148:151], v[232:235], a[216:219], v[148:151]
    v_mfma_f32_16x16x32_bf16 v[148:151], v[236:239], a[220:223], v[148:151]
    v_mfma_f32_16x16x32_bf16 v[156:159], v[224:227], a[240:243], v[156:159]
    v_mfma_f32_16x16x32_bf16 v[156:159], v[228:231], a[244:247], v[156:159]
    v_mfma_f32_16x16x32_bf16 v[156:159], v[232:235], a[248:251], v[156:159]
    v_mfma_f32_16x16x32_bf16 v[156:159], v[236:239], a[252:255], v[156:159]
    s_barrier
    v_max3_f32 v192, v192, v128, v129
    v_max3_f32 v192, v192, v130, v131
    v_max3_f32 v192, v192, v132, v133
    v_max3_f32 v192, v192, v134, v135
    v_max3_f32 v196, v196, v136, v137
    v_max3_f32 v196, v196, v138, v139
    v_max3_f32 v196, v196, v140, v141
    v_max3_f32 v196, v196, v142, v143
    v_max3_f32 v200, v200, v144, v145
    v_max3_f32 v200, v200, v146, v147
    v_max3_f32 v200, v200, v148, v149
    v_max3_f32 v200, v200, v150, v151
    v_max3_f32 v204, v204, v152, v153
    v_max3_f32 v204, v204, v154, v155
    v_max3_f32 v204, v204, v156, v157
    v_max3_f32 v204, v204, v158, v159
    s_add_u32 s41, s41, 32768
    s_add_u32 s42, s42, 32768
    s_cmp_lt_u32 s41, 0x100000
    s_cbranch_scc1 Latt_fb_loop
    v_mov_b32 v193, v192
    v_mov_b32 v197, v196
    v_mov_b32 v201, v200
    v_mov_b32 v205, v204
    v_permlane16_swap_b32 v192, v193
    v_permlane16_swap_b32 v196, v197
    v_permlane16_swap_b32 v200, v201
    v_permlane16_swap_b32 v204, v205
    v_max_f32 v192, v192, v193
    v_max_f32 v196, v196, v197
    v_max_f32 v200, v200, v201
    v_max_f32 v204, v204, v205
    v_mov_b32 v193, v192
    v_mov_b32 v197, v196
    v_mov_b32 v201, v200
    v_mov_b32 v205, v204
    v_permlane32_swap_b32 v192, v193
    v_permlane32_swap_b32 v196, v197
    v_permlane32_swap_b32 v200, v201
    v_permlane32_swap_b32 v204, v205
    v_max_f32 v192, v192, v193
    v_max_f32 v196, v196, v197
    v_max_f32 v200, v200, v201
    v_max_f32 v204, v204, v205
    v_sub_f32 v192, 0, v192
    v_mov_b32 v193, v192
    v_mov_b32 v194, v192
    v_mov_b32 v195, v192
    v_sub_f32 v196, 0, v196
    v_mov_b32 v197, v196
    v_mov_b32 v198, v196
    v_mov_b32 v199, v196
    v_sub_f32 v200, 0, v200
    v_mov_b32 v201, v200
    v_mov_b32 v202, v200
    v_mov_b32 v203, v200
    v_sub_f32 v204, 0, v204
    v_mov_b32 v205, v204
    v_mov_b32 v206, v204
    v_mov_b32 v207, v204
    s_mov_b32 s41, 0
    s_mov_b32 s42, 4096
    s_add_u32 m0, s40, 0
    s_nop 0
    buffer_load_dwordx4 v246, s[8:11], s41 offen offset:0 nt lds
    s_add_u32 m0, s40, 32
    s_nop 0
    buffer_load_dwordx4 v246, s[8:11], s41 offen offset:1024 nt lds
    s_add_u32 m0, s40, 64
    s_nop 0
    buffer_load_dwordx4 v246, s[8:11], s41 offen offset:2048 nt lds
    s_add_u32 m0, s40, 96
    s_nop 0
    buffer_load_dwordx4 v246, s[8:11], s41 offen offset:3072 nt lds
    s_add_u32 m0, s40, 4224
    s_nop 0
    buffer_load_dwordx4 v246, s[8:11], s42 offen offset:0 nt lds
    s_add_u32 m0, s40, 4256
    s_nop 0
    buffer_load_dwordx4 v246, s[8:11], s42 offen offset:1024 nt lds
    s_add_u32 m0, s40, 4288
    s_nop 0
    buffer_load_dwordx4 v246, s[8:11], s42 offen offset:2048 nt lds
    s_add_u32 m0, s40, 4320
    s_nop 0
    buffer_load_dwordx4 v246, s[8:11], s42 offen offset:3072 nt lds
    s_mov_b32 s41, 32768
    s_mov_b32 s42, 36864
    s_add_u32 m0, s40, 33792
    s_nop 0
    buffer_load_dwordx4 v246, s[8:11], s41 offen offset:0 nt lds
    s_add_u32 m0, s40, 33824
    s_nop 0
    buffer_load_dwordx4 v246, s[8:11], s41 offen offset:1024 nt lds
    s_add_u32 m0, s40, 33856
    s_nop 0
    buffer_load_dwordx4 v246, s[8:11], s41 offen offset:2048 nt lds
    s_add_u32 m0, s40, 33888
    s_nop 0
    buffer_load_dwordx4 v246, s[8:11], s41 offen offset:3072 nt lds
    s_add_u32 m0, s40, 38016
    s_nop 0
    buffer_load_dwordx4 v246, s[8:11], s42 offen offset:0 nt lds
    s_add_u32 m0, s40, 38048
    s_nop 0
    buffer_load_dwordx4 v246, s[8:11], s42 offen offset:1024 nt lds
    s_add_u32 m0, s40, 38080
    s_nop 0
    buffer_load_dwordx4 v246, s[8:11], s42 offen offset:2048 nt lds
    s_add_u32 m0, s40, 38112
    s_nop 0
    buffer_load_dwordx4 v246, s[8:11], s42 offen offset:3072 nt lds
    s_waitcnt vmcnt(0)
    s_barrier
    ds_read_b128 v[208:211], v244 offset:0
    ds_read_b128 v[212:215], v244 offset:64
    ds_read_b128 v[216:219], v244 offset:128
    ds_read_b128 v[220:223], v244 offset:192
    s_waitcnt lgkmcnt(0)
    s_branch Latt_restart

.text
.globl cd_kernel
.p2align 8
.type cd_kernel,@function
cd_kernel:
    s_cmp_ge_u32 s2, 256
    s_cbranch_scc1 Lcd_done
    s_load_dwordx2 s[6:7], s[0:1], 112
    s_load_dwordx2 s[36:37], s[0:1], 56
    s_load_dwordx2 s[44:45], s[0:1], 72
    v_lshrrev_b32 v1, 6, v0
    v_and_b32 v2, 63, v0
    v_readfirstlane_b32 s3, v1
    s_and_b32 s20, s2, 7
    s_lshr_b32 s21, s2, 3
    s_and_b32 s22, s21, 3
    s_lshr_b32 s21, s21, 2
    s_lshl_b32 s20, s20, 3
    s_add_u32 s20, s20, s21
    v_and_b32 v3, 7, v0
    v_lshrrev_b32 v4, 3, v0
    v_lshlrev_b32 v6, 9, v4
    v_lshl_add_u32 v6, v3, 4, v6
    s_mul_i32 s25, s20, 28672
    v_lshlrev_b32 v8, 5, v4
    v_lshlrev_b32 v14, 4, v2
    s_mul_i32 s27, s22, 7
    s_add_u32 s27, s27, s3
    s_lshr_b32 s28, s27, 1
    s_mul_i32 s28, s28, 114688
    s_and_b32 s29, s27, 1
    s_lshl_b32 s29, s29, 12
    s_add_u32 s28, s28, s29
    s_add_u32 s28, s28, 29360128
    s_waitcnt lgkmcnt(0)
    s_add_u32 s8, s6, 33554432
    s_addc_u32 s9, s7, 0
    s_mov_b32 s10, 14680064
    s_mov_b32 s11, 0x20000
    s_add_u32 s40, s6, s28
    s_addc_u32 s41, s7, 0
    s_mov_b32 s42, 110592
    s_mov_b32 s43, 0x20000
    s_add_u32 s29, s25, 0
    buffer_load_dwordx4 v[128:131], v6, s[8:11], s29 offen offset:0
    buffer_load_dwordx4 v[136:139], v6, s[8:11], s29 offen offset:128
    buffer_load_dwordx4 v[132:135], v6, s[8:11], s29 offen offset:256
    buffer_load_dwordx4 v[140:143], v6, s[8:11], s29 offen offset:384
    s_add_u32 s29, s25, 1835008
    buffer_load_dwordx4 v[144:147], v6, s[8:11], s29 offen offset:0
    buffer_load_dwordx4 v[152:155], v6, s[8:11], s29 offen offset:128
    buffer_load_dwordx4 v[148:151], v6, s[8:11], s29 offen offset:256
    buffer_load_dwordx4 v[156:159], v6, s[8:11], s29 offen offset:384
    s_add_u32 s29, s25, 3670016
    buffer_load_dwordx4 v[160:163], v6, s[8:11], s29 offen offset:0
    buffer_load_dwordx4 v[168:171], v6, s[8:11], s29 offen offset:128
    buffer_load_dwordx4 v[164:167], v6, s[8:11], s29 offen offset:256
    buffer_load_dwordx4 v[172:175], v6, s[8:11], s29 offen offset:384
    s_add_u32 s29, s25, 5505024
    buffer_load_dwordx4 v[176:179], v6, s[8:11], s29 offen offset:0
    buffer_load_dwordx4 v[184:187], v6, s[8:11], s29 offen offset:128
    buffer_load_dwordx4 v[180:183], v6, s[8:11], s29 offen offset:256
    buffer_load_dwordx4 v[188:191], v6, s[8:11], s29 offen offset:384
    s_add_u32 s29, s25, 7340032
    buffer_load_dwordx4 v[192:195], v6, s[8:11], s29 offen offset:0
    buffer_load_dwordx4 v[200:203], v6, s[8:11], s29 offen offset:128
    buffer_load_dwordx4 v[196:199], v6, s[8:11], s29 offen offset:256
    buffer_load_dwordx4 v[204:207], v6, s[8:11], s29 offen offset:384
    s_add_u32 s29, s25, 9175040
    buffer_load_dwordx4 v[208:211], v6, s[8:11], s29 offen offset:0
    buffer_load_dwordx4 v[216:219], v6, s[8:11], s29 offen offset:128
    buffer_load_dwordx4 v[212:215], v6, s[8:11], s29 offen offset:256
    buffer_load_dwordx4 v[220:223], v6, s[8:11], s29 offen offset:384
    s_add_u32 s29, s25, 11010048
    buffer_load_dwordx4 v[224:227], v6, s[8:11], s29 offen offset:0
    buffer_load_dwordx4 v[232:235], v6, s[8:11], s29 offen offset:128
    buffer_load_dwordx4 v[228:231], v6, s[8:11], s29 offen offset:256
    buffer_load_dwordx4 v[236:239], v6, s[8:11], s29 offen offset:384
    s_add_u32 s29, s25, 12845056
    buffer_load_dwordx4 v[240:243], v6, s[8:11], s29 offen offset:0
    buffer_load_dwordx4 v[248:251], v6, s[8:11], s29 offen offset:128
    buffer_load_dwordx4 v[244:247], v6, s[8:11], s29 offen offset:256
    buffer_load_dwordx4 v[252:255], v6, s[8:11], s29 offen offset:384
    s_add_u32 s29, s25, 65536
    s_add_u32 s12, s6, s29
    s_addc_u32 s13, s7, 0
    s_mov_b32 s14, 28672
    s_mov_b32 s15, 0x20000
    s_mov_b32 s16, s6
    s_mov_b32 s17, s7
    s_mov_b32 s18, 10752
    s_mov_b32 s19, 0x20000
    buffer_load_dwordx4 v[16:19], v6, s[12:15], 0 offen offset:0
    buffer_load_dwordx4 v[20:23], v6, s[12:15], 0 offen offset:128
    buffer_load_dwordx4 v[24:27], v6, s[12:15], 0 offen offset:256
    buffer_load_dwordx4 v[28:31], v6, s[12:15], 0 offen offset:384
    s_movk_i32 s30, 3584
    s_movk_i32 s31, 5376
    s_movk_i32 s32, 7168
    buffer_load_dwordx4 v[96:99], v8, s[16:19], s30 offen offset:0
    buffer_load_dwordx4 v[100:103], v8, s[16:19], s30 offen offset:16
    buffer_load_dwordx4 v[104:107], v8, s[16:19], s31 offen offset:0
    buffer_load_dwordx4 v[108:111], v8, s[16:19], s31 offen offset:16
    buffer_load_dwordx4 v[112:115], v8, s[16:19], s32 offen offset:0
    buffer_load_dwordx4 v[116:119], v8, s[16:19], s32 offen offset:16
    v_mov_b32 v120, 0x3f80
    v_mov_b32 v121, 0x3f800000
    s_waitcnt vmcnt(41)
    v_lshlrev_b32 v32, 16, v128
    v_and_b32 v33, 0xffff0000, v128
    v_lshlrev_b32 v34, 16, v129
    v_and_b32 v35, 0xffff0000, v129
    v_lshlrev_b32 v48, 16, v130
    v_and_b32 v49, 0xffff0000, v130
    v_lshlrev_b32 v50, 16, v131
    v_and_b32 v51, 0xffff0000, v131
    s_waitcnt vmcnt(39)
    v_lshlrev_b32 v36, 16, v132
    v_and_b32 v37, 0xffff0000, v132
    v_lshlrev_b32 v38, 16, v133
    v_and_b32 v39, 0xffff0000, v133
    v_lshlrev_b32 v52, 16, v134
    v_and_b32 v53, 0xffff0000, v134
    v_lshlrev_b32 v54, 16, v135
    v_and_b32 v55, 0xffff0000, v135
    v_lshlrev_b32 v40, 16, v136
    v_and_b32 v41, 0xffff0000, v136
    v_lshlrev_b32 v42, 16, v137
    v_and_b32 v43, 0xffff0000, v137
    v_lshlrev_b32 v56, 16, v138
    v_and_b32 v57, 0xffff0000, v138
    v_lshlrev_b32 v58, 16, v139
    v_and_b32 v59, 0xffff0000, v139
    s_waitcnt vmcnt(38)
    v_lshlrev_b32 v44, 16, v140
    v_and_b32 v45, 0xffff0000, v140
    v_lshlrev_b32 v46, 16, v141
    v_and_b32 v47, 0xffff0000, v141
    v_lshlrev_b32 v60, 16, v142
    v_and_b32 v61, 0xffff0000, v142
    v_lshlrev_b32 v62, 16, v143
    v_and_b32 v63, 0xffff0000, v143
    s_mov_b32 s33, 0
    buffer_load_dwordx4 v[128:131], v14, s[40:43], s33 offen offset:0
    buffer_load_dwordx4 v[132:135], v14, s[40:43], s33 offen offset:1024
    buffer_load_dwordx4 v[136:139], v14, s[40:43], s33 offen offset:2048
    buffer_load_dwordx4 v[140:143], v14, s[40:43], s33 offen offset:3072
    s_waitcnt vmcnt(41)
    v_dot2c_f32_bf16 v32, v144, v120
    v_dot2c_f32_bf16 v33, v144, v121
    v_dot2c_f32_bf16 v34, v145, v120
    v_dot2c_f32_bf16 v35, v145, v121
    v_dot2c_f32_bf16 v48, v146, v120
    v_dot2c_f32_bf16 v49, v146, v121
    v_dot2c_f32_bf16 v50, v147, v120
    v_dot2c_f32_bf16 v51, v147, v121
    s_waitcnt vmcnt(39)
    v_dot2c_f32_bf16 v36, v148, v120
    v_dot2c_f32_bf16 v37, v148, v121
    v_dot2c_f32_bf16 v38, v149, v120
    v_dot2c_f32_bf16 v39, v149, v121
    v_dot2c_f32_bf16 v52, v150, v120
    v_dot2c_f32_bf16 v53, v150, v121
    v_dot2c_f32_bf16 v54, v151, v120
    v_dot2c_f32_bf16 v55, v151, v121
    v_dot2c_f32_bf16 v40, v152, v120
    v_dot2c_f32_bf16 v41, v152, v121
    v_dot2c_f32_bf16 v42, v153, v120
    v_dot2c_f32_bf16 v43, v153, v121
    v_dot2c_f32_bf16 v56, v154, v120
    v_dot2c_f32_bf16 v57, v154, v121
    v_dot2c_f32_bf16 v58, v155, v120
    v_dot2c_f32_bf16 v59, v155, v121
    s_waitcnt vmcnt(38)
    v_dot2c_f32_bf16 v44, v156, v120
    v_dot2c_f32_bf16 v45, v156, v121
    v_dot2c_f32_bf16 v46, v157, v120
    v_dot2c_f32_bf16 v47, v157, v121
    v_dot2c_f32_bf16 v60, v158, v120
    v_dot2c_f32_bf16 v61, v158, v121
    v_dot2c_f32_bf16 v62, v159, v120
    v_dot2c_f32_bf16 v63, v159, v121
    s_mov_b32 s33, 8192
    buffer_load_dwordx4 v[144:147], v14, s[40:43], s33 offen offset:0
    buffer_load_dwordx4 v[148:151], v14, s[40:43], s33 offen offset:1024
    buffer_load_dwordx4 v[152:155], v14, s[40:43], s33 offen offset:2048
    buffer_load_dwordx4 v[156:159], v14, s[40:43], s33 offen offset:3072
    s_waitcnt vmcnt(41)
    v_dot2c_f32_bf16 v32, v160, v120
    v_dot2c_f32_bf16 v33, v160, v121
    v_dot2c_f32_bf16 v34, v161, v120
    v_dot2c_f32_bf16 v35, v161, v121
    v_dot2c_f32_bf16 v48, v162, v120
    v_dot2c_f32_bf16 v49, v162, v121
    v_dot2c_f32_bf16 v50, v163, v120
    v_dot2c_f32_bf16 v51, v163, v121
    s_waitcnt vmcnt(39)
    v_dot2c_f32_bf16 v36, v164, v120
    v_dot2c_f32_bf16 v37, v164, v121
    v_dot2c_f32_bf16 v38, v165, v120
    v_dot2c_f32_bf16 v39, v165, v121
    v_dot2c_f32_bf16 v52, v166, v120
    v_dot2c_f32_bf16 v53, v166, v121
    v_dot2c_f32_bf16 v54, v167, v120
    v_dot2c_f32_bf16 v55, v167, v121
    v_dot2c_f32_bf16 v40, v168, v120
    v_dot2c_f32_bf16 v41, v168, v121
    v_dot2c_f32_bf16 v42, v169, v120
    v_dot2c_f32_bf16 v43, v169, v121
    v_dot2c_f32_bf16 v56, v170, v120
    v_dot2c_f32_bf16 v57, v170, v121
    v_dot2c_f32_bf16 v58, v171, v120
    v_dot2c_f32_bf16 v59, v171, v121
    s_waitcnt vmcnt(38)
    v_dot2c_f32_bf16 v44, v172, v120
    v_dot2c_f32_bf16 v45, v172, v121
    v_dot2c_f32_bf16 v46, v173, v120
    v_dot2c_f32_bf16 v47, v173, v121
    v_dot2c_f32_bf16 v60, v174, v120
    v_dot2c_f32_bf16 v61, v174, v121
    v_dot2c_f32_bf16 v62, v175, v120
    v_dot2c_f32_bf16 v63, v175, v121
    s_waitcnt vmcnt(37)
    v_dot2c_f32_bf16 v32, v176, v120
    v_dot2c_f32_bf16 v33, v176, v121
    v_dot2c_f32_bf16 v34, v177, v120
    v_dot2c_f32_bf16 v35, v177, v121
    v_dot2c_f32_bf16 v48, v178, v120
    v_dot2c_f32_bf16 v49, v178, v121
    v_dot2c_f32_bf16 v50, v179, v120
    v_dot2c_f32_bf16 v51, v179, v121
    s_waitcnt vmcnt(35)
    v_dot2c_f32_bf16 v36, v180, v120
    v_dot2c_f32_bf16 v37, v180, v121
    v_dot2c_f32_bf16 v38, v181, v120
    v_dot2c_f32_bf16 v39, v181, v121
    v_dot2c_f32_bf16 v52, v182, v120
    v_dot2c_f32_bf16 v53, v182, v121
    v_dot2c_f32_bf16 v54, v183, v120
    v_dot2c_f32_bf16 v55, v183, v121
    v_dot2c_f32_bf16 v40, v184, v120
    v_dot2c_f32_bf16 v41, v184, v121
    v_dot2c_f32_bf16 v42, v185, v120
    v_dot2c_f32_bf16 v43, v185, v121
    v_dot2c_f32_bf16 v56, v186, v120
    v_dot2c_f32_bf16 v57, v186, v121
    v_dot2c_f32_bf16 v58, v187, v120
    v_dot2c_f32_bf16 v59, v187, v121
    s_waitcnt vmcnt(34)
    v_dot2c_f32_bf16 v44, v188, v120
    v_dot2c_f32_bf16 v45, v188, v121
    v_dot2c_f32_bf16 v46, v189, v120
    v_dot2c_f32_bf16 v47, v189, v121
    v_dot2c_f32_bf16 v60, v190, v120
    v_dot2c_f32_bf16 v61, v190, v121
    v_dot2c_f32_bf16 v62, v191, v120
    v_dot2c_f32_bf16 v63, v191, v121
    s_waitcnt vmcnt(33)
    v_dot2c_f32_bf16 v32, v192, v120
    v_dot2c_f32_bf16 v33, v192, v121
    v_dot2c_f32_bf16 v34, v193, v120
    v_dot2c_f32_bf16 v35, v193, v121
    v_dot2c_f32_bf16 v48, v194, v120
    v_dot2c_f32_bf16 v49, v194, v121
    v_dot2c_f32_bf16 v50, v195, v120
    v_dot2c_f32_bf16 v51, v195, v121
    s_waitcnt vmcnt(31)
    v_dot2c_f32_bf16 v36, v196, v120
    v_dot2c_f32_bf16 v37, v196, v121
    v_dot2c_f32_bf16 v38, v197, v120
    v_dot2c_f32_bf16 v39, v197, v121
    v_dot2c_f32_bf16 v52, v198, v120
    v_dot2c_f32_bf16 v53, v198, v121
    v_dot2c_f32_bf16 v54, v199, v120
    v_dot2c_f32_bf16 v55, v199, v121
    v_dot2c_f32_bf16 v40, v200, v120
    v_dot2c_f32_bf16 v41, v200, v121
    v_dot2c_f32_bf16 v42, v201, v120
    v_dot2c_f32_bf16 v43, v201, v121
    v_dot2c_f32_bf16 v56, v202, v120
    v_dot2c_f32_bf16 v57, v202, v121
    v_dot2c_f32_bf16 v58, v203, v120
    v_dot2c_f32_bf16 v59, v203, v121
    s_waitcnt vmcnt(30)
    v_dot2c_f32_bf16 v44, v204, v120
    v_dot2c_f32_bf16 v45, v204, v121
    v_dot2c_f32_bf16 v46, v205, v120
    v_dot2c_f32_bf16 v47, v205, v121
    v_dot2c_f32_bf16 v60, v206, v120
    v_dot2c_f32_bf16 v61, v206, v121
    v_dot2c_f32_bf16 v62, v207, v120
    v_dot2c_f32_bf16 v63, v207, v121
    s_waitcnt vmcnt(29)
    v_dot2c_f32_bf16 v32, v208, v120
    v_dot2c_f32_bf16 v33, v208, v121
    v_dot2c_f32_bf16 v34, v209, v120
    v_dot2c_f32_bf16 v35, v209, v121
    v_dot2c_f32_bf16 v48, v210, v120
    v_dot2c_f32_bf16 v49, v210, v121
    v_dot2c_f32_bf16 v50, v211, v120
    v_dot2c_f32_bf16 v51, v211, v121
    s_waitcnt vmcnt(27)
    v_dot2c_f32_bf16 v36, v212, v120
    v_dot2c_f32_bf16 v37, v212, v121
    v_dot2c_f32_bf16 v38, v213, v120
    v_dot2c_f32_bf16 v39, v213, v121
    v_dot2c_f32_bf16 v52, v214, v120
    v_dot2c_f32_bf16 v53, v214, v121
    v_dot2c_f32_bf16 v54, v215, v120
    v_dot2c_f32_bf16 v55, v215, v121
    v_dot2c_f32_bf16 v40, v216, v120
    v_dot2c_f32_bf16 v41, v216, v121
    v_dot2c_f32_bf16 v42, v217, v120
    v_dot2c_f32_bf16 v43, v217, v121
    v_dot2c_f32_bf16 v56, v218, v120
    v_dot2c_f32_bf16 v57, v218, v121
    v_dot2c_f32_bf16 v58, v219, v120
    v_dot2c_f32_bf16 v59, v219, v121
    s_waitcnt vmcnt(26)
    v_dot2c_f32_bf16 v44, v220, v120
    v_dot2c_f32_bf16 v45, v220, v121
    v_dot2c_f32_bf16 v46, v221, v120
    v_dot2c_f32_bf16 v47, v221, v121
    v_dot2c_f32_bf16 v60, v222, v120
    v_dot2c_f32_bf16 v61, v222, v121
    v_dot2c_f32_bf16 v62, v223, v120
    v_dot2c_f32_bf16 v63, v223, v121
    s_waitcnt vmcnt(25)
    v_dot2c_f32_bf16 v32, v224, v120
    v_dot2c_f32_bf16 v33, v224, v121
    v_dot2c_f32_bf16 v34, v225, v120
    v_dot2c_f32_bf16 v35, v225, v121
    v_dot2c_f32_bf16 v48, v226, v120
    v_dot2c_f32_bf16 v49, v226, v121
    v_dot2c_f32_bf16 v50, v227, v120
    v_dot2c_f32_bf16 v51, v227, v121
    s_waitcnt vmcnt(23)
    v_dot2c_f32_bf16 v36, v228, v120
    v_dot2c_f32_bf16 v37, v228, v121
    v_dot2c_f32_bf16 v38, v229, v120
    v_dot2c_f32_bf16 v39, v229, v121
    v_dot2c_f32_bf16 v52, v230, v120
    v_dot2c_f32_bf16 v53, v230, v121
    v_dot2c_f32_bf16 v54, v231, v120
    v_dot2c_f32_bf16 v55, v231, v121
    v_dot2c_f32_bf16 v40, v232, v120
    v_dot2c_f32_bf16 v41, v232, v121
    v_dot2c_f32_bf16 v42, v233, v120
    v_dot2c_f32_bf16 v43, v233, v121
    v_dot2c_f32_bf16 v56, v234, v120
    v_dot2c_f32_bf16 v57, v234, v121
    v_dot2c_f32_bf16 v58, v235, v120
    v_dot2c_f32_bf16 v59, v235, v121
    s_waitcnt vmcnt(22)
    v_dot2c_f32_bf16 v44, v236, v120
    v_dot2c_f32_bf16 v45, v236, v121
    v_dot2c_f32_bf16 v46, v237, v120
    v_dot2c_f32_bf16 v47, v237, v121
    v_dot2c_f32_bf16 v60, v238, v120
    v_dot2c_f32_bf16 v61, v238, v121
    v_dot2c_f32_bf16 v62, v239, v120
    v_dot2c_f32_bf16 v63, v239, v121
    s_waitcnt vmcnt(21)
    v_dot2c_f32_bf16 v32, v240, v120
    v_dot2c_f32_bf16 v33, v240, v121
    v_dot2c_f32_bf16 v34, v241, v120
    v_dot2c_f32_bf16 v35, v241, v121
    v_dot2c_f32_bf16 v48, v242, v120
    v_dot2c_f32_bf16 v49, v242, v121
    v_dot2c_f32_bf16 v50, v243, v120
    v_dot2c_f32_bf16 v51, v243, v121
    s_waitcnt vmcnt(19)
    v_dot2c_f32_bf16 v36, v244, v120
    v_dot2c_f32_bf16 v37, v244, v121
    v_dot2c_f32_bf16 v38, v245, v120
    v_dot2c_f32_bf16 v39, v245, v121
    v_dot2c_f32_bf16 v52, v246, v120
    v_dot2c_f32_bf16 v53, v246, v121
    v_dot2c_f32_bf16 v54, v247, v120
    v_dot2c_f32_bf16 v55, v247, v121
    v_dot2c_f32_bf16 v40, v248, v120
    v_dot2c_f32_bf16 v41, v248, v121
    v_dot2c_f32_bf16 v42, v249, v120
    v_dot2c_f32_bf16 v43, v249, v121
    v_dot2c_f32_bf16 v56, v250, v120
    v_dot2c_f32_bf16 v57, v250, v121
    v_dot2c_f32_bf16 v58, v251, v120
    v_dot2c_f32_bf16 v59, v251, v121
    s_waitcnt vmcnt(18)
    v_dot2c_f32_bf16 v44, v252, v120
    v_dot2c_f32_bf16 v45, v252, v121
    v_dot2c_f32_bf16 v46, v253, v120
    v_dot2c_f32_bf16 v47, v253, v121
    v_dot2c_f32_bf16 v60, v254, v120
    v_dot2c_f32_bf16 v61, v254, v121
    v_dot2c_f32_bf16 v62, v255, v120
    v_dot2c_f32_bf16 v63, v255, v121
    s_nop 2
    s_waitcnt vmcnt(17)
    v_lshlrev_b32 v64, 16, v16
    v_and_b32 v65, 0xffff0000, v16
    v_lshlrev_b32 v66, 16, v17
    v_and_b32 v67, 0xffff0000, v17
    v_lshlrev_b32 v68, 16, v18
    v_and_b32 v69, 0xffff0000, v18
    v_lshlrev_b32 v70, 16, v19
    v_and_b32 v71, 0xffff0000, v19
    s_waitcnt vmcnt(13)
    v_fmac_f32 v64, v96, v32
    v_fmac_f32 v65, v97, v33
    v_fmac_f32 v66, v98, v34
    v_fmac_f32 v67, v99, v35
    s_waitcnt vmcnt(12)
    v_fmac_f32 v68, v100, v36
    v_fmac_f32 v69, v101, v37
    v_fmac_f32 v70, v102, v38
    v_fmac_f32 v71, v103, v39
    v_cvt_pk_bf16_f32 v16, v64, v65
    v_cvt_pk_bf16_f32 v17, v66, v67
    v_cvt_pk_bf16_f32 v18, v68, v69
    v_cvt_pk_bf16_f32 v19, v70, v71
    v_lshlrev_b32 v72, 16, v20
    v_and_b32 v73, 0xffff0000, v20
    v_lshlrev_b32 v74, 16, v21
    v_and_b32 v75, 0xffff0000, v21
    v_lshlrev_b32 v76, 16, v22
    v_and_b32 v77, 0xffff0000, v22
    v_lshlrev_b32 v78, 16, v23
    v_and_b32 v79, 0xffff0000, v23
    v_fmac_f32 v72, v96, v40
    v_fmac_f32 v73, v97, v41
    v_fmac_f32 v74, v98, v42
    v_fmac_f32 v75, v99, v43
    v_fmac_f32 v76, v100, v44
    v_fmac_f32 v77, v101, v45
    v_fmac_f32 v78, v102, v46
    v_fmac_f32 v79, v103, v47
    v_cvt_pk_bf16_f32 v20, v72, v73
    v_cvt_pk_bf16_f32 v21, v74, v75
    v_cvt_pk_bf16_f32 v22, v76, v77
    v_cvt_pk_bf16_f32 v23, v78, v79
    v_lshlrev_b32 v80, 16, v24
    v_and_b32 v81, 0xffff0000, v24
    v_lshlrev_b32 v82, 16, v25
    v_and_b32 v83, 0xffff0000, v25
    v_lshlrev_b32 v84, 16, v26
    v_and_b32 v85, 0xffff0000, v26
    v_lshlrev_b32 v86, 16, v27
    v_and_b32 v87, 0xffff0000, v27
    v_fmac_f32 v80, v96, v48
    v_fmac_f32 v81, v97, v49
    v_fmac_f32 v82, v98, v50
    v_fmac_f32 v83, v99, v51
    v_fmac_f32 v84, v100, v52
    v_fmac_f32 v85, v101, v53
    v_fmac_f32 v86, v102, v54
    v_fmac_f32 v87, v103, v55
    v_cvt_pk_bf16_f32 v24, v80, v81
    v_cvt_pk_bf16_f32 v25, v82, v83
    v_cvt_pk_bf16_f32 v26, v84, v85
    v_cvt_pk_bf16_f32 v27, v86, v87
    v_lshlrev_b32 v88, 16, v28
    v_and_b32 v89, 0xffff0000, v28
    v_lshlrev_b32 v90, 16, v29
    v_and_b32 v91, 0xffff0000, v29
    v_lshlrev_b32 v92, 16, v30
    v_and_b32 v93, 0xffff0000, v30
    v_lshlrev_b32 v94, 16, v31
    v_and_b32 v95, 0xffff0000, v31
    v_fmac_f32 v88, v96, v56
    v_fmac_f32 v89, v97, v57
    v_fmac_f32 v90, v98, v58
    v_fmac_f32 v91, v99, v59
    v_fmac_f32 v92, v100, v60
    v_fmac_f32 v93, v101, v61
    v_fmac_f32 v94, v102, v62
    v_fmac_f32 v95, v103, v63
    v_cvt_pk_bf16_f32 v28, v88, v89
    v_cvt_pk_bf16_f32 v29, v90, v91
    v_cvt_pk_bf16_f32 v30, v92, v93
    v_cvt_pk_bf16_f32 v31, v94, v95
    s_add_u32 s29, s25, 4194304
    s_add_u32 s12, s6, s29
    s_addc_u32 s13, s7, 0
    s_cmp_eq_u32 s22, 0
    s_cselect_b32 s14, 28672, 0
    buffer_store_dwordx4 v[16:19], v6, s[12:15], 0 offen offset:0 sc1
    s_cmp_eq_u32 s22, 1
    s_cselect_b32 s14, 28672, 0
    buffer_store_dwordx4 v[20:23], v6, s[12:15], 0 offen offset:128 sc1
    s_cmp_eq_u32 s22, 2
    s_cselect_b32 s14, 28672, 0
    buffer_store_dwordx4 v[24:27], v6, s[12:15], 0 offen offset:256 sc1
    s_cmp_eq_u32 s22, 3
    s_cselect_b32 s14, 28672, 0
    buffer_store_dwordx4 v[28:31], v6, s[12:15], 0 offen offset:384 sc1
    v_add_f32 v32, v64, v65
    v_mul_f32 v33, v64, v64
    v_fmac_f32 v33, v65, v65
    v_add_f32 v32, v32, v66
    v_fmac_f32 v33, v66, v66
    v_add_f32 v32, v32, v67
    v_fmac_f32 v33, v67, v67
    v_add_f32 v32, v32, v68
    v_fmac_f32 v33, v68, v68
    v_add_f32 v32, v32, v69
    v_fmac_f32 v33, v69, v69
    v_add_f32 v32, v32, v70
    v_fmac_f32 v33, v70, v70
    v_add_f32 v32, v32, v71
    v_fmac_f32 v33, v71, v71
    v_add_f32 v34, v72, v73
    v_mul_f32 v35, v72, v72
    v_fmac_f32 v35, v73, v73
    v_add_f32 v34, v34, v74
    v_fmac_f32 v35, v74, v74
    v_add_f32 v34, v34, v75
    v_fmac_f32 v35, v75, v75
    v_add_f32 v34, v34, v76
    v_fmac_f32 v35, v76, v76
    v_add_f32 v34, v34, v77
    v_fmac_f32 v35, v77, v77
    v_add_f32 v34, v34, v78
    v_fmac_f32 v35, v78, v78
    v_add_f32 v34, v34, v79
    v_fmac_f32 v35, v79, v79
    v_add_f32 v36, v80, v81
    v_mul_f32 v37, v80, v80
    v_fmac_f32 v37, v81, v81
    v_add_f32 v36, v36, v82
    v_fmac_f32 v37, v82, v82
    v_add_f32 v36, v36, v83
    v_fmac_f32 v37, v83, v83
    v_add_f32 v36, v36, v84
    v_fmac_f32 v37, v84, v84
    v_add_f32 v36, v36, v85
    v_fmac_f32 v37, v85, v85
    v_add_f32 v36, v36, v86
    v_fmac_f32 v37, v86, v86
    v_add_f32 v36, v36, v87
    v_fmac_f32 v37, v87, v87
    v_add_f32 v38, v88, v89
    v_mul_f32 v39, v88, v88
    v_fmac_f32 v39, v89, v89
    v_add_f32 v38, v38, v90
    v_fmac_f32 v39, v90, v90
    v_add_f32 v38, v38, v91
    v_fmac_f32 v39, v91, v91
    v_add_f32 v38, v38, v92
    v_fmac_f32 v39, v92, v92
    v_add_f32 v38, v38, v93
    v_fmac_f32 v39, v93, v93
    v_add_f32 v38, v38, v94
    v_fmac_f32 v39, v94, v94
    v_add_f32 v38, v38, v95
    v_fmac_f32 v39, v95, v95
    v_add_f32_dpp v32, v32, v32 row_ror:8 row_mask:0xf bank_mask:0xf
    v_add_f32_dpp v33, v33, v33 row_ror:8 row_mask:0xf bank_mask:0xf
    v_add_f32_dpp v34, v34, v34 row_ror:8 row_mask:0xf bank_mask:0xf
    v_add_f32_dpp v35, v35, v35 row_ror:8 row_mask:0xf bank_mask:0xf
    v_add_f32_dpp v36, v36, v36 row_ror:8 row_mask:0xf bank_mask:0xf
    v_add_f32_dpp v37, v37, v37 row_ror:8 row_mask:0xf bank_mask:0xf
    v_add_f32_dpp v38, v38, v38 row_ror:8 row_mask:0xf bank_mask:0xf
    v_add_f32_dpp v39, v39, v39 row_ror:8 row_mask:0xf bank_mask:0xf
    v_mov_b32 v40, v32
    v_mov_b32 v41, v33
    v_mov_b32 v42, v34
    v_mov_b32 v43, v35
    v_mov_b32 v44, v36
    v_mov_b32 v45, v37
    v_mov_b32 v46, v38
    v_mov_b32 v47, v39
    v_permlane16_swap_b32 v32, v40
    v_permlane16_swap_b32 v33, v41
    v_permlane16_swap_b32 v34, v42
    v_permlane16_swap_b32 v35, v43
    v_permlane16_swap_b32 v36, v44
    v_permlane16_swap_b32 v37, v45
    v_permlane16_swap_b32 v38, v46
    v_permlane16_swap_b32 v39, v47
    v_add_f32 v32, v32, v40
    v_add_f32 v33, v33, v41
    v_add_f32 v34, v34, v42
    v_add_f32 v35, v35, v43
    v_add_f32 v36, v36, v44
    v_add_f32 v37, v37, v45
    v_add_f32 v38, v38, v46
    v_add_f32 v39, v39, v47
    v_mov_b32 v40, v32
    v_mov_b32 v41, v33
    v_mov_b32 v42, v34
    v_mov_b32 v43, v35
    v_mov_b32 v44, v36
    v_mov_b32 v45, v37
    v_mov_b32 v46, v38
    v_mov_b32 v47, v39
    v_permlane32_swap_b32 v32, v40
    v_permlane32_swap_b32 v33, v41
    v_permlane32_swap_b32 v34, v42
    v_permlane32_swap_b32 v35, v43
    v_permlane32_swap_b32 v36, v44
    v_permlane32_swap_b32 v37, v45
    v_permlane32_swap_b32 v38, v46
    v_permlane32_swap_b32 v39, v47
    v_add_f32 v32, v32, v40
    v_add_f32 v33, v33, v41
    v_add_f32 v34, v34, v42
    v_add_f32 v35, v35, v43
    v_add_f32 v36, v36, v44
    v_add_f32 v37, v37, v45
    v_add_f32 v38, v38, v46
    v_add_f32 v39, v39, v47
    v_lshlrev_b32 v9, 8, v1
    v_lshl_add_u32 v9, v3, 5, v9
    ds_write_b128 v9, v[32:35] offset:28672
    ds_write_b128 v9, v[36:39] offset:28688
    v_lshlrev_b32 v10, 5, v3
    s_mov_b32 s33, 16384
    buffer_load_dwordx4 v[160:163], v14, s[40:43], s33 offen offset:0
    buffer_load_dwordx4 v[164:167], v14, s[40:43], s33 offen offset:1024
    buffer_load_dwordx4 v[168:171], v14, s[40:43], s33 offen offset:2048
    buffer_load_dwordx4 v[172:175], v14, s[40:43], s33 offen offset:3072
    s_mov_b32 s33, 24576
    buffer_load_dwordx4 v[176:179], v14, s[40:43], s33 offen offset:0
    buffer_load_dwordx4 v[180:183], v14, s[40:43], s33 offen offset:1024
    buffer_load_dwordx4 v[184:187], v14, s[40:43], s33 offen offset:2048
    buffer_load_dwordx4 v[188:191], v14, s[40:43], s33 offen offset:3072
    s_waitcnt lgkmcnt(0)
    s_barrier
    ds_read_b128 v[192:195], v10 offset:28672
    ds_read_b128 v[196:199], v10 offset:28688
    ds_read_b128 v[200:203], v10 offset:28928
    ds_read_b128 v[204:207], v10 offset:28944
    ds_read_b128 v[208:211], v10 offset:29184
    ds_read_b128 v[212:215], v10 offset:29200
    ds_read_b128 v[216:219], v10 offset:29440
    ds_read_b128 v[220:223], v10 offset:29456
    ds_read_b128 v[224:227], v10 offset:29696
    ds_read_b128 v[228:231], v10 offset:29712
    ds_read_b128 v[232:235], v10 offset:29952
    ds_read_b128 v[236:239], v10 offset:29968
    ds_read_b128 v[240:243], v10 offset:30208
    ds_read_b128 v[244:247], v10 offset:30224
    s_waitcnt lgkmcnt(11)
    v_add_f32 v32, v192, v200
    v_add_f32 v33, v193, v201
    v_add_f32 v34, v194, v202
    v_add_f32 v35, v195, v203
    s_waitcnt lgkmcnt(10)
    v_add_f32 v36, v196, v204
    v_add_f32 v37, v197, v205
    v_add_f32 v38, v198, v206
    v_add_f32 v39, v199, v207
    s_waitcnt lgkmcnt(9)
    v_add_f32 v32, v32, v208
    v_add_f32 v33, v33, v209
    v_add_f32 v34, v34, v210
    v_add_f32 v35, v35, v211
    s_waitcnt lgkmcnt(8)
    v_add_f32 v36, v36, v212
    v_add_f32 v37, v37, v213
    v_add_f32 v38, v38, v214
    v_add_f32 v39, v39, v215
    s_waitcnt lgkmcnt(7)
    v_add_f32 v32, v32, v216
    v_add_f32 v33, v33, v217
    v_add_f32 v34, v34, v218
    v_add_f32 v35, v35, v219
    s_waitcnt lgkmcnt(6)
    v_add_f32 v36, v36, v220
    v_add_f32 v37, v37, v221
    v_add_f32 v38, v38, v222
    v_add_f32 v39, v39, v223
    s_waitcnt lgkmcnt(5)
    v_add_f32 v32, v32, v224
    v_add_f32 v33, v33, v225
    v_add_f32 v34, v34, v226
    v_add_f32 v35, v35, v227
    s_waitcnt lgkmcnt(4)
    v_add_f32 v36, v36, v228
    v_add_f32 v37, v37, v229
    v_add_f32 v38, v38, v230
    v_add_f32 v39, v39, v231
    s_waitcnt lgkmcnt(3)
    v_add_f32 v32, v32, v232
    v_add_f32 v33, v33, v233
    v_add_f32 v34, v34, v234
    v_add_f32 v35, v35, v235
    s_waitcnt lgkmcnt(2)
    v_add_f32 v36, v36, v236
    v_add_f32 v37, v37, v237
    v_add_f32 v38, v38, v238
    v_add_f32 v39, v39, v239
    s_waitcnt lgkmcnt(1)
    v_add_f32 v32, v32, v240
    v_add_f32 v33, v33, v241
    v_add_f32 v34, v34, v242
    v_add_f32 v35, v35, v243
    s_waitcnt lgkmcnt(0)
    v_add_f32 v36, v36, v244
    v_add_f32 v37, v37, v245
    v_add_f32 v38, v38, v246
    v_add_f32 v39, v39, v247
    s_mov_b32 s33, 32768
    buffer_load_dwordx4 v[192:195], v14, s[40:43], s33 offen offset:0
    buffer_load_dwordx4 v[196:199], v14, s[40:43], s33 offen offset:1024
    buffer_load_dwordx4 v[200:203], v14, s[40:43], s33 offen offset:2048
    buffer_load_dwordx4 v[204:207], v14, s[40:43], s33 offen offset:3072
    s_mov_b32 s33, 40960
    buffer_load_dwordx4 v[208:211], v14, s[40:43], s33 offen offset:0
    buffer_load_dwordx4 v[212:215], v14, s[40:43], s33 offen offset:1024
    buffer_load_dwordx4 v[216:219], v14, s[40:43], s33 offen offset:2048
    buffer_load_dwordx4 v[220:223], v14, s[40:43], s33 offen offset:3072
    s_mov_b32 s33, 49152
    buffer_load_dwordx4 v[224:227], v14, s[40:43], s33 offen offset:0
    buffer_load_dwordx4 v[228:231], v14, s[40:43], s33 offen offset:1024
    buffer_load_dwordx4 v[232:235], v14, s[40:43], s33 offen offset:2048
    buffer_load_dwordx4 v[236:239], v14, s[40:43], s33 offen offset:3072
    s_mov_b32 s33, 57344
    buffer_load_dwordx4 v[240:243], v14, s[40:43], s33 offen offset:0
    buffer_load_dwordx4 v[244:247], v14, s[40:43], s33 offen offset:1024
    buffer_load_dwordx4 v[248:251], v14, s[40:43], s33 offen offset:2048
    buffer_load_dwordx4 v[252:255], v14, s[40:43], s33 offen offset:3072
    v_mul_f32 v32, 991054117, v32
    v_mul_f32 v33, 991054117, v33
    v_fma_f32 v33, -v32, v32, v33
    v_max_f32 v33, 0, v33
    v_add_f32 v33, 925353388, v33
    v_rsq_f32 v33, v33
    v_mul_f32 v34, 991054117, v34
    v_mul_f32 v35, 991054117, v35
    v_fma_f32 v35, -v34, v34, v35
    v_max_f32 v35, 0, v35
    v_add_f32 v35, 925353388, v35
    v_rsq_f32 v35, v35
    v_mul_f32 v36, 991054117, v36
    v_mul_f32 v37, 991054117, v37
    v_fma_f32 v37, -v36, v36, v37
    v_max_f32 v37, 0, v37
    v_add_f32 v37, 925353388, v37
    v_rsq_f32 v37, v37
    v_mul_f32 v38, 991054117, v38
    v_mul_f32 v39, 991054117, v39
    v_fma_f32 v39, -v38, v38, v39
    v_max_f32 v39, 0, v39
    v_add_f32 v39, 925353388, v39
    v_rsq_f32 v39, v39
    v_mul_f32 v32, -v32, v33
    v_fma_f32 v64, v64, v33, v32
    v_fma_f32 v65, v65, v33, v32
    v_fma_f32 v66, v66, v33, v32
    v_fma_f32 v67, v67, v33, v32
    v_fma_f32 v68, v68, v33, v32
    v_fma_f32 v69, v69, v33, v32
    v_fma_f32 v70, v70, v33, v32
    v_fma_f32 v71, v71, v33, v32
    s_waitcnt vmcnt(37)
    v_fma_f32 v64, v64, v112, v104
    v_fma_f32 v65, v65, v113, v105
    v_fma_f32 v66, v66, v114, v106
    v_fma_f32 v67, v67, v115, v107
    s_waitcnt vmcnt(36)
    v_fma_f32 v68, v68, v116, v108
    v_fma_f32 v69, v69, v117, v109
    v_fma_f32 v70, v70, v118, v110
    v_fma_f32 v71, v71, v119, v111
    v_cvt_pk_bf16_f32 v16, v64, v65
    v_cvt_pk_bf16_f32 v17, v66, v67
    v_cvt_pk_bf16_f32 v18, v68, v69
    v_cvt_pk_bf16_f32 v19, v70, v71
    ds_write_b128 v6, v[16:19] offset:0
    v_mul_f32 v34, -v34, v35
    v_fma_f32 v72, v72, v35, v34
    v_fma_f32 v73, v73, v35, v34
    v_fma_f32 v74, v74, v35, v34
    v_fma_f32 v75, v75, v35, v34
    v_fma_f32 v76, v76, v35, v34
    v_fma_f32 v77, v77, v35, v34
    v_fma_f32 v78, v78, v35, v34
    v_fma_f32 v79, v79, v35, v34
    v_fma_f32 v72, v72, v112, v104
    v_fma_f32 v73, v73, v113, v105
    v_fma_f32 v74, v74, v114, v106
    v_fma_f32 v75, v75, v115, v107
    v_fma_f32 v76, v76, v116, v108
    v_fma_f32 v77, v77, v117, v109
    v_fma_f32 v78, v78, v118, v110
    v_fma_f32 v79, v79, v119, v111
    v_cvt_pk_bf16_f32 v20, v72, v73
    v_cvt_pk_bf16_f32 v21, v74, v75
    v_cvt_pk_bf16_f32 v22, v76, v77
    v_cvt_pk_bf16_f32 v23, v78, v79
    ds_write_b128 v6, v[20:23] offset:128
    v_mul_f32 v36, -v36, v37
    v_fma_f32 v80, v80, v37, v36
    v_fma_f32 v81, v81, v37, v36
    v_fma_f32 v82, v82, v37, v36
    v_fma_f32 v83, v83, v37, v36
    v_fma_f32 v84, v84, v37, v36
    v_fma_f32 v85, v85, v37, v36
    v_fma_f32 v86, v86, v37, v36
    v_fma_f32 v87, v87, v37, v36
    v_fma_f32 v80, v80, v112, v104
    v_fma_f32 v81, v81, v113, v105
    v_fma_f32 v82, v82, v114, v106
    v_fma_f32 v83, v83, v115, v107
    v_fma_f32 v84, v84, v116, v108
    v_fma_f32 v85, v85, v117, v109
    v_fma_f32 v86, v86, v118, v110
    v_fma_f32 v87, v87, v119, v111
    v_cvt_pk_bf16_f32 v24, v80, v81
    v_cvt_pk_bf16_f32 v25, v82, v83
    v_cvt_pk_bf16_f32 v26, v84, v85
    v_cvt_pk_bf16_f32 v27, v86, v87
    ds_write_b128 v6, v[24:27] offset:256
    v_mul_f32 v38, -v38, v39
    v_fma_f32 v88, v88, v39, v38
    v_fma_f32 v89, v89, v39, v38
    v_fma_f32 v90, v90, v39, v38
    v_fma_f32 v91, v91, v39, v38
    v_fma_f32 v92, v92, v39, v38
    v_fma_f32 v93, v93, v39, v38
    v_fma_f32 v94, v94, v39, v38
    v_fma_f32 v95, v95, v39, v38
    v_fma_f32 v88, v88, v112, v104
    v_fma_f32 v89, v89, v113, v105
    v_fma_f32 v90, v90, v114, v106
    v_fma_f32 v91, v91, v115, v107
    v_fma_f32 v92, v92, v116, v108
    v_fma_f32 v93, v93, v117, v109
    v_fma_f32 v94, v94, v118, v110
    v_fma_f32 v95, v95, v119, v111
    v_cvt_pk_bf16_f32 v28, v88, v89
    v_cvt_pk_bf16_f32 v29, v90, v91
    v_cvt_pk_bf16_f32 v30, v92, v93
    v_cvt_pk_bf16_f32 v31, v94, v95
    ds_write_b128 v6, v[28:31] offset:384
    v_lshrrev_b32 v3, 4, v2
    v_and_b32 v4, 15, v2
    v_lshlrev_b32 v6, 9, v3
    v_lshl_add_u32 v6, v4, 4, v6
    s_waitcnt lgkmcnt(0)
    s_barrier
    ds_read_b128 v[64:67], v6 offset:0
    ds_read_b128 v[68:71], v6 offset:256
    ds_read_b128 v[72:75], v6 offset:2048
    ds_read_b128 v[76:79], v6 offset:2304
    ds_read_b128 v[80:83], v6 offset:4096
    ds_read_b128 v[84:87], v6 offset:4352
    ds_read_b128 v[88:91], v6 offset:6144
    ds_read_b128 v[92:95], v6 offset:6400
    s_waitcnt vmcnt(35) lgkmcnt(7)
    v_mfma_f32_16x16x32_bf16 v[32:35], v[128:131], v[64:67], 0
    s_waitcnt lgkmcnt(6)
    v_mfma_f32_16x16x32_bf16 v[48:51], v[128:131], v[68:71], 0
    s_mov_b32 s33, 65536
    buffer_load_dwordx4 v[128:131], v14, s[40:43], s33 offen offset:0
    s_waitcnt vmcnt(35)
    v_mfma_f32_16x16x32_bf16 v[36:39], v[132:135], v[64:67], 0
    v_mfma_f32_16x16x32_bf16 v[52:55], v[132:135], v[68:71], 0
    buffer_load_dwordx4 v[132:135], v14, s[40:43], s33 offen offset:1024
    s_waitcnt vmcnt(35)
    v_mfma_f32_16x16x32_bf16 v[40:43], v[136:139], v[64:67], 0
    v_mfma_f32_16x16x32_bf16 v[56:59], v[136:139], v[68:71], 0
    buffer_load_dwordx4 v[136:139], v14, s[40:43], s33 offen offset:2048
    s_waitcnt vmcnt(35)
    v_mfma_f32_16x16x32_bf16 v[44:47], v[140:143], v[64:67], 0
    v_mfma_f32_16x16x32_bf16 v[60:63], v[140:143], v[68:71], 0
    buffer_load_dwordx4 v[140:143], v14, s[40:43], s33 offen offset:3072
    ds_read_b128 v[64:67], v6 offset:8192
    ds_read_b128 v[68:71], v6 offset:8448
    s_waitcnt vmcnt(35) lgkmcnt(7)
    v_mfma_f32_16x16x32_bf16 v[32:35], v[144:147], v[72:75], v[32:35]
    s_waitcnt lgkmcnt(6)
    v_mfma_f32_16x16x32_bf16 v[48:51], v[144:147], v[76:79], v[48:51]
    s_mov_b32 s33, 73728
    buffer_load_dwordx4 v[144:147], v14, s[40:43], s33 offen offset:0
    s_waitcnt vmcnt(35)
    v_mfma_f32_16x16x32_bf16 v[36:39], v[148:151], v[72:75], v[36:39]
    v_mfma_f32_16x16x32_bf16 v[52:55], v[148:151], v[76:79], v[52:55]
    buffer_load_dwordx4 v[148:151], v14, s[40:43], s33 offen offset:1024
    s_waitcnt vmcnt(35)
    v_mfma_f32_16x16x32_bf16 v[40:43], v[152:155], v[72:75], v[40:43]
    v_mfma_f32_16x16x32_bf16 v[56:59], v[152:155], v[76:79], v[56:59]
    buffer_load_dwordx4 v[152:155], v14, s[40:43], s33 offen offset:2048
    s_waitcnt vmcnt(35)
    v_mfma_f32_16x16x32_bf16 v[44:47], v[156:159], v[72:75], v[44:47]
    v_mfma_f32_16x16x32_bf16 v[60:63], v[156:159], v[76:79], v[60:63]
    buffer_load_dwordx4 v[156:159], v14, s[40:43], s33 offen offset:3072
    ds_read_b128 v[72:75], v6 offset:10240
    ds_read_b128 v[76:79], v6 offset:10496
    s_waitcnt vmcnt(31) lgkmcnt(7)
    v_mfma_f32_16x16x32_bf16 v[32:35], v[160:163], v[80:83], v[32:35]
    s_waitcnt lgkmcnt(6)
    v_mfma_f32_16x16x32_bf16 v[48:51], v[160:163], v[84:87], v[48:51]
    s_mov_b32 s33, 81920
    buffer_load_dwordx4 v[160:163], v14, s[40:43], s33 offen offset:0
    s_waitcnt vmcnt(31)
    v_mfma_f32_16x16x32_bf16 v[36:39], v[164:167], v[80:83], v[36:39]
    v_mfma_f32_16x16x32_bf16 v[52:55], v[164:167], v[84:87], v[52:55]
    buffer_load_dwordx4 v[164:167], v14, s[40:43], s33 offen offset:1024
    s_waitcnt vmcnt(31)
    v_mfma_f32_16x16x32_bf16 v[40:43], v[168:171], v[80:83], v[40:43]
    v_mfma_f32_16x16x32_bf16 v[56:59], v[168:171], v[84:87], v[56:59]
    buffer_load_dwordx4 v[168:171], v14, s[40:43], s33 offen offset:2048
    s_waitcnt vmcnt(31)
    v_mfma_f32_16x16x32_bf16 v[44:47], v[172:175], v[80:83], v[44:47]
    v_mfma_f32_16x16x32_bf16 v[60:63], v[172:175], v[84:87], v[60:63]
    buffer_load_dwordx4 v[172:175], v14, s[40:43], s33 offen offset:3072
    ds_read_b128 v[80:83], v6 offset:12288
    ds_read_b128 v[84:87], v6 offset:12544
    s_waitcnt vmcnt(31) lgkmcnt(7)
    v_mfma_f32_16x16x32_bf16 v[32:35], v[176:179], v[88:91], v[32:35]
    s_waitcnt lgkmcnt(6)
    v_mfma_f32_16x16x32_bf16 v[48:51], v[176:179], v[92:95], v[48:51]
    s_mov_b32 s33, 90112
    buffer_load_dwordx4 v[176:179], v14, s[40:43], s33 offen offset:0
    s_waitcnt vmcnt(31)
    v_mfma_f32_16x16x32_bf16 v[36:39], v[180:183], v[88:91], v[36:39]
    v_mfma_f32_16x16x32_bf16 v[52:55], v[180:183], v[92:95], v[52:55]
    buffer_load_dwordx4 v[180:183], v14, s[40:43], s33 offen offset:1024
    s_waitcnt vmcnt(31)
    v_mfma_f32_16x16x32_bf16 v[40:43], v[184:187], v[88:91], v[40:43]
    v_mfma_f32_16x16x32_bf16 v[56:59], v[184:187], v[92:95], v[56:59]
    buffer_load_dwordx4 v[184:187], v14, s[40:43], s33 offen offset:2048
    s_waitcnt vmcnt(31)
    v_mfma_f32_16x16x32_bf16 v[44:47], v[188:191], v[88:91], v[44:47]
    v_mfma_f32_16x16x32_bf16 v[60:63], v[188:191], v[92:95], v[60:63]
    buffer_load_dwordx4 v[188:191], v14, s[40:43], s33 offen offset:3072
    ds_read_b128 v[88:91], v6 offset:14336
    ds_read_b128 v[92:95], v6 offset:14592
    s_waitcnt vmcnt(31) lgkmcnt(7)
    v_mfma_f32_16x16x32_bf16 v[32:35], v[192:195], v[64:67], v[32:35]
    s_waitcnt lgkmcnt(6)
    v_mfma_f32_16x16x32_bf16 v[48:51], v[192:195], v[68:71], v[48:51]
    s_mov_b32 s33, 98304
    buffer_load_dwordx4 v[192:195], v14, s[40:43], s33 offen offset:0
    s_waitcnt vmcnt(31)
    v_mfma_f32_16x16x32_bf16 v[36:39], v[196:199], v[64:67], v[36:39]
    v_mfma_f32_16x16x32_bf16 v[52:55], v[196:199], v[68:71], v[52:55]
    buffer_load_dwordx4 v[196:199], v14, s[40:43], s33 offen offset:1024
    s_waitcnt vmcnt(31)
    v_mfma_f32_16x16x32_bf16 v[40:43], v[200:203], v[64:67], v[40:43]
    v_mfma_f32_16x16x32_bf16 v[56:59], v[200:203], v[68:71], v[56:59]
    buffer_load_dwordx4 v[200:203], v14, s[40:43], s33 offen offset:2048
    s_waitcnt vmcnt(31)
    v_mfma_f32_16x16x32_bf16 v[44:47], v[204:207], v[64:67], v[44:47]
    v_mfma_f32_16x16x32_bf16 v[60:63], v[204:207], v[68:71], v[60:63]
    buffer_load_dwordx4 v[204:207], v14, s[40:43], s33 offen offset:3072
    ds_read_b128 v[64:67], v6 offset:16384
    ds_read_b128 v[68:71], v6 offset:16640
    s_waitcnt vmcnt(31) lgkmcnt(7)
    v_mfma_f32_16x16x32_bf16 v[32:35], v[208:211], v[72:75], v[32:35]
    s_waitcnt lgkmcnt(6)
    v_mfma_f32_16x16x32_bf16 v[48:51], v[208:211], v[76:79], v[48:51]
    s_mov_b32 s33, 106496
    buffer_load_dwordx4 v[208:211], v14, s[40:43], s33 offen offset:0
    s_waitcnt vmcnt(31)
    v_mfma_f32_16x16x32_bf16 v[36:39], v[212:215], v[72:75], v[36:39]
    v_mfma_f32_16x16x32_bf16 v[52:55], v[212:215], v[76:79], v[52:55]
    buffer_load_dwordx4 v[212:215], v14, s[40:43], s33 offen offset:1024
    s_waitcnt vmcnt(31)
    v_mfma_f32_16x16x32_bf16 v[40:43], v[216:219], v[72:75], v[40:43]
    v_mfma_f32_16x16x32_bf16 v[56:59], v[216:219], v[76:79], v[56:59]
    buffer_load_dwordx4 v[216:219], v14, s[40:43], s33 offen offset:2048
    s_waitcnt vmcnt(31)
    v_mfma_f32_16x16x32_bf16 v[44:47], v[220:223], v[72:75], v[44:47]
    v_mfma_f32_16x16x32_bf16 v[60:63], v[220:223], v[76:79], v[60:63]
    buffer_load_dwordx4 v[220:223], v14, s[40:43], s33 offen offset:3072
    ds_read_b128 v[72:75], v6 offset:18432
    ds_read_b128 v[76:79], v6 offset:18688
    s_waitcnt vmcnt(31) lgkmcnt(7)
    v_mfma_f32_16x16x32_bf16 v[32:35], v[224:227], v[80:83], v[32:35]
    s_waitcnt lgkmcnt(6)
    v_mfma_f32_16x16x32_bf16 v[48:51], v[224:227], v[84:87], v[48:51]
    s_waitcnt vmcnt(30)
    v_mfma_f32_16x16x32_bf16 v[36:39], v[228:231], v[80:83], v[36:39]
    v_mfma_f32_16x16x32_bf16 v[52:55], v[228:231], v[84:87], v[52:55]
    s_waitcnt vmcnt(29)
    v_mfma_f32_16x16x32_bf16 v[40:43], v[232:235], v[80:83], v[40:43]
    v_mfma_f32_16x16x32_bf16 v[56:59], v[232:235], v[84:87], v[56:59]
    s_waitcnt vmcnt(28)
    v_mfma_f32_16x16x32_bf16 v[44:47], v[236:239], v[80:83], v[44:47]
    v_mfma_f32_16x16x32_bf16 v[60:63], v[236:239], v[84:87], v[60:63]
    ds_read_b128 v[80:83], v6 offset:20480
    ds_read_b128 v[84:87], v6 offset:20736
    s_waitcnt vmcnt(27) lgkmcnt(7)
    v_mfma_f32_16x16x32_bf16 v[32:35], v[240:243], v[88:91], v[32:35]
    s_waitcnt lgkmcnt(6)
    v_mfma_f32_16x16x32_bf16 v[48:51], v[240:243], v[92:95], v[48:51]
    s_waitcnt vmcnt(26)
    v_mfma_f32_16x16x32_bf16 v[36:39], v[244:247], v[88:91], v[36:39]
    v_mfma_f32_16x16x32_bf16 v[52:55], v[244:247], v[92:95], v[52:55]
    s_waitcnt vmcnt(25)
    v_mfma_f32_16x16x32_bf16 v[40:43], v[248:251], v[88:91], v[40:43]
    v_mfma_f32_16x16x32_bf16 v[56:59], v[248:251], v[92:95], v[56:59]
    s_waitcnt vmcnt(24)
    v_mfma_f32_16x16x32_bf16 v[44:47], v[252:255], v[88:91], v[44:47]
    v_mfma_f32_16x16x32_bf16 v[60:63], v[252:255], v[92:95], v[60:63]
    ds_read_b128 v[88:91], v6 offset:22528
    ds_read_b128 v[92:95], v6 offset:22784
    s_waitcnt vmcnt(23) lgkmcnt(7)
    v_mfma_f32_16x16x32_bf16 v[32:35], v[128:131], v[64:67], v[32:35]
    s_waitcnt lgkmcnt(6)
    v_mfma_f32_16x16x32_bf16 v[48:51], v[128:131], v[68:71], v[48:51]
    s_waitcnt vmcnt(22)
    v_mfma_f32_16x16x32_bf16 v[36:39], v[132:135], v[64:67], v[36:39]
    v_mfma_f32_16x16x32_bf16 v[52:55], v[132:135], v[68:71], v[52:55]
    s_waitcnt vmcnt(21)
    v_mfma_f32_16x16x32_bf16 v[40:43], v[136:139], v[64:67], v[40:43]
    v_mfma_f32_16x16x32_bf16 v[56:59], v[136:139], v[68:71], v[56:59]
    s_waitcnt vmcnt(20)
    v_mfma_f32_16x16x32_bf16 v[44:47], v[140:143], v[64:67], v[44:47]
    v_mfma_f32_16x16x32_bf16 v[60:63], v[140:143], v[68:71], v[60:63]
    ds_read_b128 v[64:67], v6 offset:24576
    ds_read_b128 v[68:71], v6 offset:24832
    s_waitcnt vmcnt(19) lgkmcnt(7)
    v_mfma_f32_16x16x32_bf16 v[32:35], v[144:147], v[72:75], v[32:35]
    s_waitcnt lgkmcnt(6)
    v_mfma_f32_16x16x32_bf16 v[48:51], v[144:147], v[76:79], v[48:51]
    s_waitcnt vmcnt(18)
    v_mfma_f32_16x16x32_bf16 v[36:39], v[148:151], v[72:75], v[36:39]
    v_mfma_f32_16x16x32_bf16 v[52:55], v[148:151], v[76:79], v[52:55]
    s_waitcnt vmcnt(17)
    v_mfma_f32_16x16x32_bf16 v[40:43], v[152:155], v[72:75], v[40:43]
    v_mfma_f32_16x16x32_bf16 v[56:59], v[152:155], v[76:79], v[56:59]
    s_waitcnt vmcnt(16)
    v_mfma_f32_16x16x32_bf16 v[44:47], v[156:159], v[72:75], v[44:47]
    v_mfma_f32_16x16x32_bf16 v[60:63], v[156:159], v[76:79], v[60:63]
    ds_read_b128 v[72:75], v6 offset:26624
    ds_read_b128 v[76:79], v6 offset:26880
    s_waitcnt vmcnt(15) lgkmcnt(7)
    v_mfma_f32_16x16x32_bf16 v[32:35], v[160:163], v[80:83], v[32:35]
    s_waitcnt lgkmcnt(6)
    v_mfma_f32_16x16x32_bf16 v[48:51], v[160:163], v[84:87], v[48:51]
    s_waitcnt vmcnt(14)
    v_mfma_f32_16x16x32_bf16 v[36:39], v[164:167], v[80:83], v[36:39]
    v_mfma_f32_16x16x32_bf16 v[52:55], v[164:167], v[84:87], v[52:55]
    s_waitcnt vmcnt(13)
    v_mfma_f32_16x16x32_bf16 v[40:43], v[168:171], v[80:83], v[40:43]
    v_mfma_f32_16x16x32_bf16 v[56:59], v[168:171], v[84:87], v[56:59]
    s_waitcnt vmcnt(12)
    v_mfma_f32_16x16x32_bf16 v[44:47], v[172:175], v[80:83], v[44:47]
    v_mfma_f32_16x16x32_bf16 v[60:63], v[172:175], v[84:87], v[60:63]
    s_waitcnt vmcnt(11) lgkmcnt(5)
    v_mfma_f32_16x16x32_bf16 v[32:35], v[176:179], v[88:91], v[32:35]
    s_waitcnt lgkmcnt(4)
    v_mfma_f32_16x16x32_bf16 v[48:51], v[176:179], v[92:95], v[48:51]
    s_waitcnt vmcnt(10)
    v_mfma_f32_16x16x32_bf16 v[36:39], v[180:183], v[88:91], v[36:39]
    v_mfma_f32_16x16x32_bf16 v[52:55], v[180:183], v[92:95], v[52:55]
    s_waitcnt vmcnt(9)
    v_mfma_f32_16x16x32_bf16 v[40:43], v[184:187], v[88:91], v[40:43]
    v_mfma_f32_16x16x32_bf16 v[56:59], v[184:187], v[92:95], v[56:59]
    s_waitcnt vmcnt(8)
    v_mfma_f32_16x16x32_bf16 v[44:47], v[188:191], v[88:91], v[44:47]
    v_mfma_f32_16x16x32_bf16 v[60:63], v[188:191], v[92:95], v[60:63]
    s_waitcnt vmcnt(7) lgkmcnt(3)
    v_mfma_f32_16x16x32_bf16 v[32:35], v[192:195], v[64:67], v[32:35]
    s_waitcnt lgkmcnt(2)
    v_mfma_f32_16x16x32_bf16 v[48:51], v[192:195], v[68:71], v[48:51]
    s_waitcnt vmcnt(6)
    v_mfma_f32_16x16x32_bf16 v[36:39], v[196:199], v[64:67], v[36:39]
    v_mfma_f32_16x16x32_bf16 v[52:55], v[196:199], v[68:71], v[52:55]
    s_waitcnt vmcnt(5)
    v_mfma_f32_16x16x32_bf16 v[40:43], v[200:203], v[64:67], v[40:43]
    v_mfma_f32_16x16x32_bf16 v[56:59], v[200:203], v[68:71], v[56:59]
    s_waitcnt vmcnt(4)
    v_mfma_f32_16x16x32_bf16 v[44:47], v[204:207], v[64:67], v[44:47]
    v_mfma_f32_16x16x32_bf16 v[60:63], v[204:207], v[68:71], v[60:63]
    s_waitcnt vmcnt(3) lgkmcnt(1)
    v_mfma_f32_16x16x32_bf16 v[32:35], v[208:211], v[72:75], v[32:35]
    s_waitcnt lgkmcnt(0)
    v_mfma_f32_16x16x32_bf16 v[48:51], v[208:211], v[76:79], v[48:51]
    s_waitcnt vmcnt(2)
    v_mfma_f32_16x16x32_bf16 v[36:39], v[212:215], v[72:75], v[36:39]
    v_mfma_f32_16x16x32_bf16 v[52:55], v[212:215], v[76:79], v[52:55]
    s_waitcnt vmcnt(1)
    v_mfma_f32_16x16x32_bf16 v[40:43], v[216:219], v[72:75], v[40:43]
    v_mfma_f32_16x16x32_bf16 v[56:59], v[216:219], v[76:79], v[56:59]
    s_waitcnt vmcnt(0)
    v_mfma_f32_16x16x32_bf16 v[44:47], v[220:223], v[72:75], v[44:47]
    v_mfma_f32_16x16x32_bf16 v[60:63], v[220:223], v[76:79], v[60:63]
    s_mov_b32 s32, 3184710632
    v_mov_b32 v18, 3222493025
    v_mul_f32 v96, v32, v32
    v_mul_f32 v97, v33, v33
    v_mul_f32 v98, v34, v34
    v_mul_f32 v99, v35, v35
    v_mul_f32 v100, v36, v36
    v_mul_f32 v101, v37, v37
    v_mul_f32 v102, v38, v38
    v_mul_f32 v103, v39, v39
    v_mul_f32 v104, v40, v40
    v_mul_f32 v105, v41, v41
    v_mul_f32 v106, v42, v42
    v_mul_f32 v107, v43, v43
    v_mul_f32 v108, v44, v44
    v_mul_f32 v109, v45, v45
    v_mul_f32 v110, v46, v46
    v_mul_f32 v111, v47, v47
    v_fma_f32 v96, v96, s32, v18
    v_fma_f32 v97, v97, s32, v18
    v_fma_f32 v98, v98, s32, v18
    v_fma_f32 v99, v99, s32, v18
    v_fma_f32 v100, v100, s32, v18
    v_fma_f32 v101, v101, s32, v18
    v_fma_f32 v102, v102, s32, v18
    v_fma_f32 v103, v103, s32, v18
    v_fma_f32 v104, v104, s32, v18
    v_fma_f32 v105, v105, s32, v18
    v_fma_f32 v106, v106, s32, v18
    v_fma_f32 v107, v107, s32, v18
    v_fma_f32 v108, v108, s32, v18
    v_fma_f32 v109, v109, s32, v18
    v_fma_f32 v110, v110, s32, v18
    v_fma_f32 v111, v111, s32, v18
    v_mul_f32 v96, v96, v32
    v_mul_f32 v97, v97, v33
    v_mul_f32 v98, v98, v34
    v_mul_f32 v99, v99, v35
    v_mul_f32 v100, v100, v36
    v_mul_f32 v101, v101, v37
    v_mul_f32 v102, v102, v38
    v_mul_f32 v103, v103, v39
    v_mul_f32 v104, v104, v40
    v_mul_f32 v105, v105, v41
    v_mul_f32 v106, v106, v42
    v_mul_f32 v107, v107, v43
    v_mul_f32 v108, v108, v44
    v_mul_f32 v109, v109, v45
    v_mul_f32 v110, v110, v46
    v_mul_f32 v111, v111, v47
    v_exp_f32 v96, v96
    v_exp_f32 v97, v97
    v_exp_f32 v98, v98
    v_exp_f32 v99, v99
    v_exp_f32 v100, v100
    v_exp_f32 v101, v101
    v_exp_f32 v102, v102
    v_exp_f32 v103, v103
    v_exp_f32 v104, v104
    v_exp_f32 v105, v105
    v_exp_f32 v106, v106
    v_exp_f32 v107, v107
    v_exp_f32 v108, v108
    v_exp_f32 v109, v109
    v_exp_f32 v110, v110
    v_exp_f32 v111, v111
    v_add_f32 v96, 1.0, v96
    v_add_f32 v97, 1.0, v97
    v_add_f32 v98, 1.0, v98
    v_add_f32 v99, 1.0, v99
    v_add_f32 v100, 1.0, v100
    v_add_f32 v101, 1.0, v101
    v_add_f32 v102, 1.0, v102
    v_add_f32 v103, 1.0, v103
    v_add_f32 v104, 1.0, v104
    v_add_f32 v105, 1.0, v105
    v_add_f32 v106, 1.0, v106
    v_add_f32 v107, 1.0, v107
    v_add_f32 v108, 1.0, v108
    v_add_f32 v109, 1.0, v109
    v_add_f32 v110, 1.0, v110
    v_add_f32 v111, 1.0, v111
    v_rcp_f32 v96, v96
    v_rcp_f32 v97, v97
    v_rcp_f32 v98, v98
    v_rcp_f32 v99, v99
    v_rcp_f32 v100, v100
    v_rcp_f32 v101, v101
    v_rcp_f32 v102, v102
    v_rcp_f32 v103, v103
    v_rcp_f32 v104, v104
    v_rcp_f32 v105, v105
    v_rcp_f32 v106, v106
    v_rcp_f32 v107, v107
    v_rcp_f32 v108, v108
    v_rcp_f32 v109, v109
    v_rcp_f32 v110, v110
    v_rcp_f32 v111, v111
    v_mul_f32 v64, v96, v32
    v_mul_f32 v68, v97, v33
    v_mul_f32 v72, v98, v34
    v_mul_f32 v76, v99, v35
    v_mul_f32 v65, v100, v36
    v_mul_f32 v69, v101, v37
    v_mul_f32 v73, v102, v38
    v_mul_f32 v77, v103, v39
    v_mul_f32 v66, v104, v40
    v_mul_f32 v70, v105, v41
    v_mul_f32 v74, v106, v42
    v_mul_f32 v78, v107, v43
    v_mul_f32 v67, v108, v44
    v_mul_f32 v71, v109, v45
    v_mul_f32 v75, v110, v46
    v_mul_f32 v79, v111, v47
    v_mul_f32 v112, v48, v48
    v_mul_f32 v113, v49, v49
    v_mul_f32 v114, v50, v50
    v_mul_f32 v115, v51, v51
    v_mul_f32 v116, v52, v52
    v_mul_f32 v117, v53, v53
    v_mul_f32 v118, v54, v54
    v_mul_f32 v119, v55, v55
    v_mul_f32 v120, v56, v56
    v_mul_f32 v121, v57, v57
    v_mul_f32 v122, v58, v58
    v_mul_f32 v123, v59, v59
    v_mul_f32 v124, v60, v60
    v_mul_f32 v125, v61, v61
    v_mul_f32 v126, v62, v62
    v_mul_f32 v127, v63, v63
    v_fma_f32 v112, v112, s32, v18
    v_fma_f32 v113, v113, s32, v18
    v_fma_f32 v114, v114, s32, v18
    v_fma_f32 v115, v115, s32, v18
    v_fma_f32 v116, v116, s32, v18
    v_fma_f32 v117, v117, s32, v18
    v_fma_f32 v118, v118, s32, v18
    v_fma_f32 v119, v119, s32, v18
    v_fma_f32 v120, v120, s32, v18
    v_fma_f32 v121, v121, s32, v18
    v_fma_f32 v122, v122, s32, v18
    v_fma_f32 v123, v123, s32, v18
    v_fma_f32 v124, v124, s32, v18
    v_fma_f32 v125, v125, s32, v18
    v_fma_f32 v126, v126, s32, v18
    v_fma_f32 v127, v127, s32, v18
    v_mul_f32 v112, v112, v48
    v_mul_f32 v113, v113, v49
    v_mul_f32 v114, v114, v50
    v_mul_f32 v115, v115, v51
    v_mul_f32 v116, v116, v52
    v_mul_f32 v117, v117, v53
    v_mul_f32 v118, v118, v54
    v_mul_f32 v119, v119, v55
    v_mul_f32 v120, v120, v56
    v_mul_f32 v121, v121, v57
    v_mul_f32 v122, v122, v58
    v_mul_f32 v123, v123, v59
    v_mul_f32 v124, v124, v60
    v_mul_f32 v125, v125, v61
    v_mul_f32 v126, v126, v62
    v_mul_f32 v127, v127, v63
    v_exp_f32 v112, v112
    v_exp_f32 v113, v113
    v_exp_f32 v114, v114
    v_exp_f32 v115, v115
    v_exp_f32 v116, v116
    v_exp_f32 v117, v117
    v_exp_f32 v118, v118
    v_exp_f32 v119, v119
    v_exp_f32 v120, v120
    v_exp_f32 v121, v121
    v_exp_f32 v122, v122
    v_exp_f32 v123, v123
    v_exp_f32 v124, v124
    v_exp_f32 v125, v125
    v_exp_f32 v126, v126
    v_exp_f32 v127, v127
    v_add_f32 v112, 1.0, v112
    v_add_f32 v113, 1.0, v113
    v_add_f32 v114, 1.0, v114
    v_add_f32 v115, 1.0, v115
    v_add_f32 v116, 1.0, v116
    v_add_f32 v117, 1.0, v117
    v_add_f32 v118, 1.0, v118
    v_add_f32 v119, 1.0, v119
    v_add_f32 v120, 1.0, v120
    v_add_f32 v121, 1.0, v121
    v_add_f32 v122, 1.0, v122
    v_add_f32 v123, 1.0, v123
    v_add_f32 v124, 1.0, v124
    v_add_f32 v125, 1.0, v125
    v_add_f32 v126, 1.0, v126
    v_add_f32 v127, 1.0, v127
    v_rcp_f32 v112, v112
    v_rcp_f32 v113, v113
    v_rcp_f32 v114, v114
    v_rcp_f32 v115, v115
    v_rcp_f32 v116, v116
    v_rcp_f32 v117, v117
    v_rcp_f32 v118, v118
    v_rcp_f32 v119, v119
    v_rcp_f32 v120, v120
    v_rcp_f32 v121, v121
    v_rcp_f32 v122, v122
    v_rcp_f32 v123, v123
    v_rcp_f32 v124, v124
    v_rcp_f32 v125, v125
    v_rcp_f32 v126, v126
    v_rcp_f32 v127, v127
    v_mul_f32 v80, v112, v48
    v_mul_f32 v84, v113, v49
    v_mul_f32 v88, v114, v50
    v_mul_f32 v92, v115, v51
    v_mul_f32 v81, v116, v52
    v_mul_f32 v85, v117, v53
    v_mul_f32 v89, v118, v54
    v_mul_f32 v93, v119, v55
    v_mul_f32 v82, v120, v56
    v_mul_f32 v86, v121, v57
    v_mul_f32 v90, v122, v58
    v_mul_f32 v94, v123, v59
    v_mul_f32 v83, v124, v60
    v_mul_f32 v87, v125, v61
    v_mul_f32 v91, v126, v62
    v_mul_f32 v95, v127, v63
    s_cmp_lt_u32 s22, 2
    s_cbranch_scc0 Lcd_z2
    s_mul_i32 s29, s20, 57344
    s_lshl_b32 s34, s27, 12
    s_add_u32 s29, s29, s34
    s_add_u32 s29, s29, 8388608
    s_add_u32 s8, s6, s29
    s_addc_u32 s9, s7, 0
    s_mov_b32 s10, 4096
    s_mov_b32 s11, 0x20000
    v_cvt_pk_bf16_f32 v128, v64, v65
    v_cvt_pk_bf16_f32 v129, v66, v67
    v_cvt_pk_bf16_f32 v130, v68, v69
    v_cvt_pk_bf16_f32 v131, v70, v71
    buffer_store_dwordx4 v[128:131], v6, s[8:11], 0 offen offset:0 sc1
    v_cvt_pk_bf16_f32 v132, v72, v73
    v_cvt_pk_bf16_f32 v133, v74, v75
    v_cvt_pk_bf16_f32 v134, v76, v77
    v_cvt_pk_bf16_f32 v135, v78, v79
    buffer_store_dwordx4 v[132:135], v6, s[8:11], 0 offen offset:2048 sc1
    v_cvt_pk_bf16_f32 v136, v80, v81
    v_cvt_pk_bf16_f32 v137, v82, v83
    v_cvt_pk_bf16_f32 v138, v84, v85
    v_cvt_pk_bf16_f32 v139, v86, v87
    buffer_store_dwordx4 v[136:139], v6, s[8:11], 0 offen offset:256 sc1
    v_cvt_pk_bf16_f32 v140, v88, v89
    v_cvt_pk_bf16_f32 v141, v90, v91
    v_cvt_pk_bf16_f32 v142, v92, v93
    v_cvt_pk_bf16_f32 v143, v94, v95
    buffer_store_dwordx4 v[140:143], v6, s[8:11], 0 offen offset:2304 sc1
    s_add_u32 s8, s8, 8388608
    s_addc_u32 s9, s9, 0
    v_mov_b32 v144, -1
    v_mov_b32 v145, -1
    v_mov_b32 v146, -1
    v_mov_b32 v147, -1
    buffer_store_dwordx4 v[144:147], v14, s[8:11], 0 offen offset:0 sc1
    buffer_store_dwordx4 v[144:147], v14, s[8:11], 0 offen offset:1024 sc1
    buffer_store_dwordx4 v[144:147], v14, s[8:11], 0 offen offset:2048 sc1
    buffer_store_dwordx4 v[144:147], v14, s[8:11], 0 offen offset:3072 sc1
    s_lshl_b32 s29, s20, 1
    s_add_u32 s29, s29, s22
    s_lshl_b32 s29, s29, 16
    s_mul_i32 s30, s3, 10240
    s_add_u32 s40, s36, s29
    s_addc_u32 s41, s37, 0
    s_mov_b32 s42, 65536
    s_mov_b32 s43, 0x20000
    buffer_load_dwordx4 v[252:255], v14, s[40:43], s30 offen offset:0
    buffer_load_dwordx4 v[252:255], v14, s[40:43], s30 offen offset:1024
    buffer_load_dwordx4 v[252:255], v14, s[40:43], s30 offen offset:2048
    buffer_load_dwordx4 v[252:255], v14, s[40:43], s30 offen offset:3072
    s_add_u32 s30, s30, 4096
    buffer_load_dwordx4 v[252:255], v14, s[40:43], s30 offen offset:0
    buffer_load_dwordx4 v[252:255], v14, s[40:43], s30 offen offset:1024
    buffer_load_dwordx4 v[252:255], v14, s[40:43], s30 offen offset:2048
    buffer_load_dwordx4 v[252:255], v14, s[40:43], s30 offen offset:3072
    s_add_u32 s30, s30, 4096
    buffer_load_dwordx4 v[252:255], v14, s[40:43], s30 offen offset:0
    buffer_load_dwordx4 v[252:255], v14, s[40:43], s30 offen offset:1024
Lcd_z2ret:
Lcd_done:
    s_endpgm
Lcd_z2:
    v_add_f32 v32, v64, v65
    v_mul_f32 v33, v64, v64
    v_fmac_f32 v33, v65, v65
    v_add_f32 v32, v32, v66
    v_fmac_f32 v33, v66, v66
    v_add_f32 v32, v32, v67
    v_fmac_f32 v33, v67, v67
    v_add_f32 v32, v32, v68
    v_fmac_f32 v33, v68, v68
    v_add_f32 v32, v32, v69
    v_fmac_f32 v33, v69, v69
    v_add_f32 v32, v32, v70
    v_fmac_f32 v33, v70, v70
    v_add_f32 v32, v32, v71
    v_fmac_f32 v33, v71, v71
    v_add_f32 v32, v32, v72
    v_fmac_f32 v33, v72, v72
    v_add_f32 v32, v32, v73
    v_fmac_f32 v33, v73, v73
    v_add_f32 v32, v32, v74
    v_fmac_f32 v33, v74, v74
    v_add_f32 v32, v32, v75
    v_fmac_f32 v33, v75, v75
    v_add_f32 v32, v32, v76
    v_fmac_f32 v33, v76, v76
    v_add_f32 v32, v32, v77
    v_fmac_f32 v33, v77, v77
    v_add_f32 v32, v32, v78
    v_fmac_f32 v33, v78, v78
    v_add_f32 v32, v32, v79
    v_fmac_f32 v33, v79, v79
    v_add_f32 v34, v80, v81
    v_mul_f32 v35, v80, v80
    v_fmac_f32 v35, v81, v81
    v_add_f32 v34, v34, v82
    v_fmac_f32 v35, v82, v82
    v_add_f32 v34, v34, v83
    v_fmac_f32 v35, v83, v83
    v_add_f32 v34, v34, v84
    v_fmac_f32 v35, v84, v84
    v_add_f32 v34, v34, v85
    v_fmac_f32 v35, v85, v85
    v_add_f32 v34, v34, v86
    v_fmac_f32 v35, v86, v86
    v_add_f32 v34, v34, v87
    v_fmac_f32 v35, v87, v87
    v_add_f32 v34, v34, v88
    v_fmac_f32 v35, v88, v88
    v_add_f32 v34, v34, v89
    v_fmac_f32 v35, v89, v89
    v_add_f32 v34, v34, v90
    v_fmac_f32 v35, v90, v90
    v_add_f32 v34, v34, v91
    v_fmac_f32 v35, v91, v91
    v_add_f32 v34, v34, v92
    v_fmac_f32 v35, v92, v92
    v_add_f32 v34, v34, v93
    v_fmac_f32 v35, v93, v93
    v_add_f32 v34, v34, v94
    v_fmac_f32 v35, v94, v94
    v_add_f32 v34, v34, v95
    v_fmac_f32 v35, v95, v95
    v_mov_b32 v36, v32
    v_mov_b32 v37, v33
    v_mov_b32 v38, v34
    v_mov_b32 v39, v35
    v_permlane16_swap_b32 v32, v36
    v_permlane16_swap_b32 v33, v37
    v_permlane16_swap_b32 v34, v38
    v_permlane16_swap_b32 v35, v39
    v_add_f32 v32, v32, v36
    v_add_f32 v33, v33, v37
    v_add_f32 v34, v34, v38
    v_add_f32 v35, v35, v39
    v_mov_b32 v36, v32
    v_mov_b32 v37, v33
    v_mov_b32 v38, v34
    v_mov_b32 v39, v35
    v_permlane32_swap_b32 v32, v36
    v_permlane32_swap_b32 v33, v37
    v_permlane32_swap_b32 v34, v38
    v_permlane32_swap_b32 v35, v39
    v_add_f32 v32, v32, v36
    v_add_f32 v33, v33, v37
    v_add_f32 v34, v34, v38
    v_add_f32 v35, v35, v39
    v_lshlrev_b32 v10, 4, v4
    v_lshl_add_u32 v9, v1, 8, v10
    ds_write_b128 v9, v[32:35] offset:30720
    s_lshl_b32 s29, s20, 9
    s_add_u32 s29, s29, 32768
    s_and_b32 s34, s22, 1
    s_lshl_b32 s34, s34, 8
    s_xor_b32 s35, s34, 256
    s_add_u32 s12, s6, s29
    s_addc_u32 s13, s7, 0
    s_mov_b32 s14, 512
    s_mov_b32 s15, 0x20000
    v_lshlrev_b32 v6, 6, v4
    v_lshl_add_u32 v6, v3, 4, v6
    s_sub_u32 s29, s27, 14
    s_lshl_b32 s29, s29, 18
    s_lshl_b32 s38, s20, 11
    s_add_u32 s29, s29, s38
    s_add_u32 s29, s29, 25165824
    s_add_u32 s8, s6, s29
    s_addc_u32 s9, s7, 0
    s_mov_b32 s10, 133120
    s_mov_b32 s11, 0x20000
    s_waitcnt lgkmcnt(0)
    s_barrier
    ds_read_b128 v[96:99], v10 offset:30720
    ds_read_b128 v[100:103], v10 offset:30976
    ds_read_b128 v[104:107], v10 offset:31232
    ds_read_b128 v[108:111], v10 offset:31488
    ds_read_b128 v[112:115], v10 offset:31744
    ds_read_b128 v[116:119], v10 offset:32000
    ds_read_b128 v[120:123], v10 offset:32256
    s_waitcnt lgkmcnt(5)
    v_add_f32 v96, v96, v100
    v_add_f32 v97, v97, v101
    v_add_f32 v98, v98, v102
    v_add_f32 v99, v99, v103
    s_waitcnt lgkmcnt(4)
    v_add_f32 v96, v96, v104
    v_add_f32 v97, v97, v105
    v_add_f32 v98, v98, v106
    v_add_f32 v99, v99, v107
    s_waitcnt lgkmcnt(3)
    v_add_f32 v96, v96, v108
    v_add_f32 v97, v97, v109
    v_add_f32 v98, v98, v110
    v_add_f32 v99, v99, v111
    s_waitcnt lgkmcnt(2)
    v_add_f32 v96, v96, v112
    v_add_f32 v97, v97, v113
    v_add_f32 v98, v98, v114
    v_add_f32 v99, v99, v115
    s_waitcnt lgkmcnt(1)
    v_add_f32 v96, v96, v116
    v_add_f32 v97, v97, v117
    v_add_f32 v98, v98, v118
    v_add_f32 v99, v99, v119
    s_waitcnt lgkmcnt(0)
    v_add_f32 v96, v96, v120
    v_add_f32 v97, v97, v121
    v_add_f32 v98, v98, v122
    v_add_f32 v99, v99, v123
    s_cmp_lg_u32 s3, 0
    s_cbranch_scc1 Lcd_nopub
    buffer_store_dwordx4 v[96:99], v10, s[12:15], s34 offen sc1
Lcd_nopub:
    s_mov_b32 s38, 0x20000
Lcd_poll:
    buffer_load_dwordx4 v[100:103], v10, s[12:15], s35 offen sc1
    s_sub_u32 s38, s38, 1
    s_waitcnt vmcnt(0)
    v_or_b32 v104, v101, v103
    v_cmp_gt_i32 vcc, 0, v104
    s_cmp_eq_u32 s38, 0
    s_cbranch_scc1 Lcd_polled
    s_cbranch_vccnz Lcd_poll
Lcd_polled:
    v_add_f32 v96, v96, v100
    v_add_f32 v97, v97, v101
    v_add_f32 v98, v98, v102
    v_add_f32 v99, v99, v103
    v_mul_f32 v96, 982665509, v96
    v_mul_f32 v97, 982665509, v97
    v_fma_f32 v97, -v96, v96, v97
    v_max_f32 v97, 0, v97
    v_add_f32 v97, 925353388, v97
    v_rsq_f32 v97, v97
    v_mul_f32 v98, 982665509, v98
    v_mul_f32 v99, 982665509, v99
    v_fma_f32 v99, -v98, v98, v99
    v_max_f32 v99, 0, v99
    v_add_f32 v99, 925353388, v99
    v_rsq_f32 v99, v99
    s_mov_b32 s38, 131072
    v_mul_f32 v96, -v96, v97
    v_fma_f32 v64, v64, v97, v96
    v_fma_f32 v65, v65, v97, v96
    v_fma_f32 v66, v66, v97, v96
    v_fma_f32 v67, v67, v97, v96
    v_fma_f32 v68, v68, v97, v96
    v_fma_f32 v69, v69, v97, v96
    v_fma_f32 v70, v70, v97, v96
    v_fma_f32 v71, v71, v97, v96
    v_cvt_pk_bf16_f32 v128, v64, v65
    v_cvt_pk_bf16_f32 v129, v66, v67
    v_cvt_pk_bf16_f32 v130, v68, v69
    v_cvt_pk_bf16_f32 v131, v70, v71
    buffer_store_dwordx4 v[128:131], v6, s[8:11], 0 offen offset:0 sc1
    v_fma_f32 v72, v72, v97, v96
    v_fma_f32 v73, v73, v97, v96
    v_fma_f32 v74, v74, v97, v96
    v_fma_f32 v75, v75, v97, v96
    v_fma_f32 v76, v76, v97, v96
    v_fma_f32 v77, v77, v97, v96
    v_fma_f32 v78, v78, v97, v96
    v_fma_f32 v79, v79, v97, v96
    v_cvt_pk_bf16_f32 v132, v72, v73
    v_cvt_pk_bf16_f32 v133, v74, v75
    v_cvt_pk_bf16_f32 v134, v76, v77
    v_cvt_pk_bf16_f32 v135, v78, v79
    buffer_store_dwordx4 v[132:135], v6, s[8:11], s38 offen offset:0 sc1
    v_mul_f32 v98, -v98, v99
    v_fma_f32 v80, v80, v99, v98
    v_fma_f32 v81, v81, v99, v98
    v_fma_f32 v82, v82, v99, v98
    v_fma_f32 v83, v83, v99, v98
    v_fma_f32 v84, v84, v99, v98
    v_fma_f32 v85, v85, v99, v98
    v_fma_f32 v86, v86, v99, v98
    v_fma_f32 v87, v87, v99, v98
    v_cvt_pk_bf16_f32 v136, v80, v81
    v_cvt_pk_bf16_f32 v137, v82, v83
    v_cvt_pk_bf16_f32 v138, v84, v85
    v_cvt_pk_bf16_f32 v139, v86, v87
    buffer_store_dwordx4 v[136:139], v6, s[8:11], 0 offen offset:1024 sc1
    v_fma_f32 v88, v88, v99, v98
    v_fma_f32 v89, v89, v99, v98
    v_fma_f32 v90, v90, v99, v98
    v_fma_f32 v91, v91, v99, v98
    v_fma_f32 v92, v92, v99, v98
    v_fma_f32 v93, v93, v99, v98
    v_fma_f32 v94, v94, v99, v98
    v_fma_f32 v95, v95, v99, v98
    v_cvt_pk_bf16_f32 v140, v88, v89
    v_cvt_pk_bf16_f32 v141, v90, v91
    v_cvt_pk_bf16_f32 v142, v92, v93
    v_cvt_pk_bf16_f32 v143, v94, v95
    buffer_store_dwordx4 v[140:143], v6, s[8:11], s38 offen offset:1024 sc1
    s_branch Lcd_z2ret

.text
.globl ef_kernel
.p2align 8
.type ef_kernel,@function
ef_kernel:
    s_cmp_ge_u32 s2, 224
    s_cbranch_scc1 Lef_done
    s_load_dwordx4 s[4:7], s[0:1], 56
    s_load_dwordx2 s[36:37], s[0:1], 112
    s_load_dwordx2 s[48:49], s[0:1], 72
    s_load_dwordx2 s[50:51], s[0:1], 96
    v_lshrrev_b32 v1, 6, v0
    v_and_b32 v2, 63, v0
    v_readfirstlane_b32 s3, v1
    v_lshlrev_b32 v15, 4, v2
    v_lshrrev_b32 v3, 5, v2
    v_bfe_u32 v5, v2, 2, 2
    v_and_b32 v6, 3, v2
    v_bfe_u32 v7, v2, 4, 1
    v_and_b32 v12, 1, v6
    v_lshlrev_b32 v14, 5, v7
    v_lshl_add_u32 v14, v12, 4, v14
    v_lshrrev_b32 v12, 1, v6
    v_lshl_add_u32 v14, v12, 3, v14
    s_and_b32 s20, s2, 7
    s_lshl_b32 s20, s20, 2
    s_lshr_b32 s21, s2, 3
    s_and_b32 s22, s21, 3
    s_add_u32 s20, s20, s22
    s_lshr_b32 s21, s2, 5
    s_lshl_b32 s22, s21, 2
    s_add_u32 s22, s22, s3
    s_lshl_b32 s22, s22, 17
    s_add_u32 s22, s22, 25165824
    s_lshl_b32 s23, s20, 18
    v_lshrrev_b32 v8, 3, v2
    v_lshrrev_b32 v9, 1, v8
    v_and_b32 v10, 7, v2
    v_xor_b32 v9, v9, v10
    v_lshl_add_u32 v8, v1, 4, v8
    v_lshlrev_b32 v8, 12, v8
    v_lshl_add_u32 v16, v9, 4, v8
    v_xor_b32 v9, 4, v9
    v_lshl_add_u32 v17, v9, 4, v8
    v_add_u32 v17, 31744, v17
    s_lshl_b32 s24, s3, 12
    s_lshl_b32 s25, s3, 11
    s_add_u32 s25, s25, 16384
    s_and_b32 s26, s3, 1
    s_lshr_b32 s27, s3, 1
    s_waitcnt lgkmcnt(0)
    s_add_u32 s8, s36, s22
    s_addc_u32 s9, s37, 0
    s_mov_b32 s10, 131072
    s_mov_b32 s11, 0x20000
    s_add_u32 s12, s4, s23
    s_addc_u32 s13, s5, 0
    s_mov_b32 s14, 262144
    s_mov_b32 s15, 0x20000
    s_add_u32 m0, s24, 0
    s_mov_b32 s30, 0
    buffer_load_dwordx4 v15, s[8:11], s30 offen offset:0 lds
    buffer_load_dwordx4 v15, s[8:11], s30 offen offset:1024 lds
    buffer_load_dwordx4 v15, s[8:11], s30 offen offset:2048 lds
    buffer_load_dwordx4 v15, s[8:11], s30 offen offset:3072 lds
    s_add_u32 m0, s25, 0
    s_movk_i32 s31, 0
    buffer_load_dwordx4 v16, s[12:15], s31 offen lds
    buffer_load_dwordx4 v17, s[12:15], s31 offen offset:1024 lds
    s_add_u32 m0, s24, 24576
    s_mov_b32 s30, 4096
    buffer_load_dwordx4 v15, s[8:11], s30 offen offset:0 lds
    buffer_load_dwordx4 v15, s[8:11], s30 offen offset:1024 lds
    buffer_load_dwordx4 v15, s[8:11], s30 offen offset:2048 lds
    buffer_load_dwordx4 v15, s[8:11], s30 offen offset:3072 lds
    s_add_u32 m0, s25, 24576
    s_movk_i32 s31, 128
    buffer_load_dwordx4 v16, s[12:15], s31 offen lds
    buffer_load_dwordx4 v17, s[12:15], s31 offen offset:1024 lds
    s_add_u32 m0, s24, 49152
    s_mov_b32 s30, 8192
    buffer_load_dwordx4 v15, s[8:11], s30 offen offset:0 lds
    buffer_load_dwordx4 v15, s[8:11], s30 offen offset:1024 lds
    buffer_load_dwordx4 v15, s[8:11], s30 offen offset:2048 lds
    buffer_load_dwordx4 v15, s[8:11], s30 offen offset:3072 lds
    s_add_u32 m0, s25, 49152
    s_movk_i32 s31, 256
    buffer_load_dwordx4 v16, s[12:15], s31 offen lds
    buffer_load_dwordx4 v17, s[12:15], s31 offen offset:1024 lds
    s_add_u32 m0, s24, 73728
    s_mov_b32 s30, 12288
    buffer_load_dwordx4 v15, s[8:11], s30 offen offset:0 lds
    buffer_load_dwordx4 v15, s[8:11], s30 offen offset:1024 lds
    buffer_load_dwordx4 v15, s[8:11], s30 offen offset:2048 lds
    buffer_load_dwordx4 v15, s[8:11], s30 offen offset:3072 lds
    s_add_u32 m0, s25, 73728
    s_movk_i32 s31, 384
    buffer_load_dwordx4 v16, s[12:15], s31 offen lds
    buffer_load_dwordx4 v17, s[12:15], s31 offen offset:1024 lds
    v_lshl_add_u32 v9, v3, 3, v5
    v_lshl_add_u32 v18, v9, 6, v14
    s_lshl_b32 s28, s26, 13
    v_add_u32 v18, s28, v18
    v_add_u32 v19, 73728, v18
    v_and_b32 v9, 31, v2
    v_bfe_u32 v10, v2, 1, 3
    v_xor_b32 v10, v10, v3
    v_lshlrev_b32 v9, 7, v9
    v_lshl_add_u32 v20, v10, 4, v9
    s_lshl_b32 s28, s27, 12
    v_xor_b32 v20, s28, v20
    v_add_u32 v20, 16384, v20
    v_xor_b32 v21, 32, v20
    v_xor_b32 v22, 64, v20
    v_xor_b32 v23, 96, v20
    v_add_u32 v24, 73728, v20
    v_add_u32 v25, 73728, v21
    v_add_u32 v26, 73728, v22
    v_add_u32 v27, 73728, v23
    s_lshl_b32 s32, s20, 1
    s_add_u32 s32, s32, s27
    s_mul_i32 s33, s32, 57344
    s_lshl_b32 s34, s21, 13
    s_add_u32 s33, s33, s34
    s_lshl_b32 s34, s26, 12
    s_add_u32 s33, s33, s34
    s_add_u32 s34, s33, 8388608
    s_add_u32 s35, s33, 16777216
    v_and_b32 v9, 31, v2
    v_lshlrev_b32 v9, 1, v9
    s_lshl_b32 s32, s32, 6
    s_add_u32 s16, s36, s34
    s_addc_u32 s17, s37, 0
    s_mov_b32 s18, 4096
    s_mov_b32 s19, 0x20000
    s_add_u32 s40, s36, s35
    s_addc_u32 s41, s37, 0
    s_mov_b32 s42, 4096
    s_mov_b32 s43, 0x20000
    s_mov_b32 s44, s6
    s_mov_b32 s45, s7
    s_mov_b32 s46, 4096
    s_mov_b32 s47, 0x20000
    v_bfe_u32 v29, v2, 4, 1
    v_lshl_add_u32 v29, v29, 3, v5
    s_lshl_b32 s38, s26, 5
    s_lshl_b32 s39, s27, 6
    s_add_u32 s38, s38, s39
    v_add_u32 v29, s38, v29
    s_movk_i32 s38, 896
    v_mul_lo_u32 v29, v29, s38
    v_lshl_add_u32 v29, v3, 6, v29
    v_lshl_add_u32 v29, v6, 4, v29
    s_lshl_b32 s38, s21, 7
    v_add_u32 v29, s38, v29
    s_lshl_b32 s39, s3, 10
    s_add_u32 s39, s39, 49152
    s_mov_b32 s52, s48
    s_mov_b32 s53, s49
    s_mov_b32 s54, 802816
    s_mov_b32 s55, 0x20000
    s_waitcnt vmcnt(18)
    s_barrier
    ds_read_b128 v[160:163], v20 offset:0
    ds_read_b64_tr_b16 v[96:97], v18 offset:0
    ds_read_b64_tr_b16 v[98:99], v18 offset:256
    ds_read_b64_tr_b16 v[100:101], v18 offset:4096
    ds_read_b64_tr_b16 v[102:103], v18 offset:4352
    ds_read_b128 v[164:167], v21 offset:0
    ds_read_b64_tr_b16 v[104:105], v18 offset:1024
    ds_read_b64_tr_b16 v[106:107], v18 offset:1280
    ds_read_b64_tr_b16 v[108:109], v18 offset:5120
    ds_read_b64_tr_b16 v[110:111], v18 offset:5376
    ds_read_b128 v[168:171], v22 offset:0
    ds_read_b64_tr_b16 v[112:113], v18 offset:2048
    ds_read_b64_tr_b16 v[114:115], v18 offset:2304
    ds_read_b64_tr_b16 v[116:117], v18 offset:6144
    ds_read_b64_tr_b16 v[118:119], v18 offset:6400
    ds_read_b128 v[172:175], v23 offset:0
    ds_read_b64_tr_b16 v[120:121], v18 offset:3072
    ds_read_b64_tr_b16 v[122:123], v18 offset:3328
    ds_read_b64_tr_b16 v[124:125], v18 offset:7168
    ds_read_b64_tr_b16 v[126:127], v18 offset:7424
    s_waitcnt lgkmcnt(15)
    v_mfma_f32_32x32x16_bf16 v[64:79], v[96:99], v[160:163], 0
    s_add_u32 m0, s24, 98304
    s_mov_b32 s30, 16384
    buffer_load_dwordx4 v15, s[8:11], s30 offen offset:0 lds
    buffer_load_dwordx4 v15, s[8:11], s30 offen offset:1024 lds
    buffer_load_dwordx4 v15, s[8:11], s30 offen offset:2048 lds
    buffer_load_dwordx4 v15, s[8:11], s30 offen offset:3072 lds
    s_add_u32 m0, s25, 98304
    s_movk_i32 s31, 512
    buffer_load_dwordx4 v16, s[12:15], s31 offen lds
    buffer_load_dwordx4 v17, s[12:15], s31 offen offset:1024 lds
    s_waitcnt vmcnt(18)
    s_barrier
    ds_read_b128 v[176:179], v20 offset:24576
    ds_read_b64_tr_b16 v[128:129], v18 offset:24576
    ds_read_b64_tr_b16 v[130:131], v18 offset:24832
    s_add_u32 m0, s24, 122880
    s_mov_b32 s30, 20480
    buffer_load_dwordx4 v15, s[8:11], s30 offen offset:0 lds
    v_mfma_f32_32x32x16_bf16 v[80:95], v[100:103], v[160:163], 0
    ds_read_b64_tr_b16 v[132:133], v18 offset:28672
    ds_read_b64_tr_b16 v[134:135], v18 offset:28928
    ds_read_b128 v[180:183], v21 offset:24576
    buffer_load_dwordx4 v15, s[8:11], s30 offen offset:1024 lds
    s_waitcnt lgkmcnt(15)
    v_mfma_f32_32x32x16_bf16 v[64:79], v[104:107], v[164:167], v[64:79]
    ds_read_b64_tr_b16 v[136:137], v18 offset:25600
    ds_read_b64_tr_b16 v[138:139], v18 offset:25856
    ds_read_b64_tr_b16 v[140:141], v18 offset:29696
    buffer_load_dwordx4 v15, s[8:11], s30 offen offset:2048 lds
    v_mfma_f32_32x32x16_bf16 v[80:95], v[108:111], v[164:167], v[80:95]
    ds_read_b64_tr_b16 v[142:143], v18 offset:29952
    buffer_load_dwordx4 v15, s[8:11], s30 offen offset:3072 lds
    s_waitcnt lgkmcnt(15)
    v_mfma_f32_32x32x16_bf16 v[64:79], v[112:115], v[168:171], v[64:79]
    ds_read_b128 v[184:187], v22 offset:24576
    ds_read_b64_tr_b16 v[144:145], v18 offset:26624
    ds_read_b64_tr_b16 v[146:147], v18 offset:26880
    s_add_u32 m0, s25, 122880
    s_movk_i32 s31, 640
    buffer_load_dwordx4 v16, s[12:15], s31 offen lds
    v_mfma_f32_32x32x16_bf16 v[80:95], v[116:119], v[168:171], v[80:95]
    ds_read_b64_tr_b16 v[148:149], v18 offset:30720
    ds_read_b64_tr_b16 v[150:151], v18 offset:30976
    ds_read_b128 v[188:191], v23 offset:24576
    buffer_load_dwordx4 v17, s[12:15], s31 offen offset:1024 lds
    s_waitcnt lgkmcnt(15)
    v_mfma_f32_32x32x16_bf16 v[64:79], v[120:123], v[172:175], v[64:79]
    ds_read_b64_tr_b16 v[152:153], v18 offset:27648
    ds_read_b64_tr_b16 v[154:155], v18 offset:27904
    ds_read_b64_tr_b16 v[156:157], v18 offset:31744
    v_mfma_f32_32x32x16_bf16 v[80:95], v[124:127], v[172:175], v[80:95]
    ds_read_b64_tr_b16 v[158:159], v18 offset:32000
    s_waitcnt lgkmcnt(15)
    v_mfma_f32_32x32x16_bf16 v[64:79], v[128:131], v[176:179], v[64:79]
    s_waitcnt vmcnt(18)
    s_barrier
    ds_read_b128 v[160:163], v20 offset:49152
    ds_read_b64_tr_b16 v[96:97], v18 offset:49152
    ds_read_b64_tr_b16 v[98:99], v18 offset:49408
    s_add_u32 m0, s24, 0
    s_mov_b32 s30, 24576
    buffer_load_dwordx4 v15, s[8:11], s30 offen offset:0 lds
    v_mfma_f32_32x32x16_bf16 v[80:95], v[132:135], v[176:179], v[80:95]
    ds_read_b64_tr_b16 v[100:101], v18 offset:53248
    ds_read_b64_tr_b16 v[102:103], v18 offset:53504
    ds_read_b128 v[164:167], v21 offset:49152
    buffer_load_dwordx4 v15, s[8:11], s30 offen offset:1024 lds
    s_waitcnt lgkmcnt(15)
    v_mfma_f32_32x32x16_bf16 v[64:79], v[136:139], v[180:183], v[64:79]
    ds_read_b64_tr_b16 v[104:105], v18 offset:50176
    ds_read_b64_tr_b16 v[106:107], v18 offset:50432
    ds_read_b64_tr_b16 v[108:109], v18 offset:54272
    buffer_load_dwordx4 v15, s[8:11], s30 offen offset:2048 lds
    v_mfma_f32_32x32x16_bf16 v[80:95], v[140:143], v[180:183], v[80:95]
    ds_read_b64_tr_b16 v[110:111], v18 offset:54528
    buffer_load_dwordx4 v15, s[8:11], s30 offen offset:3072 lds
    s_waitcnt lgkmcnt(15)
    v_mfma_f32_32x32x16_bf16 v[64:79], v[144:147], v[184:187], v[64:79]
    ds_read_b128 v[168:171], v22 offset:49152
    ds_read_b64_tr_b16 v[112:113], v18 offset:51200
    ds_read_b64_tr_b16 v[114:115], v18 offset:51456
    s_add_u32 m0, s25, 0
    s_movk_i32 s31, 768
    buffer_load_dwordx4 v16, s[12:15], s31 offen lds
    v_mfma_f32_32x32x16_bf16 v[80:95], v[148:151], v[184:187], v[80:95]
    ds_read_b64_tr_b16 v[116:117], v18 offset:55296
    ds_read_b64_tr_b16 v[118:119], v18 offset:55552
    ds_read_b128 v[172:175], v23 offset:49152
    buffer_load_dwordx4 v17, s[12:15], s31 offen offset:1024 lds
    s_waitcnt lgkmcnt(15)
    v_mfma_f32_32x32x16_bf16 v[64:79], v[152:155], v[188:191], v[64:79]
    ds_read_b64_tr_b16 v[120:121], v18 offset:52224
    ds_read_b64_tr_b16 v[122:123], v18 offset:52480
    ds_read_b64_tr_b16 v[124:125], v18 offset:56320
    v_mfma_f32_32x32x16_bf16 v[80:95], v[156:159], v[188:191], v[80:95]
    ds_read_b64_tr_b16 v[126:127], v18 offset:56576
    s_waitcnt lgkmcnt(15)
    v_mfma_f32_32x32x16_bf16 v[64:79], v[96:99], v[160:163], v[64:79]
    s_waitcnt vmcnt(18)
    s_barrier
    ds_read_b128 v[176:179], v24 offset:0
    ds_read_b64_tr_b16 v[128:129], v19 offset:0
    ds_read_b64_tr_b16 v[130:131], v19 offset:256
    s_add_u32 m0, s24, 24576
    s_mov_b32 s30, 28672
    buffer_load_dwordx4 v15, s[8:11], s30 offen offset:0 lds
    v_mfma_f32_32x32x16_bf16 v[80:95], v[100:103], v[160:163], v[80:95]
    ds_read_b64_tr_b16 v[132:133], v19 offset:4096
    ds_read_b64_tr_b16 v[134:135], v19 offset:4352
    ds_read_b128 v[180:183], v25 offset:0
    buffer_load_dwordx4 v15, s[8:11], s30 offen offset:1024 lds
    s_waitcnt lgkmcnt(15)
    v_mfma_f32_32x32x16_bf16 v[64:79], v[104:107], v[164:167], v[64:79]
    ds_read_b64_tr_b16 v[136:137], v19 offset:1024
    ds_read_b64_tr_b16 v[138:139], v19 offset:1280
    ds_read_b64_tr_b16 v[140:141], v19 offset:5120
    buffer_load_dwordx4 v15, s[8:11], s30 offen offset:2048 lds
    v_mfma_f32_32x32x16_bf16 v[80:95], v[108:111], v[164:167], v[80:95]
    ds_read_b64_tr_b16 v[142:143], v19 offset:5376
    buffer_load_dwordx4 v15, s[8:11], s30 offen offset:3072 lds
    s_waitcnt lgkmcnt(15)
    v_mfma_f32_32x32x16_bf16 v[64:79], v[112:115], v[168:171], v[64:79]
    ds_read_b128 v[184:187], v26 offset:0
    ds_read_b64_tr_b16 v[144:145], v19 offset:2048
    ds_read_b64_tr_b16 v[146:147], v19 offset:2304
    s_add_u32 m0, s25, 24576
    s_movk_i32 s31, 896
    buffer_load_dwordx4 v16, s[12:15], s31 offen lds
    v_mfma_f32_32x32x16_bf16 v[80:95], v[116:119], v[168:171], v[80:95]
    ds_read_b64_tr_b16 v[148:149], v19 offset:6144
    ds_read_b64_tr_b16 v[150:151], v19 offset:6400
    ds_read_b128 v[188:191], v27 offset:0
    buffer_load_dwordx4 v17, s[12:15], s31 offen offset:1024 lds
    s_waitcnt lgkmcnt(15)
    v_mfma_f32_32x32x16_bf16 v[64:79], v[120:123], v[172:175], v[64:79]
    ds_read_b64_tr_b16 v[152:153], v19 offset:3072
    ds_read_b64_tr_b16 v[154:155], v19 offset:3328
    ds_read_b64_tr_b16 v[156:157], v19 offset:7168
    v_mfma_f32_32x32x16_bf16 v[80:95], v[124:127], v[172:175], v[80:95]
    ds_read_b64_tr_b16 v[158:159], v19 offset:7424
    s_waitcnt lgkmcnt(15)
    v_mfma_f32_32x32x16_bf16 v[64:79], v[128:131], v[176:179], v[64:79]
    s_waitcnt vmcnt(18)
    s_barrier
    ds_read_b128 v[160:163], v24 offset:24576
    ds_read_b64_tr_b16 v[96:97], v19 offset:24576
    ds_read_b64_tr_b16 v[98:99], v19 offset:24832
    s_add_u32 m0, s24, 49152
    s_mov_b32 s30, 32768
    buffer_load_dwordx4 v15, s[8:11], s30 offen offset:0 lds
    v_mfma_f32_32x32x16_bf16 v[80:95], v[132:135], v[176:179], v[80:95]
    ds_read_b64_tr_b16 v[100:101], v19 offset:28672
    ds_read_b64_tr_b16 v[102:103], v19 offset:28928
    ds_read_b128 v[164:167], v25 offset:24576
    buffer_load_dwordx4 v15, s[8:11], s30 offen offset:1024 lds
    s_waitcnt lgkmcnt(15)
    v_mfma_f32_32x32x16_bf16 v[64:79], v[136:139], v[180:183], v[64:79]
    ds_read_b64_tr_b16 v[104:105], v19 offset:25600
    ds_read_b64_tr_b16 v[106:107], v19 offset:25856
    ds_read_b64_tr_b16 v[108:109], v19 offset:29696
    buffer_load_dwordx4 v15, s[8:11], s30 offen offset:2048 lds
    v_mfma_f32_32x32x16_bf16 v[80:95], v[140:143], v[180:183], v[80:95]
    ds_read_b64_tr_b16 v[110:111], v19 offset:29952
    buffer_load_dwordx4 v15, s[8:11], s30 offen offset:3072 lds
    s_waitcnt lgkmcnt(15)
    v_mfma_f32_32x32x16_bf16 v[64:79], v[144:147], v[184:187], v[64:79]
    ds_read_b128 v[168:171], v26 offset:24576
    ds_read_b64_tr_b16 v[112:113], v19 offset:26624
    ds_read_b64_tr_b16 v[114:115], v19 offset:26880
    s_add_u32 m0, s25, 49152
    s_movk_i32 s31, 1024
    buffer_load_dwordx4 v16, s[12:15], s31 offen lds
    v_mfma_f32_32x32x16_bf16 v[80:95], v[148:151], v[184:187], v[80:95]
    ds_read_b64_tr_b16 v[116:117], v19 offset:30720
    ds_read_b64_tr_b16 v[118:119], v19 offset:30976
    ds_read_b128 v[172:175], v27 offset:24576
    buffer_load_dwordx4 v17, s[12:15], s31 offen offset:1024 lds
    s_waitcnt lgkmcnt(15)
    v_mfma_f32_32x32x16_bf16 v[64:79], v[152:155], v[188:191], v[64:79]
    ds_read_b64_tr_b16 v[120:121], v19 offset:27648
    ds_read_b64_tr_b16 v[122:123], v19 offset:27904
    ds_read_b64_tr_b16 v[124:125], v19 offset:31744
    v_mfma_f32_32x32x16_bf16 v[80:95], v[156:159], v[188:191], v[80:95]
    ds_read_b64_tr_b16 v[126:127], v19 offset:32000
    s_waitcnt lgkmcnt(15)
    v_mfma_f32_32x32x16_bf16 v[64:79], v[96:99], v[160:163], v[64:79]
    s_waitcnt vmcnt(18)
    s_barrier
    ds_read_b128 v[176:179], v24 offset:49152
    ds_read_b64_tr_b16 v[128:129], v19 offset:49152
    ds_read_b64_tr_b16 v[130:131], v19 offset:49408
    s_add_u32 m0, s24, 73728
    s_mov_b32 s30, 36864
    buffer_load_dwordx4 v15, s[8:11], s30 offen offset:0 lds
    v_mfma_f32_32x32x16_bf16 v[80:95], v[100:103], v[160:163], v[80:95]
    ds_read_b64_tr_b16 v[132:133], v19 offset:53248
    ds_read_b64_tr_b16 v[134:135], v19 offset:53504
    ds_read_b128 v[180:183], v25 offset:49152
    buffer_load_dwordx4 v15, s[8:11], s30 offen offset:1024 lds
    s_waitcnt lgkmcnt(15)
    v_mfma_f32_32x32x16_bf16 v[64:79], v[104:107], v[164:167], v[64:79]
    ds_read_b64_tr_b16 v[136:137], v19 offset:50176
    ds_read_b64_tr_b16 v[138:139], v19 offset:50432
    ds_read_b64_tr_b16 v[140:141], v19 offset:54272
    buffer_load_dwordx4 v15, s[8:11], s30 offen offset:2048 lds
    v_mfma_f32_32x32x16_bf16 v[80:95], v[108:111], v[164:167], v[80:95]
    ds_read_b64_tr_b16 v[142:143], v19 offset:54528
    buffer_load_dwordx4 v15, s[8:11], s30 offen offset:3072 lds
    s_waitcnt lgkmcnt(15)
    v_mfma_f32_32x32x16_bf16 v[64:79], v[112:115], v[168:171], v[64:79]
    ds_read_b128 v[184:187], v26 offset:49152
    ds_read_b64_tr_b16 v[144:145], v19 offset:51200
    ds_read_b64_tr_b16 v[146:147], v19 offset:51456
    s_add_u32 m0, s25, 73728
    s_movk_i32 s31, 1152
    buffer_load_dwordx4 v16, s[12:15], s31 offen lds
    v_mfma_f32_32x32x16_bf16 v[80:95], v[116:119], v[168:171], v[80:95]
    ds_read_b64_tr_b16 v[148:149], v19 offset:55296
    ds_read_b64_tr_b16 v[150:151], v19 offset:55552
    ds_read_b128 v[188:191], v27 offset:49152
    buffer_load_dwordx4 v17, s[12:15], s31 offen offset:1024 lds
    s_waitcnt lgkmcnt(15)
    v_mfma_f32_32x32x16_bf16 v[64:79], v[120:123], v[172:175], v[64:79]
    ds_read_b64_tr_b16 v[152:153], v19 offset:52224
    ds_read_b64_tr_b16 v[154:155], v19 offset:52480
    ds_read_b64_tr_b16 v[156:157], v19 offset:56320
    v_mfma_f32_32x32x16_bf16 v[80:95], v[124:127], v[172:175], v[80:95]
    ds_read_b64_tr_b16 v[158:159], v19 offset:56576
    s_waitcnt lgkmcnt(15)
    v_mfma_f32_32x32x16_bf16 v[64:79], v[128:131], v[176:179], v[64:79]
    s_waitcnt vmcnt(18)
    s_barrier
    ds_read_b128 v[160:163], v20 offset:0
    ds_read_b64_tr_b16 v[96:97], v18 offset:0
    ds_read_b64_tr_b16 v[98:99], v18 offset:256
    s_add_u32 m0, s24, 98304
    s_mov_b32 s30, 40960
    buffer_load_dwordx4 v15, s[8:11], s30 offen offset:0 lds
    v_mfma_f32_32x32x16_bf16 v[80:95], v[132:135], v[176:179], v[80:95]
    ds_read_b64_tr_b16 v[100:101], v18 offset:4096
    ds_read_b64_tr_b16 v[102:103], v18 offset:4352
    ds_read_b128 v[164:167], v21 offset:0
    buffer_load_dwordx4 v15, s[8:11], s30 offen offset:1024 lds
    s_waitcnt lgkmcnt(15)
    v_mfma_f32_32x32x16_bf16 v[64:79], v[136:139], v[180:183], v[64:79]
    ds_read_b64_tr_b16 v[104:105], v18 offset:1024
    ds_read_b64_tr_b16 v[106:107], v18 offset:1280
    ds_read_b64_tr_b16 v[108:109], v18 offset:5120
    buffer_load_dwordx4 v15, s[8:11], s30 offen offset:2048 lds
    v_mfma_f32_32x32x16_bf16 v[80:95], v[140:143], v[180:183], v[80:95]
    ds_read_b64_tr_b16 v[110:111], v18 offset:5376
    buffer_load_dwordx4 v15, s[8:11], s30 offen offset:3072 lds
    s_waitcnt lgkmcnt(15)
    v_mfma_f32_32x32x16_bf16 v[64:79], v[144:147], v[184:187], v[64:79]
    ds_read_b128 v[168:171], v22 offset:0
    ds_read_b64_tr_b16 v[112:113], v18 offset:2048
    ds_read_b64_tr_b16 v[114:115], v18 offset:2304
    s_add_u32 m0, s25, 98304
    s_movk_i32 s31, 1280
    buffer_load_dwordx4 v16, s[12:15], s31 offen lds
    v_mfma_f32_32x32x16_bf16 v[80:95], v[148:151], v[184:187], v[80:95]
    ds_read_b64_tr_b16 v[116:117], v18 offset:6144
    ds_read_b64_tr_b16 v[118:119], v18 offset:6400
    ds_read_b128 v[172:175], v23 offset:0
    buffer_load_dwordx4 v17, s[12:15], s31 offen offset:1024 lds
    s_waitcnt lgkmcnt(15)
    v_mfma_f32_32x32x16_bf16 v[64:79], v[152:155], v[188:191], v[64:79]
    ds_read_b64_tr_b16 v[120:121], v18 offset:3072
    ds_read_b64_tr_b16 v[122:123], v18 offset:3328
    ds_read_b64_tr_b16 v[124:125], v18 offset:7168
    v_mfma_f32_32x32x16_bf16 v[80:95], v[156:159], v[188:191], v[80:95]
    ds_read_b64_tr_b16 v[126:127], v18 offset:7424
    s_waitcnt lgkmcnt(15)
    v_mfma_f32_32x32x16_bf16 v[64:79], v[96:99], v[160:163], v[64:79]
    s_waitcnt vmcnt(18)
    s_barrier
    ds_read_b128 v[176:179], v20 offset:24576
    ds_read_b64_tr_b16 v[128:129], v18 offset:24576
    ds_read_b64_tr_b16 v[130:131], v18 offset:24832
    s_add_u32 m0, s24, 122880
    s_mov_b32 s30, 45056
    buffer_load_dwordx4 v15, s[8:11], s30 offen offset:0 lds
    v_mfma_f32_32x32x16_bf16 v[80:95], v[100:103], v[160:163], v[80:95]
    ds_read_b64_tr_b16 v[132:133], v18 offset:28672
    ds_read_b64_tr_b16 v[134:135], v18 offset:28928
    ds_read_b128 v[180:183], v21 offset:24576
    buffer_load_dwordx4 v15, s[8:11], s30 offen offset:1024 lds
    s_waitcnt lgkmcnt(15)
    v_mfma_f32_32x32x16_bf16 v[64:79], v[104:107], v[164:167], v[64:79]
    ds_read_b64_tr_b16 v[136:137], v18 offset:25600
    ds_read_b64_tr_b16 v[138:139], v18 offset:25856
    ds_read_b64_tr_b16 v[140:141], v18 offset:29696
    buffer_load_dwordx4 v15, s[8:11], s30 offen offset:2048 lds
    v_mfma_f32_32x32x16_bf16 v[80:95], v[108:111], v[164:167], v[80:95]
    ds_read_b64_tr_b16 v[142:143], v18 offset:29952
    buffer_load_dwordx4 v15, s[8:11], s30 offen offset:3072 lds
    s_waitcnt lgkmcnt(15)
    v_mfma_f32_32x32x16_bf16 v[64:79], v[112:115], v[168:171], v[64:79]
    ds_read_b128 v[184:187], v22 offset:24576
    ds_read_b64_tr_b16 v[144:145], v18 offset:26624
    ds_read_b64_tr_b16 v[146:147], v18 offset:26880
    s_add_u32 m0, s25, 122880
    s_movk_i32 s31, 1408
    buffer_load_dwordx4 v16, s[12:15], s31 offen lds
    v_mfma_f32_32x32x16_bf16 v[80:95], v[116:119], v[168:171], v[80:95]
    ds_read_b64_tr_b16 v[148:149], v18 offset:30720
    ds_read_b64_tr_b16 v[150:151], v18 offset:30976
    ds_read_b128 v[188:191], v23 offset:24576
    buffer_load_dwordx4 v17, s[12:15], s31 offen offset:1024 lds
    s_waitcnt lgkmcnt(15)
    v_mfma_f32_32x32x16_bf16 v[64:79], v[120:123], v[172:175], v[64:79]
    ds_read_b64_tr_b16 v[152:153], v18 offset:27648
    ds_read_b64_tr_b16 v[154:155], v18 offset:27904
    ds_read_b64_tr_b16 v[156:157], v18 offset:31744
    v_mfma_f32_32x32x16_bf16 v[80:95], v[124:127], v[172:175], v[80:95]
    ds_read_b64_tr_b16 v[158:159], v18 offset:32000
    s_waitcnt lgkmcnt(15)
    v_mfma_f32_32x32x16_bf16 v[64:79], v[128:131], v[176:179], v[64:79]
    s_waitcnt vmcnt(18)
    s_barrier
    ds_read_b128 v[160:163], v20 offset:49152
    ds_read_b64_tr_b16 v[96:97], v18 offset:49152
    ds_read_b64_tr_b16 v[98:99], v18 offset:49408
    s_add_u32 m0, s24, 0
    s_mov_b32 s30, 49152
    buffer_load_dwordx4 v15, s[8:11], s30 offen offset:0 lds
    v_mfma_f32_32x32x16_bf16 v[80:95], v[132:135], v[176:179], v[80:95]
    ds_read_b64_tr_b16 v[100:101], v18 offset:53248
    ds_read_b64_tr_b16 v[102:103], v18 offset:53504
    ds_read_b128 v[164:167], v21 offset:49152
    buffer_load_dwordx4 v15, s[8:11], s30 offen offset:1024 lds
    s_waitcnt lgkmcnt(15)
    v_mfma_f32_32x32x16_bf16 v[64:79], v[136:139], v[180:183], v[64:79]
    ds_read_b64_tr_b16 v[104:105], v18 offset:50176
    ds_read_b64_tr_b16 v[106:107], v18 offset:50432
    ds_read_b64_tr_b16 v[108:109], v18 offset:54272
    buffer_load_dwordx4 v15, s[8:11], s30 offen offset:2048 lds
    v_mfma_f32_32x32x16_bf16 v[80:95], v[140:143], v[180:183], v[80:95]
    ds_read_b64_tr_b16 v[110:111], v18 offset:54528
    buffer_load_dwordx4 v15, s[8:11], s30 offen offset:3072 lds
    s_waitcnt lgkmcnt(15)
    v_mfma_f32_32x32x16_bf16 v[64:79], v[144:147], v[184:187], v[64:79]
    ds_read_b128 v[168:171], v22 offset:49152
    ds_read_b64_tr_b16 v[112:113], v18 offset:51200
    ds_read_b64_tr_b16 v[114:115], v18 offset:51456
    s_add_u32 m0, s25, 0
    s_movk_i32 s31, 1536
    buffer_load_dwordx4 v16, s[12:15], s31 offen lds
    v_mfma_f32_32x32x16_bf16 v[80:95], v[148:151], v[184:187], v[80:95]
    ds_read_b64_tr_b16 v[116:117], v18 offset:55296
    ds_read_b64_tr_b16 v[118:119], v18 offset:55552
    ds_read_b128 v[172:175], v23 offset:49152
    buffer_load_dwordx4 v17, s[12:15], s31 offen offset:1024 lds
    s_waitcnt lgkmcnt(15)
    v_mfma_f32_32x32x16_bf16 v[64:79], v[152:155], v[188:191], v[64:79]
    ds_read_b64_tr_b16 v[120:121], v18 offset:52224
    ds_read_b64_tr_b16 v[122:123], v18 offset:52480
    ds_read_b64_tr_b16 v[124:125], v18 offset:56320
    v_mfma_f32_32x32x16_bf16 v[80:95], v[156:159], v[188:191], v[80:95]
    ds_read_b64_tr_b16 v[126:127], v18 offset:56576
    s_waitcnt lgkmcnt(15)
    v_mfma_f32_32x32x16_bf16 v[64:79], v[96:99], v[160:163], v[64:79]
    s_waitcnt vmcnt(18)
    s_barrier
    ds_read_b128 v[176:179], v24 offset:0
    ds_read_b64_tr_b16 v[128:129], v19 offset:0
    ds_read_b64_tr_b16 v[130:131], v19 offset:256
    s_add_u32 m0, s24, 24576
    s_mov_b32 s30, 53248
    buffer_load_dwordx4 v15, s[8:11], s30 offen offset:0 lds
    v_mfma_f32_32x32x16_bf16 v[80:95], v[100:103], v[160:163], v[80:95]
    ds_read_b64_tr_b16 v[132:133], v19 offset:4096
    ds_read_b64_tr_b16 v[134:135], v19 offset:4352
    ds_read_b128 v[180:183], v25 offset:0
    buffer_load_dwordx4 v15, s[8:11], s30 offen offset:1024 lds
    s_waitcnt lgkmcnt(15)
    v_mfma_f32_32x32x16_bf16 v[64:79], v[104:107], v[164:167], v[64:79]
    ds_read_b64_tr_b16 v[136:137], v19 offset:1024
    ds_read_b64_tr_b16 v[138:139], v19 offset:1280
    ds_read_b64_tr_b16 v[140:141], v19 offset:5120
    buffer_load_dwordx4 v15, s[8:11], s30 offen offset:2048 lds
    v_mfma_f32_32x32x16_bf16 v[80:95], v[108:111], v[164:167], v[80:95]
    ds_read_b64_tr_b16 v[142:143], v19 offset:5376
    buffer_load_dwordx4 v15, s[8:11], s30 offen offset:3072 lds
    s_waitcnt lgkmcnt(15)
    v_mfma_f32_32x32x16_bf16 v[64:79], v[112:115], v[168:171], v[64:79]
    ds_read_b128 v[184:187], v26 offset:0
    ds_read_b64_tr_b16 v[144:145], v19 offset:2048
    ds_read_b64_tr_b16 v[146:147], v19 offset:2304
    s_add_u32 m0, s25, 24576
    s_movk_i32 s31, 1664
    buffer_load_dwordx4 v16, s[12:15], s31 offen lds
    v_mfma_f32_32x32x16_bf16 v[80:95], v[116:119], v[168:171], v[80:95]
    ds_read_b64_tr_b16 v[148:149], v19 offset:6144
    ds_read_b64_tr_b16 v[150:151], v19 offset:6400
    ds_read_b128 v[188:191], v27 offset:0
    buffer_load_dwordx4 v17, s[12:15], s31 offen offset:1024 lds
    s_waitcnt lgkmcnt(15)
    v_mfma_f32_32x32x16_bf16 v[64:79], v[120:123], v[172:175], v[64:79]
    ds_read_b64_tr_b16 v[152:153], v19 offset:3072
    ds_read_b64_tr_b16 v[154:155], v19 offset:3328
    ds_read_b64_tr_b16 v[156:157], v19 offset:7168
    v_mfma_f32_32x32x16_bf16 v[80:95], v[124:127], v[172:175], v[80:95]
    ds_read_b64_tr_b16 v[158:159], v19 offset:7424
    s_waitcnt lgkmcnt(15)
    v_mfma_f32_32x32x16_bf16 v[64:79], v[128:131], v[176:179], v[64:79]
    s_waitcnt vmcnt(18)
    s_barrier
    ds_read_b128 v[160:163], v24 offset:24576
    ds_read_b64_tr_b16 v[96:97], v19 offset:24576
    ds_read_b64_tr_b16 v[98:99], v19 offset:24832
    s_add_u32 m0, s24, 49152
    s_mov_b32 s30, 57344
    buffer_load_dwordx4 v15, s[8:11], s30 offen offset:0 lds
    v_mfma_f32_32x32x16_bf16 v[80:95], v[132:135], v[176:179], v[80:95]
    ds_read_b64_tr_b16 v[100:101], v19 offset:28672
    ds_read_b64_tr_b16 v[102:103], v19 offset:28928
    ds_read_b128 v[164:167], v25 offset:24576
    buffer_load_dwordx4 v15, s[8:11], s30 offen offset:1024 lds
    s_waitcnt lgkmcnt(15)
    v_mfma_f32_32x32x16_bf16 v[64:79], v[136:139], v[180:183], v[64:79]
    ds_read_b64_tr_b16 v[104:105], v19 offset:25600
    ds_read_b64_tr_b16 v[106:107], v19 offset:25856
    ds_read_b64_tr_b16 v[108:109], v19 offset:29696
    buffer_load_dwordx4 v15, s[8:11], s30 offen offset:2048 lds
    v_mfma_f32_32x32x16_bf16 v[80:95], v[140:143], v[180:183], v[80:95]
    ds_read_b64_tr_b16 v[110:111], v19 offset:29952
    buffer_load_dwordx4 v15, s[8:11], s30 offen offset:3072 lds
    s_waitcnt lgkmcnt(15)
    v_mfma_f32_32x32x16_bf16 v[64:79], v[144:147], v[184:187], v[64:79]
    ds_read_b128 v[168:171], v26 offset:24576
    ds_read_b64_tr_b16 v[112:113], v19 offset:26624
    ds_read_b64_tr_b16 v[114:115], v19 offset:26880
    s_add_u32 m0, s25, 49152
    s_movk_i32 s31, 1792
    buffer_load_dwordx4 v16, s[12:15], s31 offen lds
    v_mfma_f32_32x32x16_bf16 v[80:95], v[148:151], v[184:187], v[80:95]
    ds_read_b64_tr_b16 v[116:117], v19 offset:30720
    ds_read_b64_tr_b16 v[118:119], v19 offset:30976
    ds_read_b128 v[172:175], v27 offset:24576
    buffer_load_dwordx4 v17, s[12:15], s31 offen offset:1024 lds
    s_waitcnt lgkmcnt(15)
    v_mfma_f32_32x32x16_bf16 v[64:79], v[152:155], v[188:191], v[64:79]
    ds_read_b64_tr_b16 v[120:121], v19 offset:27648
    ds_read_b64_tr_b16 v[122:123], v19 offset:27904
    ds_read_b64_tr_b16 v[124:125], v19 offset:31744
    v_mfma_f32_32x32x16_bf16 v[80:95], v[156:159], v[188:191], v[80:95]
    ds_read_b64_tr_b16 v[126:127], v19 offset:32000
    s_waitcnt lgkmcnt(15)
    v_mfma_f32_32x32x16_bf16 v[64:79], v[96:99], v[160:163], v[64:79]
    s_waitcnt vmcnt(18)
    s_barrier
    ds_read_b128 v[176:179], v24 offset:49152
    ds_read_b64_tr_b16 v[128:129], v19 offset:49152
    ds_read_b64_tr_b16 v[130:131], v19 offset:49408
    s_add_u32 m0, s24, 73728
    s_mov_b32 s30, 61440
    buffer_load_dwordx4 v15, s[8:11], s30 offen offset:0 lds
    v_mfma_f32_32x32x16_bf16 v[80:95], v[100:103], v[160:163], v[80:95]
    ds_read_b64_tr_b16 v[132:133], v19 offset:53248
    ds_read_b64_tr_b16 v[134:135], v19 offset:53504
    ds_read_b128 v[180:183], v25 offset:49152
    buffer_load_dwordx4 v15, s[8:11], s30 offen offset:1024 lds
    s_waitcnt lgkmcnt(15)
    v_mfma_f32_32x32x16_bf16 v[64:79], v[104:107], v[164:167], v[64:79]
    ds_read_b64_tr_b16 v[136:137], v19 offset:50176
    ds_read_b64_tr_b16 v[138:139], v19 offset:50432
    ds_read_b64_tr_b16 v[140:141], v19 offset:54272
    buffer_load_dwordx4 v15, s[8:11], s30 offen offset:2048 lds
    v_mfma_f32_32x32x16_bf16 v[80:95], v[108:111], v[164:167], v[80:95]
    ds_read_b64_tr_b16 v[142:143], v19 offset:54528
    buffer_load_dwordx4 v15, s[8:11], s30 offen offset:3072 lds
    s_waitcnt lgkmcnt(15)
    v_mfma_f32_32x32x16_bf16 v[64:79], v[112:115], v[168:171], v[64:79]
    ds_read_b128 v[184:187], v26 offset:49152
    ds_read_b64_tr_b16 v[144:145], v19 offset:51200
    ds_read_b64_tr_b16 v[146:147], v19 offset:51456
    s_add_u32 m0, s25, 73728
    s_movk_i32 s31, 1920
    buffer_load_dwordx4 v16, s[12:15], s31 offen lds
    v_mfma_f32_32x32x16_bf16 v[80:95], v[116:119], v[168:171], v[80:95]
    ds_read_b64_tr_b16 v[148:149], v19 offset:55296
    ds_read_b64_tr_b16 v[150:151], v19 offset:55552
    ds_read_b128 v[188:191], v27 offset:49152
    buffer_load_dwordx4 v17, s[12:15], s31 offen offset:1024 lds
    s_waitcnt lgkmcnt(15)
    v_mfma_f32_32x32x16_bf16 v[64:79], v[120:123], v[172:175], v[64:79]
    ds_read_b64_tr_b16 v[152:153], v19 offset:52224
    ds_read_b64_tr_b16 v[154:155], v19 offset:52480
    ds_read_b64_tr_b16 v[156:157], v19 offset:56320
    v_mfma_f32_32x32x16_bf16 v[80:95], v[124:127], v[172:175], v[80:95]
    ds_read_b64_tr_b16 v[158:159], v19 offset:56576
    s_waitcnt lgkmcnt(15)
    v_mfma_f32_32x32x16_bf16 v[64:79], v[128:131], v[176:179], v[64:79]
    s_waitcnt vmcnt(18)
    s_barrier
    ds_read_b128 v[160:163], v20 offset:0
    ds_read_b64_tr_b16 v[96:97], v18 offset:0
    ds_read_b64_tr_b16 v[98:99], v18 offset:256
    s_add_u32 m0, s24, 98304
    s_mov_b32 s30, 65536
    buffer_load_dwordx4 v15, s[8:11], s30 offen offset:0 lds
    v_mfma_f32_32x32x16_bf16 v[80:95], v[132:135], v[176:179], v[80:95]
    ds_read_b64_tr_b16 v[100:101], v18 offset:4096
    ds_read_b64_tr_b16 v[102:103], v18 offset:4352
    ds_read_b128 v[164:167], v21 offset:0
    buffer_load_dwordx4 v15, s[8:11], s30 offen offset:1024 lds
    s_waitcnt lgkmcnt(15)
    v_mfma_f32_32x32x16_bf16 v[64:79], v[136:139], v[180:183], v[64:79]
    ds_read_b64_tr_b16 v[104:105], v18 offset:1024
    ds_read_b64_tr_b16 v[106:107], v18 offset:1280
    ds_read_b64_tr_b16 v[108:109], v18 offset:5120
    buffer_load_dwordx4 v15, s[8:11], s30 offen offset:2048 lds
    v_mfma_f32_32x32x16_bf16 v[80:95], v[140:143], v[180:183], v[80:95]
    ds_read_b64_tr_b16 v[110:111], v18 offset:5376
    buffer_load_dwordx4 v15, s[8:11], s30 offen offset:3072 lds
    s_waitcnt lgkmcnt(15)
    v_mfma_f32_32x32x16_bf16 v[64:79], v[144:147], v[184:187], v[64:79]
    ds_read_b128 v[168:171], v22 offset:0
    ds_read_b64_tr_b16 v[112:113], v18 offset:2048
    ds_read_b64_tr_b16 v[114:115], v18 offset:2304
    s_add_u32 m0, s25, 98304
    s_movk_i32 s31, 2048
    buffer_load_dwordx4 v16, s[12:15], s31 offen lds
    v_mfma_f32_32x32x16_bf16 v[80:95], v[148:151], v[184:187], v[80:95]
    ds_read_b64_tr_b16 v[116:117], v18 offset:6144
    ds_read_b64_tr_b16 v[118:119], v18 offset:6400
    ds_read_b128 v[172:175], v23 offset:0
    buffer_load_dwordx4 v17, s[12:15], s31 offen offset:1024 lds
    s_waitcnt lgkmcnt(15)
    v_mfma_f32_32x32x16_bf16 v[64:79], v[152:155], v[188:191], v[64:79]
    ds_read_b64_tr_b16 v[120:121], v18 offset:3072
    ds_read_b64_tr_b16 v[122:123], v18 offset:3328
    ds_read_b64_tr_b16 v[124:125], v18 offset:7168
    v_mfma_f32_32x32x16_bf16 v[80:95], v[156:159], v[188:191], v[80:95]
    ds_read_b64_tr_b16 v[126:127], v18 offset:7424
    s_waitcnt lgkmcnt(15)
    v_mfma_f32_32x32x16_bf16 v[64:79], v[96:99], v[160:163], v[64:79]
    s_waitcnt vmcnt(18)
    s_barrier
    ds_read_b128 v[176:179], v20 offset:24576
    ds_read_b64_tr_b16 v[128:129], v18 offset:24576
    ds_read_b64_tr_b16 v[130:131], v18 offset:24832
    s_add_u32 m0, s24, 122880
    s_mov_b32 s30, 69632
    buffer_load_dwordx4 v15, s[8:11], s30 offen offset:0 lds
    v_mfma_f32_32x32x16_bf16 v[80:95], v[100:103], v[160:163], v[80:95]
    ds_read_b64_tr_b16 v[132:133], v18 offset:28672
    ds_read_b64_tr_b16 v[134:135], v18 offset:28928
    ds_read_b128 v[180:183], v21 offset:24576
    buffer_load_dwordx4 v15, s[8:11], s30 offen offset:1024 lds
    s_waitcnt lgkmcnt(15)
    v_mfma_f32_32x32x16_bf16 v[64:79], v[104:107], v[164:167], v[64:79]
    ds_read_b64_tr_b16 v[136:137], v18 offset:25600
    ds_read_b64_tr_b16 v[138:139], v18 offset:25856
    ds_read_b64_tr_b16 v[140:141], v18 offset:29696
    buffer_load_dwordx4 v15, s[8:11], s30 offen offset:2048 lds
    v_mfma_f32_32x32x16_bf16 v[80:95], v[108:111], v[164:167], v[80:95]
    ds_read_b64_tr_b16 v[142:143], v18 offset:29952
    buffer_load_dwordx4 v15, s[8:11], s30 offen offset:3072 lds
    s_waitcnt lgkmcnt(15)
    v_mfma_f32_32x32x16_bf16 v[64:79], v[112:115], v[168:171], v[64:79]
    ds_read_b128 v[184:187], v22 offset:24576
    ds_read_b64_tr_b16 v[144:145], v18 offset:26624
    ds_read_b64_tr_b16 v[146:147], v18 offset:26880
    s_add_u32 m0, s25, 122880
    s_movk_i32 s31, 2176
    buffer_load_dwordx4 v16, s[12:15], s31 offen lds
    v_mfma_f32_32x32x16_bf16 v[80:95], v[116:119], v[168:171], v[80:95]
    ds_read_b64_tr_b16 v[148:149], v18 offset:30720
    ds_read_b64_tr_b16 v[150:151], v18 offset:30976
    ds_read_b128 v[188:191], v23 offset:24576
    buffer_load_dwordx4 v17, s[12:15], s31 offen offset:1024 lds
    s_waitcnt lgkmcnt(15)
    v_mfma_f32_32x32x16_bf16 v[64:79], v[120:123], v[172:175], v[64:79]
    ds_read_b64_tr_b16 v[152:153], v18 offset:27648
    ds_read_b64_tr_b16 v[154:155], v18 offset:27904
    ds_read_b64_tr_b16 v[156:157], v18 offset:31744
    v_mfma_f32_32x32x16_bf16 v[80:95], v[124:127], v[172:175], v[80:95]
    ds_read_b64_tr_b16 v[158:159], v18 offset:32000
    s_waitcnt lgkmcnt(15)
    v_mfma_f32_32x32x16_bf16 v[64:79], v[128:131], v[176:179], v[64:79]
    s_waitcnt vmcnt(18)
    s_barrier
    ds_read_b128 v[160:163], v20 offset:49152
    ds_read_b64_tr_b16 v[96:97], v18 offset:49152
    ds_read_b64_tr_b16 v[98:99], v18 offset:49408
    s_add_u32 m0, s24, 0
    s_mov_b32 s30, 73728
    buffer_load_dwordx4 v15, s[8:11], s30 offen offset:0 lds
    v_mfma_f32_32x32x16_bf16 v[80:95], v[132:135], v[176:179], v[80:95]
    ds_read_b64_tr_b16 v[100:101], v18 offset:53248
    ds_read_b64_tr_b16 v[102:103], v18 offset:53504
    ds_read_b128 v[164:167], v21 offset:49152
    buffer_load_dwordx4 v15, s[8:11], s30 offen offset:1024 lds
    s_waitcnt lgkmcnt(15)
    v_mfma_f32_32x32x16_bf16 v[64:79], v[136:139], v[180:183], v[64:79]
    ds_read_b64_tr_b16 v[104:105], v18 offset:50176
    ds_read_b64_tr_b16 v[106:107], v18 offset:50432
    ds_read_b64_tr_b16 v[108:109], v18 offset:54272
    buffer_load_dwordx4 v15, s[8:11], s30 offen offset:2048 lds
    v_mfma_f32_32x32x16_bf16 v[80:95], v[140:143], v[180:183], v[80:95]
    ds_read_b64_tr_b16 v[110:111], v18 offset:54528
    buffer_load_dwordx4 v15, s[8:11], s30 offen offset:3072 lds
    s_waitcnt lgkmcnt(15)
    v_mfma_f32_32x32x16_bf16 v[64:79], v[144:147], v[184:187], v[64:79]
    ds_read_b128 v[168:171], v22 offset:49152
    ds_read_b64_tr_b16 v[112:113], v18 offset:51200
    ds_read_b64_tr_b16 v[114:115], v18 offset:51456
    s_add_u32 m0, s25, 0
    s_movk_i32 s31, 2304
    buffer_load_dwordx4 v16, s[12:15], s31 offen lds
    v_mfma_f32_32x32x16_bf16 v[80:95], v[148:151], v[184:187], v[80:95]
    ds_read_b64_tr_b16 v[116:117], v18 offset:55296
    ds_read_b64_tr_b16 v[118:119], v18 offset:55552
    ds_read_b128 v[172:175], v23 offset:49152
    buffer_load_dwordx4 v17, s[12:15], s31 offen offset:1024 lds
    s_waitcnt lgkmcnt(15)
    v_mfma_f32_32x32x16_bf16 v[64:79], v[152:155], v[188:191], v[64:79]
    ds_read_b64_tr_b16 v[120:121], v18 offset:52224
    ds_read_b64_tr_b16 v[122:123], v18 offset:52480
    ds_read_b64_tr_b16 v[124:125], v18 offset:56320
    v_mfma_f32_32x32x16_bf16 v[80:95], v[156:159], v[188:191], v[80:95]
    ds_read_b64_tr_b16 v[126:127], v18 offset:56576
    s_waitcnt lgkmcnt(15)
    v_mfma_f32_32x32x16_bf16 v[64:79], v[96:99], v[160:163], v[64:79]
    s_waitcnt vmcnt(18)
    s_barrier
    ds_read_b128 v[176:179], v24 offset:0
    ds_read_b64_tr_b16 v[128:129], v19 offset:0
    ds_read_b64_tr_b16 v[130:131], v19 offset:256
    s_add_u32 m0, s24, 24576
    s_mov_b32 s30, 77824
    buffer_load_dwordx4 v15, s[8:11], s30 offen offset:0 lds
    v_mfma_f32_32x32x16_bf16 v[80:95], v[100:103], v[160:163], v[80:95]
    ds_read_b64_tr_b16 v[132:133], v19 offset:4096
    ds_read_b64_tr_b16 v[134:135], v19 offset:4352
    ds_read_b128 v[180:183], v25 offset:0
    buffer_load_dwordx4 v15, s[8:11], s30 offen offset:1024 lds
    s_waitcnt lgkmcnt(15)
    v_mfma_f32_32x32x16_bf16 v[64:79], v[104:107], v[164:167], v[64:79]
    ds_read_b64_tr_b16 v[136:137], v19 offset:1024
    ds_read_b64_tr_b16 v[138:139], v19 offset:1280
    ds_read_b64_tr_b16 v[140:141], v19 offset:5120
    buffer_load_dwordx4 v15, s[8:11], s30 offen offset:2048 lds
    v_mfma_f32_32x32x16_bf16 v[80:95], v[108:111], v[164:167], v[80:95]
    ds_read_b64_tr_b16 v[142:143], v19 offset:5376
    buffer_load_dwordx4 v15, s[8:11], s30 offen offset:3072 lds
    s_waitcnt lgkmcnt(15)
    v_mfma_f32_32x32x16_bf16 v[64:79], v[112:115], v[168:171], v[64:79]
    ds_read_b128 v[184:187], v26 offset:0
    ds_read_b64_tr_b16 v[144:145], v19 offset:2048
    ds_read_b64_tr_b16 v[146:147], v19 offset:2304
    s_add_u32 m0, s25, 24576
    s_movk_i32 s31, 2432
    buffer_load_dwordx4 v16, s[12:15], s31 offen lds
    v_mfma_f32_32x32x16_bf16 v[80:95], v[116:119], v[168:171], v[80:95]
    ds_read_b64_tr_b16 v[148:149], v19 offset:6144
    ds_read_b64_tr_b16 v[150:151], v19 offset:6400
    ds_read_b128 v[188:191], v27 offset:0
    buffer_load_dwordx4 v17, s[12:15], s31 offen offset:1024 lds
    s_waitcnt lgkmcnt(15)
    v_mfma_f32_32x32x16_bf16 v[64:79], v[120:123], v[172:175], v[64:79]
    ds_read_b64_tr_b16 v[152:153], v19 offset:3072
    ds_read_b64_tr_b16 v[154:155], v19 offset:3328
    ds_read_b64_tr_b16 v[156:157], v19 offset:7168
    v_mfma_f32_32x32x16_bf16 v[80:95], v[124:127], v[172:175], v[80:95]
    ds_read_b64_tr_b16 v[158:159], v19 offset:7424
    s_waitcnt lgkmcnt(15)
    v_mfma_f32_32x32x16_bf16 v[64:79], v[128:131], v[176:179], v[64:79]
    s_waitcnt vmcnt(18)
    s_barrier
    ds_read_b128 v[160:163], v24 offset:24576
    ds_read_b64_tr_b16 v[96:97], v19 offset:24576
    ds_read_b64_tr_b16 v[98:99], v19 offset:24832
    s_add_u32 m0, s24, 49152
    s_mov_b32 s30, 81920
    buffer_load_dwordx4 v15, s[8:11], s30 offen offset:0 lds
    v_mfma_f32_32x32x16_bf16 v[80:95], v[132:135], v[176:179], v[80:95]
    ds_read_b64_tr_b16 v[100:101], v19 offset:28672
    ds_read_b64_tr_b16 v[102:103], v19 offset:28928
    ds_read_b128 v[164:167], v25 offset:24576
    buffer_load_dwordx4 v15, s[8:11], s30 offen offset:1024 lds
    s_waitcnt lgkmcnt(15)
    v_mfma_f32_32x32x16_bf16 v[64:79], v[136:139], v[180:183], v[64:79]
    ds_read_b64_tr_b16 v[104:105], v19 offset:25600
    ds_read_b64_tr_b16 v[106:107], v19 offset:25856
    ds_read_b64_tr_b16 v[108:109], v19 offset:29696
    buffer_load_dwordx4 v15, s[8:11], s30 offen offset:2048 lds
    v_mfma_f32_32x32x16_bf16 v[80:95], v[140:143], v[180:183], v[80:95]
    ds_read_b64_tr_b16 v[110:111], v19 offset:29952
    buffer_load_dwordx4 v15, s[8:11], s30 offen offset:3072 lds
    s_waitcnt lgkmcnt(15)
    v_mfma_f32_32x32x16_bf16 v[64:79], v[144:147], v[184:187], v[64:79]
    ds_read_b128 v[168:171], v26 offset:24576
    ds_read_b64_tr_b16 v[112:113], v19 offset:26624
    ds_read_b64_tr_b16 v[114:115], v19 offset:26880
    s_add_u32 m0, s25, 49152
    s_movk_i32 s31, 2560
    buffer_load_dwordx4 v16, s[12:15], s31 offen lds
    v_mfma_f32_32x32x16_bf16 v[80:95], v[148:151], v[184:187], v[80:95]
    ds_read_b64_tr_b16 v[116:117], v19 offset:30720
    ds_read_b64_tr_b16 v[118:119], v19 offset:30976
    ds_read_b128 v[172:175], v27 offset:24576
    buffer_load_dwordx4 v17, s[12:15], s31 offen offset:1024 lds
    s_waitcnt lgkmcnt(15)
    v_mfma_f32_32x32x16_bf16 v[64:79], v[152:155], v[188:191], v[64:79]
    ds_read_b64_tr_b16 v[120:121], v19 offset:27648
    ds_read_b64_tr_b16 v[122:123], v19 offset:27904
    ds_read_b64_tr_b16 v[124:125], v19 offset:31744
    v_mfma_f32_32x32x16_bf16 v[80:95], v[156:159], v[188:191], v[80:95]
    ds_read_b64_tr_b16 v[126:127], v19 offset:32000
    s_waitcnt lgkmcnt(15)
    v_mfma_f32_32x32x16_bf16 v[64:79], v[96:99], v[160:163], v[64:79]
    s_waitcnt vmcnt(18)
    s_barrier
    ds_read_b128 v[176:179], v24 offset:49152
    ds_read_b64_tr_b16 v[128:129], v19 offset:49152
    ds_read_b64_tr_b16 v[130:131], v19 offset:49408
    s_add_u32 m0, s24, 73728
    s_mov_b32 s30, 86016
    buffer_load_dwordx4 v15, s[8:11], s30 offen offset:0 lds
    v_mfma_f32_32x32x16_bf16 v[80:95], v[100:103], v[160:163], v[80:95]
    ds_read_b64_tr_b16 v[132:133], v19 offset:53248
    ds_read_b64_tr_b16 v[134:135], v19 offset:53504
    ds_read_b128 v[180:183], v25 offset:49152
    buffer_load_dwordx4 v15, s[8:11], s30 offen offset:1024 lds
    s_waitcnt lgkmcnt(15)
    v_mfma_f32_32x32x16_bf16 v[64:79], v[104:107], v[164:167], v[64:79]
    ds_read_b64_tr_b16 v[136:137], v19 offset:50176
    ds_read_b64_tr_b16 v[138:139], v19 offset:50432
    ds_read_b64_tr_b16 v[140:141], v19 offset:54272
    buffer_load_dwordx4 v15, s[8:11], s30 offen offset:2048 lds
    v_mfma_f32_32x32x16_bf16 v[80:95], v[108:111], v[164:167], v[80:95]
    ds_read_b64_tr_b16 v[142:143], v19 offset:54528
    buffer_load_dwordx4 v15, s[8:11], s30 offen offset:3072 lds
    s_waitcnt lgkmcnt(15)
    v_mfma_f32_32x32x16_bf16 v[64:79], v[112:115], v[168:171], v[64:79]
    ds_read_b128 v[184:187], v26 offset:49152
    ds_read_b64_tr_b16 v[144:145], v19 offset:51200
    ds_read_b64_tr_b16 v[146:147], v19 offset:51456
    s_add_u32 m0, s25, 73728
    s_movk_i32 s31, 2688
    buffer_load_dwordx4 v16, s[12:15], s31 offen lds
    v_mfma_f32_32x32x16_bf16 v[80:95], v[116:119], v[168:171], v[80:95]
    ds_read_b64_tr_b16 v[148:149], v19 offset:55296
    ds_read_b64_tr_b16 v[150:151], v19 offset:55552
    ds_read_b128 v[188:191], v27 offset:49152
    buffer_load_dwordx4 v17, s[12:15], s31 offen offset:1024 lds
    s_waitcnt lgkmcnt(15)
    v_mfma_f32_32x32x16_bf16 v[64:79], v[120:123], v[172:175], v[64:79]
    ds_read_b64_tr_b16 v[152:153], v19 offset:52224
    ds_read_b64_tr_b16 v[154:155], v19 offset:52480
    ds_read_b64_tr_b16 v[156:157], v19 offset:56320
    v_mfma_f32_32x32x16_bf16 v[80:95], v[124:127], v[172:175], v[80:95]
    ds_read_b64_tr_b16 v[158:159], v19 offset:56576
    s_waitcnt lgkmcnt(15)
    v_mfma_f32_32x32x16_bf16 v[64:79], v[128:131], v[176:179], v[64:79]
    s_waitcnt vmcnt(18)
    s_barrier
    ds_read_b128 v[160:163], v20 offset:0
    ds_read_b64_tr_b16 v[96:97], v18 offset:0
    ds_read_b64_tr_b16 v[98:99], v18 offset:256
    s_add_u32 m0, s24, 98304
    s_mov_b32 s30, 90112
    buffer_load_dwordx4 v15, s[8:11], s30 offen offset:0 lds
    v_mfma_f32_32x32x16_bf16 v[80:95], v[132:135], v[176:179], v[80:95]
    ds_read_b64_tr_b16 v[100:101], v18 offset:4096
    ds_read_b64_tr_b16 v[102:103], v18 offset:4352
    ds_read_b128 v[164:167], v21 offset:0
    buffer_load_dwordx4 v15, s[8:11], s30 offen offset:1024 lds
    s_waitcnt lgkmcnt(15)
    v_mfma_f32_32x32x16_bf16 v[64:79], v[136:139], v[180:183], v[64:79]
    ds_read_b64_tr_b16 v[104:105], v18 offset:1024
    ds_read_b64_tr_b16 v[106:107], v18 offset:1280
    ds_read_b64_tr_b16 v[108:109], v18 offset:5120
    buffer_load_dwordx4 v15, s[8:11], s30 offen offset:2048 lds
    v_mfma_f32_32x32x16_bf16 v[80:95], v[140:143], v[180:183], v[80:95]
    ds_read_b64_tr_b16 v[110:111], v18 offset:5376
    buffer_load_dwordx4 v15, s[8:11], s30 offen offset:3072 lds
    s_waitcnt lgkmcnt(15)
    v_mfma_f32_32x32x16_bf16 v[64:79], v[144:147], v[184:187], v[64:79]
    ds_read_b128 v[168:171], v22 offset:0
    ds_read_b64_tr_b16 v[112:113], v18 offset:2048
    ds_read_b64_tr_b16 v[114:115], v18 offset:2304
    s_add_u32 m0, s25, 98304
    s_movk_i32 s31, 2816
    buffer_load_dwordx4 v16, s[12:15], s31 offen lds
    v_mfma_f32_32x32x16_bf16 v[80:95], v[148:151], v[184:187], v[80:95]
    ds_read_b64_tr_b16 v[116:117], v18 offset:6144
    ds_read_b64_tr_b16 v[118:119], v18 offset:6400
    ds_read_b128 v[172:175], v23 offset:0
    buffer_load_dwordx4 v17, s[12:15], s31 offen offset:1024 lds
    s_waitcnt lgkmcnt(15)
    v_mfma_f32_32x32x16_bf16 v[64:79], v[152:155], v[188:191], v[64:79]
    ds_read_b64_tr_b16 v[120:121], v18 offset:3072
    ds_read_b64_tr_b16 v[122:123], v18 offset:3328
    ds_read_b64_tr_b16 v[124:125], v18 offset:7168
    v_mfma_f32_32x32x16_bf16 v[80:95], v[156:159], v[188:191], v[80:95]
    ds_read_b64_tr_b16 v[126:127], v18 offset:7424
    s_waitcnt lgkmcnt(15)
    v_mfma_f32_32x32x16_bf16 v[64:79], v[96:99], v[160:163], v[64:79]
    s_waitcnt vmcnt(18)
    s_barrier
    ds_read_b128 v[176:179], v20 offset:24576
    ds_read_b64_tr_b16 v[128:129], v18 offset:24576
    ds_read_b64_tr_b16 v[130:131], v18 offset:24832
    s_add_u32 m0, s24, 122880
    s_mov_b32 s30, 94208
    buffer_load_dwordx4 v15, s[8:11], s30 offen offset:0 lds
    v_mfma_f32_32x32x16_bf16 v[80:95], v[100:103], v[160:163], v[80:95]
    ds_read_b64_tr_b16 v[132:133], v18 offset:28672
    ds_read_b64_tr_b16 v[134:135], v18 offset:28928
    ds_read_b128 v[180:183], v21 offset:24576
    buffer_load_dwordx4 v15, s[8:11], s30 offen offset:1024 lds
    s_waitcnt lgkmcnt(15)
    v_mfma_f32_32x32x16_bf16 v[64:79], v[104:107], v[164:167], v[64:79]
    ds_read_b64_tr_b16 v[136:137], v18 offset:25600
    ds_read_b64_tr_b16 v[138:139], v18 offset:25856
    ds_read_b64_tr_b16 v[140:141], v18 offset:29696
    buffer_load_dwordx4 v15, s[8:11], s30 offen offset:2048 lds
    v_mfma_f32_32x32x16_bf16 v[80:95], v[108:111], v[164:167], v[80:95]
    ds_read_b64_tr_b16 v[142:143], v18 offset:29952
    buffer_load_dwordx4 v15, s[8:11], s30 offen offset:3072 lds
    s_waitcnt lgkmcnt(15)
    v_mfma_f32_32x32x16_bf16 v[64:79], v[112:115], v[168:171], v[64:79]
    ds_read_b128 v[184:187], v22 offset:24576
    ds_read_b64_tr_b16 v[144:145], v18 offset:26624
    ds_read_b64_tr_b16 v[146:147], v18 offset:26880
    s_add_u32 m0, s25, 122880
    s_movk_i32 s31, 2944
    buffer_load_dwordx4 v16, s[12:15], s31 offen lds
    v_mfma_f32_32x32x16_bf16 v[80:95], v[116:119], v[168:171], v[80:95]
    ds_read_b64_tr_b16 v[148:149], v18 offset:30720
    ds_read_b64_tr_b16 v[150:151], v18 offset:30976
    ds_read_b128 v[188:191], v23 offset:24576
    buffer_load_dwordx4 v17, s[12:15], s31 offen offset:1024 lds
    s_waitcnt lgkmcnt(15)
    v_mfma_f32_32x32x16_bf16 v[64:79], v[120:123], v[172:175], v[64:79]
    ds_read_b64_tr_b16 v[152:153], v18 offset:27648
    ds_read_b64_tr_b16 v[154:155], v18 offset:27904
    ds_read_b64_tr_b16 v[156:157], v18 offset:31744
    v_mfma_f32_32x32x16_bf16 v[80:95], v[124:127], v[172:175], v[80:95]
    ds_read_b64_tr_b16 v[158:159], v18 offset:32000
    s_waitcnt lgkmcnt(15)
    v_mfma_f32_32x32x16_bf16 v[64:79], v[128:131], v[176:179], v[64:79]
    s_waitcnt vmcnt(18)
    s_barrier
    ds_read_b128 v[160:163], v20 offset:49152
    ds_read_b64_tr_b16 v[96:97], v18 offset:49152
    ds_read_b64_tr_b16 v[98:99], v18 offset:49408
    s_add_u32 m0, s24, 0
    s_mov_b32 s30, 98304
    buffer_load_dwordx4 v15, s[8:11], s30 offen offset:0 lds
    v_mfma_f32_32x32x16_bf16 v[80:95], v[132:135], v[176:179], v[80:95]
    ds_read_b64_tr_b16 v[100:101], v18 offset:53248
    ds_read_b64_tr_b16 v[102:103], v18 offset:53504
    ds_read_b128 v[164:167], v21 offset:49152
    buffer_load_dwordx4 v15, s[8:11], s30 offen offset:1024 lds
    s_waitcnt lgkmcnt(15)
    v_mfma_f32_32x32x16_bf16 v[64:79], v[136:139], v[180:183], v[64:79]
    ds_read_b64_tr_b16 v[104:105], v18 offset:50176
    ds_read_b64_tr_b16 v[106:107], v18 offset:50432
    ds_read_b64_tr_b16 v[108:109], v18 offset:54272
    buffer_load_dwordx4 v15, s[8:11], s30 offen offset:2048 lds
    v_mfma_f32_32x32x16_bf16 v[80:95], v[140:143], v[180:183], v[80:95]
    ds_read_b64_tr_b16 v[110:111], v18 offset:54528
    buffer_load_dwordx4 v15, s[8:11], s30 offen offset:3072 lds
    s_waitcnt lgkmcnt(15)
    v_mfma_f32_32x32x16_bf16 v[64:79], v[144:147], v[184:187], v[64:79]
    ds_read_b128 v[168:171], v22 offset:49152
    ds_read_b64_tr_b16 v[112:113], v18 offset:51200
    ds_read_b64_tr_b16 v[114:115], v18 offset:51456
    s_add_u32 m0, s25, 0
    s_movk_i32 s31, 3072
    buffer_load_dwordx4 v16, s[12:15], s31 offen lds
    v_mfma_f32_32x32x16_bf16 v[80:95], v[148:151], v[184:187], v[80:95]
    ds_read_b64_tr_b16 v[116:117], v18 offset:55296
    ds_read_b64_tr_b16 v[118:119], v18 offset:55552
    ds_read_b128 v[172:175], v23 offset:49152
    buffer_load_dwordx4 v17, s[12:15], s31 offen offset:1024 lds
    s_waitcnt lgkmcnt(15)
    v_mfma_f32_32x32x16_bf16 v[64:79], v[152:155], v[188:191], v[64:79]
    ds_read_b64_tr_b16 v[120:121], v18 offset:52224
    ds_read_b64_tr_b16 v[122:123], v18 offset:52480
    ds_read_b64_tr_b16 v[124:125], v18 offset:56320
    v_mfma_f32_32x32x16_bf16 v[80:95], v[156:159], v[188:191], v[80:95]
    ds_read_b64_tr_b16 v[126:127], v18 offset:56576
    s_waitcnt lgkmcnt(15)
    v_mfma_f32_32x32x16_bf16 v[64:79], v[96:99], v[160:163], v[64:79]
    s_waitcnt vmcnt(18)
    s_barrier
    ds_read_b128 v[176:179], v24 offset:0
    ds_read_b64_tr_b16 v[128:129], v19 offset:0
    ds_read_b64_tr_b16 v[130:131], v19 offset:256
    s_add_u32 m0, s24, 24576
    s_mov_b32 s30, 102400
    buffer_load_dwordx4 v15, s[8:11], s30 offen offset:0 lds
    v_mfma_f32_32x32x16_bf16 v[80:95], v[100:103], v[160:163], v[80:95]
    ds_read_b64_tr_b16 v[132:133], v19 offset:4096
    ds_read_b64_tr_b16 v[134:135], v19 offset:4352
    ds_read_b128 v[180:183], v25 offset:0
    buffer_load_dwordx4 v15, s[8:11], s30 offen offset:1024 lds
    s_waitcnt lgkmcnt(15)
    v_mfma_f32_32x32x16_bf16 v[64:79], v[104:107], v[164:167], v[64:79]
    ds_read_b64_tr_b16 v[136:137], v19 offset:1024
    ds_read_b64_tr_b16 v[138:139], v19 offset:1280
    ds_read_b64_tr_b16 v[140:141], v19 offset:5120
    buffer_load_dwordx4 v15, s[8:11], s30 offen offset:2048 lds
    v_mfma_f32_32x32x16_bf16 v[80:95], v[108:111], v[164:167], v[80:95]
    ds_read_b64_tr_b16 v[142:143], v19 offset:5376
    buffer_load_dwordx4 v15, s[8:11], s30 offen offset:3072 lds
    s_waitcnt lgkmcnt(15)
    v_mfma_f32_32x32x16_bf16 v[64:79], v[112:115], v[168:171], v[64:79]
    ds_read_b128 v[184:187], v26 offset:0
    ds_read_b64_tr_b16 v[144:145], v19 offset:2048
    ds_read_b64_tr_b16 v[146:147], v19 offset:2304
    s_add_u32 m0, s25, 24576
    s_movk_i32 s31, 3200
    buffer_load_dwordx4 v16, s[12:15], s31 offen lds
    v_mfma_f32_32x32x16_bf16 v[80:95], v[116:119], v[168:171], v[80:95]
    ds_read_b64_tr_b16 v[148:149], v19 offset:6144
    ds_read_b64_tr_b16 v[150:151], v19 offset:6400
    ds_read_b128 v[188:191], v27 offset:0
    buffer_load_dwordx4 v17, s[12:15], s31 offen offset:1024 lds
    s_waitcnt lgkmcnt(15)
    v_mfma_f32_32x32x16_bf16 v[64:79], v[120:123], v[172:175], v[64:79]
    ds_read_b64_tr_b16 v[152:153], v19 offset:3072
    ds_read_b64_tr_b16 v[154:155], v19 offset:3328
    ds_read_b64_tr_b16 v[156:157], v19 offset:7168
    v_mfma_f32_32x32x16_bf16 v[80:95], v[124:127], v[172:175], v[80:95]
    ds_read_b64_tr_b16 v[158:159], v19 offset:7424
    s_waitcnt lgkmcnt(15)
    v_mfma_f32_32x32x16_bf16 v[64:79], v[128:131], v[176:179], v[64:79]
    s_waitcnt vmcnt(18)
    s_barrier
    ds_read_b128 v[160:163], v24 offset:24576
    ds_read_b64_tr_b16 v[96:97], v19 offset:24576
    ds_read_b64_tr_b16 v[98:99], v19 offset:24832
    s_add_u32 m0, s24, 49152
    s_mov_b32 s30, 106496
    buffer_load_dwordx4 v15, s[8:11], s30 offen offset:0 lds
    v_mfma_f32_32x32x16_bf16 v[80:95], v[132:135], v[176:179], v[80:95]
    ds_read_b64_tr_b16 v[100:101], v19 offset:28672
    ds_read_b64_tr_b16 v[102:103], v19 offset:28928
    ds_read_b128 v[164:167], v25 offset:24576
    buffer_load_dwordx4 v15, s[8:11], s30 offen offset:1024 lds
    s_waitcnt lgkmcnt(15)
    v_mfma_f32_32x32x16_bf16 v[64:79], v[136:139], v[180:183], v[64:79]
    ds_read_b64_tr_b16 v[104:105], v19 offset:25600
    ds_read_b64_tr_b16 v[106:107], v19 offset:25856
    ds_read_b64_tr_b16 v[108:109], v19 offset:29696
    buffer_load_dwordx4 v15, s[8:11], s30 offen offset:2048 lds
    v_mfma_f32_32x32x16_bf16 v[80:95], v[140:143], v[180:183], v[80:95]
    ds_read_b64_tr_b16 v[110:111], v19 offset:29952
    buffer_load_dwordx4 v15, s[8:11], s30 offen offset:3072 lds
    s_waitcnt lgkmcnt(15)
    v_mfma_f32_32x32x16_bf16 v[64:79], v[144:147], v[184:187], v[64:79]
    ds_read_b128 v[168:171], v26 offset:24576
    ds_read_b64_tr_b16 v[112:113], v19 offset:26624
    ds_read_b64_tr_b16 v[114:115], v19 offset:26880
    s_add_u32 m0, s25, 49152
    s_movk_i32 s31, 3328
    buffer_load_dwordx4 v16, s[12:15], s31 offen lds
    v_mfma_f32_32x32x16_bf16 v[80:95], v[148:151], v[184:187], v[80:95]
    ds_read_b64_tr_b16 v[116:117], v19 offset:30720
    ds_read_b64_tr_b16 v[118:119], v19 offset:30976
    ds_read_b128 v[172:175], v27 offset:24576
    buffer_load_dwordx4 v17, s[12:15], s31 offen offset:1024 lds
    s_waitcnt lgkmcnt(15)
    v_mfma_f32_32x32x16_bf16 v[64:79], v[152:155], v[188:191], v[64:79]
    ds_read_b64_tr_b16 v[120:121], v19 offset:27648
    ds_read_b64_tr_b16 v[122:123], v19 offset:27904
    ds_read_b64_tr_b16 v[124:125], v19 offset:31744
    v_mfma_f32_32x32x16_bf16 v[80:95], v[156:159], v[188:191], v[80:95]
    ds_read_b64_tr_b16 v[126:127], v19 offset:32000
    s_waitcnt lgkmcnt(15)
    v_mfma_f32_32x32x16_bf16 v[64:79], v[96:99], v[160:163], v[64:79]
    s_waitcnt vmcnt(18)
    s_barrier
    ds_read_b128 v[176:179], v24 offset:49152
    ds_read_b64_tr_b16 v[128:129], v19 offset:49152
    ds_read_b64_tr_b16 v[130:131], v19 offset:49408
    s_add_u32 m0, s24, 73728
    s_mov_b32 s30, 110592
    buffer_load_dwordx4 v15, s[8:11], s30 offen offset:0 lds
    v_mfma_f32_32x32x16_bf16 v[80:95], v[100:103], v[160:163], v[80:95]
    ds_read_b64_tr_b16 v[132:133], v19 offset:53248
    ds_read_b64_tr_b16 v[134:135], v19 offset:53504
    ds_read_b128 v[180:183], v25 offset:49152
    buffer_load_dwordx4 v15, s[8:11], s30 offen offset:1024 lds
    s_waitcnt lgkmcnt(15)
    v_mfma_f32_32x32x16_bf16 v[64:79], v[104:107], v[164:167], v[64:79]
    ds_read_b64_tr_b16 v[136:137], v19 offset:50176
    ds_read_b64_tr_b16 v[138:139], v19 offset:50432
    ds_read_b64_tr_b16 v[140:141], v19 offset:54272
    buffer_load_dwordx4 v15, s[8:11], s30 offen offset:2048 lds
    v_mfma_f32_32x32x16_bf16 v[80:95], v[108:111], v[164:167], v[80:95]
    ds_read_b64_tr_b16 v[142:143], v19 offset:54528
    buffer_load_dwordx4 v15, s[8:11], s30 offen offset:3072 lds
    s_waitcnt lgkmcnt(15)
    v_mfma_f32_32x32x16_bf16 v[64:79], v[112:115], v[168:171], v[64:79]
    ds_read_b128 v[184:187], v26 offset:49152
    ds_read_b64_tr_b16 v[144:145], v19 offset:51200
    ds_read_b64_tr_b16 v[146:147], v19 offset:51456
    s_add_u32 m0, s25, 73728
    s_movk_i32 s31, 3456
    buffer_load_dwordx4 v16, s[12:15], s31 offen lds
    v_mfma_f32_32x32x16_bf16 v[80:95], v[116:119], v[168:171], v[80:95]
    ds_read_b64_tr_b16 v[148:149], v19 offset:55296
    ds_read_b64_tr_b16 v[150:151], v19 offset:55552
    ds_read_b128 v[188:191], v27 offset:49152
    buffer_load_dwordx4 v17, s[12:15], s31 offen offset:1024 lds
    s_waitcnt lgkmcnt(15)
    v_mfma_f32_32x32x16_bf16 v[64:79], v[120:123], v[172:175], v[64:79]
    ds_read_b64_tr_b16 v[152:153], v19 offset:52224
    ds_read_b64_tr_b16 v[154:155], v19 offset:52480
    ds_read_b64_tr_b16 v[156:157], v19 offset:56320
    v_mfma_f32_32x32x16_bf16 v[80:95], v[124:127], v[172:175], v[80:95]
    ds_read_b64_tr_b16 v[158:159], v19 offset:56576
    s_waitcnt lgkmcnt(15)
    v_mfma_f32_32x32x16_bf16 v[64:79], v[128:131], v[176:179], v[64:79]
    s_waitcnt vmcnt(18)
    s_barrier
    ds_read_b128 v[160:163], v20 offset:0
    ds_read_b64_tr_b16 v[96:97], v18 offset:0
    ds_read_b64_tr_b16 v[98:99], v18 offset:256
    s_add_u32 m0, s24, 98304
    s_mov_b32 s30, 114688
    buffer_load_dwordx4 v15, s[8:11], s30 offen offset:0 lds
    v_mfma_f32_32x32x16_bf16 v[80:95], v[132:135], v[176:179], v[80:95]
    ds_read_b64_tr_b16 v[100:101], v18 offset:4096
    ds_read_b64_tr_b16 v[102:103], v18 offset:4352
    ds_read_b128 v[164:167], v21 offset:0
    buffer_load_dwordx4 v15, s[8:11], s30 offen offset:1024 lds
    s_waitcnt lgkmcnt(15)
    v_mfma_f32_32x32x16_bf16 v[64:79], v[136:139], v[180:183], v[64:79]
    ds_read_b64_tr_b16 v[104:105], v18 offset:1024
    ds_read_b64_tr_b16 v[106:107], v18 offset:1280
    ds_read_b64_tr_b16 v[108:109], v18 offset:5120
    buffer_load_dwordx4 v15, s[8:11], s30 offen offset:2048 lds
    v_mfma_f32_32x32x16_bf16 v[80:95], v[140:143], v[180:183], v[80:95]
    ds_read_b64_tr_b16 v[110:111], v18 offset:5376
    buffer_load_dwordx4 v15, s[8:11], s30 offen offset:3072 lds
    s_waitcnt lgkmcnt(15)
    v_mfma_f32_32x32x16_bf16 v[64:79], v[144:147], v[184:187], v[64:79]
    ds_read_b128 v[168:171], v22 offset:0
    ds_read_b64_tr_b16 v[112:113], v18 offset:2048
    ds_read_b64_tr_b16 v[114:115], v18 offset:2304
    s_add_u32 m0, s25, 98304
    s_movk_i32 s31, 3584
    buffer_load_dwordx4 v16, s[12:15], s31 offen lds
    v_mfma_f32_32x32x16_bf16 v[80:95], v[148:151], v[184:187], v[80:95]
    ds_read_b64_tr_b16 v[116:117], v18 offset:6144
    ds_read_b64_tr_b16 v[118:119], v18 offset:6400
    ds_read_b128 v[172:175], v23 offset:0
    buffer_load_dwordx4 v17, s[12:15], s31 offen offset:1024 lds
    s_waitcnt lgkmcnt(15)
    v_mfma_f32_32x32x16_bf16 v[64:79], v[152:155], v[188:191], v[64:79]
    ds_read_b64_tr_b16 v[120:121], v18 offset:3072
    ds_read_b64_tr_b16 v[122:123], v18 offset:3328
    ds_read_b64_tr_b16 v[124:125], v18 offset:7168
    v_mfma_f32_32x32x16_bf16 v[80:95], v[156:159], v[188:191], v[80:95]
    ds_read_b64_tr_b16 v[126:127], v18 offset:7424
    s_waitcnt lgkmcnt(15)
    v_mfma_f32_32x32x16_bf16 v[64:79], v[96:99], v[160:163], v[64:79]
    s_waitcnt vmcnt(18)
    s_barrier
    ds_read_b128 v[176:179], v20 offset:24576
    ds_read_b64_tr_b16 v[128:129], v18 offset:24576
    ds_read_b64_tr_b16 v[130:131], v18 offset:24832
    s_add_u32 m0, s24, 122880
    s_mov_b32 s30, 118784
    buffer_load_dwordx4 v15, s[8:11], s30 offen offset:0 lds
    v_mfma_f32_32x32x16_bf16 v[80:95], v[100:103], v[160:163], v[80:95]
    ds_read_b64_tr_b16 v[132:133], v18 offset:28672
    ds_read_b64_tr_b16 v[134:135], v18 offset:28928
    ds_read_b128 v[180:183], v21 offset:24576
    buffer_load_dwordx4 v15, s[8:11], s30 offen offset:1024 lds
    s_waitcnt lgkmcnt(15)
    v_mfma_f32_32x32x16_bf16 v[64:79], v[104:107], v[164:167], v[64:79]
    ds_read_b64_tr_b16 v[136:137], v18 offset:25600
    ds_read_b64_tr_b16 v[138:139], v18 offset:25856
    ds_read_b64_tr_b16 v[140:141], v18 offset:29696
    buffer_load_dwordx4 v15, s[8:11], s30 offen offset:2048 lds
    v_mfma_f32_32x32x16_bf16 v[80:95], v[108:111], v[164:167], v[80:95]
    ds_read_b64_tr_b16 v[142:143], v18 offset:29952
    buffer_load_dwordx4 v15, s[8:11], s30 offen offset:3072 lds
    s_waitcnt lgkmcnt(15)
    v_mfma_f32_32x32x16_bf16 v[64:79], v[112:115], v[168:171], v[64:79]
    ds_read_b128 v[184:187], v22 offset:24576
    ds_read_b64_tr_b16 v[144:145], v18 offset:26624
    ds_read_b64_tr_b16 v[146:147], v18 offset:26880
    s_add_u32 m0, s25, 122880
    s_movk_i32 s31, 3712
    buffer_load_dwordx4 v16, s[12:15], s31 offen lds
    v_mfma_f32_32x32x16_bf16 v[80:95], v[116:119], v[168:171], v[80:95]
    ds_read_b64_tr_b16 v[148:149], v18 offset:30720
    ds_read_b64_tr_b16 v[150:151], v18 offset:30976
    ds_read_b128 v[188:191], v23 offset:24576
    buffer_load_dwordx4 v17, s[12:15], s31 offen offset:1024 lds
    s_waitcnt lgkmcnt(15)
    v_mfma_f32_32x32x16_bf16 v[64:79], v[120:123], v[172:175], v[64:79]
    ds_read_b64_tr_b16 v[152:153], v18 offset:27648
    ds_read_b64_tr_b16 v[154:155], v18 offset:27904
    ds_read_b64_tr_b16 v[156:157], v18 offset:31744
    v_mfma_f32_32x32x16_bf16 v[80:95], v[124:127], v[172:175], v[80:95]
    ds_read_b64_tr_b16 v[158:159], v18 offset:32000
    s_waitcnt lgkmcnt(15)
    v_mfma_f32_32x32x16_bf16 v[64:79], v[128:131], v[176:179], v[64:79]
    s_waitcnt vmcnt(18)
    s_barrier
    ds_read_b128 v[160:163], v20 offset:49152
    ds_read_b64_tr_b16 v[96:97], v18 offset:49152
    ds_read_b64_tr_b16 v[98:99], v18 offset:49408
    s_add_u32 m0, s24, 0
    s_mov_b32 s30, 122880
    buffer_load_dwordx4 v15, s[8:11], s30 offen offset:0 lds
    v_mfma_f32_32x32x16_bf16 v[80:95], v[132:135], v[176:179], v[80:95]
    ds_read_b64_tr_b16 v[100:101], v18 offset:53248
    ds_read_b64_tr_b16 v[102:103], v18 offset:53504
    ds_read_b128 v[164:167], v21 offset:49152
    buffer_load_dwordx4 v15, s[8:11], s30 offen offset:1024 lds
    s_waitcnt lgkmcnt(15)
    v_mfma_f32_32x32x16_bf16 v[64:79], v[136:139], v[180:183], v[64:79]
    ds_read_b64_tr_b16 v[104:105], v18 offset:50176
    ds_read_b64_tr_b16 v[106:107], v18 offset:50432
    ds_read_b64_tr_b16 v[108:109], v18 offset:54272
    buffer_load_dwordx4 v15, s[8:11], s30 offen offset:2048 lds
    v_mfma_f32_32x32x16_bf16 v[80:95], v[140:143], v[180:183], v[80:95]
    ds_read_b64_tr_b16 v[110:111], v18 offset:54528
    buffer_load_dwordx4 v15, s[8:11], s30 offen offset:3072 lds
    s_waitcnt lgkmcnt(15)
    v_mfma_f32_32x32x16_bf16 v[64:79], v[144:147], v[184:187], v[64:79]
    ds_read_b128 v[168:171], v22 offset:49152
    ds_read_b64_tr_b16 v[112:113], v18 offset:51200
    ds_read_b64_tr_b16 v[114:115], v18 offset:51456
    s_add_u32 m0, s25, 0
    s_movk_i32 s31, 3840
    buffer_load_dwordx4 v16, s[12:15], s31 offen lds
    v_mfma_f32_32x32x16_bf16 v[80:95], v[148:151], v[184:187], v[80:95]
    ds_read_b64_tr_b16 v[116:117], v18 offset:55296
    ds_read_b64_tr_b16 v[118:119], v18 offset:55552
    ds_read_b128 v[172:175], v23 offset:49152
    buffer_load_dwordx4 v17, s[12:15], s31 offen offset:1024 lds
    s_waitcnt lgkmcnt(15)
    v_mfma_f32_32x32x16_bf16 v[64:79], v[152:155], v[188:191], v[64:79]
    ds_read_b64_tr_b16 v[120:121], v18 offset:52224
    ds_read_b64_tr_b16 v[122:123], v18 offset:52480
    ds_read_b64_tr_b16 v[124:125], v18 offset:56320
    v_mfma_f32_32x32x16_bf16 v[80:95], v[156:159], v[188:191], v[80:95]
    ds_read_b64_tr_b16 v[126:127], v18 offset:56576
    s_waitcnt lgkmcnt(15)
    v_mfma_f32_32x32x16_bf16 v[64:79], v[96:99], v[160:163], v[64:79]
    s_waitcnt vmcnt(18)
    s_barrier
    ds_read_b128 v[176:179], v24 offset:0
    ds_read_b64_tr_b16 v[128:129], v19 offset:0
    ds_read_b64_tr_b16 v[130:131], v19 offset:256
    s_add_u32 m0, s24, 24576
    s_mov_b32 s30, 126976
    buffer_load_dwordx4 v15, s[8:11], s30 offen offset:0 lds
    v_mfma_f32_32x32x16_bf16 v[80:95], v[100:103], v[160:163], v[80:95]
    ds_read_b64_tr_b16 v[132:133], v19 offset:4096
    ds_read_b64_tr_b16 v[134:135], v19 offset:4352
    ds_read_b128 v[180:183], v25 offset:0
    buffer_load_dwordx4 v15, s[8:11], s30 offen offset:1024 lds
    s_waitcnt lgkmcnt(15)
    v_mfma_f32_32x32x16_bf16 v[64:79], v[104:107], v[164:167], v[64:79]
    ds_read_b64_tr_b16 v[136:137], v19 offset:1024
    ds_read_b64_tr_b16 v[138:139], v19 offset:1280
    ds_read_b64_tr_b16 v[140:141], v19 offset:5120
    buffer_load_dwordx4 v15, s[8:11], s30 offen offset:2048 lds
    v_mfma_f32_32x32x16_bf16 v[80:95], v[108:111], v[164:167], v[80:95]
    ds_read_b64_tr_b16 v[142:143], v19 offset:5376
    buffer_load_dwordx4 v15, s[8:11], s30 offen offset:3072 lds
    s_waitcnt lgkmcnt(15)
    v_mfma_f32_32x32x16_bf16 v[64:79], v[112:115], v[168:171], v[64:79]
    ds_read_b128 v[184:187], v26 offset:0
    ds_read_b64_tr_b16 v[144:145], v19 offset:2048
    ds_read_b64_tr_b16 v[146:147], v19 offset:2304
    s_add_u32 m0, s25, 24576
    s_movk_i32 s31, 3968
    buffer_load_dwordx4 v16, s[12:15], s31 offen lds
    v_mfma_f32_32x32x16_bf16 v[80:95], v[116:119], v[168:171], v[80:95]
    ds_read_b64_tr_b16 v[148:149], v19 offset:6144
    ds_read_b64_tr_b16 v[150:151], v19 offset:6400
    ds_read_b128 v[188:191], v27 offset:0
    buffer_load_dwordx4 v17, s[12:15], s31 offen offset:1024 lds
    s_waitcnt lgkmcnt(15)
    v_mfma_f32_32x32x16_bf16 v[64:79], v[120:123], v[172:175], v[64:79]
    ds_read_b64_tr_b16 v[152:153], v19 offset:3072
    ds_read_b64_tr_b16 v[154:155], v19 offset:3328
    ds_read_b64_tr_b16 v[156:157], v19 offset:7168
    v_mfma_f32_32x32x16_bf16 v[80:95], v[124:127], v[172:175], v[80:95]
    ds_read_b64_tr_b16 v[158:159], v19 offset:7424
    s_waitcnt lgkmcnt(15)
    v_mfma_f32_32x32x16_bf16 v[64:79], v[128:131], v[176:179], v[64:79]
    s_waitcnt vmcnt(18)
    s_barrier
    ds_read_b128 v[160:163], v24 offset:24576
    ds_read_b64_tr_b16 v[96:97], v19 offset:24576
    ds_read_b64_tr_b16 v[98:99], v19 offset:24832
    buffer_load_dwordx4 v[32:35], v15, s[16:19], 0 offen offset:0
    v_mfma_f32_32x32x16_bf16 v[80:95], v[132:135], v[176:179], v[80:95]
    ds_read_b64_tr_b16 v[100:101], v19 offset:28672
    ds_read_b64_tr_b16 v[102:103], v19 offset:28928
    ds_read_b128 v[164:167], v25 offset:24576
    buffer_load_dwordx4 v[36:39], v15, s[16:19], 0 offen offset:1024
    s_waitcnt lgkmcnt(15)
    v_mfma_f32_32x32x16_bf16 v[64:79], v[136:139], v[180:183], v[64:79]
    ds_read_b64_tr_b16 v[104:105], v19 offset:25600
    ds_read_b64_tr_b16 v[106:107], v19 offset:25856
    ds_read_b64_tr_b16 v[108:109], v19 offset:29696
    buffer_load_dwordx4 v[40:43], v15, s[16:19], 0 offen offset:2048
    v_mfma_f32_32x32x16_bf16 v[80:95], v[140:143], v[180:183], v[80:95]
    ds_read_b64_tr_b16 v[110:111], v19 offset:29952
    buffer_load_dwordx4 v[44:47], v15, s[16:19], 0 offen offset:3072
    s_waitcnt lgkmcnt(15)
    v_mfma_f32_32x32x16_bf16 v[64:79], v[144:147], v[184:187], v[64:79]
    ds_read_b128 v[168:171], v26 offset:24576
    ds_read_b64_tr_b16 v[112:113], v19 offset:26624
    ds_read_b64_tr_b16 v[114:115], v19 offset:26880
    buffer_load_ushort v28, v9, s[44:47], s32 offen
    v_mfma_f32_32x32x16_bf16 v[80:95], v[148:151], v[184:187], v[80:95]
    ds_read_b64_tr_b16 v[116:117], v19 offset:30720
    ds_read_b64_tr_b16 v[118:119], v19 offset:30976
    ds_read_b128 v[172:175], v27 offset:24576
    s_add_u32 m0, s39, 98304
    s_mov_b32 s30, 688128
    buffer_load_dwordx4 v29, s[52:55], s30 offen lds
    s_waitcnt lgkmcnt(15)
    v_mfma_f32_32x32x16_bf16 v[64:79], v[152:155], v[188:191], v[64:79]
    ds_read_b64_tr_b16 v[120:121], v19 offset:27648
    ds_read_b64_tr_b16 v[122:123], v19 offset:27904
    ds_read_b64_tr_b16 v[124:125], v19 offset:31744
    v_mfma_f32_32x32x16_bf16 v[80:95], v[156:159], v[188:191], v[80:95]
    ds_read_b64_tr_b16 v[126:127], v19 offset:32000
    s_add_u32 m0, s39, 102400
    s_mov_b32 s30, 702464
    buffer_load_dwordx4 v29, s[52:55], s30 offen lds
    s_waitcnt lgkmcnt(15)
    v_mfma_f32_32x32x16_bf16 v[64:79], v[96:99], v[160:163], v[64:79]
    s_waitcnt vmcnt(19)
    s_barrier
    ds_read_b128 v[176:179], v24 offset:49152
    ds_read_b64_tr_b16 v[128:129], v19 offset:49152
    ds_read_b64_tr_b16 v[130:131], v19 offset:49408
    v_mfma_f32_32x32x16_bf16 v[80:95], v[100:103], v[160:163], v[80:95]
    ds_read_b64_tr_b16 v[132:133], v19 offset:53248
    ds_read_b64_tr_b16 v[134:135], v19 offset:53504
    ds_read_b128 v[180:183], v25 offset:49152
    s_add_u32 m0, s39, 106496
    s_mov_b32 s30, 691712
    buffer_load_dwordx4 v29, s[52:55], s30 offen lds
    s_waitcnt lgkmcnt(15)
    v_mfma_f32_32x32x16_bf16 v[64:79], v[104:107], v[164:167], v[64:79]
    ds_read_b64_tr_b16 v[136:137], v19 offset:50176
    ds_read_b64_tr_b16 v[138:139], v19 offset:50432
    ds_read_b64_tr_b16 v[140:141], v19 offset:54272
    v_mfma_f32_32x32x16_bf16 v[80:95], v[108:111], v[164:167], v[80:95]
    ds_read_b64_tr_b16 v[142:143], v19 offset:54528
    s_add_u32 m0, s39, 110592
    s_mov_b32 s30, 706048
    buffer_load_dwordx4 v29, s[52:55], s30 offen lds
    s_waitcnt lgkmcnt(15)
    v_mfma_f32_32x32x16_bf16 v[64:79], v[112:115], v[168:171], v[64:79]
    ds_read_b128 v[184:187], v26 offset:49152
    ds_read_b64_tr_b16 v[144:145], v19 offset:51200
    ds_read_b64_tr_b16 v[146:147], v19 offset:51456
    v_mfma_f32_32x32x16_bf16 v[80:95], v[116:119], v[168:171], v[80:95]
    ds_read_b64_tr_b16 v[148:149], v19 offset:55296
    ds_read_b64_tr_b16 v[150:151], v19 offset:55552
    ds_read_b128 v[188:191], v27 offset:49152
    s_add_u32 m0, s39, 0
    s_mov_b32 s30, 0
    buffer_load_dwordx4 v29, s[52:55], s30 offen lds
    s_waitcnt lgkmcnt(15)
    v_mfma_f32_32x32x16_bf16 v[64:79], v[120:123], v[172:175], v[64:79]
    ds_read_b64_tr_b16 v[152:153], v19 offset:52224
    ds_read_b64_tr_b16 v[154:155], v19 offset:52480
    ds_read_b64_tr_b16 v[156:157], v19 offset:56320
    v_mfma_f32_32x32x16_bf16 v[80:95], v[124:127], v[172:175], v[80:95]
    ds_read_b64_tr_b16 v[158:159], v19 offset:56576
    s_add_u32 m0, s39, 4096
    s_mov_b32 s30, 14336
    buffer_load_dwordx4 v29, s[52:55], s30 offen lds
    s_waitcnt lgkmcnt(15)
    v_mfma_f32_32x32x16_bf16 v[64:79], v[128:131], v[176:179], v[64:79]
    s_waitcnt vmcnt(17)
    s_barrier
    ds_read_b128 v[160:163], v20 offset:0
    ds_read_b64_tr_b16 v[96:97], v18 offset:0
    ds_read_b64_tr_b16 v[98:99], v18 offset:256
    v_mfma_f32_32x32x16_bf16 v[80:95], v[132:135], v[176:179], v[80:95]
    ds_read_b64_tr_b16 v[100:101], v18 offset:4096
    ds_read_b64_tr_b16 v[102:103], v18 offset:4352
    ds_read_b128 v[164:167], v21 offset:0
    s_add_u32 m0, s39, 8192
    s_mov_b32 s30, 3584
    buffer_load_dwordx4 v29, s[52:55], s30 offen lds
    s_waitcnt lgkmcnt(15)
    v_mfma_f32_32x32x16_bf16 v[64:79], v[136:139], v[180:183], v[64:79]
    ds_read_b64_tr_b16 v[104:105], v18 offset:1024
    ds_read_b64_tr_b16 v[106:107], v18 offset:1280
    ds_read_b64_tr_b16 v[108:109], v18 offset:5120
    v_mfma_f32_32x32x16_bf16 v[80:95], v[140:143], v[180:183], v[80:95]
    ds_read_b64_tr_b16 v[110:111], v18 offset:5376
    s_add_u32 m0, s39, 12288
    s_mov_b32 s30, 17920
    buffer_load_dwordx4 v29, s[52:55], s30 offen lds
    s_waitcnt lgkmcnt(15)
    v_mfma_f32_32x32x16_bf16 v[64:79], v[144:147], v[184:187], v[64:79]
    ds_read_b128 v[168:171], v22 offset:0
    ds_read_b64_tr_b16 v[112:113], v18 offset:2048
    ds_read_b64_tr_b16 v[114:115], v18 offset:2304
    v_mfma_f32_32x32x16_bf16 v[80:95], v[148:151], v[184:187], v[80:95]
    ds_read_b64_tr_b16 v[116:117], v18 offset:6144
    ds_read_b64_tr_b16 v[118:119], v18 offset:6400
    ds_read_b128 v[172:175], v23 offset:0
    s_add_u32 m0, s39, 16384
    s_mov_b32 s30, 114688
    buffer_load_dwordx4 v29, s[52:55], s30 offen lds
    s_waitcnt lgkmcnt(15)
    v_mfma_f32_32x32x16_bf16 v[64:79], v[152:155], v[188:191], v[64:79]
    ds_read_b64_tr_b16 v[120:121], v18 offset:3072
    ds_read_b64_tr_b16 v[122:123], v18 offset:3328
    ds_read_b64_tr_b16 v[124:125], v18 offset:7168
    v_mfma_f32_32x32x16_bf16 v[80:95], v[156:159], v[188:191], v[80:95]
    ds_read_b64_tr_b16 v[126:127], v18 offset:7424
    s_add_u32 m0, s39, 20480
    s_mov_b32 s30, 129024
    buffer_load_dwordx4 v29, s[52:55], s30 offen lds
    s_waitcnt lgkmcnt(15)
    v_mfma_f32_32x32x16_bf16 v[64:79], v[96:99], v[160:163], v[64:79]
    s_waitcnt vmcnt(15)
    s_barrier
    ds_read_b128 v[176:179], v20 offset:24576
    ds_read_b64_tr_b16 v[128:129], v18 offset:24576
    ds_read_b64_tr_b16 v[130:131], v18 offset:24832
    v_mfma_f32_32x32x16_bf16 v[80:95], v[100:103], v[160:163], v[80:95]
    ds_read_b64_tr_b16 v[132:133], v18 offset:28672
    ds_read_b64_tr_b16 v[134:135], v18 offset:28928
    ds_read_b128 v[180:183], v21 offset:24576
    s_add_u32 m0, s39, 24576
    s_mov_b32 s30, 118272
    buffer_load_dwordx4 v29, s[52:55], s30 offen lds
    s_waitcnt lgkmcnt(15)
    v_mfma_f32_32x32x16_bf16 v[64:79], v[104:107], v[164:167], v[64:79]
    ds_read_b64_tr_b16 v[136:137], v18 offset:25600
    ds_read_b64_tr_b16 v[138:139], v18 offset:25856
    ds_read_b64_tr_b16 v[140:141], v18 offset:29696
    v_mfma_f32_32x32x16_bf16 v[80:95], v[108:111], v[164:167], v[80:95]
    ds_read_b64_tr_b16 v[142:143], v18 offset:29952
    s_add_u32 m0, s39, 28672
    s_mov_b32 s30, 132608
    buffer_load_dwordx4 v29, s[52:55], s30 offen lds
    s_waitcnt lgkmcnt(15)
    v_mfma_f32_32x32x16_bf16 v[64:79], v[112:115], v[168:171], v[64:79]
    ds_read_b128 v[184:187], v22 offset:24576
    ds_read_b64_tr_b16 v[144:145], v18 offset:26624
    ds_read_b64_tr_b16 v[146:147], v18 offset:26880
    v_mfma_f32_32x32x16_bf16 v[80:95], v[116:119], v[168:171], v[80:95]
    ds_read_b64_tr_b16 v[148:149], v18 offset:30720
    ds_read_b64_tr_b16 v[150:151], v18 offset:30976
    ds_read_b128 v[188:191], v23 offset:24576
    s_add_u32 m0, s39, 32768
    s_mov_b32 s30, 229376
    buffer_load_dwordx4 v29, s[52:55], s30 offen lds
    s_waitcnt lgkmcnt(15)
    v_mfma_f32_32x32x16_bf16 v[64:79], v[120:123], v[172:175], v[64:79]
    ds_read_b64_tr_b16 v[152:153], v18 offset:27648
    ds_read_b64_tr_b16 v[154:155], v18 offset:27904
    ds_read_b64_tr_b16 v[156:157], v18 offset:31744
    v_mfma_f32_32x32x16_bf16 v[80:95], v[124:127], v[172:175], v[80:95]
    ds_read_b64_tr_b16 v[158:159], v18 offset:32000
    s_add_u32 m0, s39, 36864
    s_mov_b32 s30, 243712
    buffer_load_dwordx4 v29, s[52:55], s30 offen lds
    s_waitcnt lgkmcnt(15)
    v_mfma_f32_32x32x16_bf16 v[64:79], v[128:131], v[176:179], v[64:79]
    v_mfma_f32_32x32x16_bf16 v[80:95], v[132:135], v[176:179], v[80:95]
    s_add_u32 m0, s39, 40960
    s_mov_b32 s30, 232960
    buffer_load_dwordx4 v29, s[52:55], s30 offen lds
    s_waitcnt lgkmcnt(12)
    v_mfma_f32_32x32x16_bf16 v[64:79], v[136:139], v[180:183], v[64:79]
    s_waitcnt lgkmcnt(10)
    v_mfma_f32_32x32x16_bf16 v[80:95], v[140:143], v[180:183], v[80:95]
    s_add_u32 m0, s39, 45056
    s_mov_b32 s30, 247296
    buffer_load_dwordx4 v29, s[52:55], s30 offen lds
    s_waitcnt lgkmcnt(7)
    v_mfma_f32_32x32x16_bf16 v[64:79], v[144:147], v[184:187], v[64:79]
    s_waitcnt lgkmcnt(5)
    v_mfma_f32_32x32x16_bf16 v[80:95], v[148:151], v[184:187], v[80:95]
    s_add_u32 m0, s39, 49152
    s_mov_b32 s30, 344064
    buffer_load_dwordx4 v29, s[52:55], s30 offen lds
    s_waitcnt lgkmcnt(2)
    v_mfma_f32_32x32x16_bf16 v[64:79], v[152:155], v[188:191], v[64:79]
    s_waitcnt lgkmcnt(0)
    v_mfma_f32_32x32x16_bf16 v[80:95], v[156:159], v[188:191], v[80:95]
    s_add_u32 m0, s39, 53248
    s_mov_b32 s30, 358400
    buffer_load_dwordx4 v29, s[52:55], s30 offen lds
    s_waitcnt vmcnt(18)
    v_lshlrev_b32 v28, 16, v28
    v_lshlrev_b32 v128, 16, v32
    v_and_b32 v129, 0xffff0000, v32
    v_lshlrev_b32 v130, 16, v33
    v_and_b32 v131, 0xffff0000, v33
    v_lshlrev_b32 v132, 16, v34
    v_and_b32 v133, 0xffff0000, v34
    v_lshlrev_b32 v134, 16, v35
    v_and_b32 v135, 0xffff0000, v35
    v_add_f32 v64, v64, v28
    v_add_f32 v65, v65, v28
    v_add_f32 v66, v66, v28
    v_add_f32 v67, v67, v28
    v_add_f32 v68, v68, v28
    v_add_f32 v69, v69, v28
    v_add_f32 v70, v70, v28
    v_add_f32 v71, v71, v28
    v_mul_f32 v64, v64, v128
    v_mul_f32 v65, v65, v129
    v_mul_f32 v66, v66, v130
    v_mul_f32 v67, v67, v131
    v_mul_f32 v68, v68, v132
    v_mul_f32 v69, v69, v133
    v_mul_f32 v70, v70, v134
    v_mul_f32 v71, v71, v135
    v_cvt_pk_bf16_f32 v136, v64, v65
    v_cvt_pk_bf16_f32 v137, v66, v67
    v_cvt_pk_bf16_f32 v138, v68, v69
    v_cvt_pk_bf16_f32 v139, v70, v71
    buffer_store_dwordx4 v[136:139], v15, s[40:43], 0 offen offset:0 sc1
    v_lshlrev_b32 v128, 16, v36
    v_and_b32 v129, 0xffff0000, v36
    v_lshlrev_b32 v130, 16, v37
    v_and_b32 v131, 0xffff0000, v37
    v_lshlrev_b32 v132, 16, v38
    v_and_b32 v133, 0xffff0000, v38
    v_lshlrev_b32 v134, 16, v39
    v_and_b32 v135, 0xffff0000, v39
    v_add_f32 v72, v72, v28
    v_add_f32 v73, v73, v28
    v_add_f32 v74, v74, v28
    v_add_f32 v75, v75, v28
    v_add_f32 v76, v76, v28
    v_add_f32 v77, v77, v28
    v_add_f32 v78, v78, v28
    v_add_f32 v79, v79, v28
    v_mul_f32 v72, v72, v128
    v_mul_f32 v73, v73, v129
    v_mul_f32 v74, v74, v130
    v_mul_f32 v75, v75, v131
    v_mul_f32 v76, v76, v132
    v_mul_f32 v77, v77, v133
    v_mul_f32 v78, v78, v134
    v_mul_f32 v79, v79, v135
    v_cvt_pk_bf16_f32 v140, v72, v73
    v_cvt_pk_bf16_f32 v141, v74, v75
    v_cvt_pk_bf16_f32 v142, v76, v77
    v_cvt_pk_bf16_f32 v143, v78, v79
    buffer_store_dwordx4 v[140:143], v15, s[40:43], 0 offen offset:1024 sc1
    v_lshlrev_b32 v128, 16, v40
    v_and_b32 v129, 0xffff0000, v40
    v_lshlrev_b32 v130, 16, v41
    v_and_b32 v131, 0xffff0000, v41
    v_lshlrev_b32 v132, 16, v42
    v_and_b32 v133, 0xffff0000, v42
    v_lshlrev_b32 v134, 16, v43
    v_and_b32 v135, 0xffff0000, v43
    v_add_f32 v80, v80, v28
    v_add_f32 v81, v81, v28
    v_add_f32 v82, v82, v28
    v_add_f32 v83, v83, v28
    v_add_f32 v84, v84, v28
    v_add_f32 v85, v85, v28
    v_add_f32 v86, v86, v28
    v_add_f32 v87, v87, v28
    v_mul_f32 v80, v80, v128
    v_mul_f32 v81, v81, v129
    v_mul_f32 v82, v82, v130
    v_mul_f32 v83, v83, v131
    v_mul_f32 v84, v84, v132
    v_mul_f32 v85, v85, v133
    v_mul_f32 v86, v86, v134
    v_mul_f32 v87, v87, v135
    v_cvt_pk_bf16_f32 v144, v80, v81
    v_cvt_pk_bf16_f32 v145, v82, v83
    v_cvt_pk_bf16_f32 v146, v84, v85
    v_cvt_pk_bf16_f32 v147, v86, v87
    buffer_store_dwordx4 v[144:147], v15, s[40:43], 0 offen offset:2048 sc1
    v_lshlrev_b32 v128, 16, v44
    v_and_b32 v129, 0xffff0000, v44
    v_lshlrev_b32 v130, 16, v45
    v_and_b32 v131, 0xffff0000, v45
    v_lshlrev_b32 v132, 16, v46
    v_and_b32 v133, 0xffff0000, v46
    v_lshlrev_b32 v134, 16, v47
    v_and_b32 v135, 0xffff0000, v47
    v_add_f32 v88, v88, v28
    v_add_f32 v89, v89, v28
    v_add_f32 v90, v90, v28
    v_add_f32 v91, v91, v28
    v_add_f32 v92, v92, v28
    v_add_f32 v93, v93, v28
    v_add_f32 v94, v94, v28
    v_add_f32 v95, v95, v28
    v_mul_f32 v88, v88, v128
    v_mul_f32 v89, v89, v129
    v_mul_f32 v90, v90, v130
    v_mul_f32 v91, v91, v131
    v_mul_f32 v92, v92, v132
    v_mul_f32 v93, v93, v133
    v_mul_f32 v94, v94, v134
    v_mul_f32 v95, v95, v135
    v_cvt_pk_bf16_f32 v148, v88, v89
    v_cvt_pk_bf16_f32 v149, v90, v91
    v_cvt_pk_bf16_f32 v150, v92, v93
    v_cvt_pk_bf16_f32 v151, v94, v95
    buffer_store_dwordx4 v[148:151], v15, s[40:43], 0 offen offset:3072 sc1
    s_add_u32 m0, s39, 57344
    s_mov_b32 s30, 347648
    buffer_load_dwordx4 v29, s[52:55], s30 offen lds
    s_add_u32 m0, s39, 61440
    s_mov_b32 s30, 361984
    buffer_load_dwordx4 v29, s[52:55], s30 offen lds
    s_add_u32 m0, s39, 65536
    s_mov_b32 s30, 458752
    buffer_load_dwordx4 v29, s[52:55], s30 offen lds
    s_add_u32 m0, s39, 69632
    s_mov_b32 s30, 473088
    buffer_load_dwordx4 v29, s[52:55], s30 offen lds
    s_add_u32 m0, s39, 73728
    s_mov_b32 s30, 462336
    buffer_load_dwordx4 v29, s[52:55], s30 offen lds
    s_add_u32 m0, s39, 77824
    s_mov_b32 s30, 476672
    buffer_load_dwordx4 v29, s[52:55], s30 offen lds
    s_add_u32 m0, s39, 81920
    s_mov_b32 s30, 573440
    buffer_load_dwordx4 v29, s[52:55], s30 offen lds
    s_add_u32 m0, s39, 86016
    s_mov_b32 s30, 587776
    buffer_load_dwordx4 v29, s[52:55], s30 offen lds
    s_add_u32 m0, s39, 90112
    s_mov_b32 s30, 577024
    buffer_load_dwordx4 v29, s[52:55], s30 offen lds
    s_add_u32 m0, s39, 94208
    s_mov_b32 s30, 591360
    buffer_load_dwordx4 v29, s[52:55], s30 offen lds
    s_lshl_b32 s24, s20, 1
    s_add_u32 s24, s24, s26
    s_mul_i32 s25, s24, 57344
    s_mul_i32 s28, s27, 28672
    s_add_u32 s25, s25, s28
    s_add_u32 s25, s25, 16777216
    s_lshl_b32 s32, s21, 1
    s_add_u32 s32, s32, s27
    s_mul_i32 s33, s24, 28672
    s_lshl_b32 s34, s32, 11
    s_add_u32 s33, s33, s34
    s_add_u32 s33, s33, 4194304
    s_lshl_b32 s34, s32, 7
    s_add_u32 s34, s34, 8960
    v_lshlrev_b32 v9, 5, v3
    v_lshlrev_b32 v10, 10, v3
    v_lshl_add_u32 v10, v5, 6, v10
    v_add_u32 v10, v10, v14
    s_mul_i32 s29, s27, 57856
    s_add_u32 s29, s29, 49152
    v_add_u32 v10, s29, v10
    v_xor_b32 v11, 512, v10
    s_add_u32 s12, s36, s25
    s_addc_u32 s13, s37, 0
    s_mov_b32 s14, 28672
    s_mov_b32 s15, 0x20000
    s_add_u32 s16, s36, s33
    s_addc_u32 s17, s37, 0
    s_mov_b32 s18, 2048
    s_mov_b32 s19, 0x20000
    s_mov_b32 s40, s36
    s_mov_b32 s41, s37
    s_mov_b32 s42, 10752
    s_mov_b32 s43, 0x20000
    s_mov_b32 s44, s50
    s_mov_b32 s45, s51
    s_mov_b32 s46, 1835008
    s_mov_b32 s47, 0x20000
    buffer_load_dwordx4 v[208:211], v15, s[16:19], 0 offen offset:0
    buffer_load_dwordx4 v[216:219], v9, s[40:43], s34 offen offset:0
    buffer_load_dwordx4 v[220:223], v9, s[40:43], s34 offen offset:16
    buffer_load_dwordx4 v[212:215], v15, s[16:19], 0 offen offset:1024
    buffer_load_dwordx4 v[224:227], v9, s[40:43], s34 offen offset:64
    buffer_load_dwordx4 v[228:231], v9, s[40:43], s34 offen offset:80
    s_mov_b32 s38, 0x8000
    s_waitcnt vmcnt(32)
    s_movk_i32 s31, 0
    buffer_load_dwordx4 v[32:35], v15, s[12:15], s31 offen offset:0 sc1
    s_movk_i32 s31, 0
    buffer_load_dwordx4 v[36:39], v15, s[12:15], s31 offen offset:1024 sc1
    s_movk_i32 s31, 0
    buffer_load_dwordx4 v[40:43], v15, s[12:15], s31 offen offset:2048 sc1
    s_movk_i32 s31, 0
    buffer_load_dwordx4 v[44:47], v15, s[12:15], s31 offen offset:3072 sc1
    s_movk_i32 s31, 4096
    buffer_load_dwordx4 v[48:51], v15, s[12:15], s31 offen offset:0 sc1
    s_movk_i32 s31, 4096
    buffer_load_dwordx4 v[52:55], v15, s[12:15], s31 offen offset:1024 sc1
    s_movk_i32 s31, 4096
    buffer_load_dwordx4 v[56:59], v15, s[12:15], s31 offen offset:2048 sc1
    s_movk_i32 s31, 4096
    buffer_load_dwordx4 v[60:63], v15, s[12:15], s31 offen offset:3072 sc1
    s_movk_i32 s31, 8192
    buffer_load_dwordx4 v[64:67], v15, s[12:15], s31 offen offset:0 sc1
    s_movk_i32 s31, 8192
    buffer_load_dwordx4 v[68:71], v15, s[12:15], s31 offen offset:1024 sc1
    s_movk_i32 s31, 8192
    buffer_load_dwordx4 v[72:75], v15, s[12:15], s31 offen offset:2048 sc1
    s_movk_i32 s31, 8192
    buffer_load_dwordx4 v[76:79], v15, s[12:15], s31 offen offset:3072 sc1
    s_waitcnt vmcnt(18)
    s_barrier
    ds_read_b64_tr_b16 v[176:177], v10 offset:0
    ds_read_b64_tr_b16 v[178:179], v10 offset:256
    ds_read_b64_tr_b16 v[180:181], v11 offset:0
    ds_read_b64_tr_b16 v[182:183], v11 offset:256
    ds_read_b64_tr_b16 v[184:185], v10 offset:2048
    ds_read_b64_tr_b16 v[186:187], v10 offset:2304
    ds_read_b64_tr_b16 v[188:189], v11 offset:2048
    ds_read_b64_tr_b16 v[190:191], v11 offset:2304
    ds_read_b64_tr_b16 v[192:193], v10 offset:4096
    ds_read_b64_tr_b16 v[194:195], v10 offset:4352
    ds_read_b64_tr_b16 v[196:197], v11 offset:4096
    ds_read_b64_tr_b16 v[198:199], v11 offset:4352
    s_waitcnt vmcnt(11)
    v_max_u32 v16, v33, v35
    s_waitcnt vmcnt(10)
    v_max3_u32 v16, v16, v37, v39
    s_waitcnt vmcnt(9)
    v_max3_u32 v16, v16, v41, v43
    s_waitcnt vmcnt(8)
    v_max3_u32 v16, v16, v45, v47
    v_cmp_eq_u32 vcc, -1, v16
    s_cbranch_vccnz Lef_wait0
Lef_got0:
    s_waitcnt lgkmcnt(10)
    v_mfma_f32_32x32x16_bf16 v[144:159], v[176:179], v[32:35], 0
    ds_read_b64_tr_b16 v[200:201], v10 offset:6144
    ds_read_b64_tr_b16 v[202:203], v10 offset:6400
    s_movk_i32 s31, 12288
    buffer_load_dwordx4 v[80:83], v15, s[12:15], s31 offen offset:0 sc1
    s_waitcnt lgkmcnt(10)
    v_mfma_f32_32x32x16_bf16 v[160:175], v[180:183], v[32:35], 0
    ds_read_b64_tr_b16 v[204:205], v11 offset:6144
    ds_read_b64_tr_b16 v[206:207], v11 offset:6400
    s_movk_i32 s31, 12288
    buffer_load_dwordx4 v[84:87], v15, s[12:15], s31 offen offset:1024 sc1
    s_waitcnt lgkmcnt(10)
    v_mfma_f32_32x32x16_bf16 v[144:159], v[184:187], v[36:39], v[144:159]
    ds_read_b64_tr_b16 v[176:177], v10 offset:8192
    ds_read_b64_tr_b16 v[178:179], v10 offset:8448
    s_movk_i32 s31, 12288
    buffer_load_dwordx4 v[88:91], v15, s[12:15], s31 offen offset:2048 sc1
    s_waitcnt lgkmcnt(10)
    v_mfma_f32_32x32x16_bf16 v[160:175], v[188:191], v[36:39], v[160:175]
    ds_read_b64_tr_b16 v[180:181], v11 offset:8192
    ds_read_b64_tr_b16 v[182:183], v11 offset:8448
    s_movk_i32 s31, 12288
    buffer_load_dwordx4 v[92:95], v15, s[12:15], s31 offen offset:3072 sc1
    s_waitcnt lgkmcnt(10)
    v_mfma_f32_32x32x16_bf16 v[144:159], v[192:195], v[40:43], v[144:159]
    ds_read_b64_tr_b16 v[184:185], v10 offset:10240
    ds_read_b64_tr_b16 v[186:187], v10 offset:10496
    s_movk_i32 s31, 16384
    buffer_load_dwordx4 v[96:99], v15, s[12:15], s31 offen offset:0 sc1
    s_waitcnt lgkmcnt(10)
    v_mfma_f32_32x32x16_bf16 v[160:175], v[196:199], v[40:43], v[160:175]
    ds_read_b64_tr_b16 v[188:189], v11 offset:10240
    ds_read_b64_tr_b16 v[190:191], v11 offset:10496
    s_movk_i32 s31, 16384
    buffer_load_dwordx4 v[100:103], v15, s[12:15], s31 offen offset:1024 sc1
    s_waitcnt lgkmcnt(10)
    v_mfma_f32_32x32x16_bf16 v[144:159], v[200:203], v[44:47], v[144:159]
    ds_read_b64_tr_b16 v[192:193], v10 offset:12288
    ds_read_b64_tr_b16 v[194:195], v10 offset:12544
    s_movk_i32 s31, 16384
    buffer_load_dwordx4 v[104:107], v15, s[12:15], s31 offen offset:2048 sc1
    s_waitcnt lgkmcnt(10)
    v_mfma_f32_32x32x16_bf16 v[160:175], v[204:207], v[44:47], v[160:175]
    ds_read_b64_tr_b16 v[196:197], v11 offset:12288
    ds_read_b64_tr_b16 v[198:199], v11 offset:12544
    s_movk_i32 s31, 16384
    buffer_load_dwordx4 v[108:111], v15, s[12:15], s31 offen offset:3072 sc1
    s_waitcnt vmcnt(15)
    v_max_u32 v16, v49, v51
    s_waitcnt vmcnt(14)
    v_max3_u32 v16, v16, v53, v55
    s_waitcnt vmcnt(13)
    v_max3_u32 v16, v16, v57, v59
    s_waitcnt vmcnt(12)
    v_max3_u32 v16, v16, v61, v63
    v_cmp_eq_u32 vcc, -1, v16
    s_cbranch_vccnz Lef_wait1
Lef_got1:
    s_waitcnt lgkmcnt(10)
    v_mfma_f32_32x32x16_bf16 v[144:159], v[176:179], v[48:51], v[144:159]
    ds_read_b64_tr_b16 v[200:201], v10 offset:14336
    ds_read_b64_tr_b16 v[202:203], v10 offset:14592
    s_movk_i32 s31, 20480
    buffer_load_dwordx4 v[112:115], v15, s[12:15], s31 offen offset:0 sc1
    s_waitcnt lgkmcnt(10)
    v_mfma_f32_32x32x16_bf16 v[160:175], v[180:183], v[48:51], v[160:175]
    ds_read_b64_tr_b16 v[204:205], v11 offset:14336
    ds_read_b64_tr_b16 v[206:207], v11 offset:14592
    s_movk_i32 s31, 20480
    buffer_load_dwordx4 v[116:119], v15, s[12:15], s31 offen offset:1024 sc1
    s_waitcnt lgkmcnt(10)
    v_mfma_f32_32x32x16_bf16 v[144:159], v[184:187], v[52:55], v[144:159]
    ds_read_b64_tr_b16 v[176:177], v10 offset:16384
    ds_read_b64_tr_b16 v[178:179], v10 offset:16640
    s_movk_i32 s31, 20480
    buffer_load_dwordx4 v[120:123], v15, s[12:15], s31 offen offset:2048 sc1
    s_waitcnt lgkmcnt(10)
    v_mfma_f32_32x32x16_bf16 v[160:175], v[188:191], v[52:55], v[160:175]
    ds_read_b64_tr_b16 v[180:181], v11 offset:16384
    ds_read_b64_tr_b16 v[182:183], v11 offset:16640
    s_movk_i32 s31, 20480
    buffer_load_dwordx4 v[124:127], v15, s[12:15], s31 offen offset:3072 sc1
    s_waitcnt lgkmcnt(10)
    v_mfma_f32_32x32x16_bf16 v[144:159], v[192:195], v[56:59], v[144:159]
    ds_read_b64_tr_b16 v[184:185], v10 offset:18432
    ds_read_b64_tr_b16 v[186:187], v10 offset:18688
    s_movk_i32 s31, 24576
    buffer_load_dwordx4 v[128:131], v15, s[12:15], s31 offen offset:0 sc1
    s_waitcnt lgkmcnt(10)
    v_mfma_f32_32x32x16_bf16 v[160:175], v[196:199], v[56:59], v[160:175]
    ds_read_b64_tr_b16 v[188:189], v11 offset:18432
    ds_read_b64_tr_b16 v[190:191], v11 offset:18688
    s_movk_i32 s31, 24576
    buffer_load_dwordx4 v[132:135], v15, s[12:15], s31 offen offset:1024 sc1
    s_waitcnt lgkmcnt(10)
    v_mfma_f32_32x32x16_bf16 v[144:159], v[200:203], v[60:63], v[144:159]
    ds_read_b64_tr_b16 v[192:193], v10 offset:20480
    ds_read_b64_tr_b16 v[194:195], v10 offset:20736
    s_movk_i32 s31, 24576
    buffer_load_dwordx4 v[136:139], v15, s[12:15], s31 offen offset:2048 sc1
    s_waitcnt lgkmcnt(10)
    v_mfma_f32_32x32x16_bf16 v[160:175], v[204:207], v[60:63], v[160:175]
    ds_read_b64_tr_b16 v[196:197], v11 offset:20480
    ds_read_b64_tr_b16 v[198:199], v11 offset:20736
    s_movk_i32 s31, 24576
    buffer_load_dwordx4 v[140:143], v15, s[12:15], s31 offen offset:3072 sc1
    s_waitcnt vmcnt(19)
    v_max_u32 v16, v65, v67
    s_waitcnt vmcnt(18)
    v_max3_u32 v16, v16, v69, v71
    s_waitcnt vmcnt(17)
    v_max3_u32 v16, v16, v73, v75
    s_waitcnt vmcnt(16)
    v_max3_u32 v16, v16, v77, v79
    v_cmp_eq_u32 vcc, -1, v16
    s_cbranch_vccnz Lef_wait2
Lef_got2:
    s_waitcnt lgkmcnt(10)
    v_mfma_f32_32x32x16_bf16 v[144:159], v[176:179], v[64:67], v[144:159]
    ds_read_b64_tr_b16 v[200:201], v10 offset:22528
    ds_read_b64_tr_b16 v[202:203], v10 offset:22784
    s_waitcnt lgkmcnt(10)
    v_mfma_f32_32x32x16_bf16 v[160:175], v[180:183], v[64:67], v[160:175]
    ds_read_b64_tr_b16 v[204:205], v11 offset:22528
    ds_read_b64_tr_b16 v[206:207], v11 offset:22784
    s_waitcnt lgkmcnt(10)
    v_mfma_f32_32x32x16_bf16 v[144:159], v[184:187], v[68:71], v[144:159]
    ds_read_b64_tr_b16 v[176:177], v10 offset:24576
    ds_read_b64_tr_b16 v[178:179], v10 offset:24832
    s_waitcnt lgkmcnt(10)
    v_mfma_f32_32x32x16_bf16 v[160:175], v[188:191], v[68:71], v[160:175]
    ds_read_b64_tr_b16 v[180:181], v11 offset:24576
    ds_read_b64_tr_b16 v[182:183], v11 offset:24832
    s_waitcnt lgkmcnt(10)
    v_mfma_f32_32x32x16_bf16 v[144:159], v[192:195], v[72:75], v[144:159]
    ds_read_b64_tr_b16 v[184:185], v10 offset:26624
    ds_read_b64_tr_b16 v[186:187], v10 offset:26880
    s_waitcnt lgkmcnt(10)
    v_mfma_f32_32x32x16_bf16 v[160:175], v[196:199], v[72:75], v[160:175]
    ds_read_b64_tr_b16 v[188:189], v11 offset:26624
    ds_read_b64_tr_b16 v[190:191], v11 offset:26880
    s_waitcnt lgkmcnt(10)
    v_mfma_f32_32x32x16_bf16 v[144:159], v[200:203], v[76:79], v[144:159]
    ds_read_b64_tr_b16 v[192:193], v10 offset:28672
    ds_read_b64_tr_b16 v[194:195], v10 offset:28928
    s_waitcnt lgkmcnt(10)
    v_mfma_f32_32x32x16_bf16 v[160:175], v[204:207], v[76:79], v[160:175]
    ds_read_b64_tr_b16 v[196:197], v11 offset:28672
    ds_read_b64_tr_b16 v[198:199], v11 offset:28928
    s_waitcnt vmcnt(15)
    v_max_u32 v16, v81, v83
    s_waitcnt vmcnt(14)
    v_max3_u32 v16, v16, v85, v87
    s_waitcnt vmcnt(13)
    v_max3_u32 v16, v16, v89, v91
    s_waitcnt vmcnt(12)
    v_max3_u32 v16, v16, v93, v95
    v_cmp_eq_u32 vcc, -1, v16
    s_cbranch_vccnz Lef_wait3
Lef_got3:
    s_waitcnt lgkmcnt(10)
    v_mfma_f32_32x32x16_bf16 v[144:159], v[176:179], v[80:83], v[144:159]
    ds_read_b64_tr_b16 v[200:201], v10 offset:30720
    ds_read_b64_tr_b16 v[202:203], v10 offset:30976
    s_waitcnt lgkmcnt(10)
    v_mfma_f32_32x32x16_bf16 v[160:175], v[180:183], v[80:83], v[160:175]
    ds_read_b64_tr_b16 v[204:205], v11 offset:30720
    ds_read_b64_tr_b16 v[206:207], v11 offset:30976
    s_waitcnt lgkmcnt(10)
    v_mfma_f32_32x32x16_bf16 v[144:159], v[184:187], v[84:87], v[144:159]
    ds_read_b64_tr_b16 v[176:177], v10 offset:32768
    ds_read_b64_tr_b16 v[178:179], v10 offset:33024
    s_waitcnt lgkmcnt(10)
    v_mfma_f32_32x32x16_bf16 v[160:175], v[188:191], v[84:87], v[160:175]
    ds_read_b64_tr_b16 v[180:181], v11 offset:32768
    ds_read_b64_tr_b16 v[182:183], v11 offset:33024
    s_waitcnt lgkmcnt(10)
    v_mfma_f32_32x32x16_bf16 v[144:159], v[192:195], v[88:91], v[144:159]
    ds_read_b64_tr_b16 v[184:185], v10 offset:34816
    ds_read_b64_tr_b16 v[186:187], v10 offset:35072
    s_waitcnt lgkmcnt(10)
    v_mfma_f32_32x32x16_bf16 v[160:175], v[196:199], v[88:91], v[160:175]
    ds_read_b64_tr_b16 v[188:189], v11 offset:34816
    ds_read_b64_tr_b16 v[190:191], v11 offset:35072
    s_waitcnt lgkmcnt(10)
    v_mfma_f32_32x32x16_bf16 v[144:159], v[200:203], v[92:95], v[144:159]
    ds_read_b64_tr_b16 v[192:193], v10 offset:36864
    ds_read_b64_tr_b16 v[194:195], v10 offset:37120
    s_waitcnt lgkmcnt(10)
    v_mfma_f32_32x32x16_bf16 v[160:175], v[204:207], v[92:95], v[160:175]
    ds_read_b64_tr_b16 v[196:197], v11 offset:36864
    ds_read_b64_tr_b16 v[198:199], v11 offset:37120
    s_waitcnt vmcnt(11)
    v_max_u32 v16, v97, v99
    s_waitcnt vmcnt(10)
    v_max3_u32 v16, v16, v101, v103
    s_waitcnt vmcnt(9)
    v_max3_u32 v16, v16, v105, v107
    s_waitcnt vmcnt(8)
    v_max3_u32 v16, v16, v109, v111
    v_cmp_eq_u32 vcc, -1, v16
    s_cbranch_vccnz Lef_wait4
Lef_got4:
    s_waitcnt lgkmcnt(10)
    v_mfma_f32_32x32x16_bf16 v[144:159], v[176:179], v[96:99], v[144:159]
    ds_read_b64_tr_b16 v[200:201], v10 offset:38912
    ds_read_b64_tr_b16 v[202:203], v10 offset:39168
    s_waitcnt lgkmcnt(10)
    v_mfma_f32_32x32x16_bf16 v[160:175], v[180:183], v[96:99], v[160:175]
    ds_read_b64_tr_b16 v[204:205], v11 offset:38912
    ds_read_b64_tr_b16 v[206:207], v11 offset:39168
    s_waitcnt lgkmcnt(10)
    v_mfma_f32_32x32x16_bf16 v[144:159], v[184:187], v[100:103], v[144:159]
    ds_read_b64_tr_b16 v[176:177], v10 offset:40960
    ds_read_b64_tr_b16 v[178:179], v10 offset:41216
    s_waitcnt lgkmcnt(10)
    v_mfma_f32_32x32x16_bf16 v[160:175], v[188:191], v[100:103], v[160:175]
    ds_read_b64_tr_b16 v[180:181], v11 offset:40960
    ds_read_b64_tr_b16 v[182:183], v11 offset:41216
    s_waitcnt lgkmcnt(10)
    v_mfma_f32_32x32x16_bf16 v[144:159], v[192:195], v[104:107], v[144:159]
    ds_read_b64_tr_b16 v[184:185], v10 offset:43008
    ds_read_b64_tr_b16 v[186:187], v10 offset:43264
    s_waitcnt lgkmcnt(10)
    v_mfma_f32_32x32x16_bf16 v[160:175], v[196:199], v[104:107], v[160:175]
    ds_read_b64_tr_b16 v[188:189], v11 offset:43008
    ds_read_b64_tr_b16 v[190:191], v11 offset:43264
    s_waitcnt lgkmcnt(10)
    v_mfma_f32_32x32x16_bf16 v[144:159], v[200:203], v[108:111], v[144:159]
    ds_read_b64_tr_b16 v[192:193], v10 offset:45056
    ds_read_b64_tr_b16 v[194:195], v10 offset:45312
    s_waitcnt lgkmcnt(10)
    v_mfma_f32_32x32x16_bf16 v[160:175], v[204:207], v[108:111], v[160:175]
    ds_read_b64_tr_b16 v[196:197], v11 offset:45056
    ds_read_b64_tr_b16 v[198:199], v11 offset:45312
    s_waitcnt vmcnt(7)
    v_max_u32 v16, v113, v115
    s_waitcnt vmcnt(6)
    v_max3_u32 v16, v16, v117, v119
    s_waitcnt vmcnt(5)
    v_max3_u32 v16, v16, v121, v123
    s_waitcnt vmcnt(4)
    v_max3_u32 v16, v16, v125, v127
    v_cmp_eq_u32 vcc, -1, v16
    s_cbranch_vccnz Lef_wait5
Lef_got5:
    s_waitcnt lgkmcnt(10)
    v_mfma_f32_32x32x16_bf16 v[144:159], v[176:179], v[112:115], v[144:159]
    ds_read_b64_tr_b16 v[200:201], v10 offset:47104
    ds_read_b64_tr_b16 v[202:203], v10 offset:47360
    s_waitcnt lgkmcnt(10)
    v_mfma_f32_32x32x16_bf16 v[160:175], v[180:183], v[112:115], v[160:175]
    ds_read_b64_tr_b16 v[204:205], v11 offset:47104
    ds_read_b64_tr_b16 v[206:207], v11 offset:47360
    s_waitcnt lgkmcnt(10)
    v_mfma_f32_32x32x16_bf16 v[144:159], v[184:187], v[116:119], v[144:159]
    ds_read_b64_tr_b16 v[176:177], v10 offset:49152
    ds_read_b64_tr_b16 v[178:179], v10 offset:49408
    s_waitcnt lgkmcnt(10)
    v_mfma_f32_32x32x16_bf16 v[160:175], v[188:191], v[116:119], v[160:175]
    ds_read_b64_tr_b16 v[180:181], v11 offset:49152
    ds_read_b64_tr_b16 v[182:183], v11 offset:49408
    s_waitcnt lgkmcnt(10)
    v_mfma_f32_32x32x16_bf16 v[144:159], v[192:195], v[120:123], v[144:159]
    ds_read_b64_tr_b16 v[184:185], v10 offset:51200
    ds_read_b64_tr_b16 v[186:187], v10 offset:51456
    s_waitcnt lgkmcnt(10)
    v_mfma_f32_32x32x16_bf16 v[160:175], v[196:199], v[120:123], v[160:175]
    ds_read_b64_tr_b16 v[188:189], v11 offset:51200
    ds_read_b64_tr_b16 v[190:191], v11 offset:51456
    s_waitcnt lgkmcnt(10)
    v_mfma_f32_32x32x16_bf16 v[144:159], v[200:203], v[124:127], v[144:159]
    ds_read_b64_tr_b16 v[192:193], v10 offset:53248
    ds_read_b64_tr_b16 v[194:195], v10 offset:53504
    s_waitcnt lgkmcnt(10)
    v_mfma_f32_32x32x16_bf16 v[160:175], v[204:207], v[124:127], v[160:175]
    ds_read_b64_tr_b16 v[196:197], v11 offset:53248
    ds_read_b64_tr_b16 v[198:199], v11 offset:53504
    s_waitcnt vmcnt(3)
    v_max_u32 v16, v129, v131
    s_waitcnt vmcnt(2)
    v_max3_u32 v16, v16, v133, v135
    s_waitcnt vmcnt(1)
    v_max3_u32 v16, v16, v137, v139
    s_waitcnt vmcnt(0)
    v_max3_u32 v16, v16, v141, v143
    v_cmp_eq_u32 vcc, -1, v16
    s_cbranch_vccnz Lef_wait6
Lef_got6:
    s_waitcnt lgkmcnt(10)
    v_mfma_f32_32x32x16_bf16 v[144:159], v[176:179], v[128:131], v[144:159]
    ds_read_b64_tr_b16 v[200:201], v10 offset:55296
    ds_read_b64_tr_b16 v[202:203], v10 offset:55552
    s_waitcnt lgkmcnt(10)
    v_mfma_f32_32x32x16_bf16 v[160:175], v[180:183], v[128:131], v[160:175]
    ds_read_b64_tr_b16 v[204:205], v11 offset:55296
    ds_read_b64_tr_b16 v[206:207], v11 offset:55552
    s_waitcnt lgkmcnt(10)
    v_mfma_f32_32x32x16_bf16 v[144:159], v[184:187], v[132:135], v[144:159]
    s_waitcnt lgkmcnt(8)
    v_mfma_f32_32x32x16_bf16 v[160:175], v[188:191], v[132:135], v[160:175]
    s_waitcnt lgkmcnt(6)
    v_mfma_f32_32x32x16_bf16 v[144:159], v[192:195], v[136:139], v[144:159]
    s_waitcnt lgkmcnt(4)
    v_mfma_f32_32x32x16_bf16 v[160:175], v[196:199], v[136:139], v[160:175]
    s_waitcnt lgkmcnt(2)
    v_mfma_f32_32x32x16_bf16 v[144:159], v[200:203], v[140:143], v[144:159]
    s_waitcnt lgkmcnt(0)
    v_mfma_f32_32x32x16_bf16 v[160:175], v[204:207], v[140:143], v[160:175]
    s_lshl_b32 s30, s3, 12
    s_add_u32 s30, s30, 32768
    v_add_u32 v12, s30, v15
    v_xor_b32 v13, 8192, v12
    v_and_b32 v9, 31, v2
    s_movk_i32 s29, 896
    v_mul_lo_u32 v9, v9, s29
    v_lshl_add_u32 v9, v3, 4, v9
    s_mul_i32 s30, s24, 28672
    s_lshl_b32 s31, s32, 6
    s_add_u32 s30, s30, s31
    s_nop 0
    ds_write_b128 v12, v[160:163] offset:0
    ds_write_b128 v12, v[164:167] offset:1024
    ds_write_b128 v12, v[168:171] offset:2048
    ds_write_b128 v12, v[172:175] offset:3072
    s_waitcnt lgkmcnt(0)
    s_barrier
    ds_read_b128 v[64:67], v13 offset:0
    ds_read_b128 v[68:71], v13 offset:1024
    ds_read_b128 v[72:75], v13 offset:2048
    ds_read_b128 v[76:79], v13 offset:3072
    v_lshlrev_b32 v80, 16, v208
    v_and_b32 v81, 0xffff0000, v208
    v_lshlrev_b32 v82, 16, v209
    v_and_b32 v83, 0xffff0000, v209
    v_lshlrev_b32 v84, 16, v210
    v_and_b32 v85, 0xffff0000, v210
    v_lshlrev_b32 v86, 16, v211
    v_and_b32 v87, 0xffff0000, v211
    s_waitcnt lgkmcnt(3)
    v_add_f32 v144, v144, v64
    v_add_f32 v145, v145, v65
    v_add_f32 v146, v146, v66
    v_add_f32 v147, v147, v67
    s_waitcnt lgkmcnt(2)
    v_add_f32 v148, v148, v68
    v_add_f32 v149, v149, v69
    v_add_f32 v150, v150, v70
    v_add_f32 v151, v151, v71
    v_fmac_f32 v80, v144, v216
    v_fmac_f32 v81, v145, v217
    v_fmac_f32 v82, v146, v218
    v_fmac_f32 v83, v147, v219
    v_fmac_f32 v84, v148, v220
    v_fmac_f32 v85, v149, v221
    v_fmac_f32 v86, v150, v222
    v_fmac_f32 v87, v151, v223
    v_cvt_pk_bf16_f32 v88, v80, v81
    v_cvt_pk_bf16_f32 v89, v82, v83
    v_cvt_pk_bf16_f32 v90, v84, v85
    v_cvt_pk_bf16_f32 v91, v86, v87
    buffer_store_dwordx4 v[88:91], v9, s[44:47], s30 offen offset:0
    v_lshlrev_b32 v80, 16, v212
    v_and_b32 v81, 0xffff0000, v212
    v_lshlrev_b32 v82, 16, v213
    v_and_b32 v83, 0xffff0000, v213
    v_lshlrev_b32 v84, 16, v214
    v_and_b32 v85, 0xffff0000, v214
    v_lshlrev_b32 v86, 16, v215
    v_and_b32 v87, 0xffff0000, v215
    s_waitcnt lgkmcnt(1)
    v_add_f32 v152, v152, v72
    v_add_f32 v153, v153, v73
    v_add_f32 v154, v154, v74
    v_add_f32 v155, v155, v75
    s_waitcnt lgkmcnt(0)
    v_add_f32 v156, v156, v76
    v_add_f32 v157, v157, v77
    v_add_f32 v158, v158, v78
    v_add_f32 v159, v159, v79
    v_fmac_f32 v80, v152, v224
    v_fmac_f32 v81, v153, v225
    v_fmac_f32 v82, v154, v226
    v_fmac_f32 v83, v155, v227
    v_fmac_f32 v84, v156, v228
    v_fmac_f32 v85, v157, v229
    v_fmac_f32 v86, v158, v230
    v_fmac_f32 v87, v159, v231
    v_cvt_pk_bf16_f32 v92, v80, v81
    v_cvt_pk_bf16_f32 v93, v82, v83
    v_cvt_pk_bf16_f32 v94, v84, v85
    v_cvt_pk_bf16_f32 v95, v86, v87
    buffer_store_dwordx4 v[92:95], v9, s[44:47], s30 offen offset:32
Lef_done:
    s_endpgm
Lef_wait0:
    s_cmp_eq_u32 s38, 0
    s_cbranch_scc1 Lef_got0
    s_sub_u32 s38, s38, 1
    s_movk_i32 s31, 0
    buffer_load_dwordx4 v[32:35], v15, s[12:15], s31 offen offset:0 sc1
    s_movk_i32 s31, 0
    buffer_load_dwordx4 v[36:39], v15, s[12:15], s31 offen offset:1024 sc1
    s_movk_i32 s31, 0
    buffer_load_dwordx4 v[40:43], v15, s[12:15], s31 offen offset:2048 sc1
    s_movk_i32 s31, 0
    buffer_load_dwordx4 v[44:47], v15, s[12:15], s31 offen offset:3072 sc1
    s_waitcnt vmcnt(0)
    v_max_u32 v16, v33, v35
    v_max3_u32 v16, v16, v37, v39
    v_max3_u32 v16, v16, v41, v43
    v_max3_u32 v16, v16, v45, v47
    v_cmp_eq_u32 vcc, -1, v16
    s_cbranch_vccnz Lef_wait0
    s_branch Lef_got0
Lef_wait1:
    s_cmp_eq_u32 s38, 0
    s_cbranch_scc1 Lef_got1
    s_sub_u32 s38, s38, 1
    s_movk_i32 s31, 4096
    buffer_load_dwordx4 v[48:51], v15, s[12:15], s31 offen offset:0 sc1
    s_movk_i32 s31, 4096
    buffer_load_dwordx4 v[52:55], v15, s[12:15], s31 offen offset:1024 sc1
    s_movk_i32 s31, 4096
    buffer_load_dwordx4 v[56:59], v15, s[12:15], s31 offen offset:2048 sc1
    s_movk_i32 s31, 4096
    buffer_load_dwordx4 v[60:63], v15, s[12:15], s31 offen offset:3072 sc1
    s_waitcnt vmcnt(0)
    v_max_u32 v16, v49, v51
    v_max3_u32 v16, v16, v53, v55
    v_max3_u32 v16, v16, v57, v59
    v_max3_u32 v16, v16, v61, v63
    v_cmp_eq_u32 vcc, -1, v16
    s_cbranch_vccnz Lef_wait1
    s_branch Lef_got1
Lef_wait2:
    s_cmp_eq_u32 s38, 0
    s_cbranch_scc1 Lef_got2
    s_sub_u32 s38, s38, 1
    s_movk_i32 s31, 8192
    buffer_load_dwordx4 v[64:67], v15, s[12:15], s31 offen offset:0 sc1
    s_movk_i32 s31, 8192
    buffer_load_dwordx4 v[68:71], v15, s[12:15], s31 offen offset:1024 sc1
    s_movk_i32 s31, 8192
    buffer_load_dwordx4 v[72:75], v15, s[12:15], s31 offen offset:2048 sc1
    s_movk_i32 s31, 8192
    buffer_load_dwordx4 v[76:79], v15, s[12:15], s31 offen offset:3072 sc1
    s_waitcnt vmcnt(0)
    v_max_u32 v16, v65, v67
    v_max3_u32 v16, v16, v69, v71
    v_max3_u32 v16, v16, v73, v75
    v_max3_u32 v16, v16, v77, v79
    v_cmp_eq_u32 vcc, -1, v16
    s_cbranch_vccnz Lef_wait2
    s_branch Lef_got2
Lef_wait3:
    s_cmp_eq_u32 s38, 0
    s_cbranch_scc1 Lef_got3
    s_sub_u32 s38, s38, 1
    s_movk_i32 s31, 12288
    buffer_load_dwordx4 v[80:83], v15, s[12:15], s31 offen offset:0 sc1
    s_movk_i32 s31, 12288
    buffer_load_dwordx4 v[84:87], v15, s[12:15], s31 offen offset:1024 sc1
    s_movk_i32 s31, 12288
    buffer_load_dwordx4 v[88:91], v15, s[12:15], s31 offen offset:2048 sc1
    s_movk_i32 s31, 12288
    buffer_load_dwordx4 v[92:95], v15, s[12:15], s31 offen offset:3072 sc1
    s_waitcnt vmcnt(0)
    v_max_u32 v16, v81, v83
    v_max3_u32 v16, v16, v85, v87
    v_max3_u32 v16, v16, v89, v91
    v_max3_u32 v16, v16, v93, v95
    v_cmp_eq_u32 vcc, -1, v16
    s_cbranch_vccnz Lef_wait3
    s_branch Lef_got3
Lef_wait4:
    s_cmp_eq_u32 s38, 0
    s_cbranch_scc1 Lef_got4
    s_sub_u32 s38, s38, 1
    s_movk_i32 s31, 16384
    buffer_load_dwordx4 v[96:99], v15, s[12:15], s31 offen offset:0 sc1
    s_movk_i32 s31, 16384
    buffer_load_dwordx4 v[100:103], v15, s[12:15], s31 offen offset:1024 sc1
    s_movk_i32 s31, 16384
    buffer_load_dwordx4 v[104:107], v15, s[12:15], s31 offen offset:2048 sc1
    s_movk_i32 s31, 16384
    buffer_load_dwordx4 v[108:111], v15, s[12:15], s31 offen offset:3072 sc1
    s_waitcnt vmcnt(0)
    v_max_u32 v16, v97, v99
    v_max3_u32 v16, v16, v101, v103
    v_max3_u32 v16, v16, v105, v107
    v_max3_u32 v16, v16, v109, v111
    v_cmp_eq_u32 vcc, -1, v16
    s_cbranch_vccnz Lef_wait4
    s_branch Lef_got4
Lef_wait5:
    s_cmp_eq_u32 s38, 0
    s_cbranch_scc1 Lef_got5
    s_sub_u32 s38, s38, 1
    s_movk_i32 s31, 20480
    buffer_load_dwordx4 v[112:115], v15, s[12:15], s31 offen offset:0 sc1
    s_movk_i32 s31, 20480
    buffer_load_dwordx4 v[116:119], v15, s[12:15], s31 offen offset:1024 sc1
    s_movk_i32 s31, 20480
    buffer_load_dwordx4 v[120:123], v15, s[12:15], s31 offen offset:2048 sc1
    s_movk_i32 s31, 20480
    buffer_load_dwordx4 v[124:127], v15, s[12:15], s31 offen offset:3072 sc1
    s_waitcnt vmcnt(0)
    v_max_u32 v16, v113, v115
    v_max3_u32 v16, v16, v117, v119
    v_max3_u32 v16, v16, v121, v123
    v_max3_u32 v16, v16, v125, v127
    v_cmp_eq_u32 vcc, -1, v16
    s_cbranch_vccnz Lef_wait5
    s_branch Lef_got5
Lef_wait6:
    s_cmp_eq_u32 s38, 0
    s_cbranch_scc1 Lef_got6
    s_sub_u32 s38, s38, 1
    s_movk_i32 s31, 24576
    buffer_load_dwordx4 v[128:131], v15, s[12:15], s31 offen offset:0 sc1
    s_movk_i32 s31, 24576
    buffer_load_dwordx4 v[132:135], v15, s[12:15], s31 offen offset:1024 sc1
    s_movk_i32 s31, 24576
    buffer_load_dwordx4 v[136:139], v15, s[12:15], s31 offen offset:2048 sc1
    s_movk_i32 s31, 24576
    buffer_load_dwordx4 v[140:143], v15, s[12:15], s31 offen offset:3072 sc1
    s_waitcnt vmcnt(0)
    v_max_u32 v16, v129, v131
    v_max3_u32 v16, v16, v133, v135
    v_max3_u32 v16, v16, v137, v139
    v_max3_u32 v16, v16, v141, v143
    v_cmp_eq_u32 vcc, -1, v16
    s_cbranch_vccnz Lef_wait6
    s_branch Lef_got6

Ltext_end:
.section .rodata,"a"
.p2align 6
.amdhsa_kernel att_kernel
  .amdhsa_next_free_vgpr 512
  .amdhsa_next_free_sgpr 102
  .amdhsa_accum_offset 256
  .amdhsa_group_segment_fixed_size 0
  .amdhsa_kernarg_size 120
  .amdhsa_user_sgpr_count 2
  .amdhsa_user_sgpr_kernarg_segment_ptr 1
  .amdhsa_system_sgpr_workgroup_id_x 1
.end_amdhsa_kernel

.section .rodata,"a"
.p2align 6
.amdhsa_kernel cd_kernel
  .amdhsa_next_free_vgpr 256
  .amdhsa_next_free_sgpr 46
  .amdhsa_accum_offset 256
  .amdhsa_group_segment_fixed_size 0
  .amdhsa_kernarg_size 120
  .amdhsa_user_sgpr_count 2
  .amdhsa_user_sgpr_kernarg_segment_ptr 1
  .amdhsa_system_sgpr_workgroup_id_x 1
.end_amdhsa_kernel

.section .rodata,"a"
.p2align 6
.amdhsa_kernel ef_kernel
  .amdhsa_next_free_vgpr 232
  .amdhsa_next_free_sgpr 56
  .amdhsa_accum_offset 232
  .amdhsa_group_segment_fixed_size 0
  .amdhsa_kernarg_size 120
  .amdhsa_user_sgpr_count 2
  .amdhsa_user_sgpr_kernarg_segment_ptr 1
  .amdhsa_system_sgpr_workgroup_id_x 1
.end_amdhsa_kernel
```
